```python
import torch

def _softmax(x, axis=-1):
    return torch.softmax(x, dim=axis)
def _gelu(x):
    return torch.nn.functional.gelu(x, approximate="tanh")
def _silu(x):
    return torch.nn.functional.silu(x)
def _sigmoid(x):
    return torch.sigmoid(x)
def _layernorm(x, axis=-1, eps=1e-5):
    m = x.mean(dim=axis, keepdim=True)
    v = x.var(dim=axis, keepdim=True, unbiased=False)
    return (x - m) / torch.sqrt(v + eps)
def _scatter_add(tgt, idx, src, axis=0):
    return tgt.clone().index_add_(axis, idx, src)
def _segment_sum(src, seg, n):
    out = torch.zeros((n,) + src.shape[1:], dtype=src.dtype)
    return out.index_add_(0, seg, src)
def _pad(x, pw):
    flat = tuple(v for pair in reversed(pw) for v in pair)
    return torch.nn.functional.pad(x, flat)

kernel_name = 'recurrent_scan__sliding_local_dilated__glu_gated_glu__prompt'

def setup_inputs():

    _w = (lambda a: (lambda t: t.to(torch.bfloat16) if t.is_floating_point() else t)(torch.as_tensor(a)))
    def _A_setup():
        B, S, D = 1, 2048, 576
        return {
            "x": _w((lambda *s: torch.randn(*s, dtype=torch.bfloat16) * 0.05)(B, S, D)),
            "wqkv": _w((lambda *s: torch.randn(*s, dtype=torch.bfloat16) * 0.05)(D, 3 * D)),
            "wo": _w((lambda *s: torch.randn(*s, dtype=torch.bfloat16) * 0.05)(D, D)),
        }
    _A_in = _A_setup()

    def _B_setup():
        B, S, D, F = 1, 2048, 576, 4608
        return {
            "x": _w((lambda *s: torch.randn(*s, dtype=torch.bfloat16) * 0.05)(B, S, D)),
            "w_gate": _w((lambda *s: torch.randn(*s, dtype=torch.bfloat16) * 0.05)(D, F)),
            "w_up": _w((lambda *s: torch.randn(*s, dtype=torch.bfloat16) * 0.05)(D, F)),
            "w_down": _w((lambda *s: torch.randn(*s, dtype=torch.bfloat16) * 0.05)(F, D)),
        }
    _B_in = _B_setup()

    return {
        "A_x": _A_in["x"],
        "A_wqkv": _A_in["wqkv"],
        "A_wo": _A_in["wo"],
        "B_x": _B_in["x"],
        "B_w_gate": _B_in["w_gate"],
        "B_w_up": _B_in["w_up"],
        "B_w_down": _B_in["w_down"],
    }

def reference(A_x, A_wqkv, A_wo, B_x, B_w_gate, B_w_up, B_w_down):
    def _A_ref(x, wqkv, wo):
        B, S, D = x.shape
        H = 32; Dh = D // H
        W, dil = 8, 2
        qkv = (lambda x, *d: x.permute(*d))((x @ wqkv).reshape(B, S, 3, H, Dh), 2, 0, 3, 1, 4)
        q, k, v = qkv[0], qkv[1], qkv[2]
        scale = Dh ** -0.5
        pos = torch.arange(S)
        off = torch.arange(W) * dil
        idx = pos[:, None] - off[None, :]
        mask = idx >= 0
        idx_c = torch.where(mask, idx, 0).reshape(-1)
        kg = k[:, :, idx_c, :].reshape(B, H, S, W, Dh)
        vg = v[:, :, idx_c, :].reshape(B, H, S, W, Dh)
        logits = torch.einsum("bhsd,bhswd->bhsw", q, kg) * scale
        logits = torch.where(mask[None, None, :, :], logits, -1e9)
        attn = _softmax(logits, axis=-1)
        o = torch.einsum("bhsw,bhswd->bhsd", attn, vg)
        return (lambda x, *d: x.permute(*d))(o, 0, 2, 1, 3).reshape(B, S, D) @ wo

    def _B_ref(x, w_gate, w_up, w_down):
        g = torch.einsum("bsd,df->bsf", x, w_gate)
        u = torch.einsum("bsd,df->bsf", x, w_up)
        h = _sigmoid(g) * u
        return torch.einsum("bsf,fd->bsd", h, w_down)

    x = A_x
    xn = _layernorm(x, axis=-1)
    s = _A_ref(xn, A_wqkv, A_wo)
    g = _silu(_B_ref(xn, B_w_gate, B_w_up, B_w_down))
    return x + s * g
```

```asm
; @launch grid=(256,1,1) block=(256,1,1) lds=163840
.amdgcn_target "amdgcn-amd-amdhsa--gfx950"

.text
.globl recurrent_scan__sliding_local_dilated__glu_gated_glu__prompt_kernel
.p2align 8
.type recurrent_scan__sliding_local_dilated__glu_gated_glu__prompt_kernel,@function
recurrent_scan__sliding_local_dilated__glu_gated_glu__prompt_kernel:
s_mov_b32 s48, 99
s_cmp_ge_u32 s2, 256
s_cbranch_scc1 K_end
s_load_dwordx4 s[4:7], s[0:1], 0
s_load_dwordx4 s[8:11], s[0:1], 32
s_load_dwordx2 s[28:29], s[0:1], 72
s_load_dwordx2 s[68:69], s[0:1], 16
s_load_dwordx2 s[24:25], s[0:1], 48
s_load_dwordx2 s[46:47], s[0:1], 56
s_load_dwordx2 s[62:63], s[0:1], 64
v_lshrrev_b32 v192, 6, v0
v_and_b32 v193, 63, v0
v_readfirstlane_b32 s48, v192
v_lshlrev_b32 v237, 4, v193
v_lshrrev_b32 v199, 3, v193
v_and_b32 v200, 7, v193
s_and_b32 s64, s2, 7
s_lshr_b32 s65, s2, 3
s_cmp_lg_u32 s48, 3
s_cbranch_scc1 K_ln
s_getpc_b64 s[50:51]
K_pcl:
s_sub_u32 s50, s50, K_pcl-recurrent_scan__sliding_local_dilated__glu_gated_glu__prompt_kernel
s_subb_u32 s51, s51, 0
s_bitcmp1_b32 s2, 0
s_mov_b32 s52, K_main_0-recurrent_scan__sliding_local_dilated__glu_gated_glu__prompt_kernel
s_cselect_b32 s52, K_main_1-recurrent_scan__sliding_local_dilated__glu_gated_glu__prompt_kernel, s52
v_and_b32 v24, 15, v193
v_lshl_add_u32 v24, v24, 5, s65
v_lshlrev_b32 v24, 7, v24
v_cmp_gt_u32 vcc, 16, v193
v_add_u32 v25, s52, v24
v_mov_b32 v23, s51
v_cndmask_b32 v24, v24, v25, vcc
v_min_u32 v24, K_end-recurrent_scan__sliding_local_dilated__glu_gated_glu__prompt_kernel, v24
v_add_co_u32 v22, vcc, s50, v24
s_mov_b64 exec, 0x3ffff
s_nop 0
v_addc_co_u32 v23, vcc, 0, v23, vcc
global_load_dword v27, v[22:23], off
s_mov_b64 exec, -1
v_mul_u32_u24 v20, 57, v193
v_lshrrev_b32 v20, 9, v20
v_mul_u32_u24 v21, 9, v20
v_sub_u32 v21, v193, v21
v_and_b32 v24, 1, v20
v_lshrrev_b32 v20, 1, v20
s_mul_i32 s50, s65, 3
v_add_u32 v20, s50, v20
v_mul_u32_u24 v20, 9216, v20
v_lshl_add_u32 v20, v21, 7, v20
s_mul_i32 s50, s64, 1152
s_add_u32 s50, s50, 0
v_add_u32 v20, s50, v20
v_cmp_eq_u32 vcc, 1, v24
s_waitcnt lgkmcnt(0)
v_mov_b32 v56, s8
v_mov_b32 v57, s9
v_mov_b32 v25, s10
v_mov_b32 v26, s11
v_cndmask_b32 v56, v56, v25, vcc
v_cndmask_b32 v57, v57, v26, vcc
v_add_co_u32 v56, vcc, v56, v20
s_mov_b32 s30, 46379008
s_mov_b32 s31, 0x20000
v_addc_co_u32 v57, vcc, 0, v57, vcc
v_and_b32 v58, 32, v193
v_lshlrev_b32 v58, 2, v58
global_load_dword v27, v58, s[62:63]
s_mov_b32 exec_hi, 4194303
global_load_dword v27, v[56:57], off
v_add_co_u32 v56, vcc, 884736, v56
s_nop 1
v_addc_co_u32 v57, vcc, 0, v57, vcc
global_load_dword v27, v[56:57], off
v_add_co_u32 v56, vcc, 884736, v56
s_nop 1
v_addc_co_u32 v57, vcc, 0, v57, vcc
global_load_dword v27, v[56:57], off
v_add_co_u32 v56, vcc, 884736, v56
s_nop 1
v_addc_co_u32 v57, vcc, 0, v57, vcc
global_load_dword v27, v[56:57], off
v_add_co_u32 v56, vcc, 884736, v56
s_nop 1
v_addc_co_u32 v57, vcc, 0, v57, vcc
s_mov_b32 exec_hi, -1
s_branch K_s1
K_ln:
s_lshl_b32 s50, s2, 3
v_add_u32 v4, s50, v200
v_mul_u32_u24 v4, 1152, v4
v_lshl_add_u32 v5, v199, 4, v4
s_lshl_b32 s50, s48, 7
s_lshl_b32 s51, s2, 3
v_add_u32 v5, s51, v199
v_mul_u32_u24 v5, 1152, v5
v_xor_b32 v7, v200, v199
v_lshl_add_u32 v5, v7, 4, v5
s_mul_i32 s52, s48, 3072
s_add_u32 s52, s52, 148480
v_lshlrev_b32 v7, 4, v7
v_lshl_add_u32 v7, v200, 7, v7
v_add_u32 v7, s52, v7
v_mov_b32 v52, 0
v_mov_b32 v53, 0
v_mov_b32 v54, 0
v_mov_b32 v55, 0
v_lshlrev_b32 v22, 4, v200
s_lshl_b32 s51, s2, 10
s_add_u32 s51, s51, 46116864
s_cmp_eq_u32 s48, 2
s_cselect_b32 s51, s51, 46379008
s_waitcnt lgkmcnt(0)
s_mov_b32 s20, s4
s_mov_b32 s21, s5
s_mov_b32 s22, 2359296
s_mov_b32 s23, 0x20000
buffer_load_ushort v6, v4, s[20:23], 0 offen
s_add_u32 m0, s52, 0
s_nop 0
buffer_load_dwordx4 v5, s[20:23], s50 offen offset:0 lds
s_add_u32 m0, s52, 640
s_nop 0
buffer_load_dwordx4 v5, s[20:23], s50 offen offset:384 lds
s_add_u32 m0, s52, 1280
s_nop 0
buffer_load_dwordx4 v5, s[20:23], s50 offen offset:768 lds
s_mov_b32 s30, 46379008
s_mov_b32 s31, 0x20000
buffer_store_dwordx4 v[52:55], v237, s[28:31], s51 offen sc1
v_mov_b32 v56, s8
v_mov_b32 v57, s9
K_s1:
s_lshr_b32 s78, s65, 3
s_and_b32 s77, s65, 7
v_and_b32 v201, 2, v199
s_and_b32 s50, s48, 1
s_lshl_b32 s50, s50, 2
v_or_b32 v201, s50, v201
v_xor_b32 v202, v200, v201
v_lshlrev_b32 v202, 4, v202
s_lshl_b32 s50, s48, 3
v_add_u32 v203, s50, v199
v_mul_u32_u24 v234, 9216, v203
v_add_u32 v234, v234, v202
s_mul_i32 s79, s64, 9
s_add_u32 s79, s79, s78
s_lshl_b32 s51, s79, 7
s_sub_u32 s52, 5308416, s51
s_add_u32 s12, s8, s51
s_addc_u32 s13, s9, 0
s_mov_b32 s14, s52
s_mov_b32 s15, 0x20000
s_add_u32 s16, s10, s51
s_addc_u32 s17, s11, 0
s_mov_b32 s18, s52
s_mov_b32 s19, 0x20000
s_lshl_b32 s49, s48, 10
s_mov_b32 s44, s4
s_mov_b32 s45, s5
s_lshl_b32 s50, s77, 5
v_mov_b32 v49, s50
s_mov_b32 s23, 0x20000
s_lshl_b32 s55, s48, 8
s_add_u32 s55, s55, s2
v_mul_u32_u24 v40, 9216, v199
v_lshl_add_u32 v40, v200, 4, v40
v_and_b32 v20, 3, v199
v_lshrrev_b32 v21, 2, v199
v_lshl_add_u32 v20, v21, 3, v20
v_lshlrev_b32 v20, 5, v20
v_and_b32 v21, 1, v200
v_lshl_add_u32 v20, v21, 4, v20
v_lshrrev_b32 v21, 1, v200
v_mul_u32_u24 v21, 36864, v21
v_add_u32 v41, v20, v21
s_bitcmp1_b32 s2, 3
s_cselect_b32 s32, s10, s8
s_cselect_b32 s33, s11, s9
s_mov_b32 s34, 5308416
s_mov_b32 s35, 0x20000
s_lshr_b32 s52, s55, 4
s_mul_i32 s56, s52, 73728
s_mul_i32 s50, s64, 1152
s_add_u32 s56, s56, s50
s_add_u32 s56, s56, 512
s_mul_i32 s57, s64, 147456
s_lshr_b32 s50, s52, 2
s_lshl_b32 s50, s50, 11
s_add_u32 s57, s57, s50
s_and_b32 s50, s65, 1
s_lshl_b32 s50, s50, 10
s_add_u32 s57, s57, s50
s_and_b32 s50, s52, 1
s_lshl_b32 s50, s50, 7
s_add_u32 s57, s57, s50
s_and_b32 s50, s52, 2
s_lshl_b32 s50, s50, 8
s_add_u32 s57, s57, s50
s_add_u32 s57, s57, 44937216
s_mov_b32 s43, 0x20000
s_cmp_ge_u32 s55, 128
s_cbranch_scc1 K_wo
s_mov_b32 s40, s32
s_mov_b32 s41, s33
s_mov_b32 s42, 5308416
v_mov_b32 v42, v40
v_mov_b32 v43, v41
s_add_u32 s52, s52, 64
s_mul_i32 s58, s52, 73728
s_mul_i32 s50, s64, 1152
s_add_u32 s58, s58, s50
s_add_u32 s58, s58, 512
s_mul_i32 s59, s64, 147456
s_lshr_b32 s50, s52, 2
s_lshl_b32 s50, s50, 11
s_add_u32 s59, s59, s50
s_and_b32 s50, s65, 1
s_lshl_b32 s50, s50, 10
s_add_u32 s59, s59, s50
s_and_b32 s50, s52, 1
s_lshl_b32 s50, s50, 7
s_add_u32 s59, s59, s50
s_and_b32 s50, s52, 2
s_lshl_b32 s50, s50, 8
s_add_u32 s59, s59, s50
s_add_u32 s59, s59, 44937216
s_branch K_pc
K_wo:
s_sub_u32 s50, s55, 128
s_mul_i32 s51, s50, 911
s_lshr_b32 s51, s51, 16
s_mul_i32 s52, s51, 72
s_sub_u32 s52, s50, s52
s_lshr_b32 s66, s52, 3
s_and_b32 s52, s52, 7
s_cmp_lt_u32 s50, 648
s_cselect_b32 s42, 663552, 0
s_mov_b32 s40, s68
s_mov_b32 s41, s69
s_mul_i32 s59, s52, 81
s_add_u32 s59, s59, s66
s_add_u32 s59, s59, 72
s_mul_i32 s59, s59, 9216
s_add_u32 s59, s59, 21495808
s_mul_i32 s58, s52, 144
s_lshl_b32 s66, s66, 3
s_cmp_ge_u32 s51, 8
s_cbranch_scc1 K_n8
s_add_u32 s50, s66, s51
v_mov_b32 v22, s50
v_mov_b32 v21, v199
v_lshlrev_b32 v20, 4, v200
v_and_b32 v24, 3, v199
v_lshrrev_b32 v25, 2, v199
v_lshl_add_u32 v24, v25, 4, v24
s_and_b32 s50, s51, 3
s_lshl_b32 s50, s50, 2
v_add_u32 v24, s50, v24
v_and_b32 v25, 1, v200
v_lshlrev_b32 v25, 3, v25
v_xor_b32 v24, v24, v25
v_lshlrev_b32 v24, 4, v24
v_lshl_add_u32 v24, v200, 9, v24
s_lshr_b32 s50, s51, 2
s_mul_i32 s50, s50, 4608
v_add_u32 v43, s50, v24
s_branch K_nj
K_n8:
v_lshrrev_b32 v24, 5, v193
v_bfe_u32 v25, v193, 2, 2
v_lshl_add_u32 v22, v24, 2, v25
v_add_u32 v22, s66, v22
v_and_b32 v21, 3, v193
v_bfe_u32 v25, v193, 4, 1
v_lshl_add_u32 v21, v25, 2, v21
v_mov_b32 v20, 128
v_add_u32 v24, 1, v24
v_lshl_add_u32 v43, v24, 12, v237
K_nj:
v_lshrrev_b32 v25, 1, v22
v_mul_u32_u24 v25, 18, v25
v_and_b32 v26, 1, v22
v_lshl_add_u32 v25, v26, 3, v25
v_add_u32 v25, v25, v21
v_lshrrev_b32 v26, 1, v21
v_mul_u32_u24 v26, 18, v26
v_and_b32 v28, 1, v21
v_add3_u32 v26, v26, v28, 16
v_cmp_le_u32 vcc, 64, v22
v_and_b32 v23, 7, v22
v_mul_u32_u24 v23, 72, v23
v_add_u32 v26, v26, v23
v_cndmask_b32 v25, v25, v26, vcc
v_mul_u32_u24 v25, 1152, v25
v_add_u32 v42, v20, v25
K_pc:
v_add_u32 v248, s57, v41
v_add_u32 v249, s59, v43
s_cmp_lt_u32 s55, 776
s_cselect_b64 vcc, -1, 0
v_mov_b32 v20, 0x7fffff00
v_cndmask_b32 v249, v20, v249, vcc
s_cmp_eq_u32 s48, 3
s_cbranch_scc0 K_ln2
s_barrier
s_branch K_lnd
K_ln2:
v_lshlrev_b32 v22, 4, v200
v_lshrrev_b32 v20, 2, v199
v_and_b32 v21, 3, v199
v_lshl_add_u32 v45, v20, 12, v22
v_lshl_add_u32 v45, v21, 8, v45
s_mul_i32 s54, s65, 77824
s_bfe_u32 s50, s2, 0x20001
s_lshl_b32 s50, s50, 10
s_add_u32 s54, s54, s50
s_and_b32 s50, s2, 1
s_lshl_b32 s50, s50, 7
s_add_u32 s54, s54, s50
s_add_u32 s54, s54, 0
s_lshl_b32 s50, s48, 13
s_add_u32 s51, s54, s50
s_add_u32 s52, s51, 24576
s_add_u32 s66, s51, 49152
v_lshlrev_b32 v47, 5, v200
v_add_u32 v47, 147456, v47
v_lshl_add_u32 v48, s48, 3, v47
s_mov_b32 s50, 0xffff0000
s_waitcnt vmcnt(1)
ds_read_b128 v[8:11], v7 offset:0
ds_read_b128 v[12:15], v7 offset:1024
ds_read_b128 v[16:19], v7 offset:2048
s_waitcnt lgkmcnt(0)
v_lshlrev_b32 v6, 16, v6
v_lshlrev_b32 v60, 16, v8
v_and_b32 v61, s50, v8
v_lshlrev_b32 v62, 16, v9
v_and_b32 v63, s50, v9
v_lshlrev_b32 v64, 16, v10
v_and_b32 v65, s50, v10
v_lshlrev_b32 v66, 16, v11
v_and_b32 v67, s50, v11
v_lshlrev_b32 v68, 16, v12
v_and_b32 v69, s50, v12
v_lshlrev_b32 v70, 16, v13
v_and_b32 v71, s50, v13
v_lshlrev_b32 v72, 16, v14
v_and_b32 v73, s50, v14
v_lshlrev_b32 v74, 16, v15
v_and_b32 v75, s50, v15
v_lshlrev_b32 v76, 16, v16
v_and_b32 v77, s50, v16
v_lshlrev_b32 v78, 16, v17
v_and_b32 v79, s50, v17
v_lshlrev_b32 v80, 16, v18
v_and_b32 v81, s50, v18
v_lshlrev_b32 v82, 16, v19
v_and_b32 v83, s50, v19
v_pk_add_f32 v[84:85], v[60:61], v[6:7] op_sel_hi:[1,0] neg_lo:[0,1] neg_hi:[0,1]
v_pk_add_f32 v[86:87], v[62:63], v[6:7] op_sel_hi:[1,0] neg_lo:[0,1] neg_hi:[0,1]
v_pk_add_f32 v[88:89], v[64:65], v[6:7] op_sel_hi:[1,0] neg_lo:[0,1] neg_hi:[0,1]
v_pk_add_f32 v[90:91], v[66:67], v[6:7] op_sel_hi:[1,0] neg_lo:[0,1] neg_hi:[0,1]
v_pk_add_f32 v[92:93], v[68:69], v[6:7] op_sel_hi:[1,0] neg_lo:[0,1] neg_hi:[0,1]
v_pk_add_f32 v[94:95], v[70:71], v[6:7] op_sel_hi:[1,0] neg_lo:[0,1] neg_hi:[0,1]
v_pk_add_f32 v[96:97], v[72:73], v[6:7] op_sel_hi:[1,0] neg_lo:[0,1] neg_hi:[0,1]
v_pk_add_f32 v[98:99], v[74:75], v[6:7] op_sel_hi:[1,0] neg_lo:[0,1] neg_hi:[0,1]
v_pk_add_f32 v[100:101], v[76:77], v[6:7] op_sel_hi:[1,0] neg_lo:[0,1] neg_hi:[0,1]
v_pk_add_f32 v[102:103], v[78:79], v[6:7] op_sel_hi:[1,0] neg_lo:[0,1] neg_hi:[0,1]
v_pk_add_f32 v[104:105], v[80:81], v[6:7] op_sel_hi:[1,0] neg_lo:[0,1] neg_hi:[0,1]
v_pk_add_f32 v[106:107], v[82:83], v[6:7] op_sel_hi:[1,0] neg_lo:[0,1] neg_hi:[0,1]
v_pk_add_f32 v[28:29], v[84:85], v[86:87]
v_pk_mul_f32 v[30:31], v[84:85], v[84:85]
v_pk_fma_f32 v[30:31], v[86:87], v[86:87], v[30:31]
v_pk_add_f32 v[28:29], v[28:29], v[88:89]
v_pk_fma_f32 v[30:31], v[88:89], v[88:89], v[30:31]
v_pk_add_f32 v[28:29], v[28:29], v[90:91]
v_pk_fma_f32 v[30:31], v[90:91], v[90:91], v[30:31]
v_pk_add_f32 v[28:29], v[28:29], v[92:93]
v_pk_fma_f32 v[30:31], v[92:93], v[92:93], v[30:31]
v_pk_add_f32 v[28:29], v[28:29], v[94:95]
v_pk_fma_f32 v[30:31], v[94:95], v[94:95], v[30:31]
v_pk_add_f32 v[28:29], v[28:29], v[96:97]
v_pk_fma_f32 v[30:31], v[96:97], v[96:97], v[30:31]
v_pk_add_f32 v[28:29], v[28:29], v[98:99]
v_pk_fma_f32 v[30:31], v[98:99], v[98:99], v[30:31]
v_pk_add_f32 v[28:29], v[28:29], v[100:101]
v_pk_fma_f32 v[30:31], v[100:101], v[100:101], v[30:31]
v_pk_add_f32 v[28:29], v[28:29], v[102:103]
v_pk_fma_f32 v[30:31], v[102:103], v[102:103], v[30:31]
v_pk_add_f32 v[28:29], v[28:29], v[104:105]
v_pk_fma_f32 v[30:31], v[104:105], v[104:105], v[30:31]
v_pk_add_f32 v[28:29], v[28:29], v[106:107]
v_pk_fma_f32 v[30:31], v[106:107], v[106:107], v[30:31]
v_add_f32 v28, v28, v29
v_add_f32 v29, v30, v31
s_nop 1
v_add_f32_dpp v28, v28, v28 row_ror:8 row_mask:0xf bank_mask:0xf
v_add_f32_dpp v29, v29, v29 row_ror:8 row_mask:0xf bank_mask:0xf
v_mov_b32 v30, v28
v_mov_b32 v31, v29
s_nop 1
v_permlane16_swap_b32 v28, v30
v_permlane16_swap_b32 v29, v31
s_nop 1
v_add_f32 v28, v28, v30
v_add_f32 v29, v29, v31
v_mov_b32 v30, v28
v_mov_b32 v31, v29
s_nop 1
v_permlane32_swap_b32 v28, v30
v_permlane32_swap_b32 v29, v31
s_nop 1
v_add_f32 v28, v28, v30
v_add_f32 v29, v29, v31
ds_write_b64 v48, v[28:29]
s_waitcnt lgkmcnt(0)
s_barrier
ds_read_b128 v[28:31], v47
ds_read_b64 v[32:33], v47 offset:16
s_waitcnt lgkmcnt(0)
v_pk_add_f32 v[28:29], v[28:29], v[30:31]
v_pk_add_f32 v[28:29], v[28:29], v[32:33]
v_mul_f32 v28, 0x3ae38e39, v28
v_mul_f32 v29, 0x3ae38e39, v29
v_fma_f32 v29, -v28, v28, v29
v_max_f32 v29, 0, v29
v_add_f32 v28, v28, v6
v_cvt_pk_bf16_f32 v30, v28, v29
v_lshlrev_b32 v28, 16, v30
v_and_b32 v30, s50, v30
v_add_f32 v30, 0x3727c5ac, v30
v_cvt_pk_bf16_f32 v30, v30, v30
v_lshlrev_b32 v30, 16, v30
v_sqrt_f32 v30, v30
v_pk_add_f32 v[60:61], v[60:61], v[28:29] op_sel_hi:[1,0] neg_lo:[0,1] neg_hi:[0,1]
v_pk_add_f32 v[62:63], v[62:63], v[28:29] op_sel_hi:[1,0] neg_lo:[0,1] neg_hi:[0,1]
v_pk_add_f32 v[64:65], v[64:65], v[28:29] op_sel_hi:[1,0] neg_lo:[0,1] neg_hi:[0,1]
v_pk_add_f32 v[66:67], v[66:67], v[28:29] op_sel_hi:[1,0] neg_lo:[0,1] neg_hi:[0,1]
v_cvt_pk_bf16_f32 v30, v30, v30
v_lshlrev_b32 v30, 16, v30
v_rcp_f32 v30, v30
v_cvt_pk_bf16_f32 v8, v60, v61
v_cvt_pk_bf16_f32 v9, v62, v63
v_cvt_pk_bf16_f32 v10, v64, v65
v_cvt_pk_bf16_f32 v11, v66, v67
v_lshlrev_b32 v60, 16, v8
v_and_b32 v61, s50, v8
v_lshlrev_b32 v62, 16, v9
v_and_b32 v63, s50, v9
v_lshlrev_b32 v64, 16, v10
v_and_b32 v65, s50, v10
v_lshlrev_b32 v66, 16, v11
v_and_b32 v67, s50, v11
v_pk_mul_f32 v[60:61], v[60:61], v[30:31] op_sel_hi:[1,0]
v_pk_mul_f32 v[62:63], v[62:63], v[30:31] op_sel_hi:[1,0]
v_pk_mul_f32 v[64:65], v[64:65], v[30:31] op_sel_hi:[1,0]
v_pk_mul_f32 v[66:67], v[66:67], v[30:31] op_sel_hi:[1,0]
v_cvt_pk_bf16_f32 v8, v60, v61
v_cvt_pk_bf16_f32 v9, v62, v63
v_cvt_pk_bf16_f32 v10, v64, v65
v_cvt_pk_bf16_f32 v11, v66, v67
buffer_store_dwordx4 v[8:11], v45, s[28:31], s51 offen sc1
v_pk_add_f32 v[68:69], v[68:69], v[28:29] op_sel_hi:[1,0] neg_lo:[0,1] neg_hi:[0,1]
v_pk_add_f32 v[70:71], v[70:71], v[28:29] op_sel_hi:[1,0] neg_lo:[0,1] neg_hi:[0,1]
v_pk_add_f32 v[72:73], v[72:73], v[28:29] op_sel_hi:[1,0] neg_lo:[0,1] neg_hi:[0,1]
v_pk_add_f32 v[74:75], v[74:75], v[28:29] op_sel_hi:[1,0] neg_lo:[0,1] neg_hi:[0,1]
v_cvt_pk_bf16_f32 v12, v68, v69
v_cvt_pk_bf16_f32 v13, v70, v71
v_cvt_pk_bf16_f32 v14, v72, v73
v_cvt_pk_bf16_f32 v15, v74, v75
v_lshlrev_b32 v68, 16, v12
v_and_b32 v69, s50, v12
v_lshlrev_b32 v70, 16, v13
v_and_b32 v71, s50, v13
v_lshlrev_b32 v72, 16, v14
v_and_b32 v73, s50, v14
v_lshlrev_b32 v74, 16, v15
v_and_b32 v75, s50, v15
v_pk_mul_f32 v[68:69], v[68:69], v[30:31] op_sel_hi:[1,0]
v_pk_mul_f32 v[70:71], v[70:71], v[30:31] op_sel_hi:[1,0]
v_pk_mul_f32 v[72:73], v[72:73], v[30:31] op_sel_hi:[1,0]
v_pk_mul_f32 v[74:75], v[74:75], v[30:31] op_sel_hi:[1,0]
v_cvt_pk_bf16_f32 v12, v68, v69
v_cvt_pk_bf16_f32 v13, v70, v71
v_cvt_pk_bf16_f32 v14, v72, v73
v_cvt_pk_bf16_f32 v15, v74, v75
buffer_store_dwordx4 v[12:15], v45, s[28:31], s52 offen sc1
v_pk_add_f32 v[76:77], v[76:77], v[28:29] op_sel_hi:[1,0] neg_lo:[0,1] neg_hi:[0,1]
v_pk_add_f32 v[78:79], v[78:79], v[28:29] op_sel_hi:[1,0] neg_lo:[0,1] neg_hi:[0,1]
v_pk_add_f32 v[80:81], v[80:81], v[28:29] op_sel_hi:[1,0] neg_lo:[0,1] neg_hi:[0,1]
v_pk_add_f32 v[82:83], v[82:83], v[28:29] op_sel_hi:[1,0] neg_lo:[0,1] neg_hi:[0,1]
v_cvt_pk_bf16_f32 v16, v76, v77
v_cvt_pk_bf16_f32 v17, v78, v79
v_cvt_pk_bf16_f32 v18, v80, v81
v_cvt_pk_bf16_f32 v19, v82, v83
v_lshlrev_b32 v76, 16, v16
v_and_b32 v77, s50, v16
v_lshlrev_b32 v78, 16, v17
v_and_b32 v79, s50, v17
v_lshlrev_b32 v80, 16, v18
v_and_b32 v81, s50, v18
v_lshlrev_b32 v82, 16, v19
v_and_b32 v83, s50, v19
v_pk_mul_f32 v[76:77], v[76:77], v[30:31] op_sel_hi:[1,0]
v_pk_mul_f32 v[78:79], v[78:79], v[30:31] op_sel_hi:[1,0]
v_pk_mul_f32 v[80:81], v[80:81], v[30:31] op_sel_hi:[1,0]
v_pk_mul_f32 v[82:83], v[82:83], v[30:31] op_sel_hi:[1,0]
v_cvt_pk_bf16_f32 v16, v76, v77
v_cvt_pk_bf16_f32 v17, v78, v79
v_cvt_pk_bf16_f32 v18, v80, v81
v_cvt_pk_bf16_f32 v19, v82, v83
buffer_store_dwordx4 v[16:19], v45, s[28:31], s66 offen sc1
K_lnd:
s_add_u32 m0, s49, 0
s_mov_b32 s53, 0
buffer_load_dwordx4 v234, s[12:15], s53 offen lds
s_add_u32 m0, s49, 4096
s_nop 0
buffer_load_dwordx4 v234, s[16:19], s53 offen lds
s_add_u32 m0, s49, 8192
s_mov_b32 s53, 294912
buffer_load_dwordx4 v234, s[12:15], s53 offen lds
s_add_u32 m0, s49, 12288
s_nop 0
buffer_load_dwordx4 v234, s[16:19], s53 offen lds
s_add_u32 m0, s49, 16384
s_mov_b32 s53, 589824
buffer_load_dwordx4 v234, s[12:15], s53 offen lds
s_add_u32 m0, s49, 20480
s_nop 0
buffer_load_dwordx4 v234, s[16:19], s53 offen lds
s_lshr_b32 s50, s2, 5
s_lshl_b32 s50, s50, 5
v_mov_b32 v20, s50
v_mov_b32 v21, 1
s_mov_b64 exec, 0
s_bitcmp1_b32 s2, 0
s_cbranch_scc1 K_t1
s_cmp_eq_u32 s48, 0
s_cbranch_scc1 TCH_3_v0
s_cmp_eq_u32 s48, 1
s_cbranch_scc1 TCH_2_v0
s_cmp_eq_u32 s48, 2
s_cbranch_scc1 TCH_1_v0
s_branch TCH_0_v0
K_t1:
s_cmp_eq_u32 s48, 0
s_cbranch_scc1 TCH_3_v1
s_cmp_eq_u32 s48, 1
s_cbranch_scc1 TCH_2_v1
s_cmp_eq_u32 s48, 2
s_cbranch_scc1 TCH_1_v1
s_branch TCH_0_v1
TCH_back:
s_mov_b64 exec, -1
s_cmp_eq_u32 s48, 3
s_cbranch_scc1 K_w3b
s_waitcnt vmcnt(6)
s_barrier
s_cmp_lg_u32 s48, 0
s_cbranch_scc1 K_atd
s_mov_b64 exec, 1
global_atomic_add v20, v21, s[62:63] sc1
s_mov_b64 exec, -1
s_branch K_atd
K_w3b:
s_barrier
s_mov_b32 exec_hi, 4194303
global_load_dword v27, v[56:57], off
v_add_co_u32 v56, vcc, 884736, v56
s_nop 1
v_addc_co_u32 v57, vcc, 0, v57, vcc
global_load_dword v27, v[56:57], off
s_mov_b32 exec_hi, -1
K_atd:
buffer_load_dwordx4 v[184:187], v40, s[32:35], s56 offen
buffer_load_dwordx4 v[188:191], v42, s[40:43], s58 offen
s_add_u32 m0, s49, 24576
s_mov_b32 s53, 884736
buffer_load_dwordx4 v234, s[12:15], s53 offen lds
v_mul_u32_u24 v236, 3456, v203
v_add_u32 v236, v236, v202
s_lshl_b32 s67, s77, 2
s_add_u32 s67, s67, s48
s_mul_i32 s54, s67, 77824
s_add_u32 s54, s54, 0
s_add_u32 m0, s49, 28672
s_nop 0
buffer_load_dwordx4 v234, s[16:19], s53 offen lds
s_lshl_b32 s50, s48, 7
s_lshr_b32 s51, s2, 1
s_add_u32 s50, s50, s51
s_mul_i32 s51, s50, 7282
s_lshr_b32 s51, s51, 16
s_mul_i32 s52, s51, 9
s_sub_u32 s4, s50, s52
s_mul_i32 s59, s51, 64
s_mul_i32 s52, s51, 24
s_add_u32 s52, s52, 3584
s_bitcmp1_b32 s2, 0
s_cselect_b32 s59, s52, s59
s_cmp_lt_u32 s51, 56
s_cselect_b32 s59, s59, 4608
s_mov_b32 s26, 5308416
s_mov_b32 s27, 0x20000
s_mul_i32 s95, s59, 1152
s_add_u32 m0, s49, 32768
s_mov_b32 s53, 1179648
buffer_load_dwordx4 v234, s[12:15], s53 offen lds
v_xor_b32 v201, v200, v199
v_lshlrev_b32 v201, 4, v201
v_mul_u32_u24 v240, 1152, v199
v_add_u32 v240, v240, v201
v_lshl_add_u32 v240, s4, 7, v240
v_lshl_add_u32 v242, v200, 7, v201
v_add_u32 v242, s49, v242
v_add_u32 v242, 131072, v242
s_add_u32 m0, s49, 36864
s_nop 0
buffer_load_dwordx4 v234, s[16:19], s53 offen lds
v_lshl_add_u32 v201, s4, 3, v199
v_mul_u32_u24 v202, 57, v201
v_lshrrev_b32 v202, 9, v202
v_mul_u32_u24 v241, 9, v202
v_sub_u32 v201, v201, v241
v_mul_u32_u24 v241, 746496, v202
v_lshl_add_u32 v241, v201, 9, v241
v_and_b32 v201, 1, v201
v_lshl_add_u32 v241, v201, 7, v241
v_lshl_add_u32 v241, v200, 4, v241
s_add_u32 m0, s49, 40960
s_mov_b32 s53, 1474560
buffer_load_dwordx4 v234, s[12:15], s53 offen lds
v_lshrrev_b32 v194, 4, v193
v_bfe_u32 v195, v193, 2, 2
v_and_b32 v196, 3, v193
v_lshrrev_b32 v197, 1, v195
v_and_b32 v198, 1, v194
v_lshl_add_u32 v197, v198, 1, v197
v_lshl_add_u32 v198, v194, 3, v195
v_lshlrev_b32 v198, 7, v198
s_add_u32 m0, s49, 45056
s_nop 0
buffer_load_dwordx4 v234, s[16:19], s53 offen lds
v_xor_b32 v201, 0, v197
v_lshl_add_u32 v201, v201, 5, v198
v_lshl_add_u32 v228, v196, 3, v201
s_add_u32 m0, s49, 49152
s_mov_b32 s53, 1769472
buffer_load_dwordx4 v234, s[12:15], s53 offen lds
v_xor_b32 v201, 1, v197
v_lshl_add_u32 v201, v201, 5, v198
v_lshl_add_u32 v229, v196, 3, v201
s_add_u32 m0, s49, 53248
s_nop 0
buffer_load_dwordx4 v234, s[16:19], s53 offen lds
v_xor_b32 v201, 2, v197
v_lshl_add_u32 v201, v201, 5, v198
v_lshl_add_u32 v230, v196, 3, v201
s_add_u32 m0, s49, 57344
s_mov_b32 s53, 2064384
buffer_load_dwordx4 v234, s[12:15], s53 offen lds
v_xor_b32 v201, 3, v197
v_lshl_add_u32 v201, v201, 5, v198
v_lshl_add_u32 v231, v196, 3, v201
s_add_u32 m0, s49, 61440
s_nop 0
buffer_load_dwordx4 v234, s[16:19], s53 offen lds
v_lshlrev_b32 v201, 1, v197
v_xor_b32 v201, v201, v196
v_lshl_add_u32 v233, v201, 4, v198
v_and_b32 v201, 1, v194
v_lshl_add_u32 v201, v201, 2, v195
v_lshrrev_b32 v202, 1, v194
v_lshl_add_u32 v201, v202, 4, v201
s_add_u32 m0, s49, 65536
s_mov_b32 s53, 2359296
buffer_load_dwordx4 v234, s[12:15], s53 offen lds
v_lshlrev_b32 v201, 5, v201
v_lshl_add_u32 v232, v196, 3, v201
s_mul_i32 s55, s67, 593920
s_add_u32 s55, s55, 2490368
s_add_u32 m0, s49, 69632
s_nop 0
buffer_load_dwordx4 v234, s[16:19], s53 offen lds
s_mul_i32 s56, s64, 36
s_add_u32 s56, s56, 16
s_add_u32 s56, s56, s78
s_lshl_b32 s56, s56, 11
s_add_u32 s56, s56, s55
s_lshl_b32 s50, s79, 13
s_add_u32 s55, s55, s50
s_add_u32 m0, s49, 73728
s_mov_b32 s53, 2654208
buffer_load_dwordx4 v234, s[12:15], s53 offen lds
s_lshl_b32 s69, s64, 2
s_add_u32 s69, s69, s78
s_mul_i32 s57, s69, 36864
s_add_u32 s57, s57, s49
s_add_u32 s57, s57, 44937216
s_lshl_b32 s60, s2, 2
s_add_u32 s60, s60, 46247936
s_add_u32 m0, s49, 77824
s_nop 0
buffer_load_dwordx4 v234, s[16:19], s53 offen lds
s_lshl_b32 s97, s67, 2
s_lshr_b32 s50, s69, 3
s_add_u32 s97, s97, s50
s_lshl_b32 s97, s97, 5
s_and_b32 s50, s69, 7
s_add_u32 s97, s97, s50
s_lshl_b32 s97, s97, 2
s_add_u32 s97, s97, 46116864
s_mov_b32 s96, 0xbfb8aa3b
s_add_u32 m0, s49, 81920
s_mov_b32 s53, 2949120
buffer_load_dwordx4 v234, s[12:15], s53 offen lds
s_mul_i32 s69, s64, 7
s_add_u32 s69, s69, 1
s_lshr_b32 s69, s69, 1
s_min_u32 s69, s69, 24
s_lshl_b32 s69, s69, 1
s_lshl_b32 s50, s78, 1
s_lshr_b32 s51, s78, 1
s_add_u32 s51, s51, s78
s_bitcmp1_b32 s2, 0
s_cselect_b32 s50, s51, s50
s_add_u32 s50, s50, s69
s_lshl_b32 s50, s50, 6
s_sub_u32 s22, 1990656, s50
s_add_u32 s20, s6, s50
s_addc_u32 s21, s7, 0
s_mul_i32 s58, s67, 221184
s_add_u32 s58, s58, 27467776
s_add_u32 s58, s58, s50
s_add_u32 m0, s49, 86016
s_nop 0
buffer_load_dwordx4 v234, s[16:19], s53 offen lds
s_lshl_b32 s50, s78, 1
s_lshl_b32 s51, s78, 1
s_max_u32 s51, s51, 1
s_sub_u32 s51, s51, 1
s_bitcmp1_b32 s2, 0
s_cselect_b32 s50, s51, s50
s_add_u32 s50, s50, s69
s_mul_i32 s51, s50, 57
s_lshr_b32 s51, s51, 10
s_mul_i32 s51, s51, 14
s_add_u32 s50, s50, s51
s_lshl_b32 s3, s67, 7
s_add_u32 s3, s3, s50
s_lshl_b32 s3, s3, 2
s_add_u32 s3, s3, 46198784
s_add_u32 m0, s49, 90112
s_mov_b32 s53, 3244032
buffer_load_dwordx4 v234, s[12:15], s53 offen lds
s_lshl_b32 s50, s78, 1
s_add_u32 s50, s50, 1
s_lshl_b32 s51, s78, 1
s_min_u32 s51, s51, 5
s_bitcmp1_b32 s2, 0
s_cselect_b32 s50, s51, s50
s_add_u32 s50, s50, s69
s_mul_i32 s51, s50, 57
s_lshr_b32 s51, s51, 10
s_mul_i32 s51, s51, 14
s_add_u32 s50, s50, s51
s_lshl_b32 s91, s67, 7
s_add_u32 s91, s91, s50
s_lshl_b32 s91, s91, 2
s_add_u32 s91, s91, 46198784
s_add_u32 m0, s49, 94208
s_nop 0
buffer_load_dwordx4 v234, s[16:19], s53 offen lds
s_mov_b32 s32, s28
s_mov_b32 s33, s29
s_and_b32 s50, s2, 0xc7
s_cmp_lg_u32 s50, 0xc6
s_cselect_b32 s34, 46379008, 0
s_cselect_b32 s22, s22, 0
s_mov_b32 s40, s28
s_mov_b32 s41, s29
s_cmp_eq_u32 s48, 0
s_cselect_b32 s42, 46379008, 0
s_and_b32 s69, s78, s2
s_and_b32 s69, s69, 1
s_lshl_b32 s50, s69, 6
v_xor_b32 v233, s50, v233
s_add_u32 m0, s49, 98304
s_mov_b32 s53, 3538944
buffer_load_dwordx4 v234, s[12:15], s53 offen lds
v_and_b32 v201, 15, v193
v_mul_u32_u24 v201, 3456, v201
v_lshl_add_u32 v239, v194, 4, v201
v_lshl_add_u32 v239, s69, 6, v239
s_lshl_b32 s69, s69, 1
s_mul_i32 s50, s67, 18
v_add_u32 v201, s50, v193
v_cmp_gt_u32 vcc, 18, v193
v_mov_b32 v202, 0x20000
v_lshlrev_b32 v245, 5, v199
v_cndmask_b32 v201, v202, v201, vcc
v_mul_u32_u24 v243, 3456, v201
v_mul_u32_u24 v254, 9216, v201
s_add_u32 m0, s49, 102400
s_nop 0
buffer_load_dwordx4 v234, s[16:19], s53 offen lds
s_bfe_u32 s76, s2, 0x20001
s_bfe_u32 s4, s2, 0x30003
s_lshr_b32 s5, s2, 6
s_and_b32 s50, s2, 1
s_lshl_b32 s50, s50, 2
s_add_u32 s5, s5, s50
s_nop 0
s_lshl_b32 s6, s5, 2
s_add_u32 s7, s6, s76
s_add_u32 s6, s6, s48
s_add_u32 m0, s49, 106496
s_mov_b32 s53, 3833856
buffer_load_dwordx4 v234, s[12:15], s53 offen lds
s_xor_b32 s50, s69, 0
s_add_u32 s50, s76, s50
s_and_b32 s50, s50, 3
s_lshl_b32 s50, s50, 10
v_add_u32 v250, s50, v237
s_add_u32 m0, s49, 110592
s_nop 0
buffer_load_dwordx4 v234, s[16:19], s53 offen lds
s_xor_b32 s50, s69, 1
s_add_u32 s50, s76, s50
s_and_b32 s50, s50, 3
s_lshl_b32 s50, s50, 10
v_add_u32 v251, s50, v237
s_add_u32 m0, s49, 114688
s_mov_b32 s53, 4128768
buffer_load_dwordx4 v234, s[12:15], s53 offen lds
s_xor_b32 s50, s69, 2
s_add_u32 s50, s76, s50
s_and_b32 s50, s50, 3
s_lshl_b32 s50, s50, 10
v_add_u32 v252, s50, v237
s_add_u32 m0, s49, 118784
s_nop 0
buffer_load_dwordx4 v234, s[16:19], s53 offen lds
s_xor_b32 s50, s69, 3
s_add_u32 s50, s76, s50
s_and_b32 s50, s50, 3
s_lshl_b32 s50, s50, 10
v_add_u32 v253, s50, v237
s_cmp_lg_u32 s48, 0
s_cbranch_scc1 K_nop
global_load_dword v50, v49, s[62:63] sc1
K_nop:
s_add_u32 m0, s49, 122880
s_mov_b32 s53, 4423680
buffer_load_dwordx4 v234, s[12:15], s53 offen lds
s_lshl_b32 s77, s7, 6
s_cmp_eq_u32 s7, 0
s_cselect_b32 s78, 1, 0
s_mul_i32 s79, s6, 593920
s_mul_i32 s50, s76, 147456
s_add_u32 s79, s79, s50
s_add_u32 s79, s79, 2490368
s_lshl_b32 s80, s48, 6
s_add_u32 m0, s49, 126976
s_nop 0
buffer_load_dwordx4 v234, s[16:19], s53 offen lds
s_mul_i32 s82, s4, 746496
s_add_u32 s82, s82, 21495808
s_add_u32 s82, s82, s49
s_mul_i32 s81, s76, 165888
s_add_u32 s81, s81, s82
s_add_u32 s82, s82, 663552
s_add_u32 m0, s49, 131072
s_mov_b32 s53, 4718592
buffer_load_dwordx4 v234, s[12:15], s53 offen lds
s_lshl_b32 s83, s6, 2
s_add_u32 s83, s83, s76
s_lshl_b32 s83, s83, 7
s_add_u32 s83, s83, 46116864
s_mul_i32 s86, s48, 48
s_add_u32 m0, s49, 135168
s_nop 0
buffer_load_dwordx4 v234, s[16:19], s53 offen lds
s_mul_i32 s84, s4, 144
s_lshl_b32 s85, s6, 6
s_lshl_b32 s50, s76, 4
s_add_u32 s85, s85, s50
s_mul_i32 s85, s85, 1152
s_add_u32 s85, s85, s84
s_add_u32 s84, s84, 27467776
s_add_u32 m0, s49, 139264
s_mov_b32 s53, 5013504
buffer_load_dwordx4 v234, s[12:15], s53 offen lds
s_mul_i32 s50, s7, 78848
s_add_u32 s50, s50, 34549760
s_lshl_b32 s87, s4, 13
s_lshr_b32 s51, s48, 1
s_lshl_b32 s51, s51, 12
s_add_u32 s87, s87, s51
s_and_b32 s51, s48, 1
s_lshl_b32 s51, s51, 9
s_add_u32 s87, s87, s51
s_add_u32 s87, s87, s50
s_lshl_b32 s68, s4, 2
s_add_u32 s68, s68, s48
s_lshr_b32 s88, s4, 2
s_lshl_b32 s88, s88, 12
s_add_u32 s88, s88, s50
s_add_u32 s88, s88, 65536
s_and_b32 s51, s4, 3
s_lshl_b32 s51, s51, 8
s_add_u32 s88, s88, s51
s_add_u32 s88, s88, s49
s_add_u32 m0, s49, 143360
s_nop 0
buffer_load_dwordx4 v234, s[16:19], s53 offen lds
s_lshl_b32 s89, s7, 2
s_lshr_b32 s50, s68, 3
s_add_u32 s89, s89, s50
s_lshl_b32 s89, s89, 5
s_and_b32 s50, s68, 7
s_add_u32 s89, s89, s50
s_lshl_b32 s89, s89, 2
s_add_u32 s89, s89, 46182400
s_lshl_b32 s90, s6, 9
s_add_u32 s90, s90, 46182400
s_mul_i32 s61, s6, 78848
s_add_u32 s61, s61, 34549760
s_lshl_b32 s50, s76, 10
s_add_u32 s61, s61, s50
s_lshl_b32 s50, s5, 5
s_add_u32 s68, s68, s50
s_mul_i32 s92, s68, 30720
s_add_u32 s92, s92, 37072896
s_lshl_b32 s93, s68, 7
s_add_u32 s93, s93, 46215168
s_lshl_b32 s50, s76, 2
s_add_u32 s94, s93, s50
s_lshl_b32 s67, s48, 8
s_add_u32 s67, s67, 46247936
v_lshrrev_b32 v247, 2, v237
s_mov_b32 s36, s44
s_mov_b32 s37, s45
s_mov_b32 s38, 2359296
s_mov_b32 s39, 0x20000
s_waitcnt vmcnt(6)
s_cmp_lg_u32 s48, 0
s_cbranch_scc1 K_lnok
v_cmp_gt_u32 vcc, 32, v50
s_mov_b32 s65, 0
s_cbranch_vccz K_lnok
K_lnsp:
s_sleep 5
global_load_dword v50, v49, s[62:63] sc1
s_add_u32 s65, s65, 1
s_waitcnt vmcnt(0)
v_cmp_gt_u32 vcc, 32, v50
s_cmp_gt_u32 s65, 100000
s_cbranch_scc1 K_lnok
s_cbranch_vccnz K_lnsp
K_lnok:
s_barrier
s_add_u32 s52, s54, 0
buffer_load_dwordx4 a[0:3], v250, s[28:31], s52 offen sc1
buffer_load_dwordx4 a[4:7], v251, s[28:31], s52 offen sc1
buffer_load_dwordx4 a[8:11], v252, s[28:31], s52 offen sc1
buffer_load_dwordx4 a[12:15], v253, s[28:31], s52 offen sc1
s_add_u32 s52, s54, 4096
buffer_load_dwordx4 a[16:19], v250, s[28:31], s52 offen sc1
buffer_load_dwordx4 a[20:23], v251, s[28:31], s52 offen sc1
buffer_load_dwordx4 a[24:27], v252, s[28:31], s52 offen sc1
buffer_load_dwordx4 a[28:31], v253, s[28:31], s52 offen sc1
s_bitcmp1_b32 s2, 0
s_cbranch_scc1 K_main_1
s_branch K_main_0
.p2align 12
K_main_0:
TCH_0_v0:
s_cbranch_execz TCH_4_v0
ds_read_b64_tr_b16 v[192:193], v228 offset:0
ds_read_b64_tr_b16 v[194:195], v228 offset:512
ds_read_b64_tr_b16 v[196:197], v228 offset:4096
ds_read_b64_tr_b16 v[198:199], v228 offset:4608
ds_read_b64_tr_b16 v[200:201], v229 offset:0
ds_read_b64_tr_b16 v[202:203], v229 offset:512
ds_read_b64_tr_b16 v[204:205], v229 offset:4096
ds_read_b64_tr_b16 v[206:207], v229 offset:4608
s_waitcnt vmcnt(4) lgkmcnt(6)
v_mfma_f32_16x16x32_bf16 v[32:35], v[192:195], a[0:3], 0
s_add_u32 s52, s54, 8192
ds_read_b64_tr_b16 v[208:209], v230 offset:0
ds_read_b64_tr_b16 v[210:211], v230 offset:512
v_mfma_f32_16x16x32_bf16 v[36:39], v[192:195], a[4:7], 0
buffer_load_dwordx4 a[32:35], v250, s[28:31], s52 offen sc1
v_mfma_f32_16x16x32_bf16 v[40:43], v[192:195], a[8:11], 0
v_mfma_f32_16x16x32_bf16 v[44:47], v[192:195], a[12:15], 0
s_waitcnt lgkmcnt(6)
v_mfma_f32_16x16x32_bf16 v[48:51], v[196:199], a[0:3], 0
ds_read_b64_tr_b16 v[192:193], v230 offset:4096
ds_read_b64_tr_b16 v[194:195], v230 offset:4608
v_mfma_f32_16x16x32_bf16 v[52:55], v[196:199], a[4:7], 0
buffer_load_dwordx4 a[36:39], v251, s[28:31], s52 offen sc1
v_mfma_f32_16x16x32_bf16 v[56:59], v[196:199], a[8:11], 0
v_mfma_f32_16x16x32_bf16 v[60:63], v[196:199], a[12:15], 0
s_waitcnt lgkmcnt(6)
v_mfma_f32_16x16x32_bf16 v[64:67], v[200:203], a[0:3], 0
s_add_u32 s4, s59, 0
ds_read_b64_tr_b16 v[196:197], v231 offset:0
ds_read_b64_tr_b16 v[198:199], v231 offset:512
v_mfma_f32_16x16x32_bf16 v[68:71], v[200:203], a[4:7], 0
s_lshr_b32 s5, s4, 6
buffer_load_dwordx4 a[40:43], v252, s[28:31], s52 offen sc1
v_mfma_f32_16x16x32_bf16 v[72:75], v[200:203], a[8:11], 0
s_mul_i32 s6, s5, 57
v_mfma_f32_16x16x32_bf16 v[76:79], v[200:203], a[12:15], 0
s_waitcnt lgkmcnt(6)
v_mfma_f32_16x16x32_bf16 v[80:83], v[204:207], a[0:3], 0
s_lshr_b32 s6, s6, 9
ds_read_b64_tr_b16 v[200:201], v231 offset:4096
ds_read_b64_tr_b16 v[202:203], v231 offset:4608
v_mfma_f32_16x16x32_bf16 v[84:87], v[204:207], a[4:7], 0
s_mul_i32 s7, s6, 9
buffer_load_dwordx4 a[44:47], v253, s[28:31], s52 offen sc1
v_mfma_f32_16x16x32_bf16 v[88:91], v[204:207], a[8:11], 0
s_sub_u32 s5, s5, s7
v_mfma_f32_16x16x32_bf16 v[92:95], v[204:207], a[12:15], 0
s_waitcnt lgkmcnt(6)
v_mfma_f32_16x16x32_bf16 v[96:99], v[208:211], a[0:3], 0
s_bfe_u32 s7, s4, 0x10005
ds_read_b64_tr_b16 v[204:205], v228 offset:8192
ds_read_b64_tr_b16 v[206:207], v228 offset:8704
v_mfma_f32_16x16x32_bf16 v[100:103], v[208:211], a[4:7], 0
s_and_b32 s8, s6, 1
v_mfma_f32_16x16x32_bf16 v[104:107], v[208:211], a[8:11], 0
s_lshl_b32 s9, s8, 2
v_mfma_f32_16x16x32_bf16 v[108:111], v[208:211], a[12:15], 0
s_waitcnt lgkmcnt(6)
v_mfma_f32_16x16x32_bf16 v[112:115], v[192:195], a[0:3], 0
s_add_u32 s9, s9, s5
ds_read_b64_tr_b16 v[208:209], v228 offset:12288
ds_read_b64_tr_b16 v[210:211], v228 offset:12800
v_mfma_f32_16x16x32_bf16 v[116:119], v[192:195], a[4:7], 0
s_add_u32 s52, s54, 12288
buffer_load_dwordx4 a[48:51], v250, s[28:31], s52 offen sc1
v_mfma_f32_16x16x32_bf16 v[120:123], v[192:195], a[8:11], 0
s_lshl_b32 s10, s7, 3
v_mfma_f32_16x16x32_bf16 v[124:127], v[192:195], a[12:15], 0
s_waitcnt lgkmcnt(6)
v_mfma_f32_16x16x32_bf16 v[128:131], v[196:199], a[0:3], 0
s_add_u32 s9, s9, s10
ds_read_b64_tr_b16 v[192:193], v229 offset:8192
ds_read_b64_tr_b16 v[194:195], v229 offset:8704
v_mfma_f32_16x16x32_bf16 v[132:135], v[196:199], a[4:7], 0
s_cmp_ge_u32 s9, 6
s_cselect_b32 s10, 4, 0
buffer_load_dwordx4 a[52:55], v251, s[28:31], s52 offen sc1
v_mfma_f32_16x16x32_bf16 v[136:139], v[196:199], a[8:11], 0
s_cmp_gt_u32 s5, 4
s_cselect_b32 s10, 15, s10
v_mfma_f32_16x16x32_bf16 v[140:143], v[196:199], a[12:15], 0
s_waitcnt lgkmcnt(6)
v_mfma_f32_16x16x32_bf16 v[144:147], v[200:203], a[0:3], 0
s_add_u32 s9, s9, s10
ds_read_b64_tr_b16 v[196:197], v229 offset:12288
ds_read_b64_tr_b16 v[198:199], v229 offset:12800
v_mfma_f32_16x16x32_bf16 v[148:151], v[200:203], a[4:7], 0
s_lshl_b32 s8, s8, 1
buffer_load_dwordx4 a[56:59], v252, s[28:31], s52 offen sc1
v_mfma_f32_16x16x32_bf16 v[152:155], v[200:203], a[8:11], 0
s_add_u32 s8, s8, s7
v_mfma_f32_16x16x32_bf16 v[156:159], v[200:203], a[12:15], 0
s_waitcnt vmcnt(7) lgkmcnt(6)
v_mfma_f32_16x16x32_bf16 v[32:35], v[204:207], a[16:19], v[32:35]
s_add_u32 s8, s8, 6
ds_read_b64_tr_b16 v[200:201], v230 offset:8192
ds_read_b64_tr_b16 v[202:203], v230 offset:8704
v_mfma_f32_16x16x32_bf16 v[36:39], v[204:207], a[20:23], v[36:39]
s_cmp_eq_u32 s5, 4
s_cselect_b32 s9, s8, s9
buffer_load_dwordx4 a[60:63], v253, s[28:31], s52 offen sc1
v_mfma_f32_16x16x32_bf16 v[40:43], v[204:207], a[24:27], v[40:43]
v_mfma_f32_16x16x32_bf16 v[44:47], v[204:207], a[28:31], v[44:47]
s_waitcnt lgkmcnt(6)
v_mfma_f32_16x16x32_bf16 v[48:51], v[208:211], a[16:19], v[48:51]
s_lshr_b32 s6, s6, 1
ds_read_b64_tr_b16 v[204:205], v230 offset:12288
ds_read_b64_tr_b16 v[206:207], v230 offset:12800
v_mfma_f32_16x16x32_bf16 v[52:55], v[208:211], a[20:23], v[52:55]
s_mul_i32 s6, s6, 36
v_mfma_f32_16x16x32_bf16 v[56:59], v[208:211], a[24:27], v[56:59]
s_add_u32 s9, s9, s6
v_mfma_f32_16x16x32_bf16 v[60:63], v[208:211], a[28:31], v[60:63]
s_waitcnt lgkmcnt(6)
v_mfma_f32_16x16x32_bf16 v[64:67], v[192:195], a[16:19], v[64:67]
s_add_u32 s52, s54, 16384
ds_read_b64_tr_b16 v[208:209], v231 offset:8192
ds_read_b64_tr_b16 v[210:211], v231 offset:8704
v_mfma_f32_16x16x32_bf16 v[68:71], v[192:195], a[20:23], v[68:71]
s_waitcnt vmcnt(46)
buffer_load_dwordx4 a[64:67], v250, s[28:31], s52 offen sc1
buffer_store_dwordx4 v[184:187], v248, s[28:31], 0 offen sc1
v_mfma_f32_16x16x32_bf16 v[72:75], v[192:195], a[24:27], v[72:75]
s_mul_i32 s9, s9, 4608
v_mfma_f32_16x16x32_bf16 v[76:79], v[192:195], a[28:31], v[76:79]
s_waitcnt lgkmcnt(6)
v_mfma_f32_16x16x32_bf16 v[80:83], v[196:199], a[16:19], v[80:83]
s_add_u32 s9, s9, 21495808
ds_read_b64_tr_b16 v[192:193], v231 offset:12288
ds_read_b64_tr_b16 v[194:195], v231 offset:12800
v_mfma_f32_16x16x32_bf16 v[84:87], v[196:199], a[20:23], v[84:87]
s_cmp_lt_u32 s4, 4608
s_cselect_b32 s9, s9, 0x40000000
buffer_load_dwordx4 a[68:71], v251, s[28:31], s52 offen sc1
v_mfma_f32_16x16x32_bf16 v[88:91], v[196:199], a[24:27], v[88:91]
s_and_b32 s4, s4, 31
v_mfma_f32_16x16x32_bf16 v[92:95], v[196:199], a[28:31], v[92:95]
s_waitcnt lgkmcnt(6)
v_mfma_f32_16x16x32_bf16 v[96:99], v[200:203], a[16:19], v[96:99]
s_lshl_b32 s4, s4, 4
ds_read_b64_tr_b16 v[196:197], v228 offset:16384
ds_read_b64_tr_b16 v[198:199], v228 offset:16896
v_mfma_f32_16x16x32_bf16 v[100:103], v[200:203], a[20:23], v[100:103]
buffer_load_dwordx4 a[72:75], v252, s[28:31], s52 offen sc1
v_xor_b32 v212, s4, v241
v_mfma_f32_16x16x32_bf16 v[104:107], v[200:203], a[24:27], v[104:107]
v_mfma_f32_16x16x32_bf16 v[108:111], v[200:203], a[28:31], v[108:111]
s_waitcnt lgkmcnt(6)
v_mfma_f32_16x16x32_bf16 v[112:115], v[204:207], a[16:19], v[112:115]
ds_read_b64_tr_b16 v[200:201], v228 offset:20480
ds_read_b64_tr_b16 v[202:203], v228 offset:20992
v_mfma_f32_16x16x32_bf16 v[116:119], v[204:207], a[20:23], v[116:119]
buffer_load_dwordx4 a[76:79], v253, s[28:31], s52 offen sc1
v_add_u32 v212, s9, v212
v_mfma_f32_16x16x32_bf16 v[120:123], v[204:207], a[24:27], v[120:123]
v_mfma_f32_16x16x32_bf16 v[124:127], v[204:207], a[28:31], v[124:127]
s_waitcnt lgkmcnt(6)
v_mfma_f32_16x16x32_bf16 v[128:131], v[208:211], a[16:19], v[128:131]
s_add_u32 s4, s59, 8
ds_read_b64_tr_b16 v[204:205], v229 offset:16384
ds_read_b64_tr_b16 v[206:207], v229 offset:16896
v_mfma_f32_16x16x32_bf16 v[132:135], v[208:211], a[20:23], v[132:135]
s_lshr_b32 s5, s4, 6
v_mfma_f32_16x16x32_bf16 v[136:139], v[208:211], a[24:27], v[136:139]
s_mul_i32 s6, s5, 57
v_mfma_f32_16x16x32_bf16 v[140:143], v[208:211], a[28:31], v[140:143]
s_waitcnt lgkmcnt(6)
v_mfma_f32_16x16x32_bf16 v[144:147], v[192:195], a[16:19], v[144:147]
s_add_u32 s52, s54, 20480
ds_read_b64_tr_b16 v[208:209], v229 offset:20480
ds_read_b64_tr_b16 v[210:211], v229 offset:20992
v_mfma_f32_16x16x32_bf16 v[148:151], v[192:195], a[20:23], v[148:151]
s_lshr_b32 s6, s6, 9
buffer_load_dwordx4 a[80:83], v250, s[28:31], s52 offen sc1
v_mfma_f32_16x16x32_bf16 v[152:155], v[192:195], a[24:27], v[152:155]
s_mul_i32 s7, s6, 9
v_mfma_f32_16x16x32_bf16 v[156:159], v[192:195], a[28:31], v[156:159]
s_waitcnt vmcnt(10) lgkmcnt(6)
v_mfma_f32_16x16x32_bf16 v[32:35], v[196:199], a[32:35], v[32:35]
s_sub_u32 s5, s5, s7
ds_read_b64_tr_b16 v[192:193], v230 offset:16384
ds_read_b64_tr_b16 v[194:195], v230 offset:16896
v_mfma_f32_16x16x32_bf16 v[36:39], v[196:199], a[36:39], v[36:39]
s_bfe_u32 s7, s4, 0x10005
buffer_load_dwordx4 a[84:87], v251, s[28:31], s52 offen sc1
v_mfma_f32_16x16x32_bf16 v[40:43], v[196:199], a[40:43], v[40:43]
s_and_b32 s8, s6, 1
v_mfma_f32_16x16x32_bf16 v[44:47], v[196:199], a[44:47], v[44:47]
s_waitcnt lgkmcnt(6)
v_mfma_f32_16x16x32_bf16 v[48:51], v[200:203], a[32:35], v[48:51]
s_lshl_b32 s9, s8, 2
ds_read_b64_tr_b16 v[196:197], v230 offset:20480
ds_read_b64_tr_b16 v[198:199], v230 offset:20992
v_mfma_f32_16x16x32_bf16 v[52:55], v[200:203], a[36:39], v[52:55]
s_add_u32 s9, s9, s5
buffer_load_dwordx4 a[88:91], v252, s[28:31], s52 offen sc1
v_mfma_f32_16x16x32_bf16 v[56:59], v[200:203], a[40:43], v[56:59]
s_lshl_b32 s10, s7, 3
v_mfma_f32_16x16x32_bf16 v[60:63], v[200:203], a[44:47], v[60:63]
s_waitcnt lgkmcnt(6)
v_mfma_f32_16x16x32_bf16 v[64:67], v[204:207], a[32:35], v[64:67]
s_add_u32 s9, s9, s10
ds_read_b64_tr_b16 v[200:201], v231 offset:16384
ds_read_b64_tr_b16 v[202:203], v231 offset:16896
v_mfma_f32_16x16x32_bf16 v[68:71], v[204:207], a[36:39], v[68:71]
s_waitcnt vmcnt(54)
buffer_load_dwordx4 a[92:95], v253, s[28:31], s52 offen sc1
buffer_store_dwordx4 v[188:191], v249, s[28:31], 0 offen sc1
v_mfma_f32_16x16x32_bf16 v[72:75], v[204:207], a[40:43], v[72:75]
s_cmp_ge_u32 s9, 6
s_cselect_b32 s10, 4, 0
v_mfma_f32_16x16x32_bf16 v[76:79], v[204:207], a[44:47], v[76:79]
s_waitcnt lgkmcnt(6)
v_mfma_f32_16x16x32_bf16 v[80:83], v[208:211], a[32:35], v[80:83]
ds_read_b64_tr_b16 v[204:205], v231 offset:20480
ds_read_b64_tr_b16 v[206:207], v231 offset:20992
v_mfma_f32_16x16x32_bf16 v[84:87], v[208:211], a[36:39], v[84:87]
s_cmp_gt_u32 s5, 4
s_cselect_b32 s10, 15, s10
v_mfma_f32_16x16x32_bf16 v[88:91], v[208:211], a[40:43], v[88:91]
s_add_u32 s9, s9, s10
v_mfma_f32_16x16x32_bf16 v[92:95], v[208:211], a[44:47], v[92:95]
s_waitcnt lgkmcnt(6)
v_mfma_f32_16x16x32_bf16 v[96:99], v[192:195], a[32:35], v[96:99]
s_lshl_b32 s8, s8, 1
ds_read_b64_tr_b16 v[208:209], v228 offset:24576
ds_read_b64_tr_b16 v[210:211], v228 offset:25088
v_mfma_f32_16x16x32_bf16 v[100:103], v[192:195], a[36:39], v[100:103]
s_add_u32 s52, s54, 24576
buffer_load_dwordx4 a[96:99], v250, s[28:31], s52 offen sc1
v_bfe_u32 v222, v237, 4, 4
v_mfma_f32_16x16x32_bf16 v[104:107], v[192:195], a[40:43], v[104:107]
s_add_u32 s8, s8, s7
v_mfma_f32_16x16x32_bf16 v[108:111], v[192:195], a[44:47], v[108:111]
s_waitcnt lgkmcnt(6)
v_mfma_f32_16x16x32_bf16 v[112:115], v[196:199], a[32:35], v[112:115]
s_add_u32 s8, s8, 6
ds_read_b64_tr_b16 v[192:193], v228 offset:28672
ds_read_b64_tr_b16 v[194:195], v228 offset:29184
v_mfma_f32_16x16x32_bf16 v[116:119], v[196:199], a[36:39], v[116:119]
s_cmp_eq_u32 s5, 4
s_cselect_b32 s9, s8, s9
buffer_load_dwordx4 a[100:103], v251, s[28:31], s52 offen sc1
v_mfma_f32_16x16x32_bf16 v[120:123], v[196:199], a[40:43], v[120:123]
s_lshr_b32 s6, s6, 1
v_mfma_f32_16x16x32_bf16 v[124:127], v[196:199], a[44:47], v[124:127]
s_waitcnt lgkmcnt(6)
v_mfma_f32_16x16x32_bf16 v[128:131], v[200:203], a[32:35], v[128:131]
s_mul_i32 s6, s6, 36
ds_read_b64_tr_b16 v[196:197], v229 offset:24576
ds_read_b64_tr_b16 v[198:199], v229 offset:25088
v_mfma_f32_16x16x32_bf16 v[132:135], v[200:203], a[36:39], v[132:135]
s_add_u32 s9, s9, s6
buffer_load_dwordx4 a[104:107], v252, s[28:31], s52 offen sc1
v_lshrrev_b32 v223, 8, v237
v_mfma_f32_16x16x32_bf16 v[136:139], v[200:203], a[40:43], v[136:139]
s_mul_i32 s9, s9, 4608
v_mfma_f32_16x16x32_bf16 v[140:143], v[200:203], a[44:47], v[140:143]
s_waitcnt lgkmcnt(6)
v_mfma_f32_16x16x32_bf16 v[144:147], v[204:207], a[32:35], v[144:147]
s_add_u32 s9, s9, 21495808
ds_read_b64_tr_b16 v[200:201], v229 offset:28672
ds_read_b64_tr_b16 v[202:203], v229 offset:29184
v_mfma_f32_16x16x32_bf16 v[148:151], v[204:207], a[36:39], v[148:151]
s_cmp_lt_u32 s4, 4608
s_cselect_b32 s9, s9, 0x40000000
buffer_load_dwordx4 a[108:111], v253, s[28:31], s52 offen sc1
v_mfma_f32_16x16x32_bf16 v[152:155], v[204:207], a[40:43], v[152:155]
s_and_b32 s4, s4, 31
v_mfma_f32_16x16x32_bf16 v[156:159], v[204:207], a[44:47], v[156:159]
s_waitcnt vmcnt(14) lgkmcnt(6)
v_mfma_f32_16x16x32_bf16 v[32:35], v[208:211], a[48:51], v[32:35]
s_lshl_b32 s4, s4, 4
ds_read_b64_tr_b16 v[204:205], v230 offset:24576
ds_read_b64_tr_b16 v[206:207], v230 offset:25088
v_mfma_f32_16x16x32_bf16 v[36:39], v[208:211], a[52:55], v[36:39]
v_xor_b32 v213, s4, v241
v_mul_u32_u24 v222, 1152, v222
v_mfma_f32_16x16x32_bf16 v[40:43], v[208:211], a[56:59], v[40:43]
v_mfma_f32_16x16x32_bf16 v[44:47], v[208:211], a[60:63], v[44:47]
s_waitcnt lgkmcnt(6)
v_mfma_f32_16x16x32_bf16 v[48:51], v[192:195], a[48:51], v[48:51]
s_add_u32 s52, s54, 28672
ds_read_b64_tr_b16 v[208:209], v230 offset:28672
ds_read_b64_tr_b16 v[210:211], v230 offset:29184
v_mfma_f32_16x16x32_bf16 v[52:55], v[192:195], a[52:55], v[52:55]
buffer_load_dwordx4 a[112:115], v250, s[28:31], s52 offen sc1
v_add_u32 v213, s9, v213
v_mfma_f32_16x16x32_bf16 v[56:59], v[192:195], a[56:59], v[56:59]
v_mfma_f32_16x16x32_bf16 v[60:63], v[192:195], a[60:63], v[60:63]
s_waitcnt lgkmcnt(6)
v_mfma_f32_16x16x32_bf16 v[64:67], v[196:199], a[48:51], v[64:67]
s_add_u32 s4, s59, 16
ds_read_b64_tr_b16 v[192:193], v231 offset:24576
ds_read_b64_tr_b16 v[194:195], v231 offset:25088
v_mfma_f32_16x16x32_bf16 v[68:71], v[196:199], a[52:55], v[68:71]
s_lshr_b32 s5, s4, 6
buffer_load_dwordx4 a[116:119], v251, s[28:31], s52 offen sc1
v_add_u32 v222, s85, v222
v_mfma_f32_16x16x32_bf16 v[72:75], v[196:199], a[56:59], v[72:75]
v_mfma_f32_16x16x32_bf16 v[76:79], v[196:199], a[60:63], v[76:79]
s_waitcnt lgkmcnt(6)
v_mfma_f32_16x16x32_bf16 v[80:83], v[200:203], a[48:51], v[80:83]
s_mul_i32 s6, s5, 57
ds_read_b64_tr_b16 v[196:197], v231 offset:28672
ds_read_b64_tr_b16 v[198:199], v231 offset:29184
v_mfma_f32_16x16x32_bf16 v[84:87], v[200:203], a[52:55], v[84:87]
s_lshr_b32 s6, s6, 9
buffer_load_dwordx4 a[120:123], v252, s[28:31], s52 offen sc1
v_mfma_f32_16x16x32_bf16 v[88:91], v[200:203], a[56:59], v[88:91]
s_mul_i32 s7, s6, 9
v_mfma_f32_16x16x32_bf16 v[92:95], v[200:203], a[60:63], v[92:95]
s_waitcnt lgkmcnt(6)
v_mfma_f32_16x16x32_bf16 v[96:99], v[204:207], a[48:51], v[96:99]
s_sub_u32 s5, s5, s7
ds_read_b64_tr_b16 v[200:201], v228 offset:32768
ds_read_b64_tr_b16 v[202:203], v228 offset:33280
v_mfma_f32_16x16x32_bf16 v[100:103], v[204:207], a[52:55], v[100:103]
s_bfe_u32 s7, s4, 0x10005
buffer_load_dwordx4 a[124:127], v253, s[28:31], s52 offen sc1
v_lshl_add_u32 v221, v223, 3, v222
v_mfma_f32_16x16x32_bf16 v[104:107], v[204:207], a[56:59], v[104:107]
s_and_b32 s8, s6, 1
v_mfma_f32_16x16x32_bf16 v[108:111], v[204:207], a[60:63], v[108:111]
s_waitcnt lgkmcnt(6)
v_mfma_f32_16x16x32_bf16 v[112:115], v[208:211], a[48:51], v[112:115]
s_lshl_b32 s9, s8, 2
ds_read_b64_tr_b16 v[204:205], v228 offset:36864
ds_read_b64_tr_b16 v[206:207], v228 offset:37376
v_mfma_f32_16x16x32_bf16 v[116:119], v[208:211], a[52:55], v[116:119]
s_add_u32 s9, s9, s5
v_mfma_f32_16x16x32_bf16 v[120:123], v[208:211], a[56:59], v[120:123]
s_lshl_b32 s10, s7, 3
v_mfma_f32_16x16x32_bf16 v[124:127], v[208:211], a[60:63], v[124:127]
s_waitcnt lgkmcnt(6)
v_mfma_f32_16x16x32_bf16 v[128:131], v[192:195], a[48:51], v[128:131]
s_add_u32 s52, s54, 32768
ds_read_b64_tr_b16 v[208:209], v229 offset:32768
ds_read_b64_tr_b16 v[210:211], v229 offset:33280
v_mfma_f32_16x16x32_bf16 v[132:135], v[192:195], a[52:55], v[132:135]
s_add_u32 s9, s9, s10
buffer_load_dwordx4 a[128:131], v250, s[28:31], s52 offen sc1
v_and_b32 v220, 1, v223
v_mfma_f32_16x16x32_bf16 v[136:139], v[192:195], a[56:59], v[136:139]
s_cmp_ge_u32 s9, 6
s_cselect_b32 s10, 4, 0
v_mfma_f32_16x16x32_bf16 v[140:143], v[192:195], a[60:63], v[140:143]
s_waitcnt lgkmcnt(6)
v_mfma_f32_16x16x32_bf16 v[144:147], v[196:199], a[48:51], v[144:147]
ds_read_b64_tr_b16 v[192:193], v229 offset:36864
ds_read_b64_tr_b16 v[194:195], v229 offset:37376
v_mfma_f32_16x16x32_bf16 v[148:151], v[196:199], a[52:55], v[148:151]
s_cmp_gt_u32 s5, 4
s_cselect_b32 s10, 15, s10
buffer_load_dwordx4 a[132:135], v251, s[28:31], s52 offen sc1
v_mfma_f32_16x16x32_bf16 v[152:155], v[196:199], a[56:59], v[152:155]
s_add_u32 s9, s9, s10
v_mfma_f32_16x16x32_bf16 v[156:159], v[196:199], a[60:63], v[156:159]
s_waitcnt vmcnt(15) lgkmcnt(6)
v_mfma_f32_16x16x32_bf16 v[32:35], v[200:203], a[64:67], v[32:35]
s_lshl_b32 s8, s8, 1
ds_read_b64_tr_b16 v[196:197], v230 offset:32768
ds_read_b64_tr_b16 v[198:199], v230 offset:33280
v_mfma_f32_16x16x32_bf16 v[36:39], v[200:203], a[68:71], v[36:39]
s_add_u32 s8, s8, s7
buffer_load_dwordx4 a[136:139], v252, s[28:31], s52 offen sc1
v_lshl_add_u32 v222, v220, 5, v222
v_mfma_f32_16x16x32_bf16 v[40:43], v[200:203], a[72:75], v[40:43]
s_add_u32 s8, s8, 6
v_mfma_f32_16x16x32_bf16 v[44:47], v[200:203], a[76:79], v[44:47]
s_waitcnt lgkmcnt(6)
v_mfma_f32_16x16x32_bf16 v[48:51], v[204:207], a[64:67], v[48:51]
ds_read_b64_tr_b16 v[200:201], v230 offset:36864
ds_read_b64_tr_b16 v[202:203], v230 offset:37376
v_mfma_f32_16x16x32_bf16 v[52:55], v[204:207], a[68:71], v[52:55]
s_cmp_eq_u32 s5, 4
s_cselect_b32 s9, s8, s9
buffer_load_dwordx4 a[140:143], v253, s[28:31], s52 offen sc1
v_mfma_f32_16x16x32_bf16 v[56:59], v[204:207], a[72:75], v[56:59]
s_lshr_b32 s6, s6, 1
v_mfma_f32_16x16x32_bf16 v[60:63], v[204:207], a[76:79], v[60:63]
s_waitcnt lgkmcnt(6)
v_mfma_f32_16x16x32_bf16 v[64:67], v[208:211], a[64:67], v[64:67]
s_mul_i32 s6, s6, 36
ds_read_b64_tr_b16 v[204:205], v231 offset:32768
ds_read_b64_tr_b16 v[206:207], v231 offset:33280
v_mfma_f32_16x16x32_bf16 v[68:71], v[208:211], a[68:71], v[68:71]
s_add_u32 s9, s9, s6
v_lshrrev_b32 v223, 1, v223
v_mfma_f32_16x16x32_bf16 v[72:75], v[208:211], a[72:75], v[72:75]
s_mul_i32 s9, s9, 4608
v_mfma_f32_16x16x32_bf16 v[76:79], v[208:211], a[76:79], v[76:79]
s_waitcnt lgkmcnt(6)
v_mfma_f32_16x16x32_bf16 v[80:83], v[192:195], a[64:67], v[80:83]
s_add_u32 s9, s9, 21495808
ds_read_b64_tr_b16 v[208:209], v231 offset:36864
ds_read_b64_tr_b16 v[210:211], v231 offset:37376
v_mfma_f32_16x16x32_bf16 v[84:87], v[192:195], a[68:71], v[84:87]
s_add_u32 s52, s54, 36864
buffer_load_dwordx4 a[144:147], v250, s[28:31], s52 offen sc1
v_mfma_f32_16x16x32_bf16 v[88:91], v[192:195], a[72:75], v[88:91]
s_cmp_lt_u32 s4, 4608
s_cselect_b32 s9, s9, 0x40000000
v_mfma_f32_16x16x32_bf16 v[92:95], v[192:195], a[76:79], v[92:95]
s_waitcnt lgkmcnt(6)
v_mfma_f32_16x16x32_bf16 v[96:99], v[196:199], a[64:67], v[96:99]
s_and_b32 s4, s4, 31
ds_read_b64_tr_b16 v[192:193], v228 offset:40960
ds_read_b64_tr_b16 v[194:195], v228 offset:41472
v_mfma_f32_16x16x32_bf16 v[100:103], v[196:199], a[68:71], v[100:103]
s_lshl_b32 s4, s4, 4
buffer_load_dwordx4 a[148:151], v251, s[28:31], s52 offen sc1
v_xor_b32 v214, s4, v241
v_mfma_f32_16x16x32_bf16 v[104:107], v[196:199], a[72:75], v[104:107]
v_lshl_add_u32 v220, v223, 4, v222
v_mfma_f32_16x16x32_bf16 v[108:111], v[196:199], a[76:79], v[108:111]
s_waitcnt lgkmcnt(6)
v_mfma_f32_16x16x32_bf16 v[112:115], v[200:203], a[64:67], v[112:115]
ds_read_b64_tr_b16 v[196:197], v228 offset:45056
ds_read_b64_tr_b16 v[198:199], v228 offset:45568
v_mfma_f32_16x16x32_bf16 v[116:119], v[200:203], a[68:71], v[116:119]
buffer_load_dwordx4 a[152:155], v252, s[28:31], s52 offen sc1
v_add_u32 v214, s9, v214
v_mfma_f32_16x16x32_bf16 v[120:123], v[200:203], a[72:75], v[120:123]
v_mfma_f32_16x16x32_bf16 v[124:127], v[200:203], a[76:79], v[124:127]
s_waitcnt lgkmcnt(6)
v_mfma_f32_16x16x32_bf16 v[128:131], v[204:207], a[64:67], v[128:131]
s_add_u32 s4, s59, 24
ds_read_b64_tr_b16 v[200:201], v229 offset:40960
ds_read_b64_tr_b16 v[202:203], v229 offset:41472
v_mfma_f32_16x16x32_bf16 v[132:135], v[204:207], a[68:71], v[132:135]
buffer_load_dwordx4 a[156:159], v253, s[28:31], s52 offen sc1
v_lshl_add_u32 v221, v223, 30, v221
v_mfma_f32_16x16x32_bf16 v[136:139], v[204:207], a[72:75], v[136:139]
v_mfma_f32_16x16x32_bf16 v[140:143], v[204:207], a[76:79], v[140:143]
s_waitcnt lgkmcnt(6)
v_mfma_f32_16x16x32_bf16 v[144:147], v[208:211], a[64:67], v[144:147]
s_lshr_b32 s5, s4, 6
ds_read_b64_tr_b16 v[204:205], v229 offset:45056
ds_read_b64_tr_b16 v[206:207], v229 offset:45568
v_mfma_f32_16x16x32_bf16 v[148:151], v[208:211], a[68:71], v[148:151]
s_mul_i32 s6, s5, 57
v_mfma_f32_16x16x32_bf16 v[152:155], v[208:211], a[72:75], v[152:155]
s_lshr_b32 s6, s6, 9
v_mfma_f32_16x16x32_bf16 v[156:159], v[208:211], a[76:79], v[156:159]
s_waitcnt vmcnt(17) lgkmcnt(6)
v_mfma_f32_16x16x32_bf16 v[32:35], v[192:195], a[80:83], v[32:35]
s_add_u32 s52, s54, 40960
ds_read_b64_tr_b16 v[208:209], v230 offset:40960
ds_read_b64_tr_b16 v[210:211], v230 offset:41472
v_mfma_f32_16x16x32_bf16 v[36:39], v[192:195], a[84:87], v[36:39]
s_mul_i32 s7, s6, 9
buffer_load_dwordx4 a[160:163], v250, s[28:31], s52 offen sc1
v_mfma_f32_16x16x32_bf16 v[40:43], v[192:195], a[88:91], v[40:43]
s_sub_u32 s5, s5, s7
v_mfma_f32_16x16x32_bf16 v[44:47], v[192:195], a[92:95], v[44:47]
s_waitcnt lgkmcnt(6)
v_mfma_f32_16x16x32_bf16 v[48:51], v[196:199], a[80:83], v[48:51]
s_bfe_u32 s7, s4, 0x10005
ds_read_b64_tr_b16 v[192:193], v230 offset:45056
ds_read_b64_tr_b16 v[194:195], v230 offset:45568
v_mfma_f32_16x16x32_bf16 v[52:55], v[196:199], a[84:87], v[52:55]
s_and_b32 s8, s6, 1
buffer_load_dwordx4 a[164:167], v251, s[28:31], s52 offen sc1
v_mfma_f32_16x16x32_bf16 v[56:59], v[196:199], a[88:91], v[56:59]
s_lshl_b32 s9, s8, 2
v_mfma_f32_16x16x32_bf16 v[60:63], v[196:199], a[92:95], v[60:63]
s_waitcnt lgkmcnt(6)
v_mfma_f32_16x16x32_bf16 v[64:67], v[200:203], a[80:83], v[64:67]
s_add_u32 s9, s9, s5
ds_read_b64_tr_b16 v[196:197], v231 offset:40960
ds_read_b64_tr_b16 v[198:199], v231 offset:41472
v_mfma_f32_16x16x32_bf16 v[68:71], v[200:203], a[84:87], v[68:71]
s_lshl_b32 s10, s7, 3
buffer_load_dwordx4 a[168:171], v252, s[28:31], s52 offen sc1
v_mfma_f32_16x16x32_bf16 v[72:75], v[200:203], a[88:91], v[72:75]
s_add_u32 s9, s9, s10
v_mfma_f32_16x16x32_bf16 v[76:79], v[200:203], a[92:95], v[76:79]
s_waitcnt lgkmcnt(6)
v_mfma_f32_16x16x32_bf16 v[80:83], v[204:207], a[80:83], v[80:83]
ds_read_b64_tr_b16 v[200:201], v231 offset:45056
ds_read_b64_tr_b16 v[202:203], v231 offset:45568
v_mfma_f32_16x16x32_bf16 v[84:87], v[204:207], a[84:87], v[84:87]
s_cmp_ge_u32 s9, 6
s_cselect_b32 s10, 4, 0
buffer_load_dwordx4 a[172:175], v253, s[28:31], s52 offen sc1
v_mfma_f32_16x16x32_bf16 v[88:91], v[204:207], a[88:91], v[88:91]
s_cmp_gt_u32 s5, 4
s_cselect_b32 s10, 15, s10
v_mfma_f32_16x16x32_bf16 v[92:95], v[204:207], a[92:95], v[92:95]
s_waitcnt lgkmcnt(6)
v_mfma_f32_16x16x32_bf16 v[96:99], v[208:211], a[80:83], v[96:99]
s_add_u32 s9, s9, s10
ds_read_b64_tr_b16 v[204:205], v228 offset:49152
ds_read_b64_tr_b16 v[206:207], v228 offset:49664
v_mfma_f32_16x16x32_bf16 v[100:103], v[208:211], a[84:87], v[100:103]
s_lshl_b32 s8, s8, 1
v_mfma_f32_16x16x32_bf16 v[104:107], v[208:211], a[88:91], v[104:107]
s_add_u32 s8, s8, s7
v_mfma_f32_16x16x32_bf16 v[108:111], v[208:211], a[92:95], v[108:111]
s_waitcnt lgkmcnt(6)
v_mfma_f32_16x16x32_bf16 v[112:115], v[192:195], a[80:83], v[112:115]
s_add_u32 s52, s54, 45056
ds_read_b64_tr_b16 v[208:209], v228 offset:53248
ds_read_b64_tr_b16 v[210:211], v228 offset:53760
v_mfma_f32_16x16x32_bf16 v[116:119], v[192:195], a[84:87], v[116:119]
s_add_u32 s8, s8, 6
buffer_load_dwordx4 a[176:179], v250, s[28:31], s52 offen sc1
v_mfma_f32_16x16x32_bf16 v[120:123], v[192:195], a[88:91], v[120:123]
s_cmp_eq_u32 s5, 4
s_cselect_b32 s9, s8, s9
v_mfma_f32_16x16x32_bf16 v[124:127], v[192:195], a[92:95], v[124:127]
s_waitcnt lgkmcnt(6)
v_mfma_f32_16x16x32_bf16 v[128:131], v[196:199], a[80:83], v[128:131]
s_lshr_b32 s6, s6, 1
ds_read_b64_tr_b16 v[192:193], v229 offset:49152
ds_read_b64_tr_b16 v[194:195], v229 offset:49664
v_mfma_f32_16x16x32_bf16 v[132:135], v[196:199], a[84:87], v[132:135]
s_mul_i32 s6, s6, 36
buffer_load_dwordx4 a[180:183], v251, s[28:31], s52 offen sc1
v_mfma_f32_16x16x32_bf16 v[136:139], v[196:199], a[88:91], v[136:139]
s_add_u32 s9, s9, s6
v_mfma_f32_16x16x32_bf16 v[140:143], v[196:199], a[92:95], v[140:143]
s_waitcnt lgkmcnt(6)
v_mfma_f32_16x16x32_bf16 v[144:147], v[200:203], a[80:83], v[144:147]
s_mul_i32 s9, s9, 4608
ds_read_b64_tr_b16 v[196:197], v229 offset:53248
ds_read_b64_tr_b16 v[198:199], v229 offset:53760
v_mfma_f32_16x16x32_bf16 v[148:151], v[200:203], a[84:87], v[148:151]
s_add_u32 s9, s9, 21495808
buffer_load_dwordx4 a[184:187], v252, s[28:31], s52 offen sc1
v_mfma_f32_16x16x32_bf16 v[152:155], v[200:203], a[88:91], v[152:155]
s_cmp_lt_u32 s4, 4608
s_cselect_b32 s9, s9, 0x40000000
v_mfma_f32_16x16x32_bf16 v[156:159], v[200:203], a[92:95], v[156:159]
s_waitcnt vmcnt(19) lgkmcnt(6)
v_mfma_f32_16x16x32_bf16 v[32:35], v[204:207], a[96:99], v[32:35]
s_and_b32 s4, s4, 31
ds_read_b64_tr_b16 v[200:201], v230 offset:49152
ds_read_b64_tr_b16 v[202:203], v230 offset:49664
v_mfma_f32_16x16x32_bf16 v[36:39], v[204:207], a[100:103], v[36:39]
s_lshl_b32 s4, s4, 4
buffer_load_dwordx4 a[188:191], v253, s[28:31], s52 offen sc1
v_xor_b32 v215, s4, v241
v_mfma_f32_16x16x32_bf16 v[40:43], v[204:207], a[104:107], v[40:43]
v_mfma_f32_16x16x32_bf16 v[44:47], v[204:207], a[108:111], v[44:47]
s_waitcnt lgkmcnt(6)
v_mfma_f32_16x16x32_bf16 v[48:51], v[208:211], a[96:99], v[48:51]
ds_read_b64_tr_b16 v[204:205], v230 offset:53248
ds_read_b64_tr_b16 v[206:207], v230 offset:53760
v_mfma_f32_16x16x32_bf16 v[52:55], v[208:211], a[100:103], v[52:55]
v_add_u32 v215, s9, v215
v_mfma_f32_16x16x32_bf16 v[56:59], v[208:211], a[104:107], v[56:59]
v_mfma_f32_16x16x32_bf16 v[60:63], v[208:211], a[108:111], v[60:63]
s_waitcnt lgkmcnt(6)
v_mfma_f32_16x16x32_bf16 v[64:67], v[192:195], a[96:99], v[64:67]
s_add_u32 s52, s54, 49152
ds_read_b64_tr_b16 v[208:209], v231 offset:49152
ds_read_b64_tr_b16 v[210:211], v231 offset:49664
v_mfma_f32_16x16x32_bf16 v[68:71], v[192:195], a[100:103], v[68:71]
buffer_load_dwordx4 a[192:195], v250, s[28:31], s52 offen sc1
v_mfma_f32_16x16x32_bf16 v[72:75], v[192:195], a[104:107], v[72:75]
v_mfma_f32_16x16x32_bf16 v[76:79], v[192:195], a[108:111], v[76:79]
s_waitcnt lgkmcnt(6)
v_mfma_f32_16x16x32_bf16 v[80:83], v[196:199], a[96:99], v[80:83]
s_add_u32 s4, s59, 32
ds_read_b64_tr_b16 v[192:193], v231 offset:53248
ds_read_b64_tr_b16 v[194:195], v231 offset:53760
v_mfma_f32_16x16x32_bf16 v[84:87], v[196:199], a[100:103], v[84:87]
s_lshr_b32 s5, s4, 6
buffer_load_dwordx4 a[196:199], v251, s[28:31], s52 offen sc1
v_mfma_f32_16x16x32_bf16 v[88:91], v[196:199], a[104:107], v[88:91]
s_mul_i32 s6, s5, 57
v_mfma_f32_16x16x32_bf16 v[92:95], v[196:199], a[108:111], v[92:95]
s_waitcnt lgkmcnt(6)
v_mfma_f32_16x16x32_bf16 v[96:99], v[200:203], a[96:99], v[96:99]
s_lshr_b32 s6, s6, 9
ds_read_b64_tr_b16 v[196:197], v228 offset:57344
ds_read_b64_tr_b16 v[198:199], v228 offset:57856
v_mfma_f32_16x16x32_bf16 v[100:103], v[200:203], a[100:103], v[100:103]
s_mul_i32 s7, s6, 9
buffer_load_dwordx4 a[200:203], v252, s[28:31], s52 offen sc1
global_load_dword v246, v245, s[62:63] sc1
v_mfma_f32_16x16x32_bf16 v[104:107], v[200:203], a[104:107], v[104:107]
s_sub_u32 s5, s5, s7
v_mfma_f32_16x16x32_bf16 v[108:111], v[200:203], a[108:111], v[108:111]
s_waitcnt lgkmcnt(6)
v_mfma_f32_16x16x32_bf16 v[112:115], v[204:207], a[96:99], v[112:115]
s_bfe_u32 s7, s4, 0x10005
ds_read_b64_tr_b16 v[200:201], v228 offset:61440
ds_read_b64_tr_b16 v[202:203], v228 offset:61952
v_mfma_f32_16x16x32_bf16 v[116:119], v[204:207], a[100:103], v[116:119]
s_and_b32 s8, s6, 1
buffer_load_dwordx4 a[204:207], v253, s[28:31], s52 offen sc1
v_mfma_f32_16x16x32_bf16 v[120:123], v[204:207], a[104:107], v[120:123]
s_lshl_b32 s9, s8, 2
v_mfma_f32_16x16x32_bf16 v[124:127], v[204:207], a[108:111], v[124:127]
s_waitcnt lgkmcnt(6)
v_mfma_f32_16x16x32_bf16 v[128:131], v[208:211], a[96:99], v[128:131]
s_add_u32 s9, s9, s5
ds_read_b64_tr_b16 v[204:205], v229 offset:57344
ds_read_b64_tr_b16 v[206:207], v229 offset:57856
v_mfma_f32_16x16x32_bf16 v[132:135], v[208:211], a[100:103], v[132:135]
s_lshl_b32 s10, s7, 3
v_mfma_f32_16x16x32_bf16 v[136:139], v[208:211], a[104:107], v[136:139]
TCH_1_v0:
s_cbranch_execz TCH_5_v0
s_add_u32 s9, s9, s10
v_mfma_f32_16x16x32_bf16 v[140:143], v[208:211], a[108:111], v[140:143]
s_waitcnt lgkmcnt(6)
v_mfma_f32_16x16x32_bf16 v[144:147], v[192:195], a[96:99], v[144:147]
s_add_u32 s52, s54, 53248
ds_read_b64_tr_b16 v[208:209], v229 offset:61440
ds_read_b64_tr_b16 v[210:211], v229 offset:61952
v_mfma_f32_16x16x32_bf16 v[148:151], v[192:195], a[100:103], v[148:151]
s_cmp_ge_u32 s9, 6
s_cselect_b32 s10, 4, 0
buffer_load_dwordx4 a[208:211], v250, s[28:31], s52 offen sc1
v_mfma_f32_16x16x32_bf16 v[152:155], v[192:195], a[104:107], v[152:155]
s_cmp_gt_u32 s5, 4
s_cselect_b32 s10, 15, s10
v_mfma_f32_16x16x32_bf16 v[156:159], v[192:195], a[108:111], v[156:159]
s_waitcnt vmcnt(22) lgkmcnt(6)
v_mfma_f32_16x16x32_bf16 v[32:35], v[196:199], a[112:115], v[32:35]
s_add_u32 s9, s9, s10
ds_read_b64_tr_b16 v[192:193], v230 offset:57344
ds_read_b64_tr_b16 v[194:195], v230 offset:57856
v_mfma_f32_16x16x32_bf16 v[36:39], v[196:199], a[116:119], v[36:39]
s_lshl_b32 s8, s8, 1
buffer_load_dwordx4 a[212:215], v251, s[28:31], s52 offen sc1
v_mfma_f32_16x16x32_bf16 v[40:43], v[196:199], a[120:123], v[40:43]
s_add_u32 s8, s8, s7
v_mfma_f32_16x16x32_bf16 v[44:47], v[196:199], a[124:127], v[44:47]
s_waitcnt lgkmcnt(6)
v_mfma_f32_16x16x32_bf16 v[48:51], v[200:203], a[112:115], v[48:51]
s_add_u32 s8, s8, 6
ds_read_b64_tr_b16 v[196:197], v230 offset:61440
ds_read_b64_tr_b16 v[198:199], v230 offset:61952
v_mfma_f32_16x16x32_bf16 v[52:55], v[200:203], a[116:119], v[52:55]
s_cmp_eq_u32 s5, 4
s_cselect_b32 s9, s8, s9
buffer_load_dwordx4 a[216:219], v252, s[28:31], s52 offen sc1
v_mfma_f32_16x16x32_bf16 v[56:59], v[200:203], a[120:123], v[56:59]
v_mfma_f32_16x16x32_bf16 v[60:63], v[200:203], a[124:127], v[60:63]
s_waitcnt lgkmcnt(6)
v_mfma_f32_16x16x32_bf16 v[64:67], v[204:207], a[112:115], v[64:67]
s_lshr_b32 s6, s6, 1
ds_read_b64_tr_b16 v[200:201], v231 offset:57344
ds_read_b64_tr_b16 v[202:203], v231 offset:57856
v_mfma_f32_16x16x32_bf16 v[68:71], v[204:207], a[116:119], v[68:71]
s_mul_i32 s6, s6, 36
buffer_load_dwordx4 a[220:223], v253, s[28:31], s52 offen sc1
v_mfma_f32_16x16x32_bf16 v[72:75], v[204:207], a[120:123], v[72:75]
s_add_u32 s9, s9, s6
v_mfma_f32_16x16x32_bf16 v[76:79], v[204:207], a[124:127], v[76:79]
s_waitcnt lgkmcnt(6)
v_mfma_f32_16x16x32_bf16 v[80:83], v[208:211], a[112:115], v[80:83]
s_mul_i32 s9, s9, 4608
ds_read_b64_tr_b16 v[204:205], v231 offset:61440
ds_read_b64_tr_b16 v[206:207], v231 offset:61952
v_mfma_f32_16x16x32_bf16 v[84:87], v[208:211], a[116:119], v[84:87]
s_add_u32 s9, s9, 21495808
v_add_u32 v228, 65536, v228
v_mfma_f32_16x16x32_bf16 v[88:91], v[208:211], a[120:123], v[88:91]
s_cmp_lt_u32 s4, 4608
s_cselect_b32 s9, s9, 0x40000000
v_mfma_f32_16x16x32_bf16 v[92:95], v[208:211], a[124:127], v[92:95]
s_waitcnt lgkmcnt(6)
v_mfma_f32_16x16x32_bf16 v[96:99], v[192:195], a[112:115], v[96:99]
s_add_u32 s52, s54, 57344
ds_read_b64_tr_b16 v[208:209], v228 offset:0
ds_read_b64_tr_b16 v[210:211], v228 offset:512
v_mfma_f32_16x16x32_bf16 v[100:103], v[192:195], a[116:119], v[100:103]
s_and_b32 s4, s4, 31
buffer_load_dwordx4 a[224:227], v250, s[28:31], s52 offen sc1
v_mfma_f32_16x16x32_bf16 v[104:107], v[192:195], a[120:123], v[104:107]
s_lshl_b32 s4, s4, 4
v_mfma_f32_16x16x32_bf16 v[108:111], v[192:195], a[124:127], v[108:111]
s_waitcnt lgkmcnt(6)
v_mfma_f32_16x16x32_bf16 v[112:115], v[196:199], a[112:115], v[112:115]
ds_read_b64_tr_b16 v[192:193], v228 offset:4096
ds_read_b64_tr_b16 v[194:195], v228 offset:4608
v_mfma_f32_16x16x32_bf16 v[116:119], v[196:199], a[116:119], v[116:119]
v_add_u32 v229, 65536, v229
v_xor_b32 v216, s4, v241
v_mfma_f32_16x16x32_bf16 v[120:123], v[196:199], a[120:123], v[120:123]
buffer_load_dwordx4 a[228:231], v251, s[28:31], s52 offen sc1
v_mfma_f32_16x16x32_bf16 v[124:127], v[196:199], a[124:127], v[124:127]
s_waitcnt lgkmcnt(6)
v_mfma_f32_16x16x32_bf16 v[128:131], v[200:203], a[112:115], v[128:131]
ds_read_b64_tr_b16 v[196:197], v229 offset:0
ds_read_b64_tr_b16 v[198:199], v229 offset:512
v_mfma_f32_16x16x32_bf16 v[132:135], v[200:203], a[116:119], v[132:135]
buffer_load_dwordx4 a[232:235], v252, s[28:31], s52 offen sc1
v_add_u32 v216, s9, v216
v_mfma_f32_16x16x32_bf16 v[136:139], v[200:203], a[120:123], v[136:139]
v_mfma_f32_16x16x32_bf16 v[140:143], v[200:203], a[124:127], v[140:143]
s_waitcnt lgkmcnt(6)
v_mfma_f32_16x16x32_bf16 v[144:147], v[204:207], a[112:115], v[144:147]
s_add_u32 s4, s59, 40
ds_read_b64_tr_b16 v[200:201], v229 offset:4096
ds_read_b64_tr_b16 v[202:203], v229 offset:4608
v_mfma_f32_16x16x32_bf16 v[148:151], v[204:207], a[116:119], v[148:151]
s_lshr_b32 s5, s4, 6
v_add_u32 v230, 65536, v230
v_mfma_f32_16x16x32_bf16 v[152:155], v[204:207], a[120:123], v[152:155]
s_mul_i32 s6, s5, 57
buffer_load_dwordx4 a[236:239], v253, s[28:31], s52 offen sc1
v_mfma_f32_16x16x32_bf16 v[156:159], v[204:207], a[124:127], v[156:159]
s_waitcnt vmcnt(25) lgkmcnt(6)
v_mfma_f32_16x16x32_bf16 v[32:35], v[208:211], a[128:131], v[32:35]
s_lshr_b32 s6, s6, 9
ds_read_b64_tr_b16 v[204:205], v230 offset:0
ds_read_b64_tr_b16 v[206:207], v230 offset:512
v_mfma_f32_16x16x32_bf16 v[36:39], v[208:211], a[132:135], v[36:39]
s_mul_i32 s7, s6, 9
v_mfma_f32_16x16x32_bf16 v[40:43], v[208:211], a[136:139], v[40:43]
s_sub_u32 s5, s5, s7
v_mfma_f32_16x16x32_bf16 v[44:47], v[208:211], a[140:143], v[44:47]
s_waitcnt lgkmcnt(6)
v_mfma_f32_16x16x32_bf16 v[48:51], v[192:195], a[128:131], v[48:51]
s_add_u32 s52, s54, 61440
ds_read_b64_tr_b16 v[208:209], v230 offset:4096
ds_read_b64_tr_b16 v[210:211], v230 offset:4608
v_mfma_f32_16x16x32_bf16 v[52:55], v[192:195], a[132:135], v[52:55]
s_bfe_u32 s7, s4, 0x10005
v_add_u32 v231, 65536, v231
v_mfma_f32_16x16x32_bf16 v[56:59], v[192:195], a[136:139], v[56:59]
s_and_b32 s8, s6, 1
buffer_load_dwordx4 a[240:243], v250, s[28:31], s52 offen sc1
v_mfma_f32_16x16x32_bf16 v[60:63], v[192:195], a[140:143], v[60:63]
s_waitcnt lgkmcnt(6)
v_mfma_f32_16x16x32_bf16 v[64:67], v[196:199], a[128:131], v[64:67]
s_lshl_b32 s9, s8, 2
ds_read_b64_tr_b16 v[192:193], v231 offset:0
ds_read_b64_tr_b16 v[194:195], v231 offset:512
v_mfma_f32_16x16x32_bf16 v[68:71], v[196:199], a[132:135], v[68:71]
s_add_u32 s9, s9, s5
buffer_load_dwordx4 a[244:247], v251, s[28:31], s52 offen sc1
v_mfma_f32_16x16x32_bf16 v[72:75], v[196:199], a[136:139], v[72:75]
s_lshl_b32 s10, s7, 3
v_mfma_f32_16x16x32_bf16 v[76:79], v[196:199], a[140:143], v[76:79]
s_waitcnt lgkmcnt(6)
v_mfma_f32_16x16x32_bf16 v[80:83], v[200:203], a[128:131], v[80:83]
s_add_u32 s9, s9, s10
ds_read_b64_tr_b16 v[196:197], v231 offset:4096
ds_read_b64_tr_b16 v[198:199], v231 offset:4608
v_mfma_f32_16x16x32_bf16 v[84:87], v[200:203], a[132:135], v[84:87]
s_cmp_ge_u32 s9, 6
s_cselect_b32 s10, 4, 0
buffer_load_dwordx4 a[248:251], v252, s[28:31], s52 offen sc1
v_mfma_f32_16x16x32_bf16 v[88:91], v[200:203], a[136:139], v[88:91]
s_waitcnt vmcnt(12)
v_cmp_gt_u32 vcc, 32, v246
v_mfma_f32_16x16x32_bf16 v[92:95], v[200:203], a[140:143], v[92:95]
s_waitcnt lgkmcnt(6)
v_mfma_f32_16x16x32_bf16 v[96:99], v[204:207], a[128:131], v[96:99]
ds_read_b64_tr_b16 v[200:201], v228 offset:8192
ds_read_b64_tr_b16 v[202:203], v228 offset:8704
v_mfma_f32_16x16x32_bf16 v[100:103], v[204:207], a[132:135], v[100:103]
s_cbranch_vccnz spin_2_v0
ok_1_v0:
v_mfma_f32_16x16x32_bf16 v[104:107], v[204:207], a[136:139], v[104:107]
s_cmp_gt_u32 s5, 4
s_cselect_b32 s10, 15, s10
buffer_load_dwordx4 a[252:255], v253, s[28:31], s52 offen sc1
v_mfma_f32_16x16x32_bf16 v[108:111], v[204:207], a[140:143], v[108:111]
s_waitcnt lgkmcnt(6)
v_mfma_f32_16x16x32_bf16 v[112:115], v[208:211], a[128:131], v[112:115]
s_add_u32 s9, s9, s10
ds_read_b64_tr_b16 v[204:205], v228 offset:12288
ds_read_b64_tr_b16 v[206:207], v228 offset:12800
v_mfma_f32_16x16x32_bf16 v[116:119], v[208:211], a[132:135], v[116:119]
s_lshl_b32 s8, s8, 1
v_mfma_f32_16x16x32_bf16 v[120:123], v[208:211], a[136:139], v[120:123]
s_add_u32 s8, s8, s7
v_mfma_f32_16x16x32_bf16 v[124:127], v[208:211], a[140:143], v[124:127]
s_waitcnt lgkmcnt(6)
v_mfma_f32_16x16x32_bf16 v[128:131], v[192:195], a[128:131], v[128:131]
s_add_u32 s8, s8, 6
ds_read_b64_tr_b16 v[208:209], v229 offset:8192
ds_read_b64_tr_b16 v[210:211], v229 offset:8704
v_mfma_f32_16x16x32_bf16 v[132:135], v[192:195], a[132:135], v[132:135]
s_cmp_eq_u32 s5, 4
s_cselect_b32 s9, s8, s9
v_mfma_f32_16x16x32_bf16 v[136:139], v[192:195], a[136:139], v[136:139]
s_add_u32 s52, s54, 65536
buffer_load_dwordx4 v[0:3], v250, s[28:31], s52 offen sc1
v_mfma_f32_16x16x32_bf16 v[140:143], v[192:195], a[140:143], v[140:143]
s_waitcnt lgkmcnt(6)
v_mfma_f32_16x16x32_bf16 v[144:147], v[196:199], a[128:131], v[144:147]
s_lshr_b32 s6, s6, 1
ds_read_b64_tr_b16 v[192:193], v229 offset:12288
ds_read_b64_tr_b16 v[194:195], v229 offset:12800
v_mfma_f32_16x16x32_bf16 v[148:151], v[196:199], a[132:135], v[148:151]
s_mul_i32 s6, s6, 36
buffer_load_dwordx4 v[4:7], v251, s[28:31], s52 offen sc1
v_mfma_f32_16x16x32_bf16 v[152:155], v[196:199], a[136:139], v[152:155]
s_add_u32 s9, s9, s6
v_mfma_f32_16x16x32_bf16 v[156:159], v[196:199], a[140:143], v[156:159]
s_waitcnt vmcnt(27) lgkmcnt(6)
v_mfma_f32_16x16x32_bf16 v[32:35], v[200:203], a[144:147], v[32:35]
s_mul_i32 s9, s9, 4608
ds_read_b64_tr_b16 v[196:197], v230 offset:8192
ds_read_b64_tr_b16 v[198:199], v230 offset:8704
v_mfma_f32_16x16x32_bf16 v[36:39], v[200:203], a[148:151], v[36:39]
s_add_u32 s9, s9, 21495808
buffer_load_dwordx4 v[8:11], v252, s[28:31], s52 offen sc1
v_mfma_f32_16x16x32_bf16 v[40:43], v[200:203], a[152:155], v[40:43]
s_cmp_lt_u32 s4, 4608
s_cselect_b32 s9, s9, 0x40000000
v_mfma_f32_16x16x32_bf16 v[44:47], v[200:203], a[156:159], v[44:47]
s_waitcnt lgkmcnt(6)
v_mfma_f32_16x16x32_bf16 v[48:51], v[204:207], a[144:147], v[48:51]
s_and_b32 s4, s4, 31
ds_read_b64_tr_b16 v[200:201], v230 offset:12288
ds_read_b64_tr_b16 v[202:203], v230 offset:12800
v_mfma_f32_16x16x32_bf16 v[52:55], v[204:207], a[148:151], v[52:55]
s_lshl_b32 s4, s4, 4
buffer_load_dwordx4 v[12:15], v253, s[28:31], s52 offen sc1
v_xor_b32 v217, s4, v241
v_mfma_f32_16x16x32_bf16 v[56:59], v[204:207], a[152:155], v[56:59]
v_mfma_f32_16x16x32_bf16 v[60:63], v[204:207], a[156:159], v[60:63]
s_waitcnt lgkmcnt(6)
v_mfma_f32_16x16x32_bf16 v[64:67], v[208:211], a[144:147], v[64:67]
ds_read_b64_tr_b16 v[204:205], v231 offset:8192
ds_read_b64_tr_b16 v[206:207], v231 offset:8704
v_mfma_f32_16x16x32_bf16 v[68:71], v[208:211], a[148:151], v[68:71]
v_add_u32 v217, s9, v217
v_mfma_f32_16x16x32_bf16 v[72:75], v[208:211], a[152:155], v[72:75]
v_mfma_f32_16x16x32_bf16 v[76:79], v[208:211], a[156:159], v[76:79]
s_waitcnt lgkmcnt(6)
v_mfma_f32_16x16x32_bf16 v[80:83], v[192:195], a[144:147], v[80:83]
s_add_u32 s52, s54, 69632
ds_read_b64_tr_b16 v[208:209], v231 offset:12288
ds_read_b64_tr_b16 v[210:211], v231 offset:12800
v_mfma_f32_16x16x32_bf16 v[84:87], v[192:195], a[148:151], v[84:87]
s_add_u32 s4, s59, 48
buffer_load_dwordx4 v[16:19], v250, s[28:31], s52 offen sc1
v_mfma_f32_16x16x32_bf16 v[88:91], v[192:195], a[152:155], v[88:91]
s_waitcnt vmcnt(46)
s_barrier
v_mov_b32 v238, 1
buffer_store_dword v238, off, s[40:43], s60 offset:0 sc1
v_mfma_f32_16x16x32_bf16 v[92:95], v[192:195], a[156:159], v[92:95]
s_waitcnt lgkmcnt(6)
v_mfma_f32_16x16x32_bf16 v[96:99], v[196:199], a[144:147], v[96:99]
s_lshr_b32 s5, s4, 6
ds_read_b64_tr_b16 v[192:193], v228 offset:16384
ds_read_b64_tr_b16 v[194:195], v228 offset:16896
v_mfma_f32_16x16x32_bf16 v[100:103], v[196:199], a[148:151], v[100:103]
s_mul_i32 s6, s5, 57
buffer_load_dwordx4 v[20:23], v251, s[28:31], s52 offen sc1
v_mfma_f32_16x16x32_bf16 v[104:107], v[196:199], a[152:155], v[104:107]
s_lshr_b32 s6, s6, 9
v_mfma_f32_16x16x32_bf16 v[108:111], v[196:199], a[156:159], v[108:111]
s_waitcnt lgkmcnt(6)
v_mfma_f32_16x16x32_bf16 v[112:115], v[200:203], a[144:147], v[112:115]
s_mul_i32 s7, s6, 9
ds_read_b64_tr_b16 v[196:197], v228 offset:20480
ds_read_b64_tr_b16 v[198:199], v228 offset:20992
v_mfma_f32_16x16x32_bf16 v[116:119], v[200:203], a[148:151], v[116:119]
s_sub_u32 s5, s5, s7
buffer_load_dwordx4 v[24:27], v252, s[28:31], s52 offen sc1
v_mfma_f32_16x16x32_bf16 v[120:123], v[200:203], a[152:155], v[120:123]
s_bfe_u32 s7, s4, 0x10005
v_mfma_f32_16x16x32_bf16 v[124:127], v[200:203], a[156:159], v[124:127]
s_waitcnt lgkmcnt(6)
v_mfma_f32_16x16x32_bf16 v[128:131], v[204:207], a[144:147], v[128:131]
s_and_b32 s8, s6, 1
ds_read_b64_tr_b16 v[200:201], v229 offset:16384
ds_read_b64_tr_b16 v[202:203], v229 offset:16896
v_mfma_f32_16x16x32_bf16 v[132:135], v[204:207], a[148:151], v[132:135]
s_lshl_b32 s9, s8, 2
buffer_load_dwordx4 v[28:31], v253, s[28:31], s52 offen sc1
v_mfma_f32_16x16x32_bf16 v[136:139], v[204:207], a[152:155], v[136:139]
s_add_u32 s9, s9, s5
v_mfma_f32_16x16x32_bf16 v[140:143], v[204:207], a[156:159], v[140:143]
s_waitcnt lgkmcnt(6)
v_mfma_f32_16x16x32_bf16 v[144:147], v[208:211], a[144:147], v[144:147]
s_lshl_b32 s10, s7, 3
ds_read_b64_tr_b16 v[204:205], v229 offset:20480
ds_read_b64_tr_b16 v[206:207], v229 offset:20992
v_mfma_f32_16x16x32_bf16 v[148:151], v[208:211], a[148:151], v[148:151]
s_add_u32 s9, s9, s10
v_mfma_f32_16x16x32_bf16 v[152:155], v[208:211], a[152:155], v[152:155]
s_cmp_ge_u32 s9, 6
s_cselect_b32 s10, 4, 0
v_mfma_f32_16x16x32_bf16 v[156:159], v[208:211], a[156:159], v[156:159]
s_waitcnt vmcnt(30) lgkmcnt(6)
v_mfma_f32_16x16x32_bf16 v[32:35], v[192:195], a[160:163], v[32:35]
ds_read_b64_tr_b16 v[208:209], v230 offset:16384
ds_read_b64_tr_b16 v[210:211], v230 offset:16896
v_mfma_f32_16x16x32_bf16 v[36:39], v[192:195], a[164:167], v[36:39]
s_cmp_gt_u32 s5, 4
s_cselect_b32 s10, 15, s10
v_mfma_f32_16x16x32_bf16 v[40:43], v[192:195], a[168:171], v[40:43]
s_add_u32 s9, s9, s10
v_mfma_f32_16x16x32_bf16 v[44:47], v[192:195], a[172:175], v[44:47]
s_waitcnt lgkmcnt(6)
v_mfma_f32_16x16x32_bf16 v[48:51], v[196:199], a[160:163], v[48:51]
s_lshl_b32 s8, s8, 1
ds_read_b64_tr_b16 v[192:193], v230 offset:20480
ds_read_b64_tr_b16 v[194:195], v230 offset:20992
v_mfma_f32_16x16x32_bf16 v[52:55], v[196:199], a[164:167], v[52:55]
s_add_u32 s8, s8, s7
buffer_load_dword v243, v243, s[20:23], 0 offen
v_mfma_f32_16x16x32_bf16 v[56:59], v[196:199], a[168:171], v[56:59]
s_add_u32 s8, s8, 6
v_mfma_f32_16x16x32_bf16 v[60:63], v[196:199], a[172:175], v[60:63]
s_waitcnt lgkmcnt(6)
v_mfma_f32_16x16x32_bf16 v[64:67], v[200:203], a[160:163], v[64:67]
s_add_u32 m0, s49, 147456
ds_read_b64_tr_b16 v[196:197], v231 offset:16384
ds_read_b64_tr_b16 v[198:199], v231 offset:16896
v_mfma_f32_16x16x32_bf16 v[68:71], v[200:203], a[164:167], v[68:71]
s_add_u32 s50, s95, 0
buffer_load_dwordx4 v240, s[24:27], s50 offen lds
v_mfma_f32_16x16x32_bf16 v[72:75], v[200:203], a[168:171], v[72:75]
s_cmp_eq_u32 s5, 4
s_cselect_b32 s9, s8, s9
v_mfma_f32_16x16x32_bf16 v[76:79], v[200:203], a[172:175], v[76:79]
s_waitcnt lgkmcnt(6)
v_mfma_f32_16x16x32_bf16 v[80:83], v[204:207], a[160:163], v[80:83]
s_lshr_b32 s6, s6, 1
ds_read_b64_tr_b16 v[200:201], v231 offset:20480
ds_read_b64_tr_b16 v[202:203], v231 offset:20992
v_mfma_f32_16x16x32_bf16 v[84:87], v[204:207], a[164:167], v[84:87]
s_mul_i32 s6, s6, 36
v_mfma_f32_16x16x32_bf16 v[88:91], v[204:207], a[168:171], v[88:91]
s_add_u32 s9, s9, s6
v_mfma_f32_16x16x32_bf16 v[92:95], v[204:207], a[172:175], v[92:95]
s_waitcnt lgkmcnt(6)
v_mfma_f32_16x16x32_bf16 v[96:99], v[208:211], a[160:163], v[96:99]
s_mul_i32 s9, s9, 4608
ds_read_b64_tr_b16 v[204:205], v228 offset:24576
ds_read_b64_tr_b16 v[206:207], v228 offset:25088
v_mfma_f32_16x16x32_bf16 v[100:103], v[208:211], a[164:167], v[100:103]
s_add_u32 s9, s9, 21495808
v_mfma_f32_16x16x32_bf16 v[104:107], v[208:211], a[168:171], v[104:107]
s_add_u32 m0, s49, 151552
v_mfma_f32_16x16x32_bf16 v[108:111], v[208:211], a[172:175], v[108:111]
s_waitcnt lgkmcnt(6)
v_mfma_f32_16x16x32_bf16 v[112:115], v[192:195], a[160:163], v[112:115]
s_add_u32 s50, s95, 9216
ds_read_b64_tr_b16 v[208:209], v228 offset:28672
ds_read_b64_tr_b16 v[210:211], v228 offset:29184
v_mfma_f32_16x16x32_bf16 v[116:119], v[192:195], a[164:167], v[116:119]
s_cmp_lt_u32 s4, 4608
s_cselect_b32 s9, s9, 0x40000000
buffer_load_dwordx4 v240, s[24:27], s50 offen lds
v_mfma_f32_16x16x32_bf16 v[120:123], v[192:195], a[168:171], v[120:123]
s_and_b32 s4, s4, 31
v_mfma_f32_16x16x32_bf16 v[124:127], v[192:195], a[172:175], v[124:127]
s_waitcnt lgkmcnt(6)
v_mfma_f32_16x16x32_bf16 v[128:131], v[196:199], a[160:163], v[128:131]
s_add_u32 m0, s49, 155648
ds_read_b64_tr_b16 v[192:193], v229 offset:24576
ds_read_b64_tr_b16 v[194:195], v229 offset:25088
v_mfma_f32_16x16x32_bf16 v[132:135], v[196:199], a[164:167], v[132:135]
s_add_u32 s50, s95, 18432
buffer_load_dwordx4 v240, s[24:27], s50 offen lds
v_mfma_f32_16x16x32_bf16 v[136:139], v[196:199], a[168:171], v[136:139]
s_lshl_b32 s4, s4, 4
v_xor_b32 v218, s4, v241
v_add_u32 v218, s9, v218
v_mfma_f32_16x16x32_bf16 v[140:143], v[196:199], a[172:175], v[140:143]
s_waitcnt lgkmcnt(6)
v_mfma_f32_16x16x32_bf16 v[144:147], v[200:203], a[160:163], v[144:147]
s_add_u32 m0, s49, 159744
ds_read_b64_tr_b16 v[196:197], v229 offset:28672
ds_read_b64_tr_b16 v[198:199], v229 offset:29184
v_mfma_f32_16x16x32_bf16 v[148:151], v[200:203], a[164:167], v[148:151]
s_add_u32 s50, s95, 27648
buffer_load_dwordx4 v240, s[24:27], s50 offen lds
v_mfma_f32_16x16x32_bf16 v[152:155], v[200:203], a[168:171], v[152:155]
s_add_u32 s4, s59, 56
v_mfma_f32_16x16x32_bf16 v[156:159], v[200:203], a[172:175], v[156:159]
s_waitcnt vmcnt(31) lgkmcnt(6)
v_mfma_f32_16x16x32_bf16 v[32:35], v[204:207], a[176:179], v[32:35]
s_add_u32 m0, s49, 77824
ds_read_b64_tr_b16 v[200:201], v230 offset:24576
ds_read_b64_tr_b16 v[202:203], v230 offset:25088
v_mfma_f32_16x16x32_bf16 v[36:39], v[204:207], a[180:183], v[36:39]
s_add_u32 s50, s95, 36864
buffer_load_dwordx4 v240, s[24:27], s50 offen lds
v_mfma_f32_16x16x32_bf16 v[40:43], v[204:207], a[184:187], v[40:43]
s_lshr_b32 s5, s4, 6
v_mfma_f32_16x16x32_bf16 v[44:47], v[204:207], a[188:191], v[44:47]
s_waitcnt lgkmcnt(6)
v_mfma_f32_16x16x32_bf16 v[48:51], v[208:211], a[176:179], v[48:51]
s_mul_i32 s6, s5, 57
ds_read_b64_tr_b16 v[204:205], v230 offset:28672
ds_read_b64_tr_b16 v[206:207], v230 offset:29184
v_mfma_f32_16x16x32_bf16 v[52:55], v[208:211], a[180:183], v[52:55]
s_lshr_b32 s6, s6, 9
v_mfma_f32_16x16x32_bf16 v[56:59], v[208:211], a[184:187], v[56:59]
s_mul_i32 s7, s6, 9
v_mfma_f32_16x16x32_bf16 v[60:63], v[208:211], a[188:191], v[60:63]
s_waitcnt lgkmcnt(6)
v_mfma_f32_16x16x32_bf16 v[64:67], v[192:195], a[176:179], v[64:67]
s_sub_u32 s5, s5, s7
ds_read_b64_tr_b16 v[208:209], v231 offset:24576
ds_read_b64_tr_b16 v[210:211], v231 offset:25088
v_mfma_f32_16x16x32_bf16 v[68:71], v[192:195], a[180:183], v[68:71]
s_bfe_u32 s7, s4, 0x10005
v_mfma_f32_16x16x32_bf16 v[72:75], v[192:195], a[184:187], v[72:75]
s_add_u32 m0, s49, 73728
v_mfma_f32_16x16x32_bf16 v[76:79], v[192:195], a[188:191], v[76:79]
s_waitcnt lgkmcnt(6)
v_mfma_f32_16x16x32_bf16 v[80:83], v[196:199], a[176:179], v[80:83]
s_add_u32 s50, s95, 46080
ds_read_b64_tr_b16 v[192:193], v231 offset:28672
ds_read_b64_tr_b16 v[194:195], v231 offset:29184
v_mfma_f32_16x16x32_bf16 v[84:87], v[196:199], a[180:183], v[84:87]
s_and_b32 s8, s6, 1
buffer_load_dwordx4 v240, s[24:27], s50 offen lds
v_mfma_f32_16x16x32_bf16 v[88:91], v[196:199], a[184:187], v[88:91]
s_lshl_b32 s9, s8, 2
v_mfma_f32_16x16x32_bf16 v[92:95], v[196:199], a[188:191], v[92:95]
s_waitcnt lgkmcnt(6)
v_mfma_f32_16x16x32_bf16 v[96:99], v[200:203], a[176:179], v[96:99]
s_add_u32 s9, s9, s5
ds_read_b64_tr_b16 v[196:197], v228 offset:32768
ds_read_b64_tr_b16 v[198:199], v228 offset:33280
v_mfma_f32_16x16x32_bf16 v[100:103], v[200:203], a[180:183], v[100:103]
s_add_u32 m0, s49, 69632
v_mfma_f32_16x16x32_bf16 v[104:107], v[200:203], a[184:187], v[104:107]
s_add_u32 s50, s95, 55296
buffer_load_dwordx4 v240, s[24:27], s50 offen lds
v_mfma_f32_16x16x32_bf16 v[108:111], v[200:203], a[188:191], v[108:111]
s_waitcnt lgkmcnt(6)
v_mfma_f32_16x16x32_bf16 v[112:115], v[204:207], a[176:179], v[112:115]
s_lshl_b32 s10, s7, 3
ds_read_b64_tr_b16 v[200:201], v228 offset:36864
ds_read_b64_tr_b16 v[202:203], v228 offset:37376
v_mfma_f32_16x16x32_bf16 v[116:119], v[204:207], a[180:183], v[116:119]
s_add_u32 s9, s9, s10
v_mfma_f32_16x16x32_bf16 v[120:123], v[204:207], a[184:187], v[120:123]
s_cmp_ge_u32 s9, 6
s_cselect_b32 s10, 4, 0
v_mfma_f32_16x16x32_bf16 v[124:127], v[204:207], a[188:191], v[124:127]
s_waitcnt lgkmcnt(6)
v_mfma_f32_16x16x32_bf16 v[128:131], v[208:211], a[176:179], v[128:131]
s_add_u32 m0, s49, 65536
ds_read_b64_tr_b16 v[204:205], v229 offset:32768
ds_read_b64_tr_b16 v[206:207], v229 offset:33280
v_mfma_f32_16x16x32_bf16 v[132:135], v[208:211], a[180:183], v[132:135]
s_cmp_gt_u32 s5, 4
s_cselect_b32 s10, 15, s10
s_add_u32 s9, s9, s10
v_mfma_f32_16x16x32_bf16 v[136:139], v[208:211], a[184:187], v[136:139]
s_add_u32 s50, s95, 64512
buffer_load_dwordx4 v240, s[24:27], s50 offen lds
v_mfma_f32_16x16x32_bf16 v[140:143], v[208:211], a[188:191], v[140:143]
s_waitcnt lgkmcnt(6)
v_mfma_f32_16x16x32_bf16 v[144:147], v[192:195], a[176:179], v[144:147]
s_lshl_b32 s8, s8, 1
ds_read_b64_tr_b16 v[208:209], v229 offset:36864
ds_read_b64_tr_b16 v[210:211], v229 offset:37376
v_mfma_f32_16x16x32_bf16 v[148:151], v[192:195], a[180:183], v[148:151]
s_add_u32 s8, s8, s7
s_add_u32 s8, s8, 6
v_mfma_f32_16x16x32_bf16 v[152:155], v[192:195], a[184:187], v[152:155]
s_cmp_eq_u32 s5, 4
s_cselect_b32 s9, s8, s9
v_mfma_f32_16x16x32_bf16 v[156:159], v[192:195], a[188:191], v[156:159]
s_waitcnt vmcnt(30) lgkmcnt(6)
v_mfma_f32_16x16x32_bf16 v[32:35], v[196:199], a[192:195], v[32:35]
s_lshr_b32 s6, s6, 1
ds_read_b64_tr_b16 v[192:193], v230 offset:32768
ds_read_b64_tr_b16 v[194:195], v230 offset:33280
v_mfma_f32_16x16x32_bf16 v[36:39], v[196:199], a[196:199], v[36:39]
s_mul_i32 s6, s6, 36
buffer_load_dwordx4 v[248:251], v220, s[36:39], 0 offen
v_mfma_f32_16x16x32_bf16 v[40:43], v[196:199], a[200:203], v[40:43]
s_add_u32 s9, s9, s6
v_mfma_f32_16x16x32_bf16 v[44:47], v[196:199], a[204:207], v[44:47]
s_waitcnt lgkmcnt(6)
v_mfma_f32_16x16x32_bf16 v[48:51], v[200:203], a[192:195], v[48:51]
s_mul_i32 s9, s9, 4608
ds_read_b64_tr_b16 v[196:197], v230 offset:36864
ds_read_b64_tr_b16 v[198:199], v230 offset:37376
v_mfma_f32_16x16x32_bf16 v[52:55], v[200:203], a[196:199], v[52:55]
s_add_u32 s9, s9, 21495808
v_mfma_f32_16x16x32_bf16 v[56:59], v[200:203], a[200:203], v[56:59]
s_cmp_lt_u32 s4, 4608
s_cselect_b32 s9, s9, 0x40000000
v_mfma_f32_16x16x32_bf16 v[60:63], v[200:203], a[204:207], v[60:63]
s_waitcnt lgkmcnt(6)
v_mfma_f32_16x16x32_bf16 v[64:67], v[204:207], a[192:195], v[64:67]
s_and_b32 s4, s4, 31
ds_read_b64_tr_b16 v[200:201], v231 offset:32768
ds_read_b64_tr_b16 v[202:203], v231 offset:33280
v_mfma_f32_16x16x32_bf16 v[68:71], v[204:207], a[196:199], v[68:71]
s_lshl_b32 s4, s4, 4
v_xor_b32 v219, s4, v241
v_add_u32 v219, s9, v219
v_mfma_f32_16x16x32_bf16 v[72:75], v[204:207], a[200:203], v[72:75]
v_mfma_f32_16x16x32_bf16 v[76:79], v[204:207], a[204:207], v[76:79]
s_waitcnt lgkmcnt(6)
v_mfma_f32_16x16x32_bf16 v[80:83], v[208:211], a[192:195], v[80:83]
ds_read_b64_tr_b16 v[204:205], v231 offset:36864
ds_read_b64_tr_b16 v[206:207], v231 offset:37376
v_mfma_f32_16x16x32_bf16 v[84:87], v[208:211], a[196:199], v[84:87]
v_mfma_f32_16x16x32_bf16 v[88:91], v[208:211], a[200:203], v[88:91]
v_mfma_f32_16x16x32_bf16 v[92:95], v[208:211], a[204:207], v[92:95]
s_waitcnt lgkmcnt(6)
v_mfma_f32_16x16x32_bf16 v[96:99], v[192:195], a[192:195], v[96:99]
ds_read_b64_tr_b16 v[208:209], v228 offset:40960
ds_read_b64_tr_b16 v[210:211], v228 offset:41472
v_mfma_f32_16x16x32_bf16 v[100:103], v[192:195], a[196:199], v[100:103]
buffer_load_dwordx4 v[252:255], v220, s[36:39], 0 offen offset:64
v_mfma_f32_16x16x32_bf16 v[104:107], v[192:195], a[200:203], v[104:107]
v_mfma_f32_16x16x32_bf16 v[108:111], v[192:195], a[204:207], v[108:111]
s_waitcnt lgkmcnt(6)
v_mfma_f32_16x16x32_bf16 v[112:115], v[196:199], a[192:195], v[112:115]
ds_read_b64_tr_b16 v[192:193], v228 offset:45056
ds_read_b64_tr_b16 v[194:195], v228 offset:45568
v_mfma_f32_16x16x32_bf16 v[116:119], v[196:199], a[196:199], v[116:119]
v_mfma_f32_16x16x32_bf16 v[120:123], v[196:199], a[200:203], v[120:123]
v_mfma_f32_16x16x32_bf16 v[124:127], v[196:199], a[204:207], v[124:127]
s_waitcnt lgkmcnt(6)
v_mfma_f32_16x16x32_bf16 v[128:131], v[200:203], a[192:195], v[128:131]
ds_read_b64_tr_b16 v[196:197], v229 offset:40960
ds_read_b64_tr_b16 v[198:199], v229 offset:41472
v_mfma_f32_16x16x32_bf16 v[132:135], v[200:203], a[196:199], v[132:135]
v_mfma_f32_16x16x32_bf16 v[136:139], v[200:203], a[200:203], v[136:139]
v_mfma_f32_16x16x32_bf16 v[140:143], v[200:203], a[204:207], v[140:143]
s_waitcnt lgkmcnt(6)
v_mfma_f32_16x16x32_bf16 v[144:147], v[204:207], a[192:195], v[144:147]
ds_read_b64_tr_b16 v[200:201], v229 offset:45056
ds_read_b64_tr_b16 v[202:203], v229 offset:45568
v_mfma_f32_16x16x32_bf16 v[148:151], v[204:207], a[196:199], v[148:151]
v_mfma_f32_16x16x32_bf16 v[152:155], v[204:207], a[200:203], v[152:155]
v_mfma_f32_16x16x32_bf16 v[156:159], v[204:207], a[204:207], v[156:159]
s_waitcnt vmcnt(28) lgkmcnt(6)
v_mfma_f32_16x16x32_bf16 v[32:35], v[208:211], a[208:211], v[32:35]
ds_read_b64_tr_b16 v[204:205], v230 offset:40960
ds_read_b64_tr_b16 v[206:207], v230 offset:41472
v_mfma_f32_16x16x32_bf16 v[36:39], v[208:211], a[212:215], v[36:39]
buffer_load_dwordx2 v[244:245], v221, s[36:39], 0 offen offset:128
v_mfma_f32_16x16x32_bf16 v[40:43], v[208:211], a[216:219], v[40:43]
v_mfma_f32_16x16x32_bf16 v[44:47], v[208:211], a[220:223], v[44:47]
s_waitcnt lgkmcnt(6)
v_mfma_f32_16x16x32_bf16 v[48:51], v[192:195], a[208:211], v[48:51]
ds_read_b64_tr_b16 v[208:209], v230 offset:45056
ds_read_b64_tr_b16 v[210:211], v230 offset:45568
v_mfma_f32_16x16x32_bf16 v[52:55], v[192:195], a[212:215], v[52:55]
v_mfma_f32_16x16x32_bf16 v[56:59], v[192:195], a[216:219], v[56:59]
v_mfma_f32_16x16x32_bf16 v[60:63], v[192:195], a[220:223], v[60:63]
s_waitcnt lgkmcnt(6)
v_mfma_f32_16x16x32_bf16 v[64:67], v[196:199], a[208:211], v[64:67]
ds_read_b64_tr_b16 v[192:193], v231 offset:40960
ds_read_b64_tr_b16 v[194:195], v231 offset:41472
v_mfma_f32_16x16x32_bf16 v[68:71], v[196:199], a[212:215], v[68:71]
v_mfma_f32_16x16x32_bf16 v[72:75], v[196:199], a[216:219], v[72:75]
v_mfma_f32_16x16x32_bf16 v[76:79], v[196:199], a[220:223], v[76:79]
s_waitcnt lgkmcnt(6)
v_mfma_f32_16x16x32_bf16 v[80:83], v[200:203], a[208:211], v[80:83]
ds_read_b64_tr_b16 v[196:197], v231 offset:45056
ds_read_b64_tr_b16 v[198:199], v231 offset:45568
v_mfma_f32_16x16x32_bf16 v[84:87], v[200:203], a[212:215], v[84:87]
v_mfma_f32_16x16x32_bf16 v[88:91], v[200:203], a[216:219], v[88:91]
v_mfma_f32_16x16x32_bf16 v[92:95], v[200:203], a[220:223], v[92:95]
s_waitcnt lgkmcnt(6)
v_mfma_f32_16x16x32_bf16 v[96:99], v[204:207], a[208:211], v[96:99]
ds_read_b64_tr_b16 v[200:201], v228 offset:49152
ds_read_b64_tr_b16 v[202:203], v228 offset:49664
v_mfma_f32_16x16x32_bf16 v[100:103], v[204:207], a[212:215], v[100:103]
v_mfma_f32_16x16x32_bf16 v[104:107], v[204:207], a[216:219], v[104:107]
v_mfma_f32_16x16x32_bf16 v[108:111], v[204:207], a[220:223], v[108:111]
s_waitcnt lgkmcnt(6)
v_mfma_f32_16x16x32_bf16 v[112:115], v[208:211], a[208:211], v[112:115]
ds_read_b64_tr_b16 v[204:205], v228 offset:53248
ds_read_b64_tr_b16 v[206:207], v228 offset:53760
v_mfma_f32_16x16x32_bf16 v[116:119], v[208:211], a[212:215], v[116:119]
v_mfma_f32_16x16x32_bf16 v[120:123], v[208:211], a[216:219], v[120:123]
v_mfma_f32_16x16x32_bf16 v[124:127], v[208:211], a[220:223], v[124:127]
s_waitcnt lgkmcnt(6)
v_mfma_f32_16x16x32_bf16 v[128:131], v[192:195], a[208:211], v[128:131]
ds_read_b64_tr_b16 v[208:209], v229 offset:49152
ds_read_b64_tr_b16 v[210:211], v229 offset:49664
v_mfma_f32_16x16x32_bf16 v[132:135], v[192:195], a[212:215], v[132:135]
v_mfma_f32_16x16x32_bf16 v[136:139], v[192:195], a[216:219], v[136:139]
v_mfma_f32_16x16x32_bf16 v[140:143], v[192:195], a[220:223], v[140:143]
s_waitcnt lgkmcnt(6)
v_mfma_f32_16x16x32_bf16 v[144:147], v[196:199], a[208:211], v[144:147]
ds_read_b64_tr_b16 v[192:193], v229 offset:53248
ds_read_b64_tr_b16 v[194:195], v229 offset:53760
v_mfma_f32_16x16x32_bf16 v[148:151], v[196:199], a[212:215], v[148:151]
v_mfma_f32_16x16x32_bf16 v[152:155], v[196:199], a[216:219], v[152:155]
v_mfma_f32_16x16x32_bf16 v[156:159], v[196:199], a[220:223], v[156:159]
s_waitcnt vmcnt(25) lgkmcnt(6)
v_mfma_f32_16x16x32_bf16 v[32:35], v[200:203], a[224:227], v[32:35]
s_add_u32 m0, s49, 0
ds_read_b64_tr_b16 v[196:197], v230 offset:49152
ds_read_b64_tr_b16 v[198:199], v230 offset:49664
v_mfma_f32_16x16x32_bf16 v[36:39], v[200:203], a[228:231], v[36:39]
s_mov_b32 s50, 0
buffer_load_dwordx4 v236, s[20:23], s50 offen lds
v_mfma_f32_16x16x32_bf16 v[40:43], v[200:203], a[232:235], v[40:43]
s_waitcnt vmcnt(11)
ds_read_b128 v[160:163], v242 offset:16384
v_mfma_f32_16x16x32_bf16 v[44:47], v[200:203], a[236:239], v[44:47]
s_waitcnt lgkmcnt(7)
v_mfma_f32_16x16x32_bf16 v[48:51], v[204:207], a[224:227], v[48:51]
TCH_2_v0:
s_cbranch_execz TCH_6_v0
s_add_u32 m0, s49, 4096
ds_read_b64_tr_b16 v[200:201], v230 offset:53248
ds_read_b64_tr_b16 v[202:203], v230 offset:53760
v_mfma_f32_16x16x32_bf16 v[52:55], v[204:207], a[228:231], v[52:55]
s_mov_b32 s50, 110592
buffer_load_dwordx4 v236, s[20:23], s50 offen lds
v_mfma_f32_16x16x32_bf16 v[56:59], v[204:207], a[232:235], v[56:59]
s_waitcnt vmcnt(11)
ds_read_b128 v[164:167], v242 offset:20480
v_mfma_f32_16x16x32_bf16 v[60:63], v[204:207], a[236:239], v[60:63]
s_waitcnt lgkmcnt(8)
v_mfma_f32_16x16x32_bf16 v[64:67], v[208:211], a[224:227], v[64:67]
s_waitcnt vmcnt(10)
ds_read_b64_tr_b16 v[204:205], v231 offset:49152
ds_read_b64_tr_b16 v[206:207], v231 offset:49664
v_mfma_f32_16x16x32_bf16 v[68:71], v[208:211], a[228:231], v[68:71]
buffer_load_dword v246, v247, s[28:31], s67 offen offset:0 sc1
ds_read_b128 v[168:171], v242 offset:24576
v_mfma_f32_16x16x32_bf16 v[72:75], v[208:211], a[232:235], v[72:75]
s_waitcnt vmcnt(10)
ds_read_b128 v[172:175], v242 offset:28672
v_add_u32 v242, 4294901760, v242
v_mfma_f32_16x16x32_bf16 v[76:79], v[208:211], a[236:239], v[76:79]
s_waitcnt lgkmcnt(10)
s_waitcnt vmcnt(9)
ds_read_b128 v[176:179], v242 offset:12288
v_mfma_f32_16x16x32_bf16 v[80:83], v[192:195], a[224:227], v[80:83]
s_waitcnt vmcnt(8)
ds_read_b64_tr_b16 v[208:209], v231 offset:53248
ds_read_b64_tr_b16 v[210:211], v231 offset:53760
v_mfma_f32_16x16x32_bf16 v[84:87], v[192:195], a[228:231], v[84:87]
s_add_u32 m0, s49, 8192
v_mfma_f32_16x16x32_bf16 v[88:91], v[192:195], a[232:235], v[88:91]
s_mov_b32 s50, 221184
buffer_load_dwordx4 v236, s[20:23], s50 offen lds
v_mfma_f32_16x16x32_bf16 v[92:95], v[192:195], a[236:239], v[92:95]
s_waitcnt lgkmcnt(11)
ds_read_b128 v[180:183], v242 offset:8192
s_waitcnt vmcnt(8)
v_mfma_f32_16x16x32_bf16 v[96:99], v[196:199], a[224:227], v[96:99]
ds_read_b64_tr_b16 v[192:193], v228 offset:57344
ds_read_b64_tr_b16 v[194:195], v228 offset:57856
v_mfma_f32_16x16x32_bf16 v[100:103], v[196:199], a[228:231], v[100:103]
v_mfma_f32_16x16x32_bf16 v[104:107], v[196:199], a[232:235], v[104:107]
v_mfma_f32_16x16x32_bf16 v[108:111], v[196:199], a[236:239], v[108:111]
s_waitcnt lgkmcnt(11)
ds_read_b128 v[184:187], v242 offset:4096
s_waitcnt vmcnt(7)
v_mfma_f32_16x16x32_bf16 v[112:115], v[200:203], a[224:227], v[112:115]
s_add_u32 m0, s49, 12288
ds_read_b64_tr_b16 v[196:197], v228 offset:61440
ds_read_b64_tr_b16 v[198:199], v228 offset:61952
v_mfma_f32_16x16x32_bf16 v[116:119], v[200:203], a[228:231], v[116:119]
s_mov_b32 s50, 331776
buffer_load_dwordx4 v236, s[20:23], s50 offen lds
v_mfma_f32_16x16x32_bf16 v[120:123], v[200:203], a[232:235], v[120:123]
v_mfma_f32_16x16x32_bf16 v[124:127], v[200:203], a[236:239], v[124:127]
s_waitcnt lgkmcnt(11)
ds_read_b128 v[188:191], v242 offset:0
v_mfma_f32_16x16x32_bf16 v[128:131], v[204:207], a[224:227], v[128:131]
s_add_u32 m0, s49, 16384
ds_read_b64_tr_b16 v[200:201], v229 offset:57344
ds_read_b64_tr_b16 v[202:203], v229 offset:57856
v_mfma_f32_16x16x32_bf16 v[132:135], v[204:207], a[228:231], v[132:135]
s_mov_b32 s50, 442368
buffer_load_dwordx4 v236, s[20:23], s50 offen lds
v_mfma_f32_16x16x32_bf16 v[136:139], v[204:207], a[232:235], v[136:139]
v_mfma_f32_16x16x32_bf16 v[140:143], v[204:207], a[236:239], v[140:143]
s_waitcnt lgkmcnt(9)
v_mfma_f32_16x16x32_bf16 v[144:147], v[208:211], a[224:227], v[144:147]
ds_read_b64_tr_b16 v[204:205], v229 offset:61440
ds_read_b64_tr_b16 v[206:207], v229 offset:61952
v_mfma_f32_16x16x32_bf16 v[148:151], v[208:211], a[228:231], v[148:151]
buffer_store_dwordx4 v[160:163], v212, s[28:31], 0 offen sc1
v_mfma_f32_16x16x32_bf16 v[152:155], v[208:211], a[232:235], v[152:155]
v_mfma_f32_16x16x32_bf16 v[156:159], v[208:211], a[236:239], v[156:159]
s_waitcnt vmcnt(28) lgkmcnt(8)
v_mfma_f32_16x16x32_bf16 v[32:35], v[192:195], a[240:243], v[32:35]
s_add_u32 m0, s49, 20480
ds_read_b64_tr_b16 v[208:209], v230 offset:57344
ds_read_b64_tr_b16 v[210:211], v230 offset:57856
v_mfma_f32_16x16x32_bf16 v[36:39], v[192:195], a[244:247], v[36:39]
s_mov_b32 s50, 552960
buffer_load_dwordx4 v236, s[20:23], s50 offen lds
v_mfma_f32_16x16x32_bf16 v[40:43], v[192:195], a[248:251], v[40:43]
v_mfma_f32_16x16x32_bf16 v[44:47], v[192:195], a[252:255], v[44:47]
s_waitcnt lgkmcnt(7)
v_mfma_f32_16x16x32_bf16 v[48:51], v[196:199], a[240:243], v[48:51]
ds_read_b64_tr_b16 v[192:193], v230 offset:61440
ds_read_b64_tr_b16 v[194:195], v230 offset:61952
v_mfma_f32_16x16x32_bf16 v[52:55], v[196:199], a[244:247], v[52:55]
buffer_store_dwordx4 v[164:167], v213, s[28:31], 0 offen sc1
v_mfma_f32_16x16x32_bf16 v[56:59], v[196:199], a[248:251], v[56:59]
v_mfma_f32_16x16x32_bf16 v[60:63], v[196:199], a[252:255], v[60:63]
s_waitcnt lgkmcnt(6)
v_mfma_f32_16x16x32_bf16 v[64:67], v[200:203], a[240:243], v[64:67]
s_add_u32 m0, s49, 24576
ds_read_b64_tr_b16 v[196:197], v231 offset:57344
ds_read_b64_tr_b16 v[198:199], v231 offset:57856
v_mfma_f32_16x16x32_bf16 v[68:71], v[200:203], a[244:247], v[68:71]
s_mov_b32 s50, 663552
v_mfma_f32_16x16x32_bf16 v[72:75], v[200:203], a[248:251], v[72:75]
v_mfma_f32_16x16x32_bf16 v[76:79], v[200:203], a[252:255], v[76:79]
s_waitcnt lgkmcnt(6)
v_mfma_f32_16x16x32_bf16 v[80:83], v[204:207], a[240:243], v[80:83]
ds_read_b64_tr_b16 v[200:201], v231 offset:61440
ds_read_b64_tr_b16 v[202:203], v231 offset:61952
v_mfma_f32_16x16x32_bf16 v[84:87], v[204:207], a[244:247], v[84:87]
v_add_u32 v228, 65536, v228
v_mfma_f32_16x16x32_bf16 v[88:91], v[204:207], a[248:251], v[88:91]
buffer_load_dwordx4 v236, s[20:23], s50 offen lds
v_mfma_f32_16x16x32_bf16 v[92:95], v[204:207], a[252:255], v[92:95]
s_waitcnt lgkmcnt(6)
v_mfma_f32_16x16x32_bf16 v[96:99], v[208:211], a[240:243], v[96:99]
s_add_u32 m0, s49, 28672
ds_read_b64_tr_b16 v[204:205], v228 offset:0
ds_read_b64_tr_b16 v[206:207], v228 offset:512
v_mfma_f32_16x16x32_bf16 v[100:103], v[208:211], a[244:247], v[100:103]
s_mov_b32 s50, 774144
buffer_load_dwordx4 v236, s[20:23], s50 offen lds
v_mfma_f32_16x16x32_bf16 v[104:107], v[208:211], a[248:251], v[104:107]
v_mfma_f32_16x16x32_bf16 v[108:111], v[208:211], a[252:255], v[108:111]
s_waitcnt lgkmcnt(6)
v_mfma_f32_16x16x32_bf16 v[112:115], v[192:195], a[240:243], v[112:115]
s_add_u32 m0, s49, 32768
ds_read_b64_tr_b16 v[208:209], v228 offset:4096
ds_read_b64_tr_b16 v[210:211], v228 offset:4608
v_mfma_f32_16x16x32_bf16 v[116:119], v[192:195], a[244:247], v[116:119]
s_mov_b32 s50, 884736
v_add_u32 v229, 65536, v229
v_mfma_f32_16x16x32_bf16 v[120:123], v[192:195], a[248:251], v[120:123]
buffer_load_dwordx4 v236, s[20:23], s50 offen lds
v_mfma_f32_16x16x32_bf16 v[124:127], v[192:195], a[252:255], v[124:127]
s_waitcnt lgkmcnt(6)
v_mfma_f32_16x16x32_bf16 v[128:131], v[196:199], a[240:243], v[128:131]
ds_read_b64_tr_b16 v[192:193], v229 offset:0
ds_read_b64_tr_b16 v[194:195], v229 offset:512
v_mfma_f32_16x16x32_bf16 v[132:135], v[196:199], a[244:247], v[132:135]
v_mfma_f32_16x16x32_bf16 v[136:139], v[196:199], a[248:251], v[136:139]
buffer_store_dwordx4 v[168:171], v214, s[28:31], 0 offen sc1
v_mfma_f32_16x16x32_bf16 v[140:143], v[196:199], a[252:255], v[140:143]
s_waitcnt lgkmcnt(6)
v_mfma_f32_16x16x32_bf16 v[144:147], v[200:203], a[240:243], v[144:147]
s_add_u32 m0, s49, 36864
ds_read_b64_tr_b16 v[196:197], v229 offset:4096
ds_read_b64_tr_b16 v[198:199], v229 offset:4608
v_mfma_f32_16x16x32_bf16 v[148:151], v[200:203], a[244:247], v[148:151]
s_mov_b32 s50, 995328
v_add_u32 v230, 65536, v230
v_mfma_f32_16x16x32_bf16 v[152:155], v[200:203], a[248:251], v[152:155]
v_mfma_f32_16x16x32_bf16 v[156:159], v[200:203], a[252:255], v[156:159]
s_waitcnt vmcnt(30) lgkmcnt(6)
v_mfma_f32_16x16x32_bf16 v[32:35], v[204:207], v[0:3], v[32:35]
ds_read_b64_tr_b16 v[200:201], v230 offset:0
ds_read_b64_tr_b16 v[202:203], v230 offset:512
v_mfma_f32_16x16x32_bf16 v[36:39], v[204:207], v[4:7], v[36:39]
v_mfma_f32_16x16x32_bf16 v[40:43], v[204:207], v[8:11], v[40:43]
v_mfma_f32_16x16x32_bf16 v[44:47], v[204:207], v[12:15], v[44:47]
s_waitcnt lgkmcnt(6)
v_mfma_f32_16x16x32_bf16 v[48:51], v[208:211], v[0:3], v[48:51]
ds_read_b64_tr_b16 v[204:205], v230 offset:4096
ds_read_b64_tr_b16 v[206:207], v230 offset:4608
v_mfma_f32_16x16x32_bf16 v[52:55], v[208:211], v[4:7], v[52:55]
v_add_u32 v231, 65536, v231
v_mfma_f32_16x16x32_bf16 v[56:59], v[208:211], v[8:11], v[56:59]
buffer_load_dwordx4 v236, s[20:23], s50 offen lds
v_mfma_f32_16x16x32_bf16 v[60:63], v[208:211], v[12:15], v[60:63]
s_waitcnt lgkmcnt(6)
v_mfma_f32_16x16x32_bf16 v[64:67], v[192:195], v[0:3], v[64:67]
s_add_u32 m0, s49, 40960
ds_read_b64_tr_b16 v[208:209], v231 offset:0
ds_read_b64_tr_b16 v[210:211], v231 offset:512
v_mfma_f32_16x16x32_bf16 v[68:71], v[192:195], v[4:7], v[68:71]
s_mov_b32 s50, 1105920
buffer_load_dwordx4 v236, s[20:23], s50 offen lds
v_mfma_f32_16x16x32_bf16 v[72:75], v[192:195], v[8:11], v[72:75]
s_add_u32 m0, s49, 45056
v_mfma_f32_16x16x32_bf16 v[76:79], v[192:195], v[12:15], v[76:79]
s_waitcnt lgkmcnt(6)
v_mfma_f32_16x16x32_bf16 v[80:83], v[196:199], v[0:3], v[80:83]
s_mov_b32 s50, 1216512
ds_read_b64_tr_b16 v[192:193], v231 offset:4096
ds_read_b64_tr_b16 v[194:195], v231 offset:4608
v_mfma_f32_16x16x32_bf16 v[84:87], v[196:199], v[4:7], v[84:87]
buffer_load_dwordx4 v236, s[20:23], s50 offen lds
v_mfma_f32_16x16x32_bf16 v[88:91], v[196:199], v[8:11], v[88:91]
s_waitcnt vmcnt(13)
v_cmp_gt_u32 vcc, 1, v246
v_mfma_f32_16x16x32_bf16 v[92:95], v[196:199], v[12:15], v[92:95]
s_waitcnt lgkmcnt(6)
v_mfma_f32_16x16x32_bf16 v[96:99], v[200:203], v[0:3], v[96:99]
ds_read_b64_tr_b16 v[196:197], v228 offset:8192
ds_read_b64_tr_b16 v[198:199], v228 offset:8704
v_mfma_f32_16x16x32_bf16 v[100:103], v[200:203], v[4:7], v[100:103]
s_cbranch_vccnz spin_4_v0
ok_3_v0:
v_mfma_f32_16x16x32_bf16 v[104:107], v[200:203], v[8:11], v[104:107]
s_add_u32 m0, s49, 49152
buffer_store_dwordx4 v[172:175], v215, s[28:31], 0 offen sc1
v_mfma_f32_16x16x32_bf16 v[108:111], v[200:203], v[12:15], v[108:111]
s_waitcnt lgkmcnt(6)
v_mfma_f32_16x16x32_bf16 v[112:115], v[204:207], v[0:3], v[112:115]
s_mov_b32 s50, 1327104
ds_read_b64_tr_b16 v[200:201], v228 offset:12288
ds_read_b64_tr_b16 v[202:203], v228 offset:12800
v_mfma_f32_16x16x32_bf16 v[116:119], v[204:207], v[4:7], v[116:119]
v_mfma_f32_16x16x32_bf16 v[120:123], v[204:207], v[8:11], v[120:123]
v_mfma_f32_16x16x32_bf16 v[124:127], v[204:207], v[12:15], v[124:127]
s_waitcnt lgkmcnt(6)
v_mfma_f32_16x16x32_bf16 v[128:131], v[208:211], v[0:3], v[128:131]
ds_read_b64_tr_b16 v[204:205], v229 offset:8192
ds_read_b64_tr_b16 v[206:207], v229 offset:8704
v_mfma_f32_16x16x32_bf16 v[132:135], v[208:211], v[4:7], v[132:135]
v_mfma_f32_16x16x32_bf16 v[136:139], v[208:211], v[8:11], v[136:139]
v_mfma_f32_16x16x32_bf16 v[140:143], v[208:211], v[12:15], v[140:143]
s_waitcnt lgkmcnt(6)
v_mfma_f32_16x16x32_bf16 v[144:147], v[192:195], v[0:3], v[144:147]
ds_read_b64_tr_b16 v[208:209], v229 offset:12288
ds_read_b64_tr_b16 v[210:211], v229 offset:12800
v_mfma_f32_16x16x32_bf16 v[148:151], v[192:195], v[4:7], v[148:151]
buffer_store_dwordx4 v[176:179], v216, s[28:31], 0 offen sc1
v_mfma_f32_16x16x32_bf16 v[152:155], v[192:195], v[8:11], v[152:155]
v_mfma_f32_16x16x32_bf16 v[156:159], v[192:195], v[12:15], v[156:159]
s_waitcnt vmcnt(30) lgkmcnt(6)
v_mfma_f32_16x16x32_bf16 v[32:35], v[196:199], v[16:19], v[32:35]
ds_read_b64_tr_b16 v[192:193], v230 offset:8192
ds_read_b64_tr_b16 v[194:195], v230 offset:8704
v_mfma_f32_16x16x32_bf16 v[36:39], v[196:199], v[20:23], v[36:39]
v_mfma_f32_16x16x32_bf16 v[40:43], v[196:199], v[24:27], v[40:43]
v_mfma_f32_16x16x32_bf16 v[44:47], v[196:199], v[28:31], v[44:47]
s_waitcnt lgkmcnt(6)
v_mfma_f32_16x16x32_bf16 v[48:51], v[200:203], v[16:19], v[48:51]
ds_read_b64_tr_b16 v[196:197], v230 offset:12288
ds_read_b64_tr_b16 v[198:199], v230 offset:12800
v_mfma_f32_16x16x32_bf16 v[52:55], v[200:203], v[20:23], v[52:55]
v_mfma_f32_16x16x32_bf16 v[56:59], v[200:203], v[24:27], v[56:59]
v_mfma_f32_16x16x32_bf16 v[60:63], v[200:203], v[28:31], v[60:63]
s_waitcnt lgkmcnt(6)
buffer_store_dwordx4 v[180:183], v217, s[28:31], 0 offen sc1
v_mfma_f32_16x16x32_bf16 v[64:67], v[204:207], v[16:19], v[64:67]
ds_read_b64_tr_b16 v[200:201], v231 offset:8192
ds_read_b64_tr_b16 v[202:203], v231 offset:8704
v_mfma_f32_16x16x32_bf16 v[68:71], v[204:207], v[20:23], v[68:71]
v_mfma_f32_16x16x32_bf16 v[72:75], v[204:207], v[24:27], v[72:75]
v_mfma_f32_16x16x32_bf16 v[76:79], v[204:207], v[28:31], v[76:79]
s_waitcnt lgkmcnt(6)
v_mfma_f32_16x16x32_bf16 v[80:83], v[208:211], v[16:19], v[80:83]
ds_read_b64_tr_b16 v[204:205], v231 offset:12288
ds_read_b64_tr_b16 v[206:207], v231 offset:12800
v_mfma_f32_16x16x32_bf16 v[84:87], v[208:211], v[20:23], v[84:87]
buffer_store_dwordx4 v[184:187], v218, s[28:31], 0 offen sc1
buffer_store_dwordx4 v[188:191], v219, s[28:31], 0 offen sc1
v_mfma_f32_16x16x32_bf16 v[88:91], v[208:211], v[24:27], v[88:91]
s_waitcnt vmcnt(9)
s_barrier
v_mfma_f32_16x16x32_bf16 v[92:95], v[208:211], v[28:31], v[92:95]
s_waitcnt lgkmcnt(6)
v_mfma_f32_16x16x32_bf16 v[96:99], v[192:195], v[16:19], v[96:99]
ds_read_b64_tr_b16 v[208:209], v233 offset:0
ds_read_b64_tr_b16 v[210:211], v233 offset:512
v_mfma_f32_16x16x32_bf16 v[100:103], v[192:195], v[20:23], v[100:103]
v_mfma_f32_16x16x32_bf16 v[104:107], v[192:195], v[24:27], v[104:107]
v_mfma_f32_16x16x32_bf16 v[108:111], v[192:195], v[28:31], v[108:111]
s_waitcnt lgkmcnt(6)
v_mfma_f32_16x16x32_bf16 v[112:115], v[196:199], v[16:19], v[112:115]
ds_read_b64_tr_b16 v[192:193], v233 offset:8
ds_read_b64_tr_b16 v[194:195], v233 offset:520
v_mfma_f32_16x16x32_bf16 v[116:119], v[196:199], v[20:23], v[116:119]
v_mfma_f32_16x16x32_bf16 v[120:123], v[196:199], v[24:27], v[120:123]
v_mfma_f32_16x16x32_bf16 v[124:127], v[196:199], v[28:31], v[124:127]
s_waitcnt lgkmcnt(6)
v_mfma_f32_16x16x32_bf16 v[128:131], v[200:203], v[16:19], v[128:131]
ds_read_b64_tr_b16 v[196:197], v233 offset:4096
ds_read_b64_tr_b16 v[198:199], v233 offset:4608
v_mfma_f32_16x16x32_bf16 v[132:135], v[200:203], v[20:23], v[132:135]
v_mfma_f32_16x16x32_bf16 v[136:139], v[200:203], v[24:27], v[136:139]
v_mfma_f32_16x16x32_bf16 v[140:143], v[200:203], v[28:31], v[140:143]
s_waitcnt lgkmcnt(6)
v_mfma_f32_16x16x32_bf16 v[144:147], v[204:207], v[16:19], v[144:147]
ds_read_b64_tr_b16 v[200:201], v233 offset:4104
ds_read_b64_tr_b16 v[202:203], v233 offset:4616
v_mfma_f32_16x16x32_bf16 v[148:151], v[204:207], v[20:23], v[148:151]
v_mfma_f32_16x16x32_bf16 v[152:155], v[204:207], v[24:27], v[152:155]
v_mfma_f32_16x16x32_bf16 v[156:159], v[204:207], v[28:31], v[156:159]
s_waitcnt lgkmcnt(6)
v_mfma_f32_16x16x32_bf16 v[160:163], v[208:211], a[0:3], 0
ds_read_b64_tr_b16 v[204:205], v233 offset:8192
ds_read_b64_tr_b16 v[206:207], v233 offset:8704
v_mfma_f32_16x16x32_bf16 v[164:167], v[208:211], a[4:7], 0
v_mfma_f32_16x16x32_bf16 v[168:171], v[208:211], a[8:11], 0
v_mfma_f32_16x16x32_bf16 v[172:175], v[208:211], a[12:15], 0
s_waitcnt lgkmcnt(6)
v_mfma_f32_16x16x32_bf16 v[176:179], v[192:195], a[0:3], 0
ds_read_b64_tr_b16 v[208:209], v233 offset:8200
ds_read_b64_tr_b16 v[210:211], v233 offset:8712
v_mfma_f32_16x16x32_bf16 v[180:183], v[192:195], a[4:7], 0
v_mul_f32 v32, s96, v32
v_mul_f32 v33, s96, v33
v_mfma_f32_16x16x32_bf16 v[184:187], v[192:195], a[8:11], 0
v_mul_f32 v34, s96, v34
v_mul_f32 v35, s96, v35
v_mfma_f32_16x16x32_bf16 v[188:191], v[192:195], a[12:15], 0
s_waitcnt lgkmcnt(6)
buffer_load_dwordx4 v236, s[20:23], s50 offen lds
s_add_u32 m0, s49, 53248
v_mfma_f32_16x16x32_bf16 v[160:163], v[196:199], a[16:19], v[160:163]
s_mov_b32 s50, 1437696
ds_read_b64_tr_b16 v[192:193], v233 offset:12288
ds_read_b64_tr_b16 v[194:195], v233 offset:12800
v_mfma_f32_16x16x32_bf16 v[164:167], v[196:199], a[20:23], v[164:167]
v_exp_f32 v32, v32
v_mfma_f32_16x16x32_bf16 v[168:171], v[196:199], a[24:27], v[168:171]
v_exp_f32 v33, v33
v_mfma_f32_16x16x32_bf16 v[172:175], v[196:199], a[28:31], v[172:175]
s_waitcnt lgkmcnt(6)
buffer_load_dwordx4 v236, s[20:23], s50 offen lds
v_bfe_u32 v241, v237, 2, 5
v_mfma_f32_16x16x32_bf16 v[176:179], v[200:203], a[16:19], v[176:179]
s_add_u32 m0, s49, 57344
ds_read_b64_tr_b16 v[196:197], v233 offset:12296
ds_read_b64_tr_b16 v[198:199], v233 offset:12808
v_mfma_f32_16x16x32_bf16 v[180:183], v[200:203], a[20:23], v[180:183]
s_mov_b32 s50, 1548288
v_exp_f32 v34, v34
v_mfma_f32_16x16x32_bf16 v[184:187], v[200:203], a[24:27], v[184:187]
v_mfma_f32_16x16x32_bf16 v[188:191], v[200:203], a[28:31], v[188:191]
s_waitcnt lgkmcnt(6)
v_mfma_f32_16x16x32_bf16 v[160:163], v[204:207], a[32:35], v[160:163]
ds_read_b64_tr_b16 v[200:201], v233 offset:16384
ds_read_b64_tr_b16 v[202:203], v233 offset:16896
v_mfma_f32_16x16x32_bf16 v[164:167], v[204:207], a[36:39], v[164:167]
buffer_load_dwordx4 v236, s[20:23], s50 offen lds
v_add_u32 v241, s83, v241
v_mfma_f32_16x16x32_bf16 v[168:171], v[204:207], a[40:43], v[168:171]
s_add_u32 m0, s49, 61440
v_exp_f32 v35, v35
v_mfma_f32_16x16x32_bf16 v[172:175], v[204:207], a[44:47], v[172:175]
s_waitcnt lgkmcnt(6)
v_add_f32 v32, 1.0, v32
v_add_f32 v33, 1.0, v33
v_mfma_f32_16x16x32_bf16 v[176:179], v[208:211], a[32:35], v[176:179]
s_mov_b32 s50, 1658880
ds_read_b64_tr_b16 v[204:205], v233 offset:16392
ds_read_b64_tr_b16 v[206:207], v233 offset:16904
v_mfma_f32_16x16x32_bf16 v[180:183], v[208:211], a[36:39], v[180:183]
buffer_load_dwordx4 v236, s[20:23], s50 offen lds
v_add_f32 v34, 1.0, v34
v_mfma_f32_16x16x32_bf16 v[184:187], v[208:211], a[40:43], v[184:187]
s_add_u32 m0, s49, 65536
v_add_f32 v35, 1.0, v35
v_mul_f32 v36, s96, v36
v_mfma_f32_16x16x32_bf16 v[188:191], v[208:211], a[44:47], v[188:191]
s_waitcnt lgkmcnt(6)
v_rcp_f32 v32, v32
v_mfma_f32_16x16x32_bf16 v[160:163], v[192:195], a[48:51], v[160:163]
s_mov_b32 s50, 1769472
ds_read_b64_tr_b16 v[208:209], v233 offset:20480
ds_read_b64_tr_b16 v[210:211], v233 offset:20992
v_mfma_f32_16x16x32_bf16 v[164:167], v[192:195], a[52:55], v[164:167]
s_mov_b32 s7, 32768
buffer_load_dwordx4 v236, s[20:23], s50 offen lds
v_mul_f32 v37, s96, v37
v_mfma_f32_16x16x32_bf16 v[168:171], v[192:195], a[56:59], v[168:171]
s_add_u32 m0, s49, 69632
v_mul_f32 v38, s96, v38
v_mul_f32 v39, s96, v39
v_mfma_f32_16x16x32_bf16 v[172:175], v[192:195], a[60:63], v[172:175]
s_waitcnt lgkmcnt(6)
v_rcp_f32 v33, v33
v_mfma_f32_16x16x32_bf16 v[176:179], v[196:199], a[48:51], v[176:179]
s_mov_b32 s50, 1880064
ds_read_b64_tr_b16 v[192:193], v233 offset:20488
ds_read_b64_tr_b16 v[194:195], v233 offset:21000
v_mfma_f32_16x16x32_bf16 v[180:183], v[196:199], a[52:55], v[180:183]
s_mov_b32 s68, 147456
buffer_load_dwordx4 v236, s[20:23], s50 offen lds
v_mfma_f32_16x16x32_bf16 v[184:187], v[196:199], a[56:59], v[184:187]
s_mov_b32 s83, 49152
v_exp_f32 v36, v36
v_mfma_f32_16x16x32_bf16 v[188:191], v[196:199], a[60:63], v[188:191]
s_waitcnt lgkmcnt(6)
v_exp_f32 v37, v37
v_mfma_f32_16x16x32_bf16 v[160:163], v[200:203], a[64:67], v[160:163]
ds_read_b64_tr_b16 v[196:197], v233 offset:24576
ds_read_b64_tr_b16 v[198:199], v233 offset:25088
v_mfma_f32_16x16x32_bf16 v[164:167], v[200:203], a[68:71], v[164:167]
v_rcp_f32 v34, v34
v_mfma_f32_16x16x32_bf16 v[168:171], v[200:203], a[72:75], v[168:171]
v_rcp_f32 v35, v35
v_mfma_f32_16x16x32_bf16 v[172:175], v[200:203], a[76:79], v[172:175]
s_waitcnt lgkmcnt(6)
v_exp_f32 v38, v38
v_mfma_f32_16x16x32_bf16 v[176:179], v[204:207], a[64:67], v[176:179]
ds_read_b64_tr_b16 v[200:201], v233 offset:24584
ds_read_b64_tr_b16 v[202:203], v233 offset:25096
v_mfma_f32_16x16x32_bf16 v[180:183], v[204:207], a[68:71], v[180:183]
v_mul_f32 v48, v32, v48
v_mul_f32 v49, v33, v49
v_mfma_f32_16x16x32_bf16 v[184:187], v[204:207], a[72:75], v[184:187]
v_mul_f32 v50, v34, v50
v_mul_f32 v51, v35, v51
v_mfma_f32_16x16x32_bf16 v[188:191], v[204:207], a[76:79], v[188:191]
s_waitcnt lgkmcnt(6)
v_exp_f32 v39, v39
v_mfma_f32_16x16x32_bf16 v[160:163], v[208:211], a[80:83], v[160:163]
ds_read_b64_tr_b16 v[204:205], v233 offset:28672
ds_read_b64_tr_b16 v[206:207], v233 offset:29184
v_mfma_f32_16x16x32_bf16 v[164:167], v[208:211], a[84:87], v[164:167]
v_add_f32 v36, 1.0, v36
v_add_f32 v37, 1.0, v37
v_mfma_f32_16x16x32_bf16 v[168:171], v[208:211], a[88:91], v[168:171]
v_cvt_pk_bf16_f32 v212, v48, v49
v_cvt_pk_bf16_f32 v213, v50, v51
v_mfma_f32_16x16x32_bf16 v[172:175], v[208:211], a[92:95], v[172:175]
s_waitcnt lgkmcnt(6)
v_add_f32 v38, 1.0, v38
v_add_f32 v39, 1.0, v39
v_mfma_f32_16x16x32_bf16 v[176:179], v[192:195], a[80:83], v[176:179]
ds_read_b64_tr_b16 v[208:209], v233 offset:28680
ds_read_b64_tr_b16 v[210:211], v233 offset:29192
v_mfma_f32_16x16x32_bf16 v[180:183], v[192:195], a[84:87], v[180:183]
v_rcp_f32 v36, v36
v_mfma_f32_16x16x32_bf16 v[184:187], v[192:195], a[88:91], v[184:187]
v_mul_f32 v40, s96, v40
v_mul_f32 v41, s96, v41
v_mfma_f32_16x16x32_bf16 v[188:191], v[192:195], a[92:95], v[188:191]
s_waitcnt lgkmcnt(6)
v_mul_f32 v42, s96, v42
v_mul_f32 v43, s96, v43
v_mfma_f32_16x16x32_bf16 v[160:163], v[196:199], a[96:99], v[160:163]
ds_read_b64_tr_b16 v[192:193], v233 offset:32768
ds_read_b64_tr_b16 v[194:195], v233 offset:33280
v_mfma_f32_16x16x32_bf16 v[164:167], v[196:199], a[100:103], v[164:167]
v_rcp_f32 v37, v37
v_mfma_f32_16x16x32_bf16 v[168:171], v[196:199], a[104:107], v[168:171]
v_exp_f32 v40, v40
v_mfma_f32_16x16x32_bf16 v[172:175], v[196:199], a[108:111], v[172:175]
s_waitcnt lgkmcnt(6)
v_exp_f32 v41, v41
v_mfma_f32_16x16x32_bf16 v[176:179], v[200:203], a[96:99], v[176:179]
ds_read_b64_tr_b16 v[196:197], v233 offset:32776
ds_read_b64_tr_b16 v[198:199], v233 offset:33288
v_mfma_f32_16x16x32_bf16 v[180:183], v[200:203], a[100:103], v[180:183]
v_rcp_f32 v38, v38
v_mfma_f32_16x16x32_bf16 v[184:187], v[200:203], a[104:107], v[184:187]
s_waitcnt vmcnt(0)
s_barrier
v_mfma_f32_16x16x32_bf16 v[188:191], v[200:203], a[108:111], v[188:191]
s_waitcnt lgkmcnt(6)
v_rcp_f32 v39, v39
v_mfma_f32_16x16x32_bf16 v[160:163], v[204:207], a[112:115], v[160:163]
s_add_u32 m0, s49, 73728
ds_read_b64_tr_b16 v[200:201], v233 offset:36864
ds_read_b64_tr_b16 v[202:203], v233 offset:37376
v_mfma_f32_16x16x32_bf16 v[164:167], v[204:207], a[116:119], v[164:167]
s_add_u32 s50, s57, 0
buffer_load_dwordx4 v237, s[28:31], s50 offen sc1 lds
v_mul_f32 v52, v36, v52
v_mfma_f32_16x16x32_bf16 v[168:171], v[204:207], a[120:123], v[168:171]
v_exp_f32 v42, v42
v_mfma_f32_16x16x32_bf16 v[172:175], v[204:207], a[124:127], v[172:175]
s_waitcnt lgkmcnt(6)
v_mul_f32 v53, v37, v53
v_mul_f32 v54, v38, v54
v_mfma_f32_16x16x32_bf16 v[176:179], v[208:211], a[112:115], v[176:179]
ds_read_b64_tr_b16 v[204:205], v233 offset:36872
ds_read_b64_tr_b16 v[206:207], v233 offset:37384
v_mfma_f32_16x16x32_bf16 v[180:183], v[208:211], a[116:119], v[180:183]
v_exp_f32 v43, v43
v_mfma_f32_16x16x32_bf16 v[184:187], v[208:211], a[120:123], v[184:187]
v_add_f32 v40, 1.0, v40
v_add_f32 v41, 1.0, v41
v_mfma_f32_16x16x32_bf16 v[188:191], v[208:211], a[124:127], v[188:191]
s_waitcnt lgkmcnt(6)
v_mul_f32 v55, v39, v55
v_cvt_pk_bf16_f32 v216, v52, v53
v_mfma_f32_16x16x32_bf16 v[160:163], v[192:195], a[128:131], v[160:163]
s_add_u32 m0, s49, 110592
ds_read_b64_tr_b16 v[208:209], v233 offset:40960
ds_read_b64_tr_b16 v[210:211], v233 offset:41472
v_mfma_f32_16x16x32_bf16 v[164:167], v[192:195], a[132:135], v[164:167]
s_mov_b32 s53, 640
buffer_load_dwordx4 v234, s[12:15], s53 offen lds
v_cvt_pk_bf16_f32 v217, v54, v55
v_mfma_f32_16x16x32_bf16 v[168:171], v[192:195], a[136:139], v[168:171]
v_add_f32 v42, 1.0, v42
v_add_f32 v43, 1.0, v43
v_mfma_f32_16x16x32_bf16 v[172:175], v[192:195], a[140:143], v[172:175]
s_waitcnt lgkmcnt(6)
v_rcp_f32 v40, v40
v_mfma_f32_16x16x32_bf16 v[176:179], v[196:199], a[128:131], v[176:179]
ds_read_b64_tr_b16 v[192:193], v233 offset:40968
ds_read_b64_tr_b16 v[194:195], v233 offset:41480
v_mfma_f32_16x16x32_bf16 v[180:183], v[196:199], a[132:135], v[180:183]
v_mul_f32 v44, s96, v44
v_mul_f32 v45, s96, v45
v_mfma_f32_16x16x32_bf16 v[184:187], v[196:199], a[136:139], v[184:187]
v_mul_f32 v46, s96, v46
v_mul_f32 v47, s96, v47
v_mfma_f32_16x16x32_bf16 v[188:191], v[196:199], a[140:143], v[188:191]
s_waitcnt lgkmcnt(6)
v_rcp_f32 v41, v41
v_mfma_f32_16x16x32_bf16 v[160:163], v[200:203], a[144:147], v[160:163]
s_add_u32 m0, s49, 77824
ds_read_b64_tr_b16 v[196:197], v233 offset:45056
ds_read_b64_tr_b16 v[198:199], v233 offset:45568
v_mfma_f32_16x16x32_bf16 v[164:167], v[200:203], a[148:151], v[164:167]
s_add_u32 s50, s57, 4096
v_exp_f32 v44, v44
v_mfma_f32_16x16x32_bf16 v[168:171], v[200:203], a[152:155], v[168:171]
v_exp_f32 v45, v45
v_mfma_f32_16x16x32_bf16 v[172:175], v[200:203], a[156:159], v[172:175]
s_waitcnt lgkmcnt(6)
v_rcp_f32 v42, v42
v_mfma_f32_16x16x32_bf16 v[176:179], v[204:207], a[144:147], v[176:179]
ds_read_b64_tr_b16 v[200:201], v233 offset:45064
ds_read_b64_tr_b16 v[202:203], v233 offset:45576
v_mfma_f32_16x16x32_bf16 v[180:183], v[204:207], a[148:151], v[180:183]
buffer_load_dwordx4 v237, s[28:31], s50 offen sc1 lds
v_mfma_f32_16x16x32_bf16 v[184:187], v[204:207], a[152:155], v[184:187]
v_rcp_f32 v43, v43
v_mfma_f32_16x16x32_bf16 v[188:191], v[204:207], a[156:159], v[188:191]
s_waitcnt lgkmcnt(6)
v_exp_f32 v46, v46
v_mfma_f32_16x16x32_bf16 v[160:163], v[208:211], a[160:163], v[160:163]
s_add_u32 m0, s49, 114688
ds_read_b64_tr_b16 v[204:205], v233 offset:49152
ds_read_b64_tr_b16 v[206:207], v233 offset:49664
v_mfma_f32_16x16x32_bf16 v[164:167], v[208:211], a[164:167], v[164:167]
buffer_load_dwordx4 v234, s[16:19], s53 offen lds
v_mul_f32 v56, v40, v56
v_mfma_f32_16x16x32_bf16 v[168:171], v[208:211], a[168:171], v[168:171]
v_mul_f32 v57, v41, v57
v_mul_f32 v58, v42, v58
v_mfma_f32_16x16x32_bf16 v[172:175], v[208:211], a[172:175], v[172:175]
s_waitcnt lgkmcnt(6)
v_exp_f32 v47, v47
v_mfma_f32_16x16x32_bf16 v[176:179], v[192:195], a[160:163], v[176:179]
ds_read_b64_tr_b16 v[208:209], v233 offset:49160
ds_read_b64_tr_b16 v[210:211], v233 offset:49672
v_mfma_f32_16x16x32_bf16 v[180:183], v[192:195], a[164:167], v[180:183]
v_add_f32 v44, 1.0, v44
v_add_f32 v45, 1.0, v45
v_mfma_f32_16x16x32_bf16 v[184:187], v[192:195], a[168:171], v[184:187]
v_mul_f32 v59, v43, v59
v_cvt_pk_bf16_f32 v220, v56, v57
v_mfma_f32_16x16x32_bf16 v[188:191], v[192:195], a[172:175], v[188:191]
s_waitcnt lgkmcnt(6)
v_cvt_pk_bf16_f32 v221, v58, v59
v_add_f32 v46, 1.0, v46
v_mfma_f32_16x16x32_bf16 v[160:163], v[196:199], a[176:179], v[160:163]
ds_read_b64_tr_b16 v[192:193], v233 offset:53248
ds_read_b64_tr_b16 v[194:195], v233 offset:53760
v_mfma_f32_16x16x32_bf16 v[164:167], v[196:199], a[180:183], v[164:167]
v_add_f32 v47, 1.0, v47
v_mfma_f32_16x16x32_bf16 v[168:171], v[196:199], a[184:187], v[168:171]
v_rcp_f32 v44, v44
v_mfma_f32_16x16x32_bf16 v[172:175], v[196:199], a[188:191], v[172:175]
s_waitcnt lgkmcnt(6)
v_rcp_f32 v45, v45
v_mfma_f32_16x16x32_bf16 v[176:179], v[200:203], a[176:179], v[176:179]
s_add_u32 m0, s49, 81920
ds_read_b64_tr_b16 v[196:197], v233 offset:53256
ds_read_b64_tr_b16 v[198:199], v233 offset:53768
v_mfma_f32_16x16x32_bf16 v[180:183], v[200:203], a[180:183], v[180:183]
s_add_u32 s50, s57, 8192
buffer_load_dwordx4 v237, s[28:31], s50 offen sc1 lds
v_mul_f32 v64, s96, v64
v_mfma_f32_16x16x32_bf16 v[184:187], v[200:203], a[184:187], v[184:187]
v_rcp_f32 v46, v46
v_mfma_f32_16x16x32_bf16 v[188:191], v[200:203], a[188:191], v[188:191]
s_waitcnt lgkmcnt(6)
v_rcp_f32 v47, v47
v_mfma_f32_16x16x32_bf16 v[160:163], v[204:207], a[192:195], v[160:163]
ds_read_b64_tr_b16 v[200:201], v233 offset:57344
ds_read_b64_tr_b16 v[202:203], v233 offset:57856
v_mfma_f32_16x16x32_bf16 v[164:167], v[204:207], a[196:199], v[164:167]
v_mul_f32 v60, v44, v60
v_mul_f32 v61, v45, v61
v_mfma_f32_16x16x32_bf16 v[168:171], v[204:207], a[200:203], v[168:171]
v_mul_f32 v62, v46, v62
v_mul_f32 v63, v47, v63
v_mfma_f32_16x16x32_bf16 v[172:175], v[204:207], a[204:207], v[172:175]
s_waitcnt lgkmcnt(6)
v_cvt_pk_bf16_f32 v224, v60, v61
v_cvt_pk_bf16_f32 v225, v62, v63
v_mfma_f32_16x16x32_bf16 v[176:179], v[208:211], a[192:195], v[176:179]
s_add_u32 m0, s49, 118784
ds_read_b64_tr_b16 v[204:205], v233 offset:57352
ds_read_b64_tr_b16 v[206:207], v233 offset:57864
v_mfma_f32_16x16x32_bf16 v[180:183], v[208:211], a[196:199], v[180:183]
TCH_3_v0:
s_cbranch_execz TCH_7_v0
s_mov_b32 s53, 295552
buffer_load_dwordx4 v234, s[12:15], s53 offen lds
v_mul_f32 v65, s96, v65
v_mfma_f32_16x16x32_bf16 v[184:187], v[208:211], a[200:203], v[184:187]
s_waitcnt vmcnt(12)
s_barrier
v_mov_b32 v242, 1
buffer_store_dword v242, off, s[40:43], s60 offset:1024 sc1
v_mfma_f32_16x16x32_bf16 v[188:191], v[208:211], a[204:207], v[188:191]
s_waitcnt lgkmcnt(6)
v_mul_f32 v66, s96, v66
v_mul_f32 v67, s96, v67
v_mfma_f32_16x16x32_bf16 v[160:163], v[192:195], a[208:211], v[160:163]
ds_read_b64_tr_b16 v[208:209], v233 offset:61440
ds_read_b64_tr_b16 v[210:211], v233 offset:61952
v_mfma_f32_16x16x32_bf16 v[164:167], v[192:195], a[212:215], v[164:167]
v_exp_f32 v64, v64
v_mfma_f32_16x16x32_bf16 v[168:171], v[192:195], a[216:219], v[168:171]
v_exp_f32 v65, v65
v_mfma_f32_16x16x32_bf16 v[172:175], v[192:195], a[220:223], v[172:175]
s_waitcnt lgkmcnt(6)
v_exp_f32 v66, v66
v_mfma_f32_16x16x32_bf16 v[176:179], v[196:199], a[208:211], v[176:179]
ds_read_b64_tr_b16 v[192:193], v233 offset:61448
ds_read_b64_tr_b16 v[194:195], v233 offset:61960
v_mfma_f32_16x16x32_bf16 v[180:183], v[196:199], a[212:215], v[180:183]
v_add_u32 v233, 65536, v233
v_mul_f32 v68, s96, v68
v_mfma_f32_16x16x32_bf16 v[184:187], v[196:199], a[216:219], v[184:187]
v_exp_f32 v67, v67
v_mfma_f32_16x16x32_bf16 v[188:191], v[196:199], a[220:223], v[188:191]
s_waitcnt lgkmcnt(6)
v_add_f32 v64, 1.0, v64
v_add_f32 v65, 1.0, v65
v_mfma_f32_16x16x32_bf16 v[160:163], v[200:203], a[224:227], v[160:163]
s_add_u32 m0, s49, 86016
ds_read_b64_tr_b16 v[196:197], v233 offset:0
ds_read_b64_tr_b16 v[198:199], v233 offset:512
v_mfma_f32_16x16x32_bf16 v[164:167], v[200:203], a[228:231], v[164:167]
s_add_u32 s50, s57, 12288
buffer_load_dwordx4 v237, s[28:31], s50 offen sc1 lds
v_add_f32 v66, 1.0, v66
v_mfma_f32_16x16x32_bf16 v[168:171], v[200:203], a[232:235], v[168:171]
v_add_f32 v67, 1.0, v67
v_mul_f32 v69, s96, v69
v_mfma_f32_16x16x32_bf16 v[172:175], v[200:203], a[236:239], v[172:175]
s_waitcnt lgkmcnt(6)
v_rcp_f32 v64, v64
v_mfma_f32_16x16x32_bf16 v[176:179], v[204:207], a[224:227], v[176:179]
ds_read_b64_tr_b16 v[200:201], v233 offset:8
ds_read_b64_tr_b16 v[202:203], v233 offset:520
v_mfma_f32_16x16x32_bf16 v[180:183], v[204:207], a[228:231], v[180:183]
v_mul_f32 v70, s96, v70
v_mul_f32 v71, s96, v71
v_mfma_f32_16x16x32_bf16 v[184:187], v[204:207], a[232:235], v[184:187]
v_rcp_f32 v65, v65
v_mfma_f32_16x16x32_bf16 v[188:191], v[204:207], a[236:239], v[188:191]
s_waitcnt lgkmcnt(6)
v_rcp_f32 v66, v66
v_mfma_f32_16x16x32_bf16 v[160:163], v[208:211], a[240:243], v[160:163]
s_add_u32 m0, s49, 122880
ds_read_b64_tr_b16 v[204:205], v233 offset:4096
ds_read_b64_tr_b16 v[206:207], v233 offset:4608
v_mfma_f32_16x16x32_bf16 v[164:167], v[208:211], a[244:247], v[164:167]
v_exp_f32 v68, v68
v_mfma_f32_16x16x32_bf16 v[168:171], v[208:211], a[248:251], v[168:171]
v_exp_f32 v69, v69
v_mfma_f32_16x16x32_bf16 v[172:175], v[208:211], a[252:255], v[172:175]
s_waitcnt lgkmcnt(6)
v_rcp_f32 v67, v67
v_mfma_f32_16x16x32_bf16 v[176:179], v[192:195], a[240:243], v[176:179]
ds_read_b64_tr_b16 v[208:209], v233 offset:4104
ds_read_b64_tr_b16 v[210:211], v233 offset:4616
v_mfma_f32_16x16x32_bf16 v[180:183], v[192:195], a[244:247], v[180:183]
v_xor_b32 v233, 64, v233
v_add_u32 v233, 4294901760, v233
v_mfma_f32_16x16x32_bf16 v[184:187], v[192:195], a[248:251], v[184:187]
buffer_load_dwordx4 v234, s[16:19], s53 offen lds
v_mul_f32 v80, v64, v80
v_mfma_f32_16x16x32_bf16 v[188:191], v[192:195], a[252:255], v[188:191]
s_waitcnt lgkmcnt(6)
v_exp_f32 v70, v70
v_mfma_f32_16x16x32_bf16 v[160:163], v[196:199], v[0:3], v[160:163]
s_add_u32 m0, s49, 90112
ds_read_b64_tr_b16 v[192:193], v233 offset:0
ds_read_b64_tr_b16 v[194:195], v233 offset:512
v_mfma_f32_16x16x32_bf16 v[164:167], v[196:199], v[4:7], v[164:167]
s_add_u32 s50, s57, 16384
buffer_load_dwordx4 v237, s[28:31], s50 offen sc1 lds
v_mul_f32 v81, v65, v81
v_mfma_f32_16x16x32_bf16 v[168:171], v[196:199], v[8:11], v[168:171]
v_exp_f32 v71, v71
v_mfma_f32_16x16x32_bf16 v[172:175], v[196:199], v[12:15], v[172:175]
s_waitcnt lgkmcnt(6)
v_mul_f32 v82, v66, v82
v_mul_f32 v83, v67, v83
v_mfma_f32_16x16x32_bf16 v[176:179], v[200:203], v[0:3], v[176:179]
s_add_u32 s51, s55, 0
ds_read_b64_tr_b16 v[196:197], v233 offset:8
ds_read_b64_tr_b16 v[198:199], v233 offset:520
v_mfma_f32_16x16x32_bf16 v[180:183], v[200:203], v[4:7], v[180:183]
v_add_f32 v68, 1.0, v68
v_add_f32 v69, 1.0, v69
v_mfma_f32_16x16x32_bf16 v[184:187], v[200:203], v[8:11], v[184:187]
v_cvt_pk_bf16_f32 v214, v80, v81
v_cvt_pk_bf16_f32 v215, v82, v83
v_mfma_f32_16x16x32_bf16 v[188:191], v[200:203], v[12:15], v[188:191]
s_waitcnt lgkmcnt(6)
buffer_store_dwordx4 v[212:215], v237, s[28:31], s51 offen offset:0 sc1
v_add_f32 v70, 1.0, v70
v_mfma_f32_16x16x32_bf16 v[160:163], v[204:207], v[16:19], v[160:163]
s_add_u32 m0, s49, 126976
ds_read_b64_tr_b16 v[200:201], v233 offset:4096
ds_read_b64_tr_b16 v[202:203], v233 offset:4608
v_mfma_f32_16x16x32_bf16 v[164:167], v[204:207], v[20:23], v[164:167]
s_mov_b32 s53, 590464
buffer_load_dwordx4 v234, s[12:15], s53 offen lds
v_add_f32 v71, 1.0, v71
v_mfma_f32_16x16x32_bf16 v[168:171], v[204:207], v[24:27], v[168:171]
v_rcp_f32 v68, v68
v_mfma_f32_16x16x32_bf16 v[172:175], v[204:207], v[28:31], v[172:175]
s_waitcnt lgkmcnt(6)
v_mul_f32 v72, s96, v72
v_mul_f32 v73, s96, v73
v_mfma_f32_16x16x32_bf16 v[176:179], v[208:211], v[16:19], v[176:179]
ds_read_b64_tr_b16 v[204:205], v233 offset:4104
ds_read_b64_tr_b16 v[206:207], v233 offset:4616
v_mfma_f32_16x16x32_bf16 v[180:183], v[208:211], v[20:23], v[180:183]
v_mul_f32 v74, s96, v74
v_mul_f32 v75, s96, v75
v_mfma_f32_16x16x32_bf16 v[184:187], v[208:211], v[24:27], v[184:187]
v_rcp_f32 v69, v69
v_mfma_f32_16x16x32_bf16 v[188:191], v[208:211], v[28:31], v[188:191]
s_waitcnt lgkmcnt(6)
v_rcp_f32 v70, v70
v_mfma_f32_16x16x32_bf16 v[32:35], v[192:195], a[0:3], 0
ds_read_b64_tr_b16 v[208:209], v233 offset:8192
ds_read_b64_tr_b16 v[210:211], v233 offset:8704
v_mfma_f32_16x16x32_bf16 v[36:39], v[192:195], a[4:7], 0
v_exp_f32 v72, v72
v_mfma_f32_16x16x32_bf16 v[40:43], v[192:195], a[8:11], 0
v_exp_f32 v73, v73
v_mfma_f32_16x16x32_bf16 v[44:47], v[192:195], a[12:15], 0
s_waitcnt lgkmcnt(6)
v_rcp_f32 v71, v71
v_mfma_f32_16x16x32_bf16 v[48:51], v[196:199], a[0:3], 0
s_add_u32 m0, s49, 94208
ds_read_b64_tr_b16 v[192:193], v233 offset:8200
ds_read_b64_tr_b16 v[194:195], v233 offset:8712
v_mfma_f32_16x16x32_bf16 v[52:55], v[196:199], a[4:7], 0
s_add_u32 s50, s57, 20480
buffer_load_dwordx4 v237, s[28:31], s50 offen sc1 lds
v_mul_f32 v84, v68, v84
v_mfma_f32_16x16x32_bf16 v[56:59], v[196:199], a[8:11], 0
v_exp_f32 v74, v74
v_mfma_f32_16x16x32_bf16 v[60:63], v[196:199], a[12:15], 0
s_waitcnt lgkmcnt(6)
v_exp_f32 v75, v75
v_mfma_f32_16x16x32_bf16 v[32:35], v[200:203], a[16:19], v[32:35]
ds_read_b64_tr_b16 v[196:197], v233 offset:12288
ds_read_b64_tr_b16 v[198:199], v233 offset:12800
v_mfma_f32_16x16x32_bf16 v[36:39], v[200:203], a[20:23], v[36:39]
v_mul_f32 v85, v69, v85
v_mul_f32 v86, v70, v86
v_mfma_f32_16x16x32_bf16 v[40:43], v[200:203], a[24:27], v[40:43]
v_mul_f32 v87, v71, v87
v_add_f32 v72, 1.0, v72
v_mfma_f32_16x16x32_bf16 v[44:47], v[200:203], a[28:31], v[44:47]
s_waitcnt lgkmcnt(6)
v_add_f32 v73, 1.0, v73
v_add_f32 v74, 1.0, v74
v_mfma_f32_16x16x32_bf16 v[48:51], v[204:207], a[16:19], v[48:51]
s_add_u32 s66, s55, 0
ds_read_b64_tr_b16 v[200:201], v233 offset:12296
ds_read_b64_tr_b16 v[202:203], v233 offset:12808
v_mfma_f32_16x16x32_bf16 v[52:55], v[204:207], a[20:23], v[52:55]
s_add_u32 m0, s49, 131072
v_cvt_pk_bf16_f32 v218, v84, v85
v_cvt_pk_bf16_f32 v219, v86, v87
v_mfma_f32_16x16x32_bf16 v[56:59], v[204:207], a[24:27], v[56:59]
buffer_store_dwordx4 v[216:219], v237, s[28:31], s66 offen offset:1024 sc1
buffer_load_dwordx4 v234, s[16:19], s53 offen lds
v_mfma_f32_16x16x32_bf16 v[60:63], v[204:207], a[28:31], v[60:63]
s_waitcnt lgkmcnt(6)
v_add_f32 v75, 1.0, v75
v_mul_f32 v76, s96, v76
v_mfma_f32_16x16x32_bf16 v[32:35], v[208:211], a[32:35], v[32:35]
ds_read_b64_tr_b16 v[204:205], v233 offset:16384
ds_read_b64_tr_b16 v[206:207], v233 offset:16896
v_mfma_f32_16x16x32_bf16 v[36:39], v[208:211], a[36:39], v[36:39]
v_rcp_f32 v72, v72
v_mfma_f32_16x16x32_bf16 v[40:43], v[208:211], a[40:43], v[40:43]
v_mul_f32 v77, s96, v77
v_mul_f32 v78, s96, v78
v_mfma_f32_16x16x32_bf16 v[44:47], v[208:211], a[44:47], v[44:47]
s_waitcnt lgkmcnt(6)
v_rcp_f32 v73, v73
v_mfma_f32_16x16x32_bf16 v[48:51], v[192:195], a[32:35], v[48:51]
ds_read_b64_tr_b16 v[208:209], v233 offset:16392
ds_read_b64_tr_b16 v[210:211], v233 offset:16904
v_mfma_f32_16x16x32_bf16 v[52:55], v[192:195], a[36:39], v[52:55]
v_rcp_f32 v74, v74
v_mfma_f32_16x16x32_bf16 v[56:59], v[192:195], a[40:43], v[56:59]
v_rcp_f32 v75, v75
v_mfma_f32_16x16x32_bf16 v[60:63], v[192:195], a[44:47], v[60:63]
s_waitcnt lgkmcnt(6)
v_mul_f32 v79, s96, v79
v_mul_f32 v88, v72, v88
v_mfma_f32_16x16x32_bf16 v[32:35], v[196:199], a[48:51], v[32:35]
s_add_u32 m0, s49, 98304
ds_read_b64_tr_b16 v[192:193], v233 offset:20480
ds_read_b64_tr_b16 v[194:195], v233 offset:20992
v_mfma_f32_16x16x32_bf16 v[36:39], v[196:199], a[52:55], v[36:39]
s_add_u32 s50, s57, 24576
buffer_load_dwordx4 v237, s[28:31], s50 offen sc1 lds
v_mul_f32 v89, v73, v89
v_mfma_f32_16x16x32_bf16 v[40:43], v[196:199], a[56:59], v[40:43]
v_exp_f32 v76, v76
v_mfma_f32_16x16x32_bf16 v[44:47], v[196:199], a[60:63], v[44:47]
s_waitcnt lgkmcnt(6)
v_exp_f32 v77, v77
v_mfma_f32_16x16x32_bf16 v[48:51], v[200:203], a[48:51], v[48:51]
ds_read_b64_tr_b16 v[196:197], v233 offset:20488
ds_read_b64_tr_b16 v[198:199], v233 offset:21000
v_mfma_f32_16x16x32_bf16 v[52:55], v[200:203], a[52:55], v[52:55]
v_exp_f32 v78, v78
v_mfma_f32_16x16x32_bf16 v[56:59], v[200:203], a[56:59], v[56:59]
v_exp_f32 v79, v79
v_mfma_f32_16x16x32_bf16 v[60:63], v[200:203], a[60:63], v[60:63]
s_waitcnt lgkmcnt(6)
v_mul_f32 v90, v74, v90
v_mul_f32 v91, v75, v91
v_mfma_f32_16x16x32_bf16 v[32:35], v[204:207], a[64:67], v[32:35]
s_add_u32 m0, s49, 135168
ds_read_b64_tr_b16 v[200:201], v233 offset:24576
ds_read_b64_tr_b16 v[202:203], v233 offset:25088
v_mfma_f32_16x16x32_bf16 v[36:39], v[204:207], a[68:71], v[36:39]
s_mov_b32 s53, 885376
buffer_load_dwordx4 v234, s[12:15], s53 offen lds
v_add_f32 v76, 1.0, v76
v_mfma_f32_16x16x32_bf16 v[40:43], v[204:207], a[72:75], v[40:43]
v_add_f32 v77, 1.0, v77
v_cvt_pk_bf16_f32 v222, v88, v89
v_mfma_f32_16x16x32_bf16 v[44:47], v[204:207], a[76:79], v[44:47]
s_waitcnt lgkmcnt(6)
v_cvt_pk_bf16_f32 v223, v90, v91
v_add_f32 v78, 1.0, v78
v_mfma_f32_16x16x32_bf16 v[48:51], v[208:211], a[64:67], v[48:51]
s_xor_b32 s64, s69, 0
ds_read_b64_tr_b16 v[204:205], v233 offset:24584
ds_read_b64_tr_b16 v[206:207], v233 offset:25096
v_mfma_f32_16x16x32_bf16 v[52:55], v[208:211], a[68:71], v[52:55]
s_add_u32 s64, s76, s64
buffer_store_dwordx4 v[220:223], v237, s[28:31], s51 offen offset:2048 sc1
v_add_f32 v79, 1.0, v79
v_mfma_f32_16x16x32_bf16 v[56:59], v[208:211], a[72:75], v[56:59]
s_and_b32 s64, s64, 3
v_rcp_f32 v76, v76
v_mfma_f32_16x16x32_bf16 v[60:63], v[208:211], a[76:79], v[60:63]
s_waitcnt lgkmcnt(6)
v_rcp_f32 v77, v77
v_mfma_f32_16x16x32_bf16 v[32:35], v[192:195], a[80:83], v[32:35]
s_mul_i32 s64, s64, 55296
ds_read_b64_tr_b16 v[208:209], v233 offset:28672
ds_read_b64_tr_b16 v[210:211], v233 offset:29184
v_mfma_f32_16x16x32_bf16 v[36:39], v[192:195], a[84:87], v[36:39]
s_add_u32 s11, s97, 0
v_rcp_f32 v78, v78
v_mfma_f32_16x16x32_bf16 v[40:43], v[192:195], a[88:91], v[40:43]
s_add_u32 m0, s49, 102400
v_rcp_f32 v79, v79
v_mfma_f32_16x16x32_bf16 v[44:47], v[192:195], a[92:95], v[44:47]
s_waitcnt lgkmcnt(6)
v_mul_f32 v92, v76, v92
v_mul_f32 v93, v77, v93
v_mfma_f32_16x16x32_bf16 v[48:51], v[196:199], a[80:83], v[48:51]
s_add_u32 s50, s57, 28672
ds_read_b64_tr_b16 v[192:193], v233 offset:28680
ds_read_b64_tr_b16 v[194:195], v233 offset:29192
v_mfma_f32_16x16x32_bf16 v[52:55], v[196:199], a[84:87], v[52:55]
s_add_u32 s64, s64, s58
buffer_load_dwordx4 v237, s[28:31], s50 offen sc1 lds
v_mul_f32 v94, v78, v94
v_mfma_f32_16x16x32_bf16 v[56:59], v[196:199], a[88:91], v[56:59]
v_mul_f32 v95, v79, v95
v_cvt_pk_bf16_f32 v226, v92, v93
v_mfma_f32_16x16x32_bf16 v[60:63], v[196:199], a[92:95], v[60:63]
s_waitcnt lgkmcnt(6)
v_cvt_pk_bf16_f32 v227, v94, v95
v_mul_f32 v96, s96, v96
v_mfma_f32_16x16x32_bf16 v[32:35], v[200:203], a[96:99], v[32:35]
s_add_u32 m0, s49, 139264
ds_read_b64_tr_b16 v[196:197], v233 offset:32768
ds_read_b64_tr_b16 v[198:199], v233 offset:33280
v_mfma_f32_16x16x32_bf16 v[36:39], v[200:203], a[100:103], v[36:39]
buffer_store_dwordx4 v[224:227], v237, s[28:31], s66 offen offset:3072 sc1
v_mul_f32 v97, s96, v97
v_mfma_f32_16x16x32_bf16 v[40:43], v[200:203], a[104:107], v[40:43]
v_mul_f32 v98, s96, v98
v_mul_f32 v99, s96, v99
v_mfma_f32_16x16x32_bf16 v[44:47], v[200:203], a[108:111], v[44:47]
s_waitcnt lgkmcnt(6)
v_cvt_pk_bf16_f32 v160, v160, v161
v_cvt_pk_bf16_f32 v161, v162, v163
v_mfma_f32_16x16x32_bf16 v[48:51], v[204:207], a[96:99], v[48:51]
ds_read_b64_tr_b16 v[200:201], v233 offset:32776
ds_read_b64_tr_b16 v[202:203], v233 offset:33288
v_mfma_f32_16x16x32_bf16 v[52:55], v[204:207], a[100:103], v[52:55]
v_exp_f32 v96, v96
v_mfma_f32_16x16x32_bf16 v[56:59], v[204:207], a[104:107], v[56:59]
v_exp_f32 v97, v97
v_mfma_f32_16x16x32_bf16 v[60:63], v[204:207], a[108:111], v[60:63]
s_waitcnt lgkmcnt(6)
buffer_load_dwordx4 v234, s[16:19], s53 offen lds
v_cvt_pk_bf16_f32 v162, v176, v177
v_mfma_f32_16x16x32_bf16 v[32:35], v[208:211], a[112:115], v[32:35]
ds_read_b64_tr_b16 v[204:205], v233 offset:36864
ds_read_b64_tr_b16 v[206:207], v233 offset:37376
v_mfma_f32_16x16x32_bf16 v[36:39], v[208:211], a[116:119], v[36:39]
v_exp_f32 v98, v98
v_mfma_f32_16x16x32_bf16 v[40:43], v[208:211], a[120:123], v[40:43]
v_cvt_pk_bf16_f32 v163, v178, v179
v_mul_f32 v100, s96, v100
v_mfma_f32_16x16x32_bf16 v[44:47], v[208:211], a[124:127], v[44:47]
s_waitcnt lgkmcnt(6)
v_exp_f32 v99, v99
v_mfma_f32_16x16x32_bf16 v[48:51], v[192:195], a[112:115], v[48:51]
s_add_u32 m0, s49, 106496
ds_read_b64_tr_b16 v[208:209], v233 offset:36872
ds_read_b64_tr_b16 v[210:211], v233 offset:37384
v_mfma_f32_16x16x32_bf16 v[52:55], v[192:195], a[116:119], v[52:55]
s_add_u32 s50, s57, 32768
buffer_store_dwordx4 v[160:163], v239, s[32:35], s64 offen sc1
v_add_f32 v96, 1.0, v96
v_mfma_f32_16x16x32_bf16 v[56:59], v[192:195], a[120:123], v[56:59]
s_xor_b32 s64, s69, 1
v_add_f32 v97, 1.0, v97
v_add_f32 v98, 1.0, v98
v_mfma_f32_16x16x32_bf16 v[60:63], v[192:195], a[124:127], v[60:63]
s_waitcnt lgkmcnt(6)
v_add_f32 v99, 1.0, v99
v_mul_f32 v101, s96, v101
v_mfma_f32_16x16x32_bf16 v[32:35], v[196:199], a[128:131], v[32:35]
s_add_u32 s64, s76, s64
ds_read_b64_tr_b16 v[192:193], v233 offset:40960
ds_read_b64_tr_b16 v[194:195], v233 offset:41472
v_mfma_f32_16x16x32_bf16 v[36:39], v[196:199], a[132:135], v[36:39]
s_and_b32 s64, s64, 3
v_rcp_f32 v96, v96
v_mfma_f32_16x16x32_bf16 v[40:43], v[196:199], a[136:139], v[40:43]
s_mul_i32 s64, s64, 55296
v_mul_f32 v102, s96, v102
v_mul_f32 v103, s96, v103
v_mfma_f32_16x16x32_bf16 v[44:47], v[196:199], a[140:143], v[44:47]
s_waitcnt lgkmcnt(6)
v_rcp_f32 v97, v97
v_mfma_f32_16x16x32_bf16 v[48:51], v[200:203], a[128:131], v[48:51]
s_add_u32 s64, s64, s58
ds_read_b64_tr_b16 v[196:197], v233 offset:40968
ds_read_b64_tr_b16 v[198:199], v233 offset:41480
v_mfma_f32_16x16x32_bf16 v[52:55], v[200:203], a[132:135], v[52:55]
v_exp_f32 v100, v100
v_mfma_f32_16x16x32_bf16 v[56:59], v[200:203], a[136:139], v[56:59]
v_exp_f32 v101, v101
v_mfma_f32_16x16x32_bf16 v[60:63], v[200:203], a[140:143], v[60:63]
s_waitcnt lgkmcnt(6)
v_cvt_pk_bf16_f32 v164, v164, v165
v_cvt_pk_bf16_f32 v165, v166, v167
v_mfma_f32_16x16x32_bf16 v[32:35], v[204:207], a[144:147], v[32:35]
ds_read_b64_tr_b16 v[200:201], v233 offset:45056
ds_read_b64_tr_b16 v[202:203], v233 offset:45568
v_mfma_f32_16x16x32_bf16 v[36:39], v[204:207], a[148:151], v[36:39]
v_rcp_f32 v98, v98
v_mfma_f32_16x16x32_bf16 v[40:43], v[204:207], a[152:155], v[40:43]
v_rcp_f32 v99, v99
v_mfma_f32_16x16x32_bf16 v[44:47], v[204:207], a[156:159], v[44:47]
s_waitcnt lgkmcnt(6)
v_exp_f32 v102, v102
v_mfma_f32_16x16x32_bf16 v[48:51], v[208:211], a[144:147], v[48:51]
ds_read_b64_tr_b16 v[204:205], v233 offset:45064
ds_read_b64_tr_b16 v[206:207], v233 offset:45576
v_mfma_f32_16x16x32_bf16 v[52:55], v[208:211], a[148:151], v[52:55]
v_mul_f32 v112, v96, v112
v_mul_f32 v113, v97, v113
v_mfma_f32_16x16x32_bf16 v[56:59], v[208:211], a[152:155], v[56:59]
buffer_load_dwordx4 v237, s[28:31], s50 offen sc1 lds
v_mul_f32 v114, v98, v114
v_mfma_f32_16x16x32_bf16 v[60:63], v[208:211], a[156:159], v[60:63]
s_waitcnt lgkmcnt(6)
v_exp_f32 v103, v103
v_mfma_f32_16x16x32_bf16 v[32:35], v[192:195], a[160:163], v[32:35]
s_add_u32 m0, s49, 143360
ds_read_b64_tr_b16 v[208:209], v233 offset:49152
ds_read_b64_tr_b16 v[210:211], v233 offset:49664
v_mfma_f32_16x16x32_bf16 v[36:39], v[192:195], a[164:167], v[36:39]
s_mov_b32 s53, 1180288
v_add_f32 v100, 1.0, v100
v_add_f32 v101, 1.0, v101
v_mfma_f32_16x16x32_bf16 v[40:43], v[192:195], a[168:171], v[40:43]
buffer_load_dwordx4 v234, s[12:15], s53 offen lds
v_cvt_pk_bf16_f32 v166, v180, v181
v_mfma_f32_16x16x32_bf16 v[44:47], v[192:195], a[172:175], v[44:47]
s_waitcnt lgkmcnt(6)
v_mul_f32 v115, v99, v115
v_cvt_pk_bf16_f32 v212, v112, v113
v_mfma_f32_16x16x32_bf16 v[48:51], v[196:199], a[160:163], v[48:51]
ds_read_b64_tr_b16 v[192:193], v233 offset:49160
ds_read_b64_tr_b16 v[194:195], v233 offset:49672
v_mfma_f32_16x16x32_bf16 v[52:55], v[196:199], a[164:167], v[52:55]
v_cvt_pk_bf16_f32 v213, v114, v115
v_add_f32 v102, 1.0, v102
v_mfma_f32_16x16x32_bf16 v[56:59], v[196:199], a[168:171], v[56:59]
v_add_f32 v103, 1.0, v103
v_cvt_pk_bf16_f32 v167, v182, v183
v_mfma_f32_16x16x32_bf16 v[60:63], v[196:199], a[172:175], v[60:63]
s_waitcnt lgkmcnt(6)
v_rcp_f32 v100, v100
v_mfma_f32_16x16x32_bf16 v[32:35], v[200:203], a[176:179], v[32:35]
s_add_u32 m0, s49, 147456
ds_read_b64_tr_b16 v[196:197], v233 offset:53248
ds_read_b64_tr_b16 v[198:199], v233 offset:53760
v_mfma_f32_16x16x32_bf16 v[36:39], v[200:203], a[180:183], v[36:39]
buffer_store_dwordx4 v[164:167], v239, s[32:35], s64 offen sc1
v_mul_f32 v104, s96, v104
v_mfma_f32_16x16x32_bf16 v[40:43], v[200:203], a[184:187], v[40:43]
s_xor_b32 s64, s69, 2
v_mul_f32 v105, s96, v105
v_mul_f32 v106, s96, v106
v_mfma_f32_16x16x32_bf16 v[44:47], v[200:203], a[188:191], v[44:47]
s_waitcnt lgkmcnt(6)
v_rcp_f32 v101, v101
v_mfma_f32_16x16x32_bf16 v[48:51], v[204:207], a[176:179], v[48:51]
s_add_u32 s64, s76, s64
ds_read_b64_tr_b16 v[200:201], v233 offset:53256
ds_read_b64_tr_b16 v[202:203], v233 offset:53768
v_mfma_f32_16x16x32_bf16 v[52:55], v[204:207], a[180:183], v[52:55]
s_and_b32 s64, s64, 3
v_rcp_f32 v102, v102
v_mfma_f32_16x16x32_bf16 v[56:59], v[204:207], a[184:187], v[56:59]
s_mul_i32 s64, s64, 55296
v_rcp_f32 v103, v103
v_mfma_f32_16x16x32_bf16 v[60:63], v[204:207], a[188:191], v[60:63]
s_waitcnt lgkmcnt(6)
v_mul_f32 v107, s96, v107
v_mul_f32 v116, v100, v116
v_mfma_f32_16x16x32_bf16 v[32:35], v[208:211], a[192:195], v[32:35]
s_add_u32 s64, s64, s58
ds_read_b64_tr_b16 v[204:205], v233 offset:57344
ds_read_b64_tr_b16 v[206:207], v233 offset:57856
v_mfma_f32_16x16x32_bf16 v[36:39], v[208:211], a[196:199], v[36:39]
v_exp_f32 v104, v104
v_mfma_f32_16x16x32_bf16 v[40:43], v[208:211], a[200:203], v[40:43]
v_exp_f32 v105, v105
v_mfma_f32_16x16x32_bf16 v[44:47], v[208:211], a[204:207], v[44:47]
s_waitcnt lgkmcnt(6)
v_exp_f32 v106, v106
v_mfma_f32_16x16x32_bf16 v[48:51], v[192:195], a[192:195], v[48:51]
ds_read_b64_tr_b16 v[208:209], v233 offset:57352
ds_read_b64_tr_b16 v[210:211], v233 offset:57864
v_mfma_f32_16x16x32_bf16 v[52:55], v[192:195], a[196:199], v[52:55]
v_mul_f32 v117, v101, v117
v_mul_f32 v118, v102, v118
v_mfma_f32_16x16x32_bf16 v[56:59], v[192:195], a[200:203], v[56:59]
v_cvt_pk_bf16_f32 v168, v168, v169
v_mul_f32 v119, v103, v119
v_mfma_f32_16x16x32_bf16 v[60:63], v[192:195], a[204:207], v[60:63]
s_waitcnt lgkmcnt(6)
v_exp_f32 v107, v107
v_mfma_f32_16x16x32_bf16 v[32:35], v[196:199], a[208:211], v[32:35]
s_waitcnt vmcnt(5)
ds_read_b64_tr_b16 v[192:193], v233 offset:61440
ds_read_b64_tr_b16 v[194:195], v233 offset:61952
v_mfma_f32_16x16x32_bf16 v[36:39], v[196:199], a[212:215], v[36:39]
v_add_f32 v104, 1.0, v104
v_add_f32 v105, 1.0, v105
v_mfma_f32_16x16x32_bf16 v[40:43], v[196:199], a[216:219], v[40:43]
buffer_store_dword v242, off, s[28:31], s11 sc1
v_cvt_pk_bf16_f32 v216, v116, v117
v_mfma_f32_16x16x32_bf16 v[44:47], v[196:199], a[220:223], v[44:47]
s_waitcnt lgkmcnt(6)
v_cvt_pk_bf16_f32 v217, v118, v119
v_cvt_pk_bf16_f32 v169, v170, v171
v_mfma_f32_16x16x32_bf16 v[48:51], v[200:203], a[208:211], v[48:51]
ds_read_b64_tr_b16 v[196:197], v233 offset:61448
ds_read_b64_tr_b16 v[198:199], v233 offset:61960
v_mfma_f32_16x16x32_bf16 v[52:55], v[200:203], a[212:215], v[52:55]
v_add_u32 v233, 65536, v233
v_cvt_pk_bf16_f32 v170, v184, v185
v_mfma_f32_16x16x32_bf16 v[56:59], v[200:203], a[216:219], v[56:59]
buffer_load_dwordx4 v234, s[16:19], s53 offen lds
v_add_f32 v106, 1.0, v106
v_mfma_f32_16x16x32_bf16 v[60:63], v[200:203], a[220:223], v[60:63]
s_waitcnt lgkmcnt(6)
v_add_f32 v107, 1.0, v107
v_mul_f32 v108, s96, v108
v_mfma_f32_16x16x32_bf16 v[32:35], v[204:207], a[224:227], v[32:35]
s_add_u32 m0, s49, 151552
ds_read_b64_tr_b16 v[200:201], v233 offset:0
ds_read_b64_tr_b16 v[202:203], v233 offset:512
v_mfma_f32_16x16x32_bf16 v[36:39], v[204:207], a[228:231], v[36:39]
s_mov_b32 s53, 1475200
buffer_load_dwordx4 v234, s[12:15], s53 offen lds
v_mul_f32 v109, s96, v109
v_mfma_f32_16x16x32_bf16 v[40:43], v[204:207], a[232:235], v[40:43]
v_rcp_f32 v104, v104
v_mfma_f32_16x16x32_bf16 v[44:47], v[204:207], a[236:239], v[44:47]
s_waitcnt lgkmcnt(6)
v_mul_f32 v110, s96, v110
v_mul_f32 v111, s96, v111
v_mfma_f32_16x16x32_bf16 v[48:51], v[208:211], a[224:227], v[48:51]
ds_read_b64_tr_b16 v[204:205], v233 offset:8
ds_read_b64_tr_b16 v[206:207], v233 offset:520
v_mfma_f32_16x16x32_bf16 v[52:55], v[208:211], a[228:231], v[52:55]
v_rcp_f32 v105, v105
v_mfma_f32_16x16x32_bf16 v[56:59], v[208:211], a[232:235], v[56:59]
v_exp_f32 v108, v108
v_mfma_f32_16x16x32_bf16 v[60:63], v[208:211], a[236:239], v[60:63]
s_waitcnt lgkmcnt(6)
v_exp_f32 v109, v109
v_mfma_f32_16x16x32_bf16 v[32:35], v[192:195], a[240:243], v[32:35]
ds_read_b64_tr_b16 v[208:209], v233 offset:4096
ds_read_b64_tr_b16 v[210:211], v233 offset:4608
v_mfma_f32_16x16x32_bf16 v[36:39], v[192:195], a[244:247], v[36:39]
v_rcp_f32 v106, v106
v_mfma_f32_16x16x32_bf16 v[40:43], v[192:195], a[248:251], v[40:43]
v_rcp_f32 v107, v107
v_mfma_f32_16x16x32_bf16 v[44:47], v[192:195], a[252:255], v[44:47]
s_waitcnt lgkmcnt(6)
v_cvt_pk_bf16_f32 v171, v186, v187
v_mul_f32 v120, v104, v120
v_mfma_f32_16x16x32_bf16 v[48:51], v[196:199], a[240:243], v[48:51]
s_add_u32 m0, s49, 155648
ds_read_b64_tr_b16 v[192:193], v233 offset:4104
ds_read_b64_tr_b16 v[194:195], v233 offset:4616
v_mfma_f32_16x16x32_bf16 v[52:55], v[196:199], a[244:247], v[52:55]
v_add_u32 v232, 65536, v232
v_mul_f32 v121, v105, v121
v_mfma_f32_16x16x32_bf16 v[56:59], v[196:199], a[248:251], v[56:59]
s_waitcnt vmcnt(5)
s_barrier
v_mfma_f32_16x16x32_bf16 v[60:63], v[196:199], a[252:255], v[60:63]
s_waitcnt lgkmcnt(6)
buffer_store_dwordx4 v[168:171], v239, s[32:35], s64 offen sc1
v_mul_f32 v122, v106, v122
v_mfma_f32_16x16x32_bf16 v[32:35], v[200:203], v[0:3], v[32:35]
s_xor_b32 s64, s69, 3
ds_read_b64_tr_b16 v[196:197], v232 offset:8192
ds_read_b64_tr_b16 v[198:199], v232 offset:8448
v_mfma_f32_16x16x32_bf16 v[36:39], v[200:203], v[4:7], v[36:39]
s_add_u32 s64, s76, s64
v_exp_f32 v110, v110
v_mfma_f32_16x16x32_bf16 v[40:43], v[200:203], v[8:11], v[40:43]
s_and_b32 s64, s64, 3
v_exp_f32 v111, v111
v_mfma_f32_16x16x32_bf16 v[44:47], v[200:203], v[12:15], v[44:47]
s_waitcnt lgkmcnt(6)
v_add_f32 v108, 1.0, v108
v_add_f32 v109, 1.0, v109
v_mfma_f32_16x16x32_bf16 v[48:51], v[204:207], v[0:3], v[48:51]
s_mul_i32 s64, s64, 55296
ds_read_b64_tr_b16 v[200:201], v232 offset:9216
ds_read_b64_tr_b16 v[202:203], v232 offset:9472
v_mfma_f32_16x16x32_bf16 v[52:55], v[204:207], v[4:7], v[52:55]
s_add_u32 s64, s64, s58
v_cvt_pk_bf16_f32 v172, v172, v173
v_mul_f32 v123, v107, v123
v_mfma_f32_16x16x32_bf16 v[56:59], v[204:207], v[8:11], v[56:59]
v_cvt_pk_bf16_f32 v220, v120, v121
v_cvt_pk_bf16_f32 v221, v122, v123
v_mfma_f32_16x16x32_bf16 v[60:63], v[204:207], v[12:15], v[60:63]
s_waitcnt lgkmcnt(6)
v_add_f32 v110, 1.0, v110
v_add_f32 v111, 1.0, v111
v_mfma_f32_16x16x32_bf16 v[32:35], v[208:211], v[16:19], v[32:35]
ds_read_b64_tr_b16 v[204:205], v232 offset:10240
ds_read_b64_tr_b16 v[206:207], v232 offset:10496
v_mfma_f32_16x16x32_bf16 v[36:39], v[208:211], v[20:23], v[36:39]
buffer_load_dwordx4 v234, s[16:19], s53 offen lds
v_cvt_pk_bf16_f32 v173, v174, v175
v_mfma_f32_16x16x32_bf16 v[40:43], v[208:211], v[24:27], v[40:43]
v_rcp_f32 v108, v108
v_mfma_f32_16x16x32_bf16 v[44:47], v[208:211], v[28:31], v[44:47]
s_waitcnt lgkmcnt(6)
v_rcp_f32 v109, v109
v_mfma_f32_16x16x32_bf16 v[48:51], v[192:195], v[16:19], v[48:51]
ds_read_b64_tr_b16 v[208:209], v232 offset:11264
ds_read_b64_tr_b16 v[210:211], v232 offset:11520
v_mfma_f32_16x16x32_bf16 v[52:55], v[192:195], v[20:23], v[52:55]
v_cvt_pk_bf16_f32 v174, v188, v189
v_cvt_pk_bf16_f32 v175, v190, v191
v_mfma_f32_16x16x32_bf16 v[56:59], v[192:195], v[24:27], v[56:59]
buffer_store_dwordx4 v[172:175], v239, s[32:35], s64 offen sc1
v_mul_f32 v128, s96, v128
v_mfma_f32_16x16x32_bf16 v[60:63], v[192:195], v[28:31], v[60:63]
s_waitcnt lgkmcnt(6)
v_rcp_f32 v110, v110
v_mfma_f32_16x16x32_bf16 v[64:67], v[196:199], a[0:3], 0
ds_read_b64_tr_b16 v[192:193], v232 offset:12288
ds_read_b64_tr_b16 v[194:195], v232 offset:12544
v_mfma_f32_16x16x32_bf16 v[68:71], v[196:199], a[4:7], 0
v_rcp_f32 v111, v111
v_mfma_f32_16x16x32_bf16 v[72:75], v[196:199], a[8:11], 0
v_mul_f32 v124, v108, v124
v_mul_f32 v125, v109, v125
v_mfma_f32_16x16x32_bf16 v[76:79], v[196:199], a[12:15], 0
s_waitcnt lgkmcnt(6)
v_mul_f32 v126, v110, v126
v_mul_f32 v127, v111, v127
v_mfma_f32_16x16x32_bf16 v[80:83], v[200:203], a[0:3], 0
s_add_u32 m0, s49, 0
ds_read_b64_tr_b16 v[196:197], v232 offset:13312
ds_read_b64_tr_b16 v[198:199], v232 offset:13568
v_mfma_f32_16x16x32_bf16 v[84:87], v[200:203], a[4:7], 0
s_mov_b32 s53, 1770112
v_cvt_pk_bf16_f32 v224, v124, v125
v_cvt_pk_bf16_f32 v225, v126, v127
v_mfma_f32_16x16x32_bf16 v[88:91], v[200:203], a[8:11], 0
v_mul_f32 v129, s96, v129
v_mul_f32 v130, s96, v130
v_mfma_f32_16x16x32_bf16 v[92:95], v[200:203], a[12:15], 0
s_waitcnt lgkmcnt(6)
v_mul_f32 v131, s96, v131
v_mul_f32 v132, s96, v132
v_mfma_f32_16x16x32_bf16 v[64:67], v[204:207], a[16:19], v[64:67]
ds_read_b64_tr_b16 v[200:201], v232 offset:14336
ds_read_b64_tr_b16 v[202:203], v232 offset:14592
v_mfma_f32_16x16x32_bf16 v[68:71], v[204:207], a[20:23], v[68:71]
v_exp_f32 v128, v128
v_mfma_f32_16x16x32_bf16 v[72:75], v[204:207], a[24:27], v[72:75]
v_exp_f32 v129, v129
v_mfma_f32_16x16x32_bf16 v[76:79], v[204:207], a[28:31], v[76:79]
TCH_4_v0:
s_cbranch_execz TCH_8_v0
s_waitcnt lgkmcnt(6)
v_exp_f32 v130, v130
v_mfma_f32_16x16x32_bf16 v[80:83], v[208:211], a[16:19], v[80:83]
ds_read_b64_tr_b16 v[204:205], v232 offset:15360
ds_read_b64_tr_b16 v[206:207], v232 offset:15616
v_mfma_f32_16x16x32_bf16 v[84:87], v[208:211], a[20:23], v[84:87]
v_exp_f32 v131, v131
v_mfma_f32_16x16x32_bf16 v[88:91], v[208:211], a[24:27], v[88:91]
v_add_f32 v128, 1.0, v128
v_add_f32 v129, 1.0, v129
v_mfma_f32_16x16x32_bf16 v[92:95], v[208:211], a[28:31], v[92:95]
s_waitcnt lgkmcnt(6)
v_add_f32 v130, 1.0, v130
v_add_f32 v131, 1.0, v131
v_mfma_f32_16x16x32_bf16 v[64:67], v[192:195], a[32:35], v[64:67]
ds_read_b64_tr_b16 v[208:209], v232 offset:16384
ds_read_b64_tr_b16 v[210:211], v232 offset:16640
v_mfma_f32_16x16x32_bf16 v[68:71], v[192:195], a[36:39], v[68:71]
buffer_load_dwordx4 v234, s[12:15], s53 offen lds
v_mul_f32 v133, s96, v133
v_mfma_f32_16x16x32_bf16 v[72:75], v[192:195], a[40:43], v[72:75]
s_add_u32 m0, s49, 4096
v_rcp_f32 v128, v128
v_mfma_f32_16x16x32_bf16 v[76:79], v[192:195], a[44:47], v[76:79]
s_waitcnt lgkmcnt(6)
v_rcp_f32 v129, v129
v_mfma_f32_16x16x32_bf16 v[80:83], v[196:199], a[32:35], v[80:83]
ds_read_b64_tr_b16 v[192:193], v232 offset:17408
ds_read_b64_tr_b16 v[194:195], v232 offset:17664
v_mfma_f32_16x16x32_bf16 v[84:87], v[196:199], a[36:39], v[84:87]
v_mul_f32 v134, s96, v134
v_mul_f32 v135, s96, v135
v_mfma_f32_16x16x32_bf16 v[88:91], v[196:199], a[40:43], v[88:91]
buffer_load_dwordx4 v234, s[16:19], s53 offen lds
v_mfma_f32_16x16x32_bf16 v[92:95], v[196:199], a[44:47], v[92:95]
s_waitcnt lgkmcnt(6)
v_rcp_f32 v130, v130
v_mfma_f32_16x16x32_bf16 v[64:67], v[200:203], a[48:51], v[64:67]
s_add_u32 m0, s49, 8192
ds_read_b64_tr_b16 v[196:197], v232 offset:18432
ds_read_b64_tr_b16 v[198:199], v232 offset:18688
v_mfma_f32_16x16x32_bf16 v[68:71], v[200:203], a[52:55], v[68:71]
s_mov_b32 s53, 2065024
v_exp_f32 v132, v132
v_mfma_f32_16x16x32_bf16 v[72:75], v[200:203], a[56:59], v[72:75]
v_exp_f32 v133, v133
v_mfma_f32_16x16x32_bf16 v[76:79], v[200:203], a[60:63], v[76:79]
s_waitcnt lgkmcnt(6)
buffer_load_dwordx4 v234, s[12:15], s53 offen lds
v_mfma_f32_16x16x32_bf16 v[80:83], v[204:207], a[48:51], v[80:83]
s_add_u32 m0, s49, 12288
ds_read_b64_tr_b16 v[200:201], v232 offset:19456
ds_read_b64_tr_b16 v[202:203], v232 offset:19712
v_mfma_f32_16x16x32_bf16 v[84:87], v[204:207], a[52:55], v[84:87]
v_rcp_f32 v131, v131
v_mfma_f32_16x16x32_bf16 v[88:91], v[204:207], a[56:59], v[88:91]
v_mul_f32 v144, v128, v144
v_mul_f32 v145, v129, v145
v_mfma_f32_16x16x32_bf16 v[92:95], v[204:207], a[60:63], v[92:95]
s_waitcnt lgkmcnt(6)
v_exp_f32 v134, v134
v_mfma_f32_16x16x32_bf16 v[64:67], v[208:211], a[64:67], v[64:67]
ds_read_b64_tr_b16 v[204:205], v232 offset:20480
ds_read_b64_tr_b16 v[206:207], v232 offset:20736
v_mfma_f32_16x16x32_bf16 v[68:71], v[208:211], a[68:71], v[68:71]
buffer_load_dwordx4 v234, s[16:19], s53 offen lds
v_mul_f32 v146, v130, v146
v_mfma_f32_16x16x32_bf16 v[72:75], v[208:211], a[72:75], v[72:75]
v_exp_f32 v135, v135
v_mfma_f32_16x16x32_bf16 v[76:79], v[208:211], a[76:79], v[76:79]
s_waitcnt lgkmcnt(6)
v_mul_f32 v147, v131, v147
v_add_f32 v132, 1.0, v132
v_mfma_f32_16x16x32_bf16 v[80:83], v[192:195], a[64:67], v[80:83]
s_add_u32 m0, s49, 16384
ds_read_b64_tr_b16 v[208:209], v232 offset:21504
ds_read_b64_tr_b16 v[210:211], v232 offset:21760
v_mfma_f32_16x16x32_bf16 v[84:87], v[192:195], a[68:71], v[84:87]
s_mov_b32 s53, 2359936
buffer_load_dwordx4 v234, s[12:15], s53 offen lds
v_add_f32 v133, 1.0, v133
v_mfma_f32_16x16x32_bf16 v[88:91], v[192:195], a[72:75], v[88:91]
s_add_u32 s51, s55, 4096
v_cvt_pk_bf16_f32 v214, v144, v145
v_cvt_pk_bf16_f32 v215, v146, v147
v_mfma_f32_16x16x32_bf16 v[92:95], v[192:195], a[76:79], v[92:95]
s_waitcnt lgkmcnt(6)
v_add_f32 v134, 1.0, v134
v_add_f32 v135, 1.0, v135
v_mfma_f32_16x16x32_bf16 v[64:67], v[196:199], a[80:83], v[64:67]
ds_read_b64_tr_b16 v[192:193], v232 offset:22528
ds_read_b64_tr_b16 v[194:195], v232 offset:22784
v_mfma_f32_16x16x32_bf16 v[68:71], v[196:199], a[84:87], v[68:71]
v_rcp_f32 v132, v132
v_mfma_f32_16x16x32_bf16 v[72:75], v[196:199], a[88:91], v[72:75]
v_rcp_f32 v133, v133
v_mfma_f32_16x16x32_bf16 v[76:79], v[196:199], a[92:95], v[76:79]
s_waitcnt lgkmcnt(6)
v_rcp_f32 v134, v134
v_mfma_f32_16x16x32_bf16 v[80:83], v[200:203], a[80:83], v[80:83]
ds_read_b64_tr_b16 v[196:197], v232 offset:23552
ds_read_b64_tr_b16 v[198:199], v232 offset:23808
v_mfma_f32_16x16x32_bf16 v[84:87], v[200:203], a[84:87], v[84:87]
buffer_load_dword v246, v247, s[28:31], s67 offen offset:1024 sc1
v_mfma_f32_16x16x32_bf16 v[88:91], v[200:203], a[88:91], v[88:91]
s_add_u32 m0, s49, 20480
buffer_store_dwordx4 v[212:215], v237, s[28:31], s51 offen offset:0 sc1
v_mul_f32 v136, s96, v136
v_mfma_f32_16x16x32_bf16 v[92:95], v[200:203], a[92:95], v[92:95]
s_waitcnt lgkmcnt(6)
v_mul_f32 v137, s96, v137
v_mul_f32 v138, s96, v138
v_mfma_f32_16x16x32_bf16 v[64:67], v[204:207], a[96:99], v[64:67]
ds_read_b64_tr_b16 v[200:201], v232 offset:24576
ds_read_b64_tr_b16 v[202:203], v232 offset:24832
v_mfma_f32_16x16x32_bf16 v[68:71], v[204:207], a[100:103], v[68:71]
v_rcp_f32 v135, v135
v_mfma_f32_16x16x32_bf16 v[72:75], v[204:207], a[104:107], v[72:75]
v_mul_f32 v139, s96, v139
v_mul_f32 v148, v132, v148
v_mfma_f32_16x16x32_bf16 v[76:79], v[204:207], a[108:111], v[76:79]
s_waitcnt lgkmcnt(6)
v_exp_f32 v136, v136
v_mfma_f32_16x16x32_bf16 v[80:83], v[208:211], a[96:99], v[80:83]
ds_read_b64_tr_b16 v[204:205], v232 offset:25600
ds_read_b64_tr_b16 v[206:207], v232 offset:25856
v_mfma_f32_16x16x32_bf16 v[84:87], v[208:211], a[100:103], v[84:87]
v_exp_f32 v137, v137
v_mfma_f32_16x16x32_bf16 v[88:91], v[208:211], a[104:107], v[88:91]
v_exp_f32 v138, v138
v_mfma_f32_16x16x32_bf16 v[92:95], v[208:211], a[108:111], v[92:95]
s_waitcnt lgkmcnt(6)
v_exp_f32 v139, v139
v_mfma_f32_16x16x32_bf16 v[64:67], v[192:195], a[112:115], v[64:67]
ds_read_b64_tr_b16 v[208:209], v232 offset:26624
ds_read_b64_tr_b16 v[210:211], v232 offset:26880
v_mfma_f32_16x16x32_bf16 v[68:71], v[192:195], a[116:119], v[68:71]
buffer_load_dwordx4 v234, s[16:19], s53 offen lds
v_add_f32 v136, 1.0, v136
v_mfma_f32_16x16x32_bf16 v[72:75], v[192:195], a[120:123], v[72:75]
s_add_u32 m0, s49, 24576
v_mul_f32 v149, v133, v149
v_mul_f32 v150, v134, v150
v_mfma_f32_16x16x32_bf16 v[76:79], v[192:195], a[124:127], v[76:79]
s_waitcnt lgkmcnt(6)
v_mul_f32 v151, v135, v151
v_add_f32 v137, 1.0, v137
v_mfma_f32_16x16x32_bf16 v[80:83], v[196:199], a[112:115], v[80:83]
s_add_u32 s66, s55, 4096
ds_read_b64_tr_b16 v[192:193], v232 offset:27648
ds_read_b64_tr_b16 v[194:195], v232 offset:27904
v_mfma_f32_16x16x32_bf16 v[84:87], v[196:199], a[116:119], v[84:87]
s_mov_b32 s53, 2654848
v_add_f32 v138, 1.0, v138
v_add_f32 v139, 1.0, v139
v_mfma_f32_16x16x32_bf16 v[88:91], v[196:199], a[120:123], v[88:91]
buffer_load_dwordx4 v234, s[12:15], s53 offen lds
v_cvt_pk_bf16_f32 v218, v148, v149
v_mfma_f32_16x16x32_bf16 v[92:95], v[196:199], a[124:127], v[92:95]
s_waitcnt lgkmcnt(6)
v_rcp_f32 v136, v136
v_mfma_f32_16x16x32_bf16 v[64:67], v[200:203], a[128:131], v[64:67]
s_add_u32 m0, s49, 28672
ds_read_b64_tr_b16 v[196:197], v232 offset:28672
ds_read_b64_tr_b16 v[198:199], v232 offset:28928
v_mfma_f32_16x16x32_bf16 v[68:71], v[200:203], a[132:135], v[68:71]
v_rcp_f32 v137, v137
v_mfma_f32_16x16x32_bf16 v[72:75], v[200:203], a[136:139], v[72:75]
v_rcp_f32 v138, v138
v_mfma_f32_16x16x32_bf16 v[76:79], v[200:203], a[140:143], v[76:79]
s_waitcnt lgkmcnt(6)
v_rcp_f32 v139, v139
v_mfma_f32_16x16x32_bf16 v[80:83], v[204:207], a[128:131], v[80:83]
ds_read_b64_tr_b16 v[200:201], v232 offset:29696
ds_read_b64_tr_b16 v[202:203], v232 offset:29952
v_mfma_f32_16x16x32_bf16 v[84:87], v[204:207], a[132:135], v[84:87]
buffer_load_dwordx4 v234, s[16:19], s53 offen lds
v_cvt_pk_bf16_f32 v219, v150, v151
v_mfma_f32_16x16x32_bf16 v[88:91], v[204:207], a[136:139], v[88:91]
s_add_u32 m0, s49, 32768
v_mul_f32 v152, v136, v152
v_mul_f32 v153, v137, v153
v_mfma_f32_16x16x32_bf16 v[92:95], v[204:207], a[140:143], v[92:95]
s_waitcnt lgkmcnt(6)
v_mul_f32 v154, v138, v154
v_mul_f32 v155, v139, v155
v_mfma_f32_16x16x32_bf16 v[64:67], v[208:211], a[144:147], v[64:67]
s_mov_b32 s53, 2949760
ds_read_b64_tr_b16 v[204:205], v232 offset:30720
ds_read_b64_tr_b16 v[206:207], v232 offset:30976
v_mfma_f32_16x16x32_bf16 v[68:71], v[208:211], a[148:151], v[68:71]
v_cvt_pk_bf16_f32 v222, v152, v153
v_cvt_pk_bf16_f32 v223, v154, v155
v_mfma_f32_16x16x32_bf16 v[72:75], v[208:211], a[152:155], v[72:75]
buffer_store_dwordx4 v[216:219], v237, s[28:31], s66 offen offset:1024 sc1
v_mul_f32 v140, s96, v140
v_mfma_f32_16x16x32_bf16 v[76:79], v[208:211], a[156:159], v[76:79]
s_waitcnt lgkmcnt(6)
v_mul_f32 v141, s96, v141
v_mul_f32 v142, s96, v142
v_mfma_f32_16x16x32_bf16 v[80:83], v[192:195], a[144:147], v[80:83]
ds_read_b64_tr_b16 v[208:209], v232 offset:31744
ds_read_b64_tr_b16 v[210:211], v232 offset:32000
v_mfma_f32_16x16x32_bf16 v[84:87], v[192:195], a[148:151], v[84:87]
v_mul_f32 v143, s96, v143
v_mfma_f32_16x16x32_bf16 v[88:91], v[192:195], a[152:155], v[88:91]
v_exp_f32 v140, v140
v_mfma_f32_16x16x32_bf16 v[92:95], v[192:195], a[156:159], v[92:95]
s_waitcnt lgkmcnt(6)
v_exp_f32 v141, v141
v_mfma_f32_16x16x32_bf16 v[64:67], v[196:199], a[160:163], v[64:67]
s_add_u32 s11, s97, 147456
ds_read_b64_tr_b16 v[192:193], v232 offset:32768
ds_read_b64_tr_b16 v[194:195], v232 offset:33024
v_mfma_f32_16x16x32_bf16 v[68:71], v[196:199], a[164:167], v[68:71]
v_exp_f32 v142, v142
v_mfma_f32_16x16x32_bf16 v[72:75], v[196:199], a[168:171], v[72:75]
v_exp_f32 v143, v143
v_mfma_f32_16x16x32_bf16 v[76:79], v[196:199], a[172:175], v[76:79]
s_waitcnt lgkmcnt(6)
v_add_f32 v140, 1.0, v140
v_add_f32 v141, 1.0, v141
v_mfma_f32_16x16x32_bf16 v[80:83], v[200:203], a[160:163], v[80:83]
ds_read_b64_tr_b16 v[196:197], v232 offset:33792
ds_read_b64_tr_b16 v[198:199], v232 offset:34048
v_mfma_f32_16x16x32_bf16 v[84:87], v[200:203], a[164:167], v[84:87]
buffer_store_dwordx4 v[220:223], v237, s[28:31], s51 offen offset:2048 sc1
v_add_f32 v142, 1.0, v142
v_mfma_f32_16x16x32_bf16 v[88:91], v[200:203], a[168:171], v[88:91]
v_add_f32 v143, 1.0, v143
v_mfma_f32_16x16x32_bf16 v[92:95], v[200:203], a[172:175], v[92:95]
s_waitcnt lgkmcnt(6)
v_rcp_f32 v140, v140
v_mfma_f32_16x16x32_bf16 v[64:67], v[204:207], a[176:179], v[64:67]
ds_read_b64_tr_b16 v[200:201], v232 offset:34816
ds_read_b64_tr_b16 v[202:203], v232 offset:35072
v_mfma_f32_16x16x32_bf16 v[68:71], v[204:207], a[180:183], v[68:71]
v_rcp_f32 v141, v141
v_mfma_f32_16x16x32_bf16 v[72:75], v[204:207], a[184:187], v[72:75]
v_rcp_f32 v142, v142
v_mfma_f32_16x16x32_bf16 v[76:79], v[204:207], a[188:191], v[76:79]
s_waitcnt lgkmcnt(6)
v_rcp_f32 v143, v143
v_mfma_f32_16x16x32_bf16 v[80:83], v[208:211], a[176:179], v[80:83]
ds_read_b64_tr_b16 v[204:205], v232 offset:35840
ds_read_b64_tr_b16 v[206:207], v232 offset:36096
v_mfma_f32_16x16x32_bf16 v[84:87], v[208:211], a[180:183], v[84:87]
v_mul_f32 v156, v140, v156
v_mul_f32 v157, v141, v157
v_mfma_f32_16x16x32_bf16 v[88:91], v[208:211], a[184:187], v[88:91]
v_mul_f32 v158, v142, v158
v_mul_f32 v159, v143, v159
v_mfma_f32_16x16x32_bf16 v[92:95], v[208:211], a[188:191], v[92:95]
s_waitcnt lgkmcnt(6)
buffer_load_dwordx4 v234, s[12:15], s53 offen lds
v_cvt_pk_bf16_f32 v226, v156, v157
v_mfma_f32_16x16x32_bf16 v[64:67], v[192:195], a[192:195], v[64:67]
s_add_u32 m0, s49, 36864
ds_read_b64_tr_b16 v[208:209], v232 offset:36864
ds_read_b64_tr_b16 v[210:211], v232 offset:37120
v_mfma_f32_16x16x32_bf16 v[68:71], v[192:195], a[196:199], v[68:71]
v_cvt_pk_bf16_f32 v227, v158, v159
v_mfma_f32_16x16x32_bf16 v[72:75], v[192:195], a[200:203], v[72:75]
v_mfma_f32_16x16x32_bf16 v[76:79], v[192:195], a[204:207], v[76:79]
s_waitcnt lgkmcnt(6)
v_mfma_f32_16x16x32_bf16 v[80:83], v[196:199], a[192:195], v[80:83]
ds_read_b64_tr_b16 v[192:193], v232 offset:37888
ds_read_b64_tr_b16 v[194:195], v232 offset:38144
v_mfma_f32_16x16x32_bf16 v[84:87], v[196:199], a[196:199], v[84:87]
buffer_load_dwordx4 v234, s[16:19], s53 offen lds
buffer_store_dwordx4 v[224:227], v237, s[28:31], s66 offen offset:3072 sc1
v_mfma_f32_16x16x32_bf16 v[88:91], v[196:199], a[200:203], v[88:91]
s_add_u32 m0, s49, 40960
s_mov_b32 s53, 3244672
buffer_load_dwordx4 v234, s[12:15], s53 offen lds
v_mfma_f32_16x16x32_bf16 v[92:95], v[196:199], a[204:207], v[92:95]
s_waitcnt lgkmcnt(6)
s_add_u32 m0, s49, 45056
v_mfma_f32_16x16x32_bf16 v[64:67], v[200:203], a[208:211], v[64:67]
ds_read_b64_tr_b16 v[196:197], v232 offset:38912
ds_read_b64_tr_b16 v[198:199], v232 offset:39168
v_mfma_f32_16x16x32_bf16 v[68:71], v[200:203], a[212:215], v[68:71]
buffer_load_dwordx4 v234, s[16:19], s53 offen lds
v_mfma_f32_16x16x32_bf16 v[72:75], v[200:203], a[216:219], v[72:75]
s_add_u32 m0, s49, 49152
v_mfma_f32_16x16x32_bf16 v[76:79], v[200:203], a[220:223], v[76:79]
s_waitcnt lgkmcnt(6)
v_mfma_f32_16x16x32_bf16 v[80:83], v[204:207], a[208:211], v[80:83]
s_mov_b32 s53, 3539584
ds_read_b64_tr_b16 v[200:201], v232 offset:39936
ds_read_b64_tr_b16 v[202:203], v232 offset:40192
v_mfma_f32_16x16x32_bf16 v[84:87], v[204:207], a[212:215], v[84:87]
buffer_load_dwordx4 v234, s[12:15], s53 offen lds
s_waitcnt vmcnt(12)
v_mfma_f32_16x16x32_bf16 v[88:91], v[204:207], a[216:219], v[88:91]
v_cmp_gt_u32 vcc, 1, v246
v_mfma_f32_16x16x32_bf16 v[92:95], v[204:207], a[220:223], v[92:95]
s_waitcnt lgkmcnt(6)
v_mfma_f32_16x16x32_bf16 v[64:67], v[208:211], a[224:227], v[64:67]
ds_read_b64_tr_b16 v[204:205], v232 offset:40960
ds_read_b64_tr_b16 v[206:207], v232 offset:41216
v_mfma_f32_16x16x32_bf16 v[68:71], v[208:211], a[228:231], v[68:71]
s_cbranch_vccnz spin_6_v0
ok_5_v0:
v_mfma_f32_16x16x32_bf16 v[72:75], v[208:211], a[232:235], v[72:75]
s_add_u32 m0, s49, 53248
v_mfma_f32_16x16x32_bf16 v[76:79], v[208:211], a[236:239], v[76:79]
s_waitcnt lgkmcnt(6)
v_mfma_f32_16x16x32_bf16 v[80:83], v[192:195], a[224:227], v[80:83]
ds_read_b64_tr_b16 v[208:209], v232 offset:41984
ds_read_b64_tr_b16 v[210:211], v232 offset:42240
v_mfma_f32_16x16x32_bf16 v[84:87], v[192:195], a[228:231], v[84:87]
v_mfma_f32_16x16x32_bf16 v[88:91], v[192:195], a[232:235], v[88:91]
v_mfma_f32_16x16x32_bf16 v[92:95], v[192:195], a[236:239], v[92:95]
s_waitcnt lgkmcnt(6)
v_mfma_f32_16x16x32_bf16 v[64:67], v[196:199], a[240:243], v[64:67]
ds_read_b64_tr_b16 v[192:193], v232 offset:43008
ds_read_b64_tr_b16 v[194:195], v232 offset:43264
v_mfma_f32_16x16x32_bf16 v[68:71], v[196:199], a[244:247], v[68:71]
v_mfma_f32_16x16x32_bf16 v[72:75], v[196:199], a[248:251], v[72:75]
v_mfma_f32_16x16x32_bf16 v[76:79], v[196:199], a[252:255], v[76:79]
s_waitcnt lgkmcnt(6)
v_mfma_f32_16x16x32_bf16 v[80:83], v[200:203], a[240:243], v[80:83]
ds_read_b64_tr_b16 v[196:197], v232 offset:44032
ds_read_b64_tr_b16 v[198:199], v232 offset:44288
v_mfma_f32_16x16x32_bf16 v[84:87], v[200:203], a[244:247], v[84:87]
v_add_u32 v228, 4294934528, v228
v_mfma_f32_16x16x32_bf16 v[88:91], v[200:203], a[248:251], v[88:91]
s_waitcnt vmcnt(10)
s_barrier
v_mfma_f32_16x16x32_bf16 v[92:95], v[200:203], a[252:255], v[92:95]
s_waitcnt lgkmcnt(6)
v_mfma_f32_16x16x32_bf16 v[64:67], v[204:207], v[0:3], v[64:67]
ds_read_b64_tr_b16 v[200:201], v228 offset:12288
ds_read_b64_tr_b16 v[202:203], v228 offset:12800
v_mfma_f32_16x16x32_bf16 v[68:71], v[204:207], v[4:7], v[68:71]
v_xor_b32 v239, 64, v239
v_mfma_f32_16x16x32_bf16 v[72:75], v[204:207], v[8:11], v[72:75]
s_xor_b32 s64, s69, 0
v_mfma_f32_16x16x32_bf16 v[76:79], v[204:207], v[12:15], v[76:79]
s_waitcnt lgkmcnt(6)
v_mfma_f32_16x16x32_bf16 v[80:83], v[208:211], v[0:3], v[80:83]
s_add_u32 s64, s76, s64
ds_read_b64_tr_b16 v[204:205], v228 offset:16384
ds_read_b64_tr_b16 v[206:207], v228 offset:16896
v_mfma_f32_16x16x32_bf16 v[84:87], v[208:211], v[4:7], v[84:87]
s_and_b32 s64, s64, 3
buffer_load_dwordx4 v234, s[16:19], s53 offen lds
s_add_u32 m0, s49, 57344
v_mfma_f32_16x16x32_bf16 v[88:91], v[208:211], v[8:11], v[88:91]
s_mov_b32 s53, 3834496
v_mfma_f32_16x16x32_bf16 v[92:95], v[208:211], v[12:15], v[92:95]
s_waitcnt lgkmcnt(6)
v_mfma_f32_16x16x32_bf16 v[64:67], v[192:195], v[16:19], v[64:67]
s_mul_i32 s64, s64, 55296
ds_read_b64_tr_b16 v[208:209], v228 offset:20480
ds_read_b64_tr_b16 v[210:211], v228 offset:20992
v_mfma_f32_16x16x32_bf16 v[68:71], v[192:195], v[20:23], v[68:71]
s_add_u32 s64, s64, s58
v_cvt_pk_bf16_f32 v32, v32, v33
v_cvt_pk_bf16_f32 v33, v34, v35
v_mfma_f32_16x16x32_bf16 v[72:75], v[192:195], v[24:27], v[72:75]
v_mfma_f32_16x16x32_bf16 v[76:79], v[192:195], v[28:31], v[76:79]
s_waitcnt lgkmcnt(6)
buffer_load_dwordx4 v234, s[12:15], s53 offen lds
s_add_u32 m0, s49, 61440
v_mfma_f32_16x16x32_bf16 v[80:83], v[196:199], v[16:19], v[80:83]
ds_read_b64_tr_b16 v[192:193], v228 offset:24576
ds_read_b64_tr_b16 v[194:195], v228 offset:25088
v_mfma_f32_16x16x32_bf16 v[84:87], v[196:199], v[20:23], v[84:87]
v_cvt_pk_bf16_f32 v34, v48, v49
v_mfma_f32_16x16x32_bf16 v[88:91], v[196:199], v[24:27], v[88:91]
v_mfma_f32_16x16x32_bf16 v[92:95], v[196:199], v[28:31], v[92:95]
s_waitcnt lgkmcnt(6)
v_mfma_f32_16x16x32_bf16 v[160:163], v[200:203], a[0:3], 0
ds_read_b64_tr_b16 v[196:197], v228 offset:28672
ds_read_b64_tr_b16 v[198:199], v228 offset:29184
v_mfma_f32_16x16x32_bf16 v[164:167], v[200:203], a[4:7], 0
buffer_load_dwordx4 v234, s[16:19], s53 offen lds
v_cvt_pk_bf16_f32 v35, v50, v51
v_mfma_f32_16x16x32_bf16 v[168:171], v[200:203], a[8:11], 0
v_mfma_f32_16x16x32_bf16 v[172:175], v[200:203], a[12:15], 0
s_waitcnt lgkmcnt(6)
v_mfma_f32_16x16x32_bf16 v[176:179], v[204:207], a[0:3], 0
s_add_u32 m0, s49, 65536
ds_read_b64_tr_b16 v[200:201], v228 offset:32768
ds_read_b64_tr_b16 v[202:203], v228 offset:33280
v_mfma_f32_16x16x32_bf16 v[180:183], v[204:207], a[4:7], 0
s_mov_b32 s53, 4129408
v_mfma_f32_16x16x32_bf16 v[184:187], v[204:207], a[8:11], 0
buffer_store_dwordx4 v[32:35], v239, s[32:35], s64 offen sc1
v_mfma_f32_16x16x32_bf16 v[188:191], v[204:207], a[12:15], 0
s_waitcnt lgkmcnt(6)
v_mfma_f32_16x16x32_bf16 v[160:163], v[208:211], a[16:19], v[160:163]
s_xor_b32 s64, s69, 1
ds_read_b64_tr_b16 v[204:205], v228 offset:36864
ds_read_b64_tr_b16 v[206:207], v228 offset:37376
v_mfma_f32_16x16x32_bf16 v[164:167], v[208:211], a[20:23], v[164:167]
s_add_u32 s64, s76, s64
v_mul_f32 v64, s96, v64
v_mul_f32 v65, s96, v65
v_mfma_f32_16x16x32_bf16 v[168:171], v[208:211], a[24:27], v[168:171]
s_and_b32 s64, s64, 3
v_mfma_f32_16x16x32_bf16 v[172:175], v[208:211], a[28:31], v[172:175]
s_waitcnt lgkmcnt(6)
v_mfma_f32_16x16x32_bf16 v[176:179], v[192:195], a[16:19], v[176:179]
s_waitcnt vmcnt(7)
ds_read_b64_tr_b16 v[208:209], v228 offset:40960
ds_read_b64_tr_b16 v[210:211], v228 offset:41472
v_mfma_f32_16x16x32_bf16 v[180:183], v[192:195], a[20:23], v[180:183]
s_mul_i32 s64, s64, 55296
v_add_u32 v229, 4294934528, v229
v_mul_f32 v66, s96, v66
v_mfma_f32_16x16x32_bf16 v[184:187], v[192:195], a[24:27], v[184:187]
s_add_u32 s64, s64, s58
v_cvt_pk_bf16_f32 v36, v36, v37
v_cvt_pk_bf16_f32 v37, v38, v39
v_mfma_f32_16x16x32_bf16 v[188:191], v[192:195], a[28:31], v[188:191]
s_waitcnt lgkmcnt(6)
v_mul_f32 v67, s96, v67
v_mfma_f32_16x16x32_bf16 v[160:163], v[196:199], a[32:35], v[160:163]
ds_read_b64_tr_b16 v[192:193], v229 offset:12288
ds_read_b64_tr_b16 v[194:195], v229 offset:12800
v_mfma_f32_16x16x32_bf16 v[164:167], v[196:199], a[36:39], v[164:167]
v_cvt_pk_bf16_f32 v38, v52, v53
v_cvt_pk_bf16_f32 v39, v54, v55
v_mfma_f32_16x16x32_bf16 v[168:171], v[196:199], a[40:43], v[168:171]
v_exp_f32 v64, v64
v_mfma_f32_16x16x32_bf16 v[172:175], v[196:199], a[44:47], v[172:175]
s_waitcnt lgkmcnt(6)
v_mfma_f32_16x16x32_bf16 v[176:179], v[200:203], a[32:35], v[176:179]
ds_read_b64_tr_b16 v[196:197], v229 offset:16384
ds_read_b64_tr_b16 v[198:199], v229 offset:16896
v_mfma_f32_16x16x32_bf16 v[180:183], v[200:203], a[36:39], v[180:183]
v_exp_f32 v65, v65
v_mfma_f32_16x16x32_bf16 v[184:187], v[200:203], a[40:43], v[184:187]
v_mfma_f32_16x16x32_bf16 v[188:191], v[200:203], a[44:47], v[188:191]
s_waitcnt lgkmcnt(6)
v_mfma_f32_16x16x32_bf16 v[160:163], v[204:207], a[48:51], v[160:163]
ds_read_b64_tr_b16 v[200:201], v229 offset:20480
ds_read_b64_tr_b16 v[202:203], v229 offset:20992
v_mfma_f32_16x16x32_bf16 v[164:167], v[204:207], a[52:55], v[164:167]
buffer_store_dword v242, off, s[28:31], s11 sc1
v_mfma_f32_16x16x32_bf16 v[168:171], v[204:207], a[56:59], v[168:171]
buffer_load_dwordx4 v234, s[12:15], s53 offen lds
s_add_u32 m0, s49, 69632
v_mfma_f32_16x16x32_bf16 v[172:175], v[204:207], a[60:63], v[172:175]
s_waitcnt lgkmcnt(6)
v_exp_f32 v66, v66
v_mfma_f32_16x16x32_bf16 v[176:179], v[208:211], a[48:51], v[176:179]
ds_read_b64_tr_b16 v[204:205], v229 offset:24576
ds_read_b64_tr_b16 v[206:207], v229 offset:25088
v_mfma_f32_16x16x32_bf16 v[180:183], v[208:211], a[52:55], v[180:183]
v_exp_f32 v67, v67
v_mfma_f32_16x16x32_bf16 v[184:187], v[208:211], a[56:59], v[184:187]
v_mfma_f32_16x16x32_bf16 v[188:191], v[208:211], a[60:63], v[188:191]
s_waitcnt lgkmcnt(6)
v_mfma_f32_16x16x32_bf16 v[96:99], v[192:195], a[0:3], 0
ds_read_b64_tr_b16 v[208:209], v229 offset:28672
ds_read_b64_tr_b16 v[210:211], v229 offset:29184
v_mfma_f32_16x16x32_bf16 v[100:103], v[192:195], a[4:7], 0
buffer_load_dwordx4 v234, s[16:19], s53 offen lds
v_add_f32 v64, 1.0, v64
v_mfma_f32_16x16x32_bf16 v[104:107], v[192:195], a[8:11], 0
s_add_u32 m0, s49, 73728
s_mov_b32 s53, 4424320
v_mfma_f32_16x16x32_bf16 v[108:111], v[192:195], a[12:15], 0
s_waitcnt lgkmcnt(6)
v_mfma_f32_16x16x32_bf16 v[112:115], v[196:199], a[0:3], 0
ds_read_b64_tr_b16 v[192:193], v229 offset:32768
ds_read_b64_tr_b16 v[194:195], v229 offset:33280
v_mfma_f32_16x16x32_bf16 v[116:119], v[196:199], a[4:7], 0
buffer_load_dwordx4 v234, s[12:15], s53 offen lds
v_add_f32 v65, 1.0, v65
v_mfma_f32_16x16x32_bf16 v[120:123], v[196:199], a[8:11], 0
s_add_u32 m0, s49, 77824
v_add_f32 v66, 1.0, v66
v_mfma_f32_16x16x32_bf16 v[124:127], v[196:199], a[12:15], 0
s_waitcnt lgkmcnt(6)
v_mfma_f32_16x16x32_bf16 v[96:99], v[200:203], a[16:19], v[96:99]
ds_read_b64_tr_b16 v[196:197], v229 offset:36864
ds_read_b64_tr_b16 v[198:199], v229 offset:37376
v_mfma_f32_16x16x32_bf16 v[100:103], v[200:203], a[20:23], v[100:103]
v_add_f32 v67, 1.0, v67
v_mul_f32 v72, s96, v72
v_mfma_f32_16x16x32_bf16 v[104:107], v[200:203], a[24:27], v[104:107]
v_rcp_f32 v64, v64
v_mfma_f32_16x16x32_bf16 v[108:111], v[200:203], a[28:31], v[108:111]
s_waitcnt lgkmcnt(6)
buffer_load_dwordx4 v234, s[16:19], s53 offen lds
v_mul_f32 v73, s96, v73
v_mfma_f32_16x16x32_bf16 v[112:115], v[204:207], a[16:19], v[112:115]
s_add_u32 m0, s49, 81920
ds_read_b64_tr_b16 v[200:201], v229 offset:40960
ds_read_b64_tr_b16 v[202:203], v229 offset:41472
v_mfma_f32_16x16x32_bf16 v[116:119], v[204:207], a[20:23], v[116:119]
s_mov_b32 s53, 4719232
v_add_u32 v230, 4294934528, v230
v_mul_f32 v74, s96, v74
v_mfma_f32_16x16x32_bf16 v[120:123], v[204:207], a[24:27], v[120:123]
buffer_load_dwordx4 v234, s[12:15], s53 offen lds
v_mul_f32 v75, s96, v75
v_mfma_f32_16x16x32_bf16 v[124:127], v[204:207], a[28:31], v[124:127]
s_waitcnt lgkmcnt(6)
v_mfma_f32_16x16x32_bf16 v[96:99], v[208:211], a[32:35], v[96:99]
s_add_u32 m0, s49, 86016
ds_read_b64_tr_b16 v[204:205], v230 offset:12288
ds_read_b64_tr_b16 v[206:207], v230 offset:12800
v_mfma_f32_16x16x32_bf16 v[100:103], v[208:211], a[36:39], v[100:103]
buffer_load_dwordx4 v234, s[16:19], s53 offen lds
buffer_load_dword v246, v241, s[28:31], 0 offen sc1
v_mfma_f32_16x16x32_bf16 v[104:107], v[208:211], a[40:43], v[104:107]
v_rcp_f32 v65, v65
v_mfma_f32_16x16x32_bf16 v[108:111], v[208:211], a[44:47], v[108:111]
s_waitcnt lgkmcnt(6)
v_exp_f32 v72, v72
v_mfma_f32_16x16x32_bf16 v[112:115], v[192:195], a[32:35], v[112:115]
s_add_u32 m0, s49, 90112
ds_read_b64_tr_b16 v[208:209], v230 offset:16384
ds_read_b64_tr_b16 v[210:211], v230 offset:16896
v_mfma_f32_16x16x32_bf16 v[116:119], v[192:195], a[36:39], v[116:119]
s_mov_b32 s53, 5014144
v_rcp_f32 v66, v66
v_mfma_f32_16x16x32_bf16 v[120:123], v[192:195], a[40:43], v[120:123]
v_exp_f32 v73, v73
v_mfma_f32_16x16x32_bf16 v[124:127], v[192:195], a[44:47], v[124:127]
s_waitcnt lgkmcnt(6)
v_mfma_f32_16x16x32_bf16 v[96:99], v[196:199], a[48:51], v[96:99]
ds_read_b64_tr_b16 v[192:193], v230 offset:20480
ds_read_b64_tr_b16 v[194:195], v230 offset:20992
v_mfma_f32_16x16x32_bf16 v[100:103], v[196:199], a[52:55], v[100:103]
v_rcp_f32 v67, v67
v_mfma_f32_16x16x32_bf16 v[104:107], v[196:199], a[56:59], v[104:107]
v_exp_f32 v74, v74
v_mfma_f32_16x16x32_bf16 v[108:111], v[196:199], a[60:63], v[108:111]
s_waitcnt lgkmcnt(6)
v_mfma_f32_16x16x32_bf16 v[112:115], v[200:203], a[48:51], v[112:115]
ds_read_b64_tr_b16 v[196:197], v230 offset:24576
ds_read_b64_tr_b16 v[198:199], v230 offset:25088
v_mfma_f32_16x16x32_bf16 v[116:119], v[200:203], a[52:55], v[116:119]
v_mul_f32 v80, v64, v80
v_mul_f32 v81, v65, v81
v_mfma_f32_16x16x32_bf16 v[120:123], v[200:203], a[56:59], v[120:123]
buffer_store_dwordx4 v[36:39], v239, s[32:35], s64 offen sc1
s_xor_b32 s64, s69, 2
v_mfma_f32_16x16x32_bf16 v[124:127], v[200:203], a[60:63], v[124:127]
s_waitcnt lgkmcnt(6)
v_exp_f32 v75, v75
v_mfma_f32_16x16x32_bf16 v[128:131], v[204:207], a[0:3], 0
s_add_u32 s64, s76, s64
ds_read_b64_tr_b16 v[200:201], v230 offset:28672
ds_read_b64_tr_b16 v[202:203], v230 offset:29184
v_mfma_f32_16x16x32_bf16 v[132:135], v[204:207], a[4:7], 0
s_and_b32 s64, s64, 3
v_mul_f32 v82, v66, v82
v_add_f32 v72, 1.0, v72
v_mfma_f32_16x16x32_bf16 v[136:139], v[204:207], a[8:11], 0
s_mul_i32 s64, s64, 55296
s_add_u32 s64, s64, s58
v_cvt_pk_bf16_f32 v40, v40, v41
v_mfma_f32_16x16x32_bf16 v[140:143], v[204:207], a[12:15], 0
s_waitcnt lgkmcnt(6)
v_cvt_pk_bf16_f32 v41, v42, v43
v_cvt_pk_bf16_f32 v42, v56, v57
v_mfma_f32_16x16x32_bf16 v[144:147], v[208:211], a[0:3], 0
ds_read_b64_tr_b16 v[204:205], v230 offset:32768
ds_read_b64_tr_b16 v[206:207], v230 offset:33280
v_mfma_f32_16x16x32_bf16 v[148:151], v[208:211], a[4:7], 0
v_cvt_pk_bf16_f32 v43, v58, v59
v_mul_f32 v83, v67, v83
v_mfma_f32_16x16x32_bf16 v[152:155], v[208:211], a[8:11], 0
v_cvt_pk_bf16_f32 v212, v80, v81
v_add_f32 v73, 1.0, v73
v_mfma_f32_16x16x32_bf16 v[156:159], v[208:211], a[12:15], 0
s_waitcnt lgkmcnt(6)
v_add_f32 v74, 1.0, v74
v_mfma_f32_16x16x32_bf16 v[128:131], v[192:195], a[16:19], v[128:131]
ds_read_b64_tr_b16 v[208:209], v230 offset:36864
ds_read_b64_tr_b16 v[210:211], v230 offset:37376
v_mfma_f32_16x16x32_bf16 v[132:135], v[192:195], a[20:23], v[132:135]
v_cvt_pk_bf16_f32 v213, v82, v83
v_mul_f32 v68, s96, v68
v_mfma_f32_16x16x32_bf16 v[136:139], v[192:195], a[24:27], v[136:139]
v_add_f32 v75, 1.0, v75
v_mfma_f32_16x16x32_bf16 v[140:143], v[192:195], a[28:31], v[140:143]
s_waitcnt lgkmcnt(6)
v_rcp_f32 v72, v72
v_mfma_f32_16x16x32_bf16 v[144:147], v[196:199], a[16:19], v[144:147]
ds_read_b64_tr_b16 v[192:193], v230 offset:40960
ds_read_b64_tr_b16 v[194:195], v230 offset:41472
v_mfma_f32_16x16x32_bf16 v[148:151], v[196:199], a[20:23], v[148:151]
v_add_u32 v231, 4294934528, v231
v_mul_f32 v69, s96, v69
v_mfma_f32_16x16x32_bf16 v[152:155], v[196:199], a[24:27], v[152:155]
buffer_store_dwordx4 v[40:43], v239, s[32:35], s64 offen sc1
v_mul_f32 v70, s96, v70
v_mfma_f32_16x16x32_bf16 v[156:159], v[196:199], a[28:31], v[156:159]
s_waitcnt lgkmcnt(6)
s_xor_b32 s64, s69, 3
s_add_u32 s64, s76, s64
v_mfma_f32_16x16x32_bf16 v[128:131], v[200:203], a[32:35], v[128:131]
s_and_b32 s64, s64, 3
ds_read_b64_tr_b16 v[196:197], v231 offset:12288
ds_read_b64_tr_b16 v[198:199], v231 offset:12800
v_mfma_f32_16x16x32_bf16 v[132:135], v[200:203], a[36:39], v[132:135]
TCH_5_v0:
s_cbranch_execz TCH_9_v0
s_mul_i32 s64, s64, 55296
v_rcp_f32 v73, v73
v_mfma_f32_16x16x32_bf16 v[136:139], v[200:203], a[40:43], v[136:139]
s_add_u32 s64, s64, s58
v_cvt_pk_bf16_f32 v44, v44, v45
v_cvt_pk_bf16_f32 v45, v46, v47
v_mfma_f32_16x16x32_bf16 v[140:143], v[200:203], a[44:47], v[140:143]
s_waitcnt lgkmcnt(6)
v_cvt_pk_bf16_f32 v46, v60, v61
v_cvt_pk_bf16_f32 v47, v62, v63
v_mfma_f32_16x16x32_bf16 v[144:147], v[204:207], a[32:35], v[144:147]
ds_read_b64_tr_b16 v[200:201], v231 offset:16384
ds_read_b64_tr_b16 v[202:203], v231 offset:16896
v_mfma_f32_16x16x32_bf16 v[148:151], v[204:207], a[36:39], v[148:151]
buffer_store_dwordx4 v[44:47], v239, s[32:35], s64 offen sc1
buffer_load_dwordx4 v234, s[12:15], s53 offen lds
v_mfma_f32_16x16x32_bf16 v[152:155], v[204:207], a[40:43], v[152:155]
s_add_u32 m0, s49, 94208
v_rcp_f32 v74, v74
v_mfma_f32_16x16x32_bf16 v[156:159], v[204:207], a[44:47], v[156:159]
s_waitcnt lgkmcnt(6)
buffer_load_dwordx4 v234, s[16:19], s53 offen lds
v_mul_f32 v71, s96, v71
v_mfma_f32_16x16x32_bf16 v[128:131], v[208:211], a[48:51], v[128:131]
ds_read_b64_tr_b16 v[204:205], v231 offset:20480
ds_read_b64_tr_b16 v[206:207], v231 offset:20992
v_mfma_f32_16x16x32_bf16 v[132:135], v[208:211], a[52:55], v[132:135]
v_exp_f32 v68, v68
v_mfma_f32_16x16x32_bf16 v[136:139], v[208:211], a[56:59], v[136:139]
v_exp_f32 v69, v69
v_mfma_f32_16x16x32_bf16 v[140:143], v[208:211], a[60:63], v[140:143]
s_waitcnt lgkmcnt(6)
v_rcp_f32 v75, v75
v_mfma_f32_16x16x32_bf16 v[144:147], v[192:195], a[48:51], v[144:147]
ds_read_b64_tr_b16 v[208:209], v231 offset:24576
ds_read_b64_tr_b16 v[210:211], v231 offset:25088
v_mfma_f32_16x16x32_bf16 v[148:151], v[192:195], a[52:55], v[148:151]
v_exp_f32 v70, v70
v_mfma_f32_16x16x32_bf16 v[152:155], v[192:195], a[56:59], v[152:155]
v_mul_f32 v88, v72, v88
v_mul_f32 v89, v73, v89
v_mfma_f32_16x16x32_bf16 v[156:159], v[192:195], a[60:63], v[156:159]
s_waitcnt lgkmcnt(6)
v_mfma_f32_16x16x32_bf16 v[32:35], v[196:199], a[0:3], 0
ds_read_b64_tr_b16 v[192:193], v231 offset:28672
ds_read_b64_tr_b16 v[194:195], v231 offset:29184
v_mfma_f32_16x16x32_bf16 v[36:39], v[196:199], a[4:7], 0
v_exp_f32 v71, v71
v_mfma_f32_16x16x32_bf16 v[40:43], v[196:199], a[8:11], 0
v_mul_f32 v90, v74, v90
v_mfma_f32_16x16x32_bf16 v[44:47], v[196:199], a[12:15], 0
s_waitcnt lgkmcnt(6)
v_mfma_f32_16x16x32_bf16 v[48:51], v[200:203], a[0:3], 0
ds_read_b64_tr_b16 v[196:197], v231 offset:32768
ds_read_b64_tr_b16 v[198:199], v231 offset:33280
v_mfma_f32_16x16x32_bf16 v[52:55], v[200:203], a[4:7], 0
v_add_f32 v68, 1.0, v68
v_add_f32 v69, 1.0, v69
v_mfma_f32_16x16x32_bf16 v[56:59], v[200:203], a[8:11], 0
v_mul_f32 v91, v75, v91
v_cvt_pk_bf16_f32 v216, v88, v89
v_mfma_f32_16x16x32_bf16 v[60:63], v[200:203], a[12:15], 0
s_waitcnt lgkmcnt(6)
v_mfma_f32_16x16x32_bf16 v[32:35], v[204:207], a[16:19], v[32:35]
ds_read_b64_tr_b16 v[200:201], v231 offset:36864
ds_read_b64_tr_b16 v[202:203], v231 offset:37376
v_mfma_f32_16x16x32_bf16 v[36:39], v[204:207], a[20:23], v[36:39]
v_add_f32 v70, 1.0, v70
v_cvt_pk_bf16_f32 v217, v90, v91
v_mfma_f32_16x16x32_bf16 v[40:43], v[204:207], a[24:27], v[40:43]
v_mul_f32 v76, s96, v76
v_mfma_f32_16x16x32_bf16 v[44:47], v[204:207], a[28:31], v[44:47]
s_waitcnt lgkmcnt(6)
v_mfma_f32_16x16x32_bf16 v[48:51], v[208:211], a[16:19], v[48:51]
s_waitcnt vmcnt(5)
ds_read_b64_tr_b16 v[204:205], v231 offset:40960
ds_read_b64_tr_b16 v[206:207], v231 offset:41472
v_mfma_f32_16x16x32_bf16 v[52:55], v[208:211], a[20:23], v[52:55]
v_cmp_gt_u32 vcc, 1, v246
v_add_f32 v71, 1.0, v71
v_mfma_f32_16x16x32_bf16 v[56:59], v[208:211], a[24:27], v[56:59]
s_cbranch_vccnz spin_8_v0
ok_7_v0:
v_mfma_f32_16x16x32_bf16 v[60:63], v[208:211], a[28:31], v[60:63]
s_waitcnt lgkmcnt(6)
v_rcp_f32 v68, v68
v_mfma_f32_16x16x32_bf16 v[32:35], v[192:195], a[32:35], v[32:35]
s_add_u32 m0, s49, 98304
ds_read_b64_tr_b16 v[208:209], v228 offset:45056
ds_read_b64_tr_b16 v[210:211], v228 offset:45568
v_mfma_f32_16x16x32_bf16 v[36:39], v[192:195], a[36:39], v[36:39]
s_add_u32 s50, s81, 0
buffer_load_dwordx4 v237, s[28:31], s50 offen sc1 lds
v_mul_f32 v77, s96, v77
v_mfma_f32_16x16x32_bf16 v[40:43], v[192:195], a[40:43], v[40:43]
v_mul_f32 v78, s96, v78
v_mul_f32 v79, s96, v79
v_mfma_f32_16x16x32_bf16 v[44:47], v[192:195], a[44:47], v[44:47]
s_waitcnt lgkmcnt(6)
v_rcp_f32 v69, v69
v_mfma_f32_16x16x32_bf16 v[48:51], v[196:199], a[32:35], v[48:51]
ds_read_b64_tr_b16 v[192:193], v228 offset:49152
ds_read_b64_tr_b16 v[194:195], v228 offset:49664
v_mfma_f32_16x16x32_bf16 v[52:55], v[196:199], a[36:39], v[52:55]
v_exp_f32 v76, v76
v_mfma_f32_16x16x32_bf16 v[56:59], v[196:199], a[40:43], v[56:59]
v_rcp_f32 v70, v70
v_mfma_f32_16x16x32_bf16 v[60:63], v[196:199], a[44:47], v[60:63]
s_waitcnt lgkmcnt(6)
v_mfma_f32_16x16x32_bf16 v[32:35], v[200:203], a[48:51], v[32:35]
s_add_u32 m0, s49, 102400
ds_read_b64_tr_b16 v[196:197], v228 offset:53248
ds_read_b64_tr_b16 v[198:199], v228 offset:53760
v_mfma_f32_16x16x32_bf16 v[36:39], v[200:203], a[52:55], v[36:39]
s_add_u32 s50, s81, 4096
v_rcp_f32 v71, v71
v_mfma_f32_16x16x32_bf16 v[40:43], v[200:203], a[56:59], v[40:43]
v_exp_f32 v77, v77
v_mfma_f32_16x16x32_bf16 v[44:47], v[200:203], a[60:63], v[44:47]
s_waitcnt lgkmcnt(6)
buffer_load_dwordx4 v237, s[28:31], s50 offen sc1 lds
v_mfma_f32_16x16x32_bf16 v[48:51], v[204:207], a[48:51], v[48:51]
s_add_u32 m0, s49, 106496
ds_read_b64_tr_b16 v[200:201], v228 offset:57344
ds_read_b64_tr_b16 v[202:203], v228 offset:57856
v_mfma_f32_16x16x32_bf16 v[52:55], v[204:207], a[52:55], v[52:55]
s_add_u32 s50, s81, 8192
v_add_u32 v228, 4294868992, v228
v_mfma_f32_16x16x32_bf16 v[56:59], v[204:207], a[56:59], v[56:59]
v_exp_f32 v78, v78
v_mfma_f32_16x16x32_bf16 v[60:63], v[204:207], a[60:63], v[60:63]
s_waitcnt lgkmcnt(6)
buffer_load_dwordx4 v237, s[28:31], s50 offen sc1 lds
v_mfma_f32_16x16x32_bf16 v[160:163], v[208:211], a[64:67], v[160:163]
s_add_u32 s52, s79, 16384
ds_read_b64_tr_b16 v[204:205], v228 offset:0
ds_read_b64_tr_b16 v[206:207], v228 offset:512
v_mfma_f32_16x16x32_bf16 v[164:167], v[208:211], a[68:71], v[164:167]
buffer_load_dwordx4 a[0:3], v237, s[28:31], s52 offen offset:0 sc1
v_mul_f32 v84, v68, v84
v_mfma_f32_16x16x32_bf16 v[168:171], v[208:211], a[72:75], v[168:171]
v_mul_f32 v85, v69, v85
v_mfma_f32_16x16x32_bf16 v[172:175], v[208:211], a[76:79], v[172:175]
s_waitcnt lgkmcnt(6)
v_exp_f32 v79, v79
v_mfma_f32_16x16x32_bf16 v[176:179], v[192:195], a[64:67], v[176:179]
ds_read_b64_tr_b16 v[208:209], v228 offset:4096
ds_read_b64_tr_b16 v[210:211], v228 offset:4608
v_mfma_f32_16x16x32_bf16 v[180:183], v[192:195], a[68:71], v[180:183]
buffer_load_dwordx4 a[4:7], v237, s[28:31], s52 offen offset:1024 sc1
v_mul_f32 v86, v70, v86
v_mfma_f32_16x16x32_bf16 v[184:187], v[192:195], a[72:75], v[184:187]
v_mul_f32 v87, v71, v87
v_add_f32 v76, 1.0, v76
v_mfma_f32_16x16x32_bf16 v[188:191], v[192:195], a[76:79], v[188:191]
s_waitcnt lgkmcnt(6)
v_add_f32 v77, 1.0, v77
v_mfma_f32_16x16x32_bf16 v[160:163], v[196:199], a[80:83], v[160:163]
ds_read_b64_tr_b16 v[192:193], v228 offset:8192
ds_read_b64_tr_b16 v[194:195], v228 offset:8704
v_mfma_f32_16x16x32_bf16 v[164:167], v[196:199], a[84:87], v[164:167]
buffer_load_dwordx4 a[8:11], v237, s[28:31], s52 offen offset:2048 sc1
v_cvt_pk_bf16_f32 v214, v84, v85
v_mfma_f32_16x16x32_bf16 v[168:171], v[196:199], a[88:91], v[168:171]
v_cvt_pk_bf16_f32 v215, v86, v87
v_add_f32 v78, 1.0, v78
v_mfma_f32_16x16x32_bf16 v[172:175], v[196:199], a[92:95], v[172:175]
s_waitcnt lgkmcnt(6)
v_mfma_f32_16x16x32_bf16 v[176:179], v[200:203], a[80:83], v[176:179]
ds_read_b64_tr_b16 v[196:197], v228 offset:12288
ds_read_b64_tr_b16 v[198:199], v228 offset:12800
v_mfma_f32_16x16x32_bf16 v[180:183], v[200:203], a[84:87], v[180:183]
buffer_store_dwordx4 v[212:215], v237, s[28:31], s56 offen offset:0 sc1
v_add_f32 v79, 1.0, v79
v_mfma_f32_16x16x32_bf16 v[184:187], v[200:203], a[88:91], v[184:187]
v_rcp_f32 v76, v76
v_mfma_f32_16x16x32_bf16 v[188:191], v[200:203], a[92:95], v[188:191]
s_waitcnt lgkmcnt(6)
v_mfma_f32_16x16x32_bf16 v[160:163], v[204:207], a[96:99], v[160:163]
ds_read_b64_tr_b16 v[200:201], v228 offset:16384
ds_read_b64_tr_b16 v[202:203], v228 offset:16896
v_mfma_f32_16x16x32_bf16 v[164:167], v[204:207], a[100:103], v[164:167]
v_rcp_f32 v77, v77
v_mfma_f32_16x16x32_bf16 v[168:171], v[204:207], a[104:107], v[168:171]
v_mfma_f32_16x16x32_bf16 v[172:175], v[204:207], a[108:111], v[172:175]
s_waitcnt lgkmcnt(6)
v_mfma_f32_16x16x32_bf16 v[176:179], v[208:211], a[96:99], v[176:179]
ds_read_b64_tr_b16 v[204:205], v228 offset:20480
ds_read_b64_tr_b16 v[206:207], v228 offset:20992
v_mfma_f32_16x16x32_bf16 v[180:183], v[208:211], a[100:103], v[180:183]
v_rcp_f32 v78, v78
v_mfma_f32_16x16x32_bf16 v[184:187], v[208:211], a[104:107], v[184:187]
buffer_load_dwordx4 a[12:15], v237, s[28:31], s52 offen offset:3072 sc1
v_mfma_f32_16x16x32_bf16 v[188:191], v[208:211], a[108:111], v[188:191]
s_waitcnt lgkmcnt(6)
v_mfma_f32_16x16x32_bf16 v[160:163], v[192:195], a[112:115], v[160:163]
s_add_u32 s52, s79, 24576
ds_read_b64_tr_b16 v[208:209], v229 offset:45056
ds_read_b64_tr_b16 v[210:211], v229 offset:45568
v_mfma_f32_16x16x32_bf16 v[164:167], v[192:195], a[116:119], v[164:167]
v_rcp_f32 v79, v79
v_mfma_f32_16x16x32_bf16 v[168:171], v[192:195], a[120:123], v[168:171]
buffer_load_dwordx4 a[16:19], v237, s[28:31], s52 offen offset:0 sc1
v_mfma_f32_16x16x32_bf16 v[172:175], v[192:195], a[124:127], v[172:175]
s_waitcnt lgkmcnt(6)
v_mfma_f32_16x16x32_bf16 v[176:179], v[196:199], a[112:115], v[176:179]
ds_read_b64_tr_b16 v[192:193], v229 offset:49152
ds_read_b64_tr_b16 v[194:195], v229 offset:49664
v_mfma_f32_16x16x32_bf16 v[180:183], v[196:199], a[116:119], v[180:183]
v_mfma_f32_16x16x32_bf16 v[184:187], v[196:199], a[120:123], v[184:187]
v_mfma_f32_16x16x32_bf16 v[188:191], v[196:199], a[124:127], v[188:191]
s_waitcnt lgkmcnt(6)
v_mfma_f32_16x16x32_bf16 v[160:163], v[200:203], a[128:131], v[160:163]
ds_read_b64_tr_b16 v[196:197], v229 offset:53248
ds_read_b64_tr_b16 v[198:199], v229 offset:53760
v_mfma_f32_16x16x32_bf16 v[164:167], v[200:203], a[132:135], v[164:167]
buffer_load_dwordx4 a[20:23], v237, s[28:31], s52 offen offset:1024 sc1
v_mul_f32 v92, v76, v92
v_mfma_f32_16x16x32_bf16 v[168:171], v[200:203], a[136:139], v[168:171]
v_mul_f32 v93, v77, v93
v_mfma_f32_16x16x32_bf16 v[172:175], v[200:203], a[140:143], v[172:175]
s_waitcnt lgkmcnt(6)
v_mfma_f32_16x16x32_bf16 v[176:179], v[204:207], a[128:131], v[176:179]
ds_read_b64_tr_b16 v[200:201], v229 offset:57344
ds_read_b64_tr_b16 v[202:203], v229 offset:57856
v_mfma_f32_16x16x32_bf16 v[180:183], v[204:207], a[132:135], v[180:183]
v_add_u32 v229, 4294868992, v229
v_mul_f32 v94, v78, v94
v_mfma_f32_16x16x32_bf16 v[184:187], v[204:207], a[136:139], v[184:187]
buffer_load_dwordx4 a[24:27], v237, s[28:31], s52 offen offset:2048 sc1
v_mul_f32 v95, v79, v95
v_mfma_f32_16x16x32_bf16 v[188:191], v[204:207], a[140:143], v[188:191]
s_waitcnt lgkmcnt(6)
v_mfma_f32_16x16x32_bf16 v[96:99], v[208:211], a[64:67], v[96:99]
s_add_u32 s11, s3, 0
ds_read_b64_tr_b16 v[204:205], v229 offset:0
ds_read_b64_tr_b16 v[206:207], v229 offset:512
v_mfma_f32_16x16x32_bf16 v[100:103], v[208:211], a[68:71], v[100:103]
s_waitcnt vmcnt(13)
buffer_store_dword v242, off, s[32:35], s11 sc1
v_cvt_pk_bf16_f32 v218, v92, v93
v_mfma_f32_16x16x32_bf16 v[104:107], v[208:211], a[72:75], v[104:107]
s_add_u32 s11, s91, 0
v_cvt_pk_bf16_f32 v219, v94, v95
v_mfma_f32_16x16x32_bf16 v[108:111], v[208:211], a[76:79], v[108:111]
s_waitcnt lgkmcnt(6)
v_mfma_f32_16x16x32_bf16 v[112:115], v[192:195], a[64:67], v[112:115]
s_waitcnt vmcnt(14)
ds_read_b64_tr_b16 v[208:209], v229 offset:4096
ds_read_b64_tr_b16 v[210:211], v229 offset:4608
v_mfma_f32_16x16x32_bf16 v[116:119], v[192:195], a[68:71], v[116:119]
buffer_store_dwordx4 v[216:219], v237, s[28:31], s56 offen offset:1024 sc1
buffer_store_dword v242, off, s[32:35], s11 sc1
v_mfma_f32_16x16x32_bf16 v[120:123], v[192:195], a[72:75], v[120:123]
s_add_u32 s11, s97, 16384
v_mfma_f32_16x16x32_bf16 v[124:127], v[192:195], a[76:79], v[124:127]
s_waitcnt lgkmcnt(6)
v_mfma_f32_16x16x32_bf16 v[96:99], v[196:199], a[80:83], v[96:99]
ds_read_b64_tr_b16 v[192:193], v229 offset:8192
ds_read_b64_tr_b16 v[194:195], v229 offset:8704
v_mfma_f32_16x16x32_bf16 v[100:103], v[196:199], a[84:87], v[100:103]
v_mfma_f32_16x16x32_bf16 v[104:107], v[196:199], a[88:91], v[104:107]
v_mfma_f32_16x16x32_bf16 v[108:111], v[196:199], a[92:95], v[108:111]
s_waitcnt lgkmcnt(6)
v_mfma_f32_16x16x32_bf16 v[112:115], v[200:203], a[80:83], v[112:115]
ds_read_b64_tr_b16 v[196:197], v229 offset:12288
ds_read_b64_tr_b16 v[198:199], v229 offset:12800
v_mfma_f32_16x16x32_bf16 v[116:119], v[200:203], a[84:87], v[116:119]
buffer_load_dwordx4 a[28:31], v237, s[28:31], s52 offen offset:3072 sc1
v_mfma_f32_16x16x32_bf16 v[120:123], v[200:203], a[88:91], v[120:123]
v_mfma_f32_16x16x32_bf16 v[124:127], v[200:203], a[92:95], v[124:127]
s_waitcnt lgkmcnt(6)
v_mfma_f32_16x16x32_bf16 v[96:99], v[204:207], a[96:99], v[96:99]
s_add_u32 s52, s79, 73728
ds_read_b64_tr_b16 v[200:201], v229 offset:16384
ds_read_b64_tr_b16 v[202:203], v229 offset:16896
v_mfma_f32_16x16x32_bf16 v[100:103], v[204:207], a[100:103], v[100:103]
buffer_load_dwordx4 a[32:35], v237, s[28:31], s52 offen offset:0 sc1
v_mfma_f32_16x16x32_bf16 v[104:107], v[204:207], a[104:107], v[104:107]
v_mfma_f32_16x16x32_bf16 v[108:111], v[204:207], a[108:111], v[108:111]
s_waitcnt lgkmcnt(6)
v_mfma_f32_16x16x32_bf16 v[112:115], v[208:211], a[96:99], v[112:115]
ds_read_b64_tr_b16 v[204:205], v229 offset:20480
ds_read_b64_tr_b16 v[206:207], v229 offset:20992
v_mfma_f32_16x16x32_bf16 v[116:119], v[208:211], a[100:103], v[116:119]
v_mfma_f32_16x16x32_bf16 v[120:123], v[208:211], a[104:107], v[120:123]
v_mfma_f32_16x16x32_bf16 v[124:127], v[208:211], a[108:111], v[124:127]
s_waitcnt lgkmcnt(6)
v_mfma_f32_16x16x32_bf16 v[96:99], v[192:195], a[112:115], v[96:99]
ds_read_b64_tr_b16 v[208:209], v230 offset:45056
ds_read_b64_tr_b16 v[210:211], v230 offset:45568
v_mfma_f32_16x16x32_bf16 v[100:103], v[192:195], a[116:119], v[100:103]
buffer_load_dwordx4 a[36:39], v237, s[28:31], s52 offen offset:1024 sc1
v_lshrrev_b32 v238, 7, v237
v_mfma_f32_16x16x32_bf16 v[104:107], v[192:195], a[120:123], v[104:107]
v_mul_u32_u24 v236, 11, v238
v_mfma_f32_16x16x32_bf16 v[108:111], v[192:195], a[124:127], v[108:111]
s_waitcnt lgkmcnt(6)
v_mfma_f32_16x16x32_bf16 v[112:115], v[196:199], a[112:115], v[112:115]
ds_read_b64_tr_b16 v[192:193], v230 offset:49152
ds_read_b64_tr_b16 v[194:195], v230 offset:49664
v_mfma_f32_16x16x32_bf16 v[116:119], v[196:199], a[116:119], v[116:119]
buffer_load_dwordx4 a[40:43], v237, s[28:31], s52 offen offset:2048 sc1
v_lshrrev_b32 v236, 5, v236
v_mfma_f32_16x16x32_bf16 v[120:123], v[196:199], a[120:123], v[120:123]
v_mul_u32_u24 v243, 3, v236
v_mfma_f32_16x16x32_bf16 v[124:127], v[196:199], a[124:127], v[124:127]
s_waitcnt lgkmcnt(6)
v_mfma_f32_16x16x32_bf16 v[96:99], v[200:203], a[128:131], v[96:99]
ds_read_b64_tr_b16 v[196:197], v230 offset:53248
ds_read_b64_tr_b16 v[198:199], v230 offset:53760
v_mfma_f32_16x16x32_bf16 v[100:103], v[200:203], a[132:135], v[100:103]
buffer_load_dwordx4 a[44:47], v237, s[28:31], s52 offen offset:3072 sc1
v_sub_u32 v243, v238, v243
v_mfma_f32_16x16x32_bf16 v[104:107], v[200:203], a[136:139], v[104:107]
s_lshr_b32 s6, s77, 6
v_sub_u32 v236, s6, v236
v_mfma_f32_16x16x32_bf16 v[108:111], v[200:203], a[140:143], v[108:111]
s_waitcnt lgkmcnt(6)
v_mfma_f32_16x16x32_bf16 v[112:115], v[204:207], a[128:131], v[112:115]
s_add_u32 s52, s79, 0
ds_read_b64_tr_b16 v[200:201], v230 offset:57344
ds_read_b64_tr_b16 v[202:203], v230 offset:57856
v_mfma_f32_16x16x32_bf16 v[116:119], v[204:207], a[132:135], v[116:119]
v_add_u32 v230, 4294868992, v230
v_max_i32 v236, 0, v236
v_mfma_f32_16x16x32_bf16 v[120:123], v[204:207], a[136:139], v[120:123]
buffer_load_dwordx4 v[64:67], v237, s[28:31], s52 offen offset:0 sc1
v_lshl_add_u32 v236, v236, 2, v243
v_mfma_f32_16x16x32_bf16 v[124:127], v[204:207], a[140:143], v[124:127]
s_waitcnt lgkmcnt(6)
v_mfma_f32_16x16x32_bf16 v[128:131], v[208:211], a[64:67], v[128:131]
s_bfe_u32 s6, s2, 0x30003
ds_read_b64_tr_b16 v[204:205], v230 offset:0
ds_read_b64_tr_b16 v[206:207], v230 offset:512
v_mfma_f32_16x16x32_bf16 v[132:135], v[208:211], a[68:71], v[132:135]
s_lshl_b32 s6, s6, 1
buffer_load_dwordx4 v[68:71], v237, s[28:31], s52 offen offset:1024 sc1
v_lshl_add_u32 v236, v236, 5, s6
v_mfma_f32_16x16x32_bf16 v[136:139], v[208:211], a[72:75], v[136:139]
v_bfe_u32 v243, v237, 4, 2
v_mfma_f32_16x16x32_bf16 v[140:143], v[208:211], a[76:79], v[140:143]
s_waitcnt lgkmcnt(6)
v_mfma_f32_16x16x32_bf16 v[144:147], v[192:195], a[64:67], v[144:147]
ds_read_b64_tr_b16 v[208:209], v230 offset:4096
ds_read_b64_tr_b16 v[210:211], v230 offset:4608
v_mfma_f32_16x16x32_bf16 v[148:151], v[192:195], a[68:71], v[148:151]
v_add_lshl_u32 v236, v236, v243, 2
v_cmp_gt_u32 s[4:5], 6, v238
v_mfma_f32_16x16x32_bf16 v[152:155], v[192:195], a[72:75], v[152:155]
v_mfma_f32_16x16x32_bf16 v[156:159], v[192:195], a[76:79], v[156:159]
s_waitcnt lgkmcnt(6)
v_mfma_f32_16x16x32_bf16 v[128:131], v[196:199], a[80:83], v[128:131]
ds_read_b64_tr_b16 v[192:193], v230 offset:8192
ds_read_b64_tr_b16 v[194:195], v230 offset:8704
v_mfma_f32_16x16x32_bf16 v[132:135], v[196:199], a[84:87], v[132:135]
buffer_load_dwordx4 v[72:75], v237, s[28:31], s52 offen offset:2048 sc1
v_add_u32 v236, 46198784, v236
v_mfma_f32_16x16x32_bf16 v[136:139], v[196:199], a[88:91], v[136:139]
v_add_u32 v234, 16384, v241
v_mfma_f32_16x16x32_bf16 v[140:143], v[196:199], a[92:95], v[140:143]
s_waitcnt lgkmcnt(6)
v_mfma_f32_16x16x32_bf16 v[144:147], v[200:203], a[80:83], v[144:147]
ds_read_b64_tr_b16 v[196:197], v230 offset:12288
ds_read_b64_tr_b16 v[198:199], v230 offset:12800
v_mfma_f32_16x16x32_bf16 v[148:151], v[200:203], a[84:87], v[148:151]
buffer_load_dwordx4 v[76:79], v237, s[28:31], s52 offen offset:3072 sc1
v_cndmask_b32 v234, v234, v236, s[4:5]
v_mfma_f32_16x16x32_bf16 v[152:155], v[200:203], a[88:91], v[152:155]
v_bfe_u32 v238, v237, 4, 4
v_lshrrev_b32 v236, 8, v237
v_mfma_f32_16x16x32_bf16 v[156:159], v[200:203], a[92:95], v[156:159]
s_waitcnt lgkmcnt(6)
v_mul_u32_u24 v238, 1152, v238
v_add_u32 v238, s85, v238
v_mfma_f32_16x16x32_bf16 v[128:131], v[204:207], a[96:99], v[128:131]
s_add_u32 s52, s79, 8192
ds_read_b64_tr_b16 v[200:201], v230 offset:16384
ds_read_b64_tr_b16 v[202:203], v230 offset:16896
v_mfma_f32_16x16x32_bf16 v[132:135], v[204:207], a[100:103], v[132:135]
buffer_load_dwordx4 v[80:83], v237, s[28:31], s52 offen offset:0 sc1
v_lshl_add_u32 v233, v236, 3, v238
v_mfma_f32_16x16x32_bf16 v[136:139], v[204:207], a[104:107], v[136:139]
v_and_b32 v232, 1, v236
v_lshl_add_u32 v238, v232, 5, v238
v_mfma_f32_16x16x32_bf16 v[140:143], v[204:207], a[108:111], v[140:143]
s_waitcnt lgkmcnt(6)
v_lshrrev_b32 v236, 1, v236
v_lshl_add_u32 v232, v236, 4, v238
v_mfma_f32_16x16x32_bf16 v[144:147], v[208:211], a[96:99], v[144:147]
s_waitcnt vmcnt(11)
ds_read_b64_tr_b16 v[204:205], v230 offset:20480
ds_read_b64_tr_b16 v[206:207], v230 offset:20992
v_mfma_f32_16x16x32_bf16 v[148:151], v[208:211], a[100:103], v[148:151]
buffer_store_dword v242, off, s[28:31], s11 sc1
buffer_load_dwordx4 v[84:87], v237, s[28:31], s52 offen offset:1024 sc1
v_mfma_f32_16x16x32_bf16 v[152:155], v[208:211], a[104:107], v[152:155]
v_lshl_add_u32 v233, v236, 30, v233
v_lshrrev_b32 v239, 1, v237
v_mfma_f32_16x16x32_bf16 v[156:159], v[208:211], a[108:111], v[156:159]
s_waitcnt lgkmcnt(6)
v_lshrrev_b32 v243, 6, v237
v_lshlrev_b32 v243, 4, v243
v_mfma_f32_16x16x32_bf16 v[128:131], v[192:195], a[112:115], v[128:131]
ds_read_b64_tr_b16 v[208:209], v231 offset:45056
ds_read_b64_tr_b16 v[210:211], v231 offset:45568
v_mfma_f32_16x16x32_bf16 v[132:135], v[192:195], a[116:119], v[132:135]
buffer_load_dwordx4 v[88:91], v237, s[28:31], s52 offen offset:2048 sc1
v_and_b32 v240, 8, v239
v_mfma_f32_16x16x32_bf16 v[136:139], v[192:195], a[120:123], v[136:139]
v_add_u32 v240, v240, v243
v_bfe_u32 v239, v237, 5, 1
v_mfma_f32_16x16x32_bf16 v[140:143], v[192:195], a[124:127], v[140:143]
s_waitcnt lgkmcnt(6)
v_mul_u32_u24 v239, 640, v239
v_xor_b32 v239, v239, v240
v_mfma_f32_16x16x32_bf16 v[144:147], v[196:199], a[112:115], v[144:147]
ds_read_b64_tr_b16 v[192:193], v231 offset:49152
ds_read_b64_tr_b16 v[194:195], v231 offset:49664
v_mfma_f32_16x16x32_bf16 v[148:151], v[196:199], a[116:119], v[148:151]
v_add_u32 v239, 98304, v239
v_add_u32 v240, 98304, v240
v_mfma_f32_16x16x32_bf16 v[152:155], v[196:199], a[120:123], v[152:155]
s_mov_b32 s24, s46
v_mfma_f32_16x16x32_bf16 v[156:159], v[196:199], a[124:127], v[156:159]
s_waitcnt lgkmcnt(6)
v_mfma_f32_16x16x32_bf16 v[128:131], v[200:203], a[128:131], v[128:131]
s_mov_b32 s25, s47
ds_read_b64_tr_b16 v[196:197], v231 offset:53248
ds_read_b64_tr_b16 v[198:199], v231 offset:53760
v_mfma_f32_16x16x32_bf16 v[132:135], v[200:203], a[132:135], v[132:135]
s_mov_b32 s26, 2359296
buffer_load_dwordx4 v[92:95], v237, s[28:31], s52 offen offset:3072 sc1
v_lshrrev_b32 v220, 4, v237
v_mfma_f32_16x16x32_bf16 v[136:139], v[200:203], a[136:139], v[136:139]
v_add_u32 v220, s80, v220
v_add_u32 v220, 0, v220
v_mfma_f32_16x16x32_bf16 v[140:143], v[200:203], a[140:143], v[140:143]
s_waitcnt lgkmcnt(6)
v_mul_u32_u24 v221, 5042, v220
v_mfma_f32_16x16x32_bf16 v[144:147], v[204:207], a[128:131], v[144:147]
s_add_u32 s52, s79, 81920
ds_read_b64_tr_b16 v[200:201], v231 offset:57344
ds_read_b64_tr_b16 v[202:203], v231 offset:57856
v_mfma_f32_16x16x32_bf16 v[148:151], v[204:207], a[132:135], v[148:151]
v_add_u32 v231, 4294868992, v231
v_lshrrev_b32 v221, 16, v221
v_mfma_f32_16x16x32_bf16 v[152:155], v[204:207], a[136:139], v[152:155]
buffer_load_dwordx4 a[48:51], v237, s[28:31], s52 offen offset:0 sc1
v_mul_u32_u24 v222, 13, v221
v_mfma_f32_16x16x32_bf16 v[156:159], v[204:207], a[140:143], v[156:159]
s_waitcnt lgkmcnt(6)
v_sub_u32 v220, v220, v222
v_mfma_f32_16x16x32_bf16 v[32:35], v[208:211], a[64:67], v[32:35]
ds_read_b64_tr_b16 v[204:205], v231 offset:0
ds_read_b64_tr_b16 v[206:207], v231 offset:512
v_mfma_f32_16x16x32_bf16 v[36:39], v[208:211], a[68:71], v[36:39]
buffer_load_dword v246, v241, s[28:31], s68 offen sc1
v_mul_u32_u24 v222, 11, v220
v_mfma_f32_16x16x32_bf16 v[40:43], v[208:211], a[72:75], v[40:43]
v_lshrrev_b32 v222, 5, v222
v_mul_u32_u24 v222, 12, v222
v_mfma_f32_16x16x32_bf16 v[44:47], v[208:211], a[76:79], v[44:47]
s_waitcnt lgkmcnt(6)
v_mfma_f32_16x16x32_bf16 v[48:51], v[192:195], a[64:67], v[48:51]
ds_read_b64_tr_b16 v[208:209], v231 offset:4096
ds_read_b64_tr_b16 v[210:211], v231 offset:4608
v_mfma_f32_16x16x32_bf16 v[52:55], v[192:195], a[68:71], v[52:55]
buffer_load_dwordx4 a[52:55], v237, s[28:31], s52 offen offset:1024 sc1
v_lshlrev_b32 v220, 4, v220
v_mfma_f32_16x16x32_bf16 v[56:59], v[192:195], a[72:75], v[56:59]
v_sub_u32 v220, v220, v222
v_add_u32 v221, s77, v221
v_mfma_f32_16x16x32_bf16 v[60:63], v[192:195], a[76:79], v[60:63]
s_waitcnt lgkmcnt(6)
v_mfma_f32_16x16x32_bf16 v[32:35], v[196:199], a[80:83], v[32:35]
ds_read_b64_tr_b16 v[192:193], v231 offset:8192
ds_read_b64_tr_b16 v[194:195], v231 offset:8704
v_mfma_f32_16x16x32_bf16 v[36:39], v[196:199], a[84:87], v[36:39]
buffer_load_dwordx4 a[56:59], v237, s[28:31], s52 offen offset:2048 sc1
v_mul_u32_u24 v222, 3456, v221
v_mfma_f32_16x16x32_bf16 v[40:43], v[196:199], a[88:91], v[40:43]
v_add_u32 v236, v222, v220
v_lshrrev_b32 v220, 4, v237
v_mfma_f32_16x16x32_bf16 v[44:47], v[196:199], a[92:95], v[44:47]
s_waitcnt lgkmcnt(6)
v_mfma_f32_16x16x32_bf16 v[48:51], v[200:203], a[80:83], v[48:51]
ds_read_b64_tr_b16 v[196:197], v231 offset:12288
ds_read_b64_tr_b16 v[198:199], v231 offset:12800
v_mfma_f32_16x16x32_bf16 v[52:55], v[200:203], a[84:87], v[52:55]
buffer_load_dwordx4 a[60:63], v237, s[28:31], s52 offen offset:3072 sc1
v_add_u32 v220, s80, v220
v_mfma_f32_16x16x32_bf16 v[56:59], v[200:203], a[88:91], v[56:59]
v_add_u32 v220, 256, v220
v_mul_u32_u24 v221, 5042, v220
v_mfma_f32_16x16x32_bf16 v[60:63], v[200:203], a[92:95], v[60:63]
s_waitcnt lgkmcnt(6)
v_mfma_f32_16x16x32_bf16 v[32:35], v[204:207], a[96:99], v[32:35]
ds_read_b64_tr_b16 v[200:201], v231 offset:16384
ds_read_b64_tr_b16 v[202:203], v231 offset:16896
v_mfma_f32_16x16x32_bf16 v[36:39], v[204:207], a[100:103], v[36:39]
v_lshrrev_b32 v221, 16, v221
v_mul_u32_u24 v222, 13, v221
v_mfma_f32_16x16x32_bf16 v[40:43], v[204:207], a[104:107], v[40:43]
v_mfma_f32_16x16x32_bf16 v[44:47], v[204:207], a[108:111], v[44:47]
s_waitcnt lgkmcnt(6)
v_mfma_f32_16x16x32_bf16 v[48:51], v[208:211], a[96:99], v[48:51]
s_add_u32 s52, s79, 90112
ds_read_b64_tr_b16 v[204:205], v231 offset:20480
ds_read_b64_tr_b16 v[206:207], v231 offset:20992
v_mfma_f32_16x16x32_bf16 v[52:55], v[208:211], a[100:103], v[52:55]
buffer_load_dwordx4 a[64:67], v237, s[28:31], s52 offen offset:0 sc1
v_sub_u32 v220, v220, v222
v_mfma_f32_16x16x32_bf16 v[56:59], v[208:211], a[104:107], v[56:59]
s_waitcnt vmcnt(34)
s_barrier
v_mfma_f32_16x16x32_bf16 v[60:63], v[208:211], a[108:111], v[60:63]
s_waitcnt lgkmcnt(6)
v_mul_u32_u24 v222, 11, v220
v_lshrrev_b32 v222, 5, v222
v_mfma_f32_16x16x32_bf16 v[32:35], v[192:195], a[112:115], v[32:35]
ds_read_b64_tr_b16 v[208:209], v228 offset:24576
ds_read_b64_tr_b16 v[210:211], v228 offset:25088
v_mfma_f32_16x16x32_bf16 v[36:39], v[192:195], a[116:119], v[36:39]
v_mul_u32_u24 v222, 12, v222
v_lshlrev_b32 v220, 4, v220
v_mfma_f32_16x16x32_bf16 v[40:43], v[192:195], a[120:123], v[40:43]
v_sub_u32 v220, v220, v222
v_mfma_f32_16x16x32_bf16 v[44:47], v[192:195], a[124:127], v[44:47]
s_waitcnt lgkmcnt(6)
v_mfma_f32_16x16x32_bf16 v[48:51], v[196:199], a[112:115], v[48:51]
ds_read_b64_tr_b16 v[192:193], v228 offset:28672
ds_read_b64_tr_b16 v[194:195], v228 offset:29184
v_mfma_f32_16x16x32_bf16 v[52:55], v[196:199], a[116:119], v[52:55]
buffer_load_dwordx4 a[68:71], v237, s[28:31], s52 offen offset:1024 sc1
v_add_u32 v221, s77, v221
v_mfma_f32_16x16x32_bf16 v[56:59], v[196:199], a[120:123], v[56:59]
v_mul_u32_u24 v222, 3456, v221
v_add_u32 v238, v222, v220
v_mfma_f32_16x16x32_bf16 v[60:63], v[196:199], a[124:127], v[60:63]
s_waitcnt lgkmcnt(6)
v_mfma_f32_16x16x32_bf16 v[32:35], v[200:203], a[128:131], v[32:35]
ds_read_b64_tr_b16 v[196:197], v228 offset:32768
ds_read_b64_tr_b16 v[198:199], v228 offset:33280
v_mfma_f32_16x16x32_bf16 v[36:39], v[200:203], a[132:135], v[36:39]
buffer_load_dwordx4 a[72:75], v237, s[28:31], s52 offen offset:2048 sc1
v_lshrrev_b32 v220, 4, v237
v_mfma_f32_16x16x32_bf16 v[40:43], v[200:203], a[136:139], v[40:43]
v_add_u32 v220, s80, v220
v_add_u32 v220, 512, v220
v_mfma_f32_16x16x32_bf16 v[44:47], v[200:203], a[140:143], v[44:47]
s_waitcnt lgkmcnt(6)
v_mfma_f32_16x16x32_bf16 v[48:51], v[204:207], a[128:131], v[48:51]
ds_read_b64_tr_b16 v[200:201], v228 offset:36864
ds_read_b64_tr_b16 v[202:203], v228 offset:37376
v_mfma_f32_16x16x32_bf16 v[52:55], v[204:207], a[132:135], v[52:55]
buffer_load_dwordx4 a[76:79], v237, s[28:31], s52 offen offset:3072 sc1
v_mul_u32_u24 v221, 5042, v220
v_mfma_f32_16x16x32_bf16 v[56:59], v[204:207], a[136:139], v[56:59]
v_lshrrev_b32 v221, 16, v221
v_mul_u32_u24 v222, 13, v221
v_mfma_f32_16x16x32_bf16 v[60:63], v[204:207], a[140:143], v[60:63]
s_waitcnt lgkmcnt(6)
v_mfma_f32_16x16x32_bf16 v[160:163], v[208:211], a[144:147], v[160:163]
s_add_u32 s52, s79, 98304
ds_read_b64_tr_b16 v[204:205], v228 offset:40960
ds_read_b64_tr_b16 v[206:207], v228 offset:41472
v_mfma_f32_16x16x32_bf16 v[164:167], v[208:211], a[148:151], v[164:167]
buffer_load_dwordx4 a[80:83], v237, s[28:31], s52 offen offset:0 sc1
v_sub_u32 v220, v220, v222
v_mfma_f32_16x16x32_bf16 v[168:171], v[208:211], a[152:155], v[168:171]
v_mul_u32_u24 v222, 11, v220
v_lshrrev_b32 v222, 5, v222
v_mfma_f32_16x16x32_bf16 v[172:175], v[208:211], a[156:159], v[172:175]
s_waitcnt lgkmcnt(6)
v_mfma_f32_16x16x32_bf16 v[176:179], v[192:195], a[144:147], v[176:179]
ds_read_b64_tr_b16 v[208:209], v228 offset:45056
ds_read_b64_tr_b16 v[210:211], v228 offset:45568
v_mfma_f32_16x16x32_bf16 v[180:183], v[192:195], a[148:151], v[180:183]
buffer_load_dwordx4 a[84:87], v237, s[28:31], s52 offen offset:1024 sc1
v_mul_u32_u24 v222, 12, v222
v_mfma_f32_16x16x32_bf16 v[184:187], v[192:195], a[152:155], v[184:187]
v_lshlrev_b32 v220, 4, v220
v_sub_u32 v220, v220, v222
v_mfma_f32_16x16x32_bf16 v[188:191], v[192:195], a[156:159], v[188:191]
s_waitcnt lgkmcnt(6)
v_mfma_f32_16x16x32_bf16 v[160:163], v[196:199], a[160:163], v[160:163]
ds_read_b64_tr_b16 v[192:193], v228 offset:49152
ds_read_b64_tr_b16 v[194:195], v228 offset:49664
v_mfma_f32_16x16x32_bf16 v[164:167], v[196:199], a[164:167], v[164:167]
v_add_u32 v221, s77, v221
v_mul_u32_u24 v222, 3456, v221
v_mfma_f32_16x16x32_bf16 v[168:171], v[196:199], a[168:171], v[168:171]
v_add_u32 v243, v222, v220
v_mfma_f32_16x16x32_bf16 v[172:175], v[196:199], a[172:175], v[172:175]
s_waitcnt lgkmcnt(6)
v_mfma_f32_16x16x32_bf16 v[176:179], v[200:203], a[160:163], v[176:179]
TCH_6_v0:
s_cbranch_execz TCH_10_v0
ds_read_b64_tr_b16 v[196:197], v228 offset:53248
ds_read_b64_tr_b16 v[198:199], v228 offset:53760
v_mfma_f32_16x16x32_bf16 v[180:183], v[200:203], a[164:167], v[180:183]
buffer_load_dwordx4 a[88:91], v237, s[28:31], s52 offen offset:2048 sc1
v_lshrrev_b32 v220, 4, v237
v_mfma_f32_16x16x32_bf16 v[184:187], v[200:203], a[168:171], v[184:187]
v_add_u32 v220, s80, v220
v_add_u32 v220, 768, v220
v_mfma_f32_16x16x32_bf16 v[188:191], v[200:203], a[172:175], v[188:191]
s_waitcnt lgkmcnt(6)
v_mfma_f32_16x16x32_bf16 v[160:163], v[204:207], a[176:179], v[160:163]
ds_read_b64_tr_b16 v[200:201], v228 offset:57344
ds_read_b64_tr_b16 v[202:203], v228 offset:57856
v_mfma_f32_16x16x32_bf16 v[164:167], v[204:207], a[180:183], v[164:167]
buffer_load_dwordx4 a[92:95], v237, s[28:31], s52 offen offset:3072 sc1
v_mul_u32_u24 v221, 5042, v220
v_mfma_f32_16x16x32_bf16 v[168:171], v[204:207], a[184:187], v[168:171]
v_lshrrev_b32 v221, 16, v221
v_mfma_f32_16x16x32_bf16 v[172:175], v[204:207], a[188:191], v[172:175]
s_waitcnt lgkmcnt(6)
v_mfma_f32_16x16x32_bf16 v[176:179], v[208:211], a[176:179], v[176:179]
s_waitcnt vmcnt(11)
ds_read_b64_tr_b16 v[204:205], v228 offset:61440
ds_read_b64_tr_b16 v[206:207], v228 offset:61952
v_mfma_f32_16x16x32_bf16 v[180:183], v[208:211], a[180:183], v[180:183]
v_add_u32 v228, 65536, v228
v_cmp_gt_u32 vcc, 1, v246
v_mfma_f32_16x16x32_bf16 v[184:187], v[208:211], a[184:187], v[184:187]
s_cbranch_vccnz spin_10_v0
ok_9_v0:
v_mfma_f32_16x16x32_bf16 v[188:191], v[208:211], a[188:191], v[188:191]
s_waitcnt lgkmcnt(6)
v_mul_u32_u24 v222, 13, v221
v_sub_u32 v220, v220, v222
v_mfma_f32_16x16x32_bf16 v[160:163], v[192:195], a[192:195], v[160:163]
s_add_u32 m0, s49, 110592
ds_read_b64_tr_b16 v[208:209], v228 offset:0
ds_read_b64_tr_b16 v[210:211], v228 offset:512
v_mfma_f32_16x16x32_bf16 v[164:167], v[192:195], a[196:199], v[164:167]
s_add_u32 s50, s81, 12288
buffer_load_dwordx4 v237, s[28:31], s50 offen sc1 lds
v_mul_u32_u24 v222, 11, v220
v_mfma_f32_16x16x32_bf16 v[168:171], v[192:195], a[200:203], v[168:171]
s_add_u32 m0, s49, 114688
v_lshrrev_b32 v222, 5, v222
v_mul_u32_u24 v222, 12, v222
v_mfma_f32_16x16x32_bf16 v[172:175], v[192:195], a[204:207], v[172:175]
s_waitcnt lgkmcnt(6)
v_lshlrev_b32 v220, 4, v220
v_mfma_f32_16x16x32_bf16 v[176:179], v[196:199], a[192:195], v[176:179]
s_add_u32 s50, s81, 16384
ds_read_b64_tr_b16 v[192:193], v228 offset:4096
ds_read_b64_tr_b16 v[194:195], v228 offset:4608
v_mfma_f32_16x16x32_bf16 v[180:183], v[196:199], a[196:199], v[180:183]
buffer_load_dwordx4 v237, s[28:31], s50 offen sc1 lds
v_sub_u32 v220, v220, v222
v_mfma_f32_16x16x32_bf16 v[184:187], v[196:199], a[200:203], v[184:187]
s_add_u32 m0, s49, 118784
v_add_u32 v221, s77, v221
v_mul_u32_u24 v222, 3456, v221
v_mfma_f32_16x16x32_bf16 v[188:191], v[196:199], a[204:207], v[188:191]
s_waitcnt lgkmcnt(6)
v_mfma_f32_16x16x32_bf16 v[160:163], v[200:203], a[208:211], v[160:163]
s_add_u32 s50, s81, 20480
ds_read_b64_tr_b16 v[196:197], v228 offset:8192
ds_read_b64_tr_b16 v[198:199], v228 offset:8704
v_mfma_f32_16x16x32_bf16 v[164:167], v[200:203], a[212:215], v[164:167]
buffer_load_dwordx4 v237, s[28:31], s50 offen sc1 lds
v_add_u32 v247, v222, v220
v_mfma_f32_16x16x32_bf16 v[168:171], v[200:203], a[216:219], v[168:171]
s_add_u32 s8, s76, 1
v_mfma_f32_16x16x32_bf16 v[172:175], v[200:203], a[220:223], v[172:175]
s_waitcnt lgkmcnt(6)
v_mfma_f32_16x16x32_bf16 v[176:179], v[204:207], a[208:211], v[176:179]
s_add_u32 m0, s49, 122880
ds_read_b64_tr_b16 v[200:201], v228 offset:12288
ds_read_b64_tr_b16 v[202:203], v228 offset:12800
v_mfma_f32_16x16x32_bf16 v[180:183], v[204:207], a[212:215], v[180:183]
s_add_u32 s50, s81, 24576
buffer_load_dwordx4 v237, s[28:31], s50 offen sc1 lds
v_mfma_f32_16x16x32_bf16 v[184:187], v[204:207], a[216:219], v[184:187]
s_and_b32 s8, s8, 3
v_mfma_f32_16x16x32_bf16 v[188:191], v[204:207], a[220:223], v[188:191]
s_waitcnt lgkmcnt(6)
v_mfma_f32_16x16x32_bf16 v[160:163], v[208:211], a[224:227], v[160:163]
s_add_u32 m0, s49, 126976
ds_read_b64_tr_b16 v[204:205], v228 offset:16384
ds_read_b64_tr_b16 v[206:207], v228 offset:16896
v_mfma_f32_16x16x32_bf16 v[164:167], v[208:211], a[228:231], v[164:167]
s_add_u32 s50, s81, 28672
buffer_load_dwordx4 v237, s[28:31], s50 offen sc1 lds
s_mul_i32 s8, s8, 7680
v_mfma_f32_16x16x32_bf16 v[168:171], v[208:211], a[232:235], v[168:171]
s_add_u32 s8, s8, s92
s_add_u32 s8, s8, 0
s_add_u32 s9, s76, 2
v_mfma_f32_16x16x32_bf16 v[172:175], v[208:211], a[236:239], v[172:175]
s_waitcnt lgkmcnt(6)
v_mfma_f32_16x16x32_bf16 v[176:179], v[192:195], a[224:227], v[176:179]
s_add_u32 m0, s49, 131072
ds_read_b64_tr_b16 v[208:209], v228 offset:20480
ds_read_b64_tr_b16 v[210:211], v228 offset:20992
v_mfma_f32_16x16x32_bf16 v[180:183], v[192:195], a[228:231], v[180:183]
s_add_u32 s50, s81, 32768
buffer_load_dwordx4 v237, s[28:31], s50 offen sc1 lds
s_and_b32 s9, s9, 3
v_mfma_f32_16x16x32_bf16 v[184:187], v[192:195], a[232:235], v[184:187]
s_mul_i32 s9, s9, 7680
s_add_u32 s9, s9, s92
s_add_u32 s9, s9, 2560
v_mfma_f32_16x16x32_bf16 v[188:191], v[192:195], a[236:239], v[188:191]
s_waitcnt lgkmcnt(6)
s_add_u32 s10, s76, 3
s_and_b32 s10, s10, 3
v_mfma_f32_16x16x32_bf16 v[160:163], v[196:199], a[240:243], v[160:163]
s_add_u32 m0, s49, 135168
ds_read_b64_tr_b16 v[192:193], v228 offset:24576
ds_read_b64_tr_b16 v[194:195], v228 offset:25088
v_mfma_f32_16x16x32_bf16 v[164:167], v[196:199], a[244:247], v[164:167]
s_add_u32 s50, s81, 36864
buffer_load_dwordx4 v237, s[28:31], s50 offen sc1 lds
s_mul_i32 s10, s10, 7680
v_mfma_f32_16x16x32_bf16 v[168:171], v[196:199], a[248:251], v[168:171]
s_add_u32 s10, s10, s92
s_add_u32 s10, s10, 5120
v_mfma_f32_16x16x32_bf16 v[172:175], v[196:199], a[252:255], v[172:175]
s_waitcnt lgkmcnt(6)
v_mfma_f32_16x16x32_bf16 v[176:179], v[200:203], a[240:243], v[176:179]
s_add_u32 m0, s49, 139264
ds_read_b64_tr_b16 v[196:197], v228 offset:28672
ds_read_b64_tr_b16 v[198:199], v228 offset:29184
v_mfma_f32_16x16x32_bf16 v[180:183], v[200:203], a[244:247], v[180:183]
s_add_u32 s50, s81, 40960
buffer_load_dwordx4 v237, s[28:31], s50 offen sc1 lds
v_mfma_f32_16x16x32_bf16 v[184:187], v[200:203], a[248:251], v[184:187]
v_mfma_f32_16x16x32_bf16 v[188:191], v[200:203], a[252:255], v[188:191]
s_waitcnt lgkmcnt(6)
v_mfma_f32_16x16x32_bf16 v[160:163], v[204:207], v[0:3], v[160:163]
ds_read_b64_tr_b16 v[200:201], v229 offset:24576
ds_read_b64_tr_b16 v[202:203], v229 offset:25088
v_mfma_f32_16x16x32_bf16 v[164:167], v[204:207], v[4:7], v[164:167]
buffer_load_dword v246, v234, s[28:31], 0 offen sc1
v_mfma_f32_16x16x32_bf16 v[168:171], v[204:207], v[8:11], v[168:171]
v_mfma_f32_16x16x32_bf16 v[172:175], v[204:207], v[12:15], v[172:175]
s_waitcnt lgkmcnt(6)
v_mfma_f32_16x16x32_bf16 v[176:179], v[208:211], v[0:3], v[176:179]
s_add_u32 m0, s49, 143360
ds_read_b64_tr_b16 v[204:205], v229 offset:28672
ds_read_b64_tr_b16 v[206:207], v229 offset:29184
v_mfma_f32_16x16x32_bf16 v[180:183], v[208:211], v[4:7], v[180:183]
s_add_u32 s50, s81, 45056
buffer_load_dwordx4 v237, s[28:31], s50 offen sc1 lds
v_mfma_f32_16x16x32_bf16 v[184:187], v[208:211], v[8:11], v[184:187]
v_mfma_f32_16x16x32_bf16 v[188:191], v[208:211], v[12:15], v[188:191]
s_waitcnt lgkmcnt(6)
v_mfma_f32_16x16x32_bf16 v[160:163], v[192:195], v[16:19], v[160:163]
s_add_u32 m0, s49, 147456
ds_read_b64_tr_b16 v[208:209], v229 offset:32768
ds_read_b64_tr_b16 v[210:211], v229 offset:33280
v_mfma_f32_16x16x32_bf16 v[164:167], v[192:195], v[20:23], v[164:167]
s_add_u32 s50, s81, 49152
buffer_load_dwordx4 v237, s[28:31], s50 offen sc1 lds
v_mfma_f32_16x16x32_bf16 v[168:171], v[192:195], v[24:27], v[168:171]
v_mfma_f32_16x16x32_bf16 v[172:175], v[192:195], v[28:31], v[172:175]
s_waitcnt lgkmcnt(6)
v_mfma_f32_16x16x32_bf16 v[176:179], v[196:199], v[16:19], v[176:179]
ds_read_b64_tr_b16 v[192:193], v229 offset:36864
ds_read_b64_tr_b16 v[194:195], v229 offset:37376
v_mfma_f32_16x16x32_bf16 v[180:183], v[196:199], v[20:23], v[180:183]
v_mfma_f32_16x16x32_bf16 v[184:187], v[196:199], v[24:27], v[184:187]
v_mfma_f32_16x16x32_bf16 v[188:191], v[196:199], v[28:31], v[188:191]
s_waitcnt lgkmcnt(6)
v_mfma_f32_16x16x32_bf16 v[96:99], v[200:203], a[144:147], v[96:99]
s_add_u32 m0, s49, 151552
ds_read_b64_tr_b16 v[196:197], v229 offset:40960
ds_read_b64_tr_b16 v[198:199], v229 offset:41472
v_mfma_f32_16x16x32_bf16 v[100:103], v[200:203], a[148:151], v[100:103]
s_add_u32 s50, s81, 53248
buffer_load_dwordx4 v237, s[28:31], s50 offen sc1 lds
v_mfma_f32_16x16x32_bf16 v[104:107], v[200:203], a[152:155], v[104:107]
v_mfma_f32_16x16x32_bf16 v[108:111], v[200:203], a[156:159], v[108:111]
s_waitcnt lgkmcnt(6)
v_mfma_f32_16x16x32_bf16 v[112:115], v[204:207], a[144:147], v[112:115]
s_add_u32 m0, s49, 155648
ds_read_b64_tr_b16 v[200:201], v229 offset:45056
ds_read_b64_tr_b16 v[202:203], v229 offset:45568
v_mfma_f32_16x16x32_bf16 v[116:119], v[204:207], a[148:151], v[116:119]
s_add_u32 s50, s81, 57344
buffer_load_dwordx4 v237, s[28:31], s50 offen sc1 lds
v_mfma_f32_16x16x32_bf16 v[120:123], v[204:207], a[152:155], v[120:123]
v_mfma_f32_16x16x32_bf16 v[124:127], v[204:207], a[156:159], v[124:127]
s_waitcnt lgkmcnt(6)
v_mfma_f32_16x16x32_bf16 v[96:99], v[208:211], a[160:163], v[96:99]
s_add_u32 m0, s49, 159744
ds_read_b64_tr_b16 v[204:205], v229 offset:49152
ds_read_b64_tr_b16 v[206:207], v229 offset:49664
v_mfma_f32_16x16x32_bf16 v[100:103], v[208:211], a[164:167], v[100:103]
s_add_u32 s50, s81, 61440
buffer_load_dwordx4 v237, s[28:31], s50 offen sc1 lds
v_mul_f32 v160, s96, v160
v_mfma_f32_16x16x32_bf16 v[104:107], v[208:211], a[168:171], v[104:107]
v_mul_f32 v161, s96, v161
v_mul_f32 v162, s96, v162
v_mfma_f32_16x16x32_bf16 v[108:111], v[208:211], a[172:175], v[108:111]
s_waitcnt lgkmcnt(6)
v_mul_f32 v163, s96, v163
v_mfma_f32_16x16x32_bf16 v[112:115], v[192:195], a[160:163], v[112:115]
s_add_u32 s52, s79, 4096
ds_read_b64_tr_b16 v[208:209], v229 offset:53248
ds_read_b64_tr_b16 v[210:211], v229 offset:53760
v_mfma_f32_16x16x32_bf16 v[116:119], v[192:195], a[164:167], v[116:119]
v_exp_f32 v160, v160
v_mfma_f32_16x16x32_bf16 v[120:123], v[192:195], a[168:171], v[120:123]
v_exp_f32 v161, v161
v_mfma_f32_16x16x32_bf16 v[124:127], v[192:195], a[172:175], v[124:127]
s_waitcnt lgkmcnt(6)
buffer_load_dwordx4 a[96:99], v237, s[28:31], s52 offen offset:0 sc1
v_mfma_f32_16x16x32_bf16 v[96:99], v[196:199], a[176:179], v[96:99]
ds_read_b64_tr_b16 v[192:193], v229 offset:57344
ds_read_b64_tr_b16 v[194:195], v229 offset:57856
v_mfma_f32_16x16x32_bf16 v[100:103], v[196:199], a[180:183], v[100:103]
v_exp_f32 v162, v162
v_mfma_f32_16x16x32_bf16 v[104:107], v[196:199], a[184:187], v[104:107]
buffer_load_dwordx4 a[100:103], v237, s[28:31], s52 offen offset:1024 sc1
v_mfma_f32_16x16x32_bf16 v[108:111], v[196:199], a[188:191], v[108:111]
s_waitcnt lgkmcnt(6)
v_mfma_f32_16x16x32_bf16 v[112:115], v[200:203], a[176:179], v[112:115]
ds_read_b64_tr_b16 v[196:197], v229 offset:61440
ds_read_b64_tr_b16 v[198:199], v229 offset:61952
v_mfma_f32_16x16x32_bf16 v[116:119], v[200:203], a[180:183], v[116:119]
v_add_u32 v229, 65536, v229
v_mfma_f32_16x16x32_bf16 v[120:123], v[200:203], a[184:187], v[120:123]
v_exp_f32 v163, v163
v_mfma_f32_16x16x32_bf16 v[124:127], v[200:203], a[188:191], v[124:127]
s_waitcnt lgkmcnt(6)
v_add_f32 v160, 1.0, v160
v_mfma_f32_16x16x32_bf16 v[96:99], v[204:207], a[192:195], v[96:99]
ds_read_b64_tr_b16 v[200:201], v229 offset:0
ds_read_b64_tr_b16 v[202:203], v229 offset:512
v_mfma_f32_16x16x32_bf16 v[100:103], v[204:207], a[196:199], v[100:103]
buffer_load_dwordx4 a[104:107], v237, s[28:31], s52 offen offset:2048 sc1
v_add_f32 v161, 1.0, v161
v_mfma_f32_16x16x32_bf16 v[104:107], v[204:207], a[200:203], v[104:107]
v_add_f32 v162, 1.0, v162
v_add_f32 v163, 1.0, v163
v_mfma_f32_16x16x32_bf16 v[108:111], v[204:207], a[204:207], v[108:111]
s_waitcnt lgkmcnt(6)
v_mul_f32 v164, s96, v164
v_mul_f32 v165, s96, v165
v_mfma_f32_16x16x32_bf16 v[112:115], v[208:211], a[192:195], v[112:115]
ds_read_b64_tr_b16 v[204:205], v229 offset:4096
ds_read_b64_tr_b16 v[206:207], v229 offset:4608
v_mfma_f32_16x16x32_bf16 v[116:119], v[208:211], a[196:199], v[116:119]
buffer_load_dwordx4 a[108:111], v237, s[28:31], s52 offen offset:3072 sc1
v_mul_f32 v166, s96, v166
v_mfma_f32_16x16x32_bf16 v[120:123], v[208:211], a[200:203], v[120:123]
v_rcp_f32 v160, v160
v_mfma_f32_16x16x32_bf16 v[124:127], v[208:211], a[204:207], v[124:127]
s_waitcnt lgkmcnt(6)
v_rcp_f32 v161, v161
v_mfma_f32_16x16x32_bf16 v[96:99], v[192:195], a[208:211], v[96:99]
s_add_u32 s52, s79, 12288
ds_read_b64_tr_b16 v[208:209], v229 offset:8192
ds_read_b64_tr_b16 v[210:211], v229 offset:8704
v_mfma_f32_16x16x32_bf16 v[100:103], v[192:195], a[212:215], v[100:103]
buffer_load_dwordx4 a[112:115], v237, s[28:31], s52 offen offset:0 sc1
v_mul_f32 v167, s96, v167
v_mfma_f32_16x16x32_bf16 v[104:107], v[192:195], a[216:219], v[104:107]
v_exp_f32 v164, v164
v_mfma_f32_16x16x32_bf16 v[108:111], v[192:195], a[220:223], v[108:111]
s_waitcnt lgkmcnt(6)
v_exp_f32 v165, v165
v_mfma_f32_16x16x32_bf16 v[112:115], v[196:199], a[208:211], v[112:115]
ds_read_b64_tr_b16 v[192:193], v229 offset:12288
ds_read_b64_tr_b16 v[194:195], v229 offset:12800
v_mfma_f32_16x16x32_bf16 v[116:119], v[196:199], a[212:215], v[116:119]
v_rcp_f32 v162, v162
v_mfma_f32_16x16x32_bf16 v[120:123], v[196:199], a[216:219], v[120:123]
v_rcp_f32 v163, v163
v_mfma_f32_16x16x32_bf16 v[124:127], v[196:199], a[220:223], v[124:127]
s_waitcnt lgkmcnt(6)
buffer_load_dwordx4 a[116:119], v237, s[28:31], s52 offen offset:1024 sc1
v_mul_f32 v176, v160, v176
v_mfma_f32_16x16x32_bf16 v[96:99], v[200:203], a[224:227], v[96:99]
ds_read_b64_tr_b16 v[196:197], v229 offset:16384
ds_read_b64_tr_b16 v[198:199], v229 offset:16896
v_mfma_f32_16x16x32_bf16 v[100:103], v[200:203], a[228:231], v[100:103]
buffer_load_dwordx4 a[120:123], v237, s[28:31], s52 offen offset:2048 sc1
v_mul_f32 v177, v161, v177
v_mfma_f32_16x16x32_bf16 v[104:107], v[200:203], a[232:235], v[104:107]
v_exp_f32 v166, v166
v_mfma_f32_16x16x32_bf16 v[108:111], v[200:203], a[236:239], v[108:111]
s_waitcnt lgkmcnt(6)
v_exp_f32 v167, v167
v_mfma_f32_16x16x32_bf16 v[112:115], v[204:207], a[224:227], v[112:115]
s_waitcnt vmcnt(12)
ds_read_b64_tr_b16 v[200:201], v229 offset:20480
ds_read_b64_tr_b16 v[202:203], v229 offset:20992
v_mfma_f32_16x16x32_bf16 v[116:119], v[204:207], a[228:231], v[116:119]
v_cmp_gt_u32 vcc, 1, v246
v_add_f32 v164, 1.0, v164
v_mfma_f32_16x16x32_bf16 v[120:123], v[204:207], a[232:235], v[120:123]
s_cbranch_vccnz spin_12_v0
ok_11_v0:
v_mfma_f32_16x16x32_bf16 v[124:127], v[204:207], a[236:239], v[124:127]
s_waitcnt lgkmcnt(6)
v_mul_f32 v178, v162, v178
v_mul_f32 v179, v163, v179
v_mfma_f32_16x16x32_bf16 v[96:99], v[208:211], a[240:243], v[96:99]
ds_read_b64_tr_b16 v[204:205], v229 offset:24576
ds_read_b64_tr_b16 v[206:207], v229 offset:25088
v_mfma_f32_16x16x32_bf16 v[100:103], v[208:211], a[244:247], v[100:103]
buffer_load_dwordx4 a[124:127], v237, s[28:31], s52 offen offset:3072 sc1
v_cvt_pk_bf16_f32 v212, v176, v177
v_mfma_f32_16x16x32_bf16 v[104:107], v[208:211], a[248:251], v[104:107]
v_add_f32 v165, 1.0, v165
v_add_f32 v166, 1.0, v166
v_mfma_f32_16x16x32_bf16 v[108:111], v[208:211], a[252:255], v[108:111]
s_waitcnt lgkmcnt(6)
v_add_f32 v167, 1.0, v167
v_cvt_pk_bf16_f32 v213, v178, v179
v_mfma_f32_16x16x32_bf16 v[112:115], v[192:195], a[240:243], v[112:115]
s_add_u32 m0, s49, 0
ds_read_b64_tr_b16 v[208:209], v229 offset:28672
ds_read_b64_tr_b16 v[210:211], v229 offset:29184
v_mfma_f32_16x16x32_bf16 v[116:119], v[192:195], a[244:247], v[116:119]
s_add_u32 s50, s84, 0
buffer_load_dwordx4 v236, s[28:31], s50 offen sc1 lds
v_mul_f32 v168, s96, v168
v_mfma_f32_16x16x32_bf16 v[120:123], v[192:195], a[248:251], v[120:123]
v_mul_f32 v169, s96, v169
v_mul_f32 v170, s96, v170
v_mfma_f32_16x16x32_bf16 v[124:127], v[192:195], a[252:255], v[124:127]
s_waitcnt lgkmcnt(6)
v_rcp_f32 v164, v164
v_mfma_f32_16x16x32_bf16 v[96:99], v[196:199], v[0:3], v[96:99]
ds_read_b64_tr_b16 v[192:193], v230 offset:24576
ds_read_b64_tr_b16 v[194:195], v230 offset:25088
v_mfma_f32_16x16x32_bf16 v[100:103], v[196:199], v[4:7], v[100:103]
v_rcp_f32 v165, v165
v_mfma_f32_16x16x32_bf16 v[104:107], v[196:199], v[8:11], v[104:107]
v_rcp_f32 v166, v166
v_mfma_f32_16x16x32_bf16 v[108:111], v[196:199], v[12:15], v[108:111]
s_waitcnt lgkmcnt(6)
v_rcp_f32 v167, v167
v_mfma_f32_16x16x32_bf16 v[112:115], v[200:203], v[0:3], v[112:115]
s_add_u32 m0, s49, 4096
ds_read_b64_tr_b16 v[196:197], v230 offset:28672
ds_read_b64_tr_b16 v[198:199], v230 offset:29184
v_mfma_f32_16x16x32_bf16 v[116:119], v[200:203], v[4:7], v[116:119]
s_add_u32 s50, s84, 0
buffer_load_dwordx4 v238, s[28:31], s50 offen sc1 lds
v_mul_f32 v171, s96, v171
v_mfma_f32_16x16x32_bf16 v[120:123], v[200:203], v[8:11], v[120:123]
v_exp_f32 v168, v168
v_mfma_f32_16x16x32_bf16 v[124:127], v[200:203], v[12:15], v[124:127]
s_waitcnt lgkmcnt(6)
v_exp_f32 v169, v169
v_mfma_f32_16x16x32_bf16 v[96:99], v[204:207], v[16:19], v[96:99]
ds_read_b64_tr_b16 v[200:201], v230 offset:32768
ds_read_b64_tr_b16 v[202:203], v230 offset:33280
v_mfma_f32_16x16x32_bf16 v[100:103], v[204:207], v[20:23], v[100:103]
v_mul_f32 v180, v164, v180
v_mul_f32 v181, v165, v181
v_mfma_f32_16x16x32_bf16 v[104:107], v[204:207], v[24:27], v[104:107]
v_exp_f32 v170, v170
v_mfma_f32_16x16x32_bf16 v[108:111], v[204:207], v[28:31], v[108:111]
s_waitcnt lgkmcnt(6)
v_exp_f32 v171, v171
v_mfma_f32_16x16x32_bf16 v[112:115], v[208:211], v[16:19], v[112:115]
s_add_u32 m0, s49, 8192
ds_read_b64_tr_b16 v[204:205], v230 offset:36864
ds_read_b64_tr_b16 v[206:207], v230 offset:37376
v_mfma_f32_16x16x32_bf16 v[116:119], v[208:211], v[20:23], v[116:119]
s_add_u32 s50, s84, 0
buffer_load_dwordx4 v243, s[28:31], s50 offen sc1 lds
v_mul_f32 v182, v166, v182
v_mfma_f32_16x16x32_bf16 v[120:123], v[208:211], v[24:27], v[120:123]
v_mul_f32 v183, v167, v183
v_cvt_pk_bf16_f32 v216, v180, v181
v_mfma_f32_16x16x32_bf16 v[124:127], v[208:211], v[28:31], v[124:127]
s_waitcnt lgkmcnt(6)
v_add_f32 v168, 1.0, v168
v_add_f32 v169, 1.0, v169
v_mfma_f32_16x16x32_bf16 v[128:131], v[192:195], a[144:147], v[128:131]
ds_read_b64_tr_b16 v[208:209], v230 offset:40960
ds_read_b64_tr_b16 v[210:211], v230 offset:41472
v_mfma_f32_16x16x32_bf16 v[132:135], v[192:195], a[148:151], v[132:135]
v_add_f32 v170, 1.0, v170
v_cvt_pk_bf16_f32 v217, v182, v183
v_mfma_f32_16x16x32_bf16 v[136:139], v[192:195], a[152:155], v[136:139]
v_mul_f32 v172, s96, v172
v_mul_f32 v173, s96, v173
v_mfma_f32_16x16x32_bf16 v[140:143], v[192:195], a[156:159], v[140:143]
s_waitcnt lgkmcnt(6)
v_add_f32 v171, 1.0, v171
v_mul_f32 v174, s96, v174
v_mfma_f32_16x16x32_bf16 v[144:147], v[196:199], a[144:147], v[144:147]
s_add_u32 m0, s49, 12288
ds_read_b64_tr_b16 v[192:193], v230 offset:45056
ds_read_b64_tr_b16 v[194:195], v230 offset:45568
v_mfma_f32_16x16x32_bf16 v[148:151], v[196:199], a[148:151], v[148:151]
s_add_u32 s50, s84, 0
buffer_load_dwordx4 v247, s[28:31], s50 offen sc1 lds
v_mul_f32 v175, s96, v175
v_mfma_f32_16x16x32_bf16 v[152:155], v[196:199], a[152:155], v[152:155]
v_rcp_f32 v168, v168
v_mfma_f32_16x16x32_bf16 v[156:159], v[196:199], a[156:159], v[156:159]
s_waitcnt lgkmcnt(6)
v_exp_f32 v172, v172
v_mfma_f32_16x16x32_bf16 v[128:131], v[200:203], a[160:163], v[128:131]
ds_read_b64_tr_b16 v[196:197], v230 offset:49152
ds_read_b64_tr_b16 v[198:199], v230 offset:49664
v_mfma_f32_16x16x32_bf16 v[132:135], v[200:203], a[164:167], v[132:135]
v_rcp_f32 v169, v169
v_mfma_f32_16x16x32_bf16 v[136:139], v[200:203], a[168:171], v[136:139]
v_rcp_f32 v170, v170
v_mfma_f32_16x16x32_bf16 v[140:143], v[200:203], a[172:175], v[140:143]
s_waitcnt lgkmcnt(6)
v_exp_f32 v173, v173
v_mfma_f32_16x16x32_bf16 v[144:147], v[204:207], a[160:163], v[144:147]
s_add_u32 m0, s49, 16384
ds_read_b64_tr_b16 v[200:201], v230 offset:53248
ds_read_b64_tr_b16 v[202:203], v230 offset:53760
v_mfma_f32_16x16x32_bf16 v[148:151], v[204:207], a[164:167], v[148:151]
s_add_u32 s50, s84, 4294920064
v_rcp_f32 v171, v171
v_mfma_f32_16x16x32_bf16 v[152:155], v[204:207], a[168:171], v[152:155]
buffer_load_dwordx4 v236, s[28:31], s50 offen sc1 lds
v_mul_f32 v184, v168, v184
v_mfma_f32_16x16x32_bf16 v[156:159], v[204:207], a[172:175], v[156:159]
s_waitcnt lgkmcnt(6)
v_exp_f32 v174, v174
v_mfma_f32_16x16x32_bf16 v[128:131], v[208:211], a[176:179], v[128:131]
ds_read_b64_tr_b16 v[204:205], v230 offset:57344
ds_read_b64_tr_b16 v[206:207], v230 offset:57856
v_mfma_f32_16x16x32_bf16 v[132:135], v[208:211], a[180:183], v[132:135]
v_exp_f32 v175, v175
v_mfma_f32_16x16x32_bf16 v[136:139], v[208:211], a[184:187], v[136:139]
v_mul_f32 v185, v169, v185
v_mul_f32 v186, v170, v186
v_mfma_f32_16x16x32_bf16 v[140:143], v[208:211], a[188:191], v[140:143]
s_waitcnt lgkmcnt(6)
v_add_f32 v172, 1.0, v172
v_add_f32 v173, 1.0, v173
v_mfma_f32_16x16x32_bf16 v[144:147], v[192:195], a[176:179], v[144:147]
s_add_u32 m0, s49, 20480
ds_read_b64_tr_b16 v[208:209], v230 offset:61440
ds_read_b64_tr_b16 v[210:211], v230 offset:61952
v_mfma_f32_16x16x32_bf16 v[148:151], v[192:195], a[180:183], v[148:151]
s_add_u32 s50, s84, 4294920064
v_add_u32 v230, 65536, v230
v_add_f32 v174, 1.0, v174
v_mfma_f32_16x16x32_bf16 v[152:155], v[192:195], a[184:187], v[152:155]
buffer_load_dwordx4 v238, s[28:31], s50 offen sc1 lds
v_mul_f32 v187, v171, v187
v_mfma_f32_16x16x32_bf16 v[156:159], v[192:195], a[188:191], v[156:159]
s_waitcnt lgkmcnt(6)
v_cvt_pk_bf16_f32 v220, v184, v185
v_cvt_pk_bf16_f32 v221, v186, v187
v_mfma_f32_16x16x32_bf16 v[128:131], v[196:199], a[192:195], v[128:131]
ds_read_b64_tr_b16 v[192:193], v230 offset:0
ds_read_b64_tr_b16 v[194:195], v230 offset:512
v_mfma_f32_16x16x32_bf16 v[132:135], v[196:199], a[196:199], v[132:135]
v_add_f32 v175, 1.0, v175
v_mfma_f32_16x16x32_bf16 v[136:139], v[196:199], a[200:203], v[136:139]
v_rcp_f32 v172, v172
v_mfma_f32_16x16x32_bf16 v[140:143], v[196:199], a[204:207], v[140:143]
s_waitcnt lgkmcnt(6)
v_rcp_f32 v173, v173
v_mfma_f32_16x16x32_bf16 v[144:147], v[200:203], a[192:195], v[144:147]
ds_read_b64_tr_b16 v[196:197], v230 offset:4096
ds_read_b64_tr_b16 v[198:199], v230 offset:4608
v_mfma_f32_16x16x32_bf16 v[148:151], v[200:203], a[196:199], v[148:151]
v_rcp_f32 v174, v174
v_mfma_f32_16x16x32_bf16 v[152:155], v[200:203], a[200:203], v[152:155]
v_rcp_f32 v175, v175
v_mfma_f32_16x16x32_bf16 v[156:159], v[200:203], a[204:207], v[156:159]
s_waitcnt lgkmcnt(6)
v_mul_f32 v188, v172, v188
v_mul_f32 v189, v173, v189
v_mfma_f32_16x16x32_bf16 v[128:131], v[204:207], a[208:211], v[128:131]
ds_read_b64_tr_b16 v[200:201], v230 offset:8192
ds_read_b64_tr_b16 v[202:203], v230 offset:8704
v_mfma_f32_16x16x32_bf16 v[132:135], v[204:207], a[212:215], v[132:135]
v_mul_f32 v190, v174, v190
v_mul_f32 v191, v175, v191
v_mfma_f32_16x16x32_bf16 v[136:139], v[204:207], a[216:219], v[136:139]
v_cvt_pk_bf16_f32 v224, v188, v189
v_cvt_pk_bf16_f32 v225, v190, v191
v_mfma_f32_16x16x32_bf16 v[140:143], v[204:207], a[220:223], v[140:143]
s_waitcnt lgkmcnt(6)
v_mul_f32 v96, s96, v96
v_mul_f32 v97, s96, v97
v_mfma_f32_16x16x32_bf16 v[144:147], v[208:211], a[208:211], v[144:147]
ds_read_b64_tr_b16 v[204:205], v230 offset:12288
ds_read_b64_tr_b16 v[206:207], v230 offset:12800
v_mfma_f32_16x16x32_bf16 v[148:151], v[208:211], a[212:215], v[148:151]
v_mul_f32 v98, s96, v98
v_mul_f32 v99, s96, v99
v_mfma_f32_16x16x32_bf16 v[152:155], v[208:211], a[216:219], v[152:155]
v_exp_f32 v96, v96
v_mfma_f32_16x16x32_bf16 v[156:159], v[208:211], a[220:223], v[156:159]
s_waitcnt lgkmcnt(6)
v_exp_f32 v97, v97
v_mfma_f32_16x16x32_bf16 v[128:131], v[192:195], a[224:227], v[128:131]
ds_read_b64_tr_b16 v[208:209], v230 offset:16384
ds_read_b64_tr_b16 v[210:211], v230 offset:16896
v_mfma_f32_16x16x32_bf16 v[132:135], v[192:195], a[228:231], v[132:135]
v_exp_f32 v98, v98
v_mfma_f32_16x16x32_bf16 v[136:139], v[192:195], a[232:235], v[136:139]
v_exp_f32 v99, v99
v_mfma_f32_16x16x32_bf16 v[140:143], v[192:195], a[236:239], v[140:143]
s_waitcnt lgkmcnt(6)
v_add_f32 v96, 1.0, v96
v_add_f32 v97, 1.0, v97
v_mfma_f32_16x16x32_bf16 v[144:147], v[196:199], a[224:227], v[144:147]
ds_read_b64_tr_b16 v[192:193], v230 offset:20480
ds_read_b64_tr_b16 v[194:195], v230 offset:20992
v_mfma_f32_16x16x32_bf16 v[148:151], v[196:199], a[228:231], v[148:151]
v_add_f32 v98, 1.0, v98
v_add_f32 v99, 1.0, v99
v_mfma_f32_16x16x32_bf16 v[152:155], v[196:199], a[232:235], v[152:155]
v_rcp_f32 v96, v96
v_mfma_f32_16x16x32_bf16 v[156:159], v[196:199], a[236:239], v[156:159]
s_waitcnt lgkmcnt(6)
v_mul_f32 v100, s96, v100
v_mul_f32 v101, s96, v101
v_mfma_f32_16x16x32_bf16 v[128:131], v[200:203], a[240:243], v[128:131]
s_add_u32 s52, s79, 32768
ds_read_b64_tr_b16 v[196:197], v230 offset:24576
ds_read_b64_tr_b16 v[198:199], v230 offset:25088
v_mfma_f32_16x16x32_bf16 v[132:135], v[200:203], a[244:247], v[132:135]
buffer_load_dwordx4 v[160:163], v237, s[28:31], s52 offen offset:0 sc1
v_mul_f32 v102, s96, v102
v_mfma_f32_16x16x32_bf16 v[136:139], v[200:203], a[248:251], v[136:139]
v_rcp_f32 v97, v97
v_mfma_f32_16x16x32_bf16 v[140:143], v[200:203], a[252:255], v[140:143]
s_waitcnt lgkmcnt(6)
v_mul_f32 v103, s96, v103
v_mfma_f32_16x16x32_bf16 v[144:147], v[204:207], a[240:243], v[144:147]
ds_read_b64_tr_b16 v[200:201], v230 offset:28672
ds_read_b64_tr_b16 v[202:203], v230 offset:29184
v_mfma_f32_16x16x32_bf16 v[148:151], v[204:207], a[244:247], v[148:151]
v_exp_f32 v100, v100
v_mfma_f32_16x16x32_bf16 v[152:155], v[204:207], a[248:251], v[152:155]
v_exp_f32 v101, v101
v_mfma_f32_16x16x32_bf16 v[156:159], v[204:207], a[252:255], v[156:159]
s_waitcnt lgkmcnt(6)
v_rcp_f32 v98, v98
v_mfma_f32_16x16x32_bf16 v[128:131], v[208:211], v[0:3], v[128:131]
ds_read_b64_tr_b16 v[204:205], v231 offset:24576
ds_read_b64_tr_b16 v[206:207], v231 offset:25088
v_mfma_f32_16x16x32_bf16 v[132:135], v[208:211], v[4:7], v[132:135]
v_rcp_f32 v99, v99
v_mfma_f32_16x16x32_bf16 v[136:139], v[208:211], v[8:11], v[136:139]
buffer_load_dwordx4 v[164:167], v237, s[28:31], s52 offen offset:2048 sc1
v_mul_f32 v112, v96, v112
v_mfma_f32_16x16x32_bf16 v[140:143], v[208:211], v[12:15], v[140:143]
s_waitcnt lgkmcnt(6)
v_exp_f32 v102, v102
v_mfma_f32_16x16x32_bf16 v[144:147], v[192:195], v[0:3], v[144:147]
ds_read_b64_tr_b16 v[208:209], v231 offset:28672
ds_read_b64_tr_b16 v[210:211], v231 offset:29184
v_mfma_f32_16x16x32_bf16 v[148:151], v[192:195], v[4:7], v[148:151]
buffer_load_dwordx4 v[168:171], v237, s[28:31], s52 offen offset:1024 sc1
v_mul_f32 v113, v97, v113
v_mfma_f32_16x16x32_bf16 v[152:155], v[192:195], v[8:11], v[152:155]
v_mul_f32 v114, v98, v114
v_mul_f32 v115, v99, v115
v_mfma_f32_16x16x32_bf16 v[156:159], v[192:195], v[12:15], v[156:159]
s_waitcnt lgkmcnt(6)
v_exp_f32 v103, v103
v_mfma_f32_16x16x32_bf16 v[128:131], v[196:199], v[16:19], v[128:131]
s_add_u32 s51, s55, 40960
ds_read_b64_tr_b16 v[192:193], v231 offset:32768
ds_read_b64_tr_b16 v[194:195], v231 offset:33280
v_mfma_f32_16x16x32_bf16 v[132:135], v[196:199], v[20:23], v[132:135]
v_add_f32 v100, 1.0, v100
v_add_f32 v101, 1.0, v101
v_mfma_f32_16x16x32_bf16 v[136:139], v[196:199], v[24:27], v[136:139]
v_cvt_pk_bf16_f32 v214, v112, v113
v_cvt_pk_bf16_f32 v215, v114, v115
v_mfma_f32_16x16x32_bf16 v[140:143], v[196:199], v[28:31], v[140:143]
s_waitcnt lgkmcnt(6)
buffer_store_dwordx4 v[212:215], v237, s[28:31], s51 offen offset:0 sc1
v_add_f32 v102, 1.0, v102
v_mfma_f32_16x16x32_bf16 v[144:147], v[200:203], v[16:19], v[144:147]
ds_read_b64_tr_b16 v[196:197], v231 offset:36864
ds_read_b64_tr_b16 v[198:199], v231 offset:37376
v_mfma_f32_16x16x32_bf16 v[148:151], v[200:203], v[20:23], v[148:151]
v_add_f32 v103, 1.0, v103
v_mul_f32 v104, s96, v104
v_mfma_f32_16x16x32_bf16 v[152:155], v[200:203], v[24:27], v[152:155]
v_rcp_f32 v100, v100
v_mfma_f32_16x16x32_bf16 v[156:159], v[200:203], v[28:31], v[156:159]
s_waitcnt lgkmcnt(6)
v_mul_f32 v105, s96, v105
v_mul_f32 v106, s96, v106
v_mfma_f32_16x16x32_bf16 v[32:35], v[204:207], a[144:147], v[32:35]
ds_read_b64_tr_b16 v[200:201], v231 offset:40960
ds_read_b64_tr_b16 v[202:203], v231 offset:41472
v_mfma_f32_16x16x32_bf16 v[36:39], v[204:207], a[148:151], v[36:39]
buffer_load_dwordx4 v[172:175], v237, s[28:31], s52 offen offset:3072 sc1
v_mul_f32 v107, s96, v107
v_mfma_f32_16x16x32_bf16 v[40:43], v[204:207], a[152:155], v[40:43]
v_rcp_f32 v101, v101
v_mfma_f32_16x16x32_bf16 v[44:47], v[204:207], a[156:159], v[44:47]
s_waitcnt lgkmcnt(6)
v_exp_f32 v104, v104
v_mfma_f32_16x16x32_bf16 v[48:51], v[208:211], a[144:147], v[48:51]
s_add_u32 s52, s79, 36864
ds_read_b64_tr_b16 v[204:205], v231 offset:45056
ds_read_b64_tr_b16 v[206:207], v231 offset:45568
v_mfma_f32_16x16x32_bf16 v[52:55], v[208:211], a[148:151], v[52:55]
v_rcp_f32 v102, v102
v_mfma_f32_16x16x32_bf16 v[56:59], v[208:211], a[152:155], v[56:59]
TCH_7_v0:
s_cbranch_execz TCH_11_v0
v_rcp_f32 v103, v103
v_mfma_f32_16x16x32_bf16 v[60:63], v[208:211], a[156:159], v[60:63]
s_waitcnt lgkmcnt(6)
buffer_load_dwordx4 v[176:179], v237, s[28:31], s52 offen offset:0 sc1
v_mul_f32 v116, v100, v116
v_mfma_f32_16x16x32_bf16 v[32:35], v[192:195], a[160:163], v[32:35]
ds_read_b64_tr_b16 v[208:209], v231 offset:49152
ds_read_b64_tr_b16 v[210:211], v231 offset:49664
v_mfma_f32_16x16x32_bf16 v[36:39], v[192:195], a[164:167], v[36:39]
v_exp_f32 v105, v105
v_mfma_f32_16x16x32_bf16 v[40:43], v[192:195], a[168:171], v[40:43]
v_exp_f32 v106, v106
v_mfma_f32_16x16x32_bf16 v[44:47], v[192:195], a[172:175], v[44:47]
s_waitcnt lgkmcnt(6)
v_mul_f32 v117, v101, v117
v_mul_f32 v118, v102, v118
v_mfma_f32_16x16x32_bf16 v[48:51], v[196:199], a[160:163], v[48:51]
ds_read_b64_tr_b16 v[192:193], v231 offset:53248
ds_read_b64_tr_b16 v[194:195], v231 offset:53760
v_mfma_f32_16x16x32_bf16 v[52:55], v[196:199], a[164:167], v[52:55]
buffer_load_dwordx4 v[180:183], v237, s[28:31], s52 offen offset:2048 sc1
v_mul_f32 v119, v103, v119
v_mfma_f32_16x16x32_bf16 v[56:59], v[196:199], a[168:171], v[56:59]
s_add_u32 s66, s55, 40960
v_exp_f32 v107, v107
v_mfma_f32_16x16x32_bf16 v[60:63], v[196:199], a[172:175], v[60:63]
s_waitcnt lgkmcnt(6)
v_cvt_pk_bf16_f32 v218, v116, v117
v_cvt_pk_bf16_f32 v219, v118, v119
v_mfma_f32_16x16x32_bf16 v[32:35], v[200:203], a[176:179], v[32:35]
ds_read_b64_tr_b16 v[196:197], v231 offset:57344
ds_read_b64_tr_b16 v[198:199], v231 offset:57856
v_mfma_f32_16x16x32_bf16 v[36:39], v[200:203], a[180:183], v[36:39]
buffer_store_dwordx4 v[216:219], v237, s[28:31], s66 offen offset:1024 sc1
v_add_f32 v104, 1.0, v104
v_mfma_f32_16x16x32_bf16 v[40:43], v[200:203], a[184:187], v[40:43]
v_add_f32 v105, 1.0, v105
v_add_f32 v106, 1.0, v106
v_mfma_f32_16x16x32_bf16 v[44:47], v[200:203], a[188:191], v[44:47]
s_waitcnt lgkmcnt(6)
v_mul_f32 v108, s96, v108
v_mul_f32 v109, s96, v109
v_mfma_f32_16x16x32_bf16 v[48:51], v[204:207], a[176:179], v[48:51]
ds_read_b64_tr_b16 v[200:201], v231 offset:61440
ds_read_b64_tr_b16 v[202:203], v231 offset:61952
v_mfma_f32_16x16x32_bf16 v[52:55], v[204:207], a[180:183], v[52:55]
v_add_u32 v231, 65536, v231
v_add_f32 v107, 1.0, v107
v_mfma_f32_16x16x32_bf16 v[56:59], v[204:207], a[184:187], v[56:59]
buffer_load_dwordx4 v[184:187], v237, s[28:31], s52 offen offset:1024 sc1
v_mul_f32 v110, s96, v110
v_mfma_f32_16x16x32_bf16 v[60:63], v[204:207], a[188:191], v[60:63]
s_waitcnt lgkmcnt(6)
v_rcp_f32 v104, v104
v_mfma_f32_16x16x32_bf16 v[32:35], v[208:211], a[192:195], v[32:35]
ds_read_b64_tr_b16 v[204:205], v231 offset:0
ds_read_b64_tr_b16 v[206:207], v231 offset:512
v_mfma_f32_16x16x32_bf16 v[36:39], v[208:211], a[196:199], v[36:39]
buffer_load_dwordx4 v[188:191], v237, s[28:31], s52 offen offset:3072 sc1
v_mul_f32 v111, s96, v111
v_mfma_f32_16x16x32_bf16 v[40:43], v[208:211], a[200:203], v[40:43]
v_exp_f32 v108, v108
v_mfma_f32_16x16x32_bf16 v[44:47], v[208:211], a[204:207], v[44:47]
s_waitcnt lgkmcnt(6)
v_rcp_f32 v105, v105
v_mfma_f32_16x16x32_bf16 v[48:51], v[192:195], a[192:195], v[48:51]
ds_read_b64_tr_b16 v[208:209], v231 offset:4096
ds_read_b64_tr_b16 v[210:211], v231 offset:4608
v_mfma_f32_16x16x32_bf16 v[52:55], v[192:195], a[196:199], v[52:55]
v_rcp_f32 v106, v106
v_mfma_f32_16x16x32_bf16 v[56:59], v[192:195], a[200:203], v[56:59]
v_exp_f32 v109, v109
v_mfma_f32_16x16x32_bf16 v[60:63], v[192:195], a[204:207], v[60:63]
s_waitcnt lgkmcnt(6)
v_exp_f32 v110, v110
v_mfma_f32_16x16x32_bf16 v[32:35], v[196:199], a[208:211], v[32:35]
ds_read_b64_tr_b16 v[192:193], v231 offset:8192
ds_read_b64_tr_b16 v[194:195], v231 offset:8704
v_mfma_f32_16x16x32_bf16 v[36:39], v[196:199], a[212:215], v[36:39]
v_rcp_f32 v107, v107
v_mfma_f32_16x16x32_bf16 v[40:43], v[196:199], a[216:219], v[40:43]
v_mul_f32 v120, v104, v120
v_mul_f32 v121, v105, v121
v_mfma_f32_16x16x32_bf16 v[44:47], v[196:199], a[220:223], v[44:47]
s_waitcnt lgkmcnt(6)
v_exp_f32 v111, v111
v_mfma_f32_16x16x32_bf16 v[48:51], v[200:203], a[208:211], v[48:51]
s_add_u32 s52, s79, 20480
ds_read_b64_tr_b16 v[196:197], v231 offset:12288
ds_read_b64_tr_b16 v[198:199], v231 offset:12800
v_mfma_f32_16x16x32_bf16 v[52:55], v[200:203], a[212:215], v[52:55]
buffer_load_dwordx4 a[128:131], v237, s[28:31], s52 offen offset:0 sc1
v_mul_f32 v122, v106, v122
v_mfma_f32_16x16x32_bf16 v[56:59], v[200:203], a[216:219], v[56:59]
v_mul_f32 v123, v107, v123
v_add_f32 v108, 1.0, v108
v_mfma_f32_16x16x32_bf16 v[60:63], v[200:203], a[220:223], v[60:63]
s_waitcnt lgkmcnt(6)
v_add_f32 v109, 1.0, v109
v_add_f32 v110, 1.0, v110
v_mfma_f32_16x16x32_bf16 v[32:35], v[204:207], a[224:227], v[32:35]
ds_read_b64_tr_b16 v[200:201], v231 offset:16384
ds_read_b64_tr_b16 v[202:203], v231 offset:16896
v_mfma_f32_16x16x32_bf16 v[36:39], v[204:207], a[228:231], v[36:39]
buffer_load_dwordx4 a[132:135], v237, s[28:31], s52 offen offset:1024 sc1
v_cvt_pk_bf16_f32 v222, v120, v121
v_mfma_f32_16x16x32_bf16 v[40:43], v[204:207], a[232:235], v[40:43]
v_cvt_pk_bf16_f32 v223, v122, v123
v_add_f32 v111, 1.0, v111
v_mfma_f32_16x16x32_bf16 v[44:47], v[204:207], a[236:239], v[44:47]
s_waitcnt lgkmcnt(6)
buffer_store_dwordx4 v[220:223], v237, s[28:31], s51 offen offset:2048 sc1
v_mfma_f32_16x16x32_bf16 v[48:51], v[208:211], a[224:227], v[48:51]
ds_read_b64_tr_b16 v[204:205], v231 offset:20480
ds_read_b64_tr_b16 v[206:207], v231 offset:20992
v_mfma_f32_16x16x32_bf16 v[52:55], v[208:211], a[228:231], v[52:55]
v_rcp_f32 v108, v108
v_mfma_f32_16x16x32_bf16 v[56:59], v[208:211], a[232:235], v[56:59]
v_rcp_f32 v109, v109
v_mfma_f32_16x16x32_bf16 v[60:63], v[208:211], a[236:239], v[60:63]
s_waitcnt lgkmcnt(6)
v_rcp_f32 v110, v110
v_mfma_f32_16x16x32_bf16 v[32:35], v[192:195], a[240:243], v[32:35]
s_add_u32 s11, s97, 32768
ds_read_b64_tr_b16 v[208:209], v231 offset:24576
ds_read_b64_tr_b16 v[210:211], v231 offset:25088
v_mfma_f32_16x16x32_bf16 v[36:39], v[192:195], a[244:247], v[36:39]
v_rcp_f32 v111, v111
v_mfma_f32_16x16x32_bf16 v[40:43], v[192:195], a[248:251], v[40:43]
v_mul_f32 v124, v108, v124
v_mul_f32 v125, v109, v125
v_mfma_f32_16x16x32_bf16 v[44:47], v[192:195], a[252:255], v[44:47]
s_waitcnt lgkmcnt(6)
v_mul_f32 v126, v110, v126
v_mul_f32 v127, v111, v127
v_mfma_f32_16x16x32_bf16 v[48:51], v[196:199], a[240:243], v[48:51]
ds_read_b64_tr_b16 v[192:193], v231 offset:28672
ds_read_b64_tr_b16 v[194:195], v231 offset:29184
v_mfma_f32_16x16x32_bf16 v[52:55], v[196:199], a[244:247], v[52:55]
buffer_load_dwordx4 a[136:139], v237, s[28:31], s52 offen offset:2048 sc1
v_cvt_pk_bf16_f32 v226, v124, v125
v_mfma_f32_16x16x32_bf16 v[56:59], v[196:199], a[248:251], v[56:59]
s_waitcnt vmcnt(40)
s_barrier
v_mfma_f32_16x16x32_bf16 v[60:63], v[196:199], a[252:255], v[60:63]
s_waitcnt lgkmcnt(6)
v_cvt_pk_bf16_f32 v227, v126, v127
v_mul_f32 v128, s96, v128
v_mfma_f32_16x16x32_bf16 v[32:35], v[200:203], v[0:3], v[32:35]
ds_read_b64_tr_b16 v[196:197], v239 offset:0
ds_read_b64_tr_b16 v[198:199], v239 offset:256
v_mfma_f32_16x16x32_bf16 v[36:39], v[200:203], v[4:7], v[36:39]
buffer_store_dwordx4 v[224:227], v237, s[28:31], s66 offen offset:3072 sc1
buffer_load_dwordx4 a[140:143], v237, s[28:31], s52 offen offset:3072 sc1
v_mfma_f32_16x16x32_bf16 v[40:43], v[200:203], v[8:11], v[40:43]
v_mul_f32 v129, s96, v129
v_mul_f32 v130, s96, v130
v_mfma_f32_16x16x32_bf16 v[44:47], v[200:203], v[12:15], v[44:47]
s_waitcnt lgkmcnt(6)
v_mul_f32 v131, s96, v131
v_mfma_f32_16x16x32_bf16 v[48:51], v[204:207], v[0:3], v[48:51]
s_add_u32 s52, s79, 28672
ds_read_b64_tr_b16 v[200:201], v239 offset:1024
ds_read_b64_tr_b16 v[202:203], v239 offset:1280
v_mfma_f32_16x16x32_bf16 v[52:55], v[204:207], v[4:7], v[52:55]
v_exp_f32 v128, v128
v_mfma_f32_16x16x32_bf16 v[56:59], v[204:207], v[8:11], v[56:59]
v_exp_f32 v129, v129
v_mfma_f32_16x16x32_bf16 v[60:63], v[204:207], v[12:15], v[60:63]
s_waitcnt lgkmcnt(6)
v_exp_f32 v130, v130
v_mfma_f32_16x16x32_bf16 v[32:35], v[208:211], v[16:19], v[32:35]
ds_read_b64_tr_b16 v[204:205], v239 offset:2048
ds_read_b64_tr_b16 v[206:207], v239 offset:2304
v_mfma_f32_16x16x32_bf16 v[36:39], v[208:211], v[20:23], v[36:39]
buffer_load_dwordx4 a[144:147], v237, s[28:31], s52 offen offset:0 sc1
v_mul_f32 v132, s96, v132
v_mfma_f32_16x16x32_bf16 v[40:43], v[208:211], v[24:27], v[40:43]
v_exp_f32 v131, v131
v_mfma_f32_16x16x32_bf16 v[44:47], v[208:211], v[28:31], v[44:47]
s_waitcnt lgkmcnt(6)
v_add_f32 v128, 1.0, v128
v_add_f32 v129, 1.0, v129
v_mfma_f32_16x16x32_bf16 v[48:51], v[192:195], v[16:19], v[48:51]
ds_read_b64_tr_b16 v[208:209], v239 offset:3072
ds_read_b64_tr_b16 v[210:211], v239 offset:3328
v_mfma_f32_16x16x32_bf16 v[52:55], v[192:195], v[20:23], v[52:55]
buffer_load_dwordx4 a[148:151], v237, s[28:31], s52 offen offset:1024 sc1
v_add_f32 v130, 1.0, v130
v_mfma_f32_16x16x32_bf16 v[56:59], v[192:195], v[24:27], v[56:59]
v_add_f32 v131, 1.0, v131
v_mul_f32 v133, s96, v133
v_mfma_f32_16x16x32_bf16 v[60:63], v[192:195], v[28:31], v[60:63]
s_waitcnt vmcnt(63) lgkmcnt(6)
v_mul_f32 v134, s96, v134
v_mul_f32 v135, s96, v135
v_mfma_f32_16x16x32_bf16 v[0:3], v[196:199], v[64:67], 0
ds_read_b64_tr_b16 v[192:193], v240 offset:4096
ds_read_b64_tr_b16 v[194:195], v240 offset:4352
v_mfma_f32_16x16x32_bf16 a[192:195], v[196:199], v[68:71], 0
v_rcp_f32 v128, v128
v_mfma_f32_16x16x32_bf16 a[196:199], v[196:199], v[72:75], 0
v_rcp_f32 v129, v129
v_mfma_f32_16x16x32_bf16 a[200:203], v[196:199], v[76:79], 0
s_waitcnt lgkmcnt(6)
v_exp_f32 v132, v132
v_mfma_f32_16x16x32_bf16 v[4:7], v[200:203], v[64:67], 0
ds_read_b64_tr_b16 v[196:197], v239 offset:4608
ds_read_b64_tr_b16 v[198:199], v239 offset:4864
v_mfma_f32_16x16x32_bf16 a[204:207], v[200:203], v[68:71], 0
buffer_load_dwordx4 a[152:155], v237, s[28:31], s52 offen offset:2048 sc1
buffer_load_dwordx4 a[156:159], v237, s[28:31], s52 offen offset:3072 sc1
v_mfma_f32_16x16x32_bf16 a[208:211], v[200:203], v[72:75], 0
v_exp_f32 v133, v133
v_mfma_f32_16x16x32_bf16 a[212:215], v[200:203], v[76:79], 0
s_waitcnt lgkmcnt(6)
v_rcp_f32 v130, v130
v_mfma_f32_16x16x32_bf16 v[8:11], v[204:207], v[64:67], 0
s_add_u32 m0, s49, 24576
ds_read_b64_tr_b16 v[200:201], v239 offset:5632
ds_read_b64_tr_b16 v[202:203], v239 offset:5888
v_mfma_f32_16x16x32_bf16 a[216:219], v[204:207], v[68:71], 0
s_add_u32 s50, s84, 4294920064
v_rcp_f32 v131, v131
v_mfma_f32_16x16x32_bf16 a[220:223], v[204:207], v[72:75], 0
buffer_load_dwordx4 v243, s[28:31], s50 offen sc1 lds
v_mul_f32 v144, v128, v144
v_mfma_f32_16x16x32_bf16 a[224:227], v[204:207], v[76:79], 0
s_waitcnt lgkmcnt(6)
v_exp_f32 v134, v134
v_mfma_f32_16x16x32_bf16 v[12:15], v[208:211], v[64:67], 0
ds_read_b64_tr_b16 v[204:205], v239 offset:6656
ds_read_b64_tr_b16 v[206:207], v239 offset:6912
v_mfma_f32_16x16x32_bf16 a[228:231], v[208:211], v[68:71], 0
v_mul_f32 v145, v129, v145
v_mul_f32 v146, v130, v146
v_mfma_f32_16x16x32_bf16 a[232:235], v[208:211], v[72:75], 0
v_exp_f32 v135, v135
v_mfma_f32_16x16x32_bf16 a[236:239], v[208:211], v[76:79], 0
s_waitcnt lgkmcnt(6)
v_add_f32 v132, 1.0, v132
v_mul_f32 v147, v131, v147
v_mfma_f32_16x16x32_bf16 v[16:19], v[192:195], v[64:67], 0
s_add_u32 m0, s49, 28672
ds_read_b64_tr_b16 v[208:209], v239 offset:7680
ds_read_b64_tr_b16 v[210:211], v239 offset:7936
v_mfma_f32_16x16x32_bf16 a[240:243], v[192:195], v[68:71], 0
s_add_u32 s50, s84, 4294920064
buffer_load_dwordx4 v247, s[28:31], s50 offen sc1 lds
v_cvt_pk_bf16_f32 v212, v144, v145
v_mfma_f32_16x16x32_bf16 a[244:247], v[192:195], v[72:75], 0
v_add_f32 v133, 1.0, v133
v_add_f32 v134, 1.0, v134
v_mfma_f32_16x16x32_bf16 a[248:251], v[192:195], v[76:79], 0
s_waitcnt vmcnt(63) lgkmcnt(6)
v_add_f32 v135, 1.0, v135
v_cvt_pk_bf16_f32 v213, v146, v147
v_mfma_f32_16x16x32_bf16 v[0:3], v[196:199], v[80:83], v[0:3]
s_add_u32 m0, s49, 32768
ds_read_b64_tr_b16 v[192:193], v240 offset:8704
ds_read_b64_tr_b16 v[194:195], v240 offset:8960
v_mfma_f32_16x16x32_bf16 a[192:195], v[196:199], v[84:87], a[192:195]
s_add_u32 s50, s84, 4294921216
buffer_load_dwordx4 v236, s[28:31], s50 offen sc1 lds
v_mul_f32 v136, s96, v136
v_mfma_f32_16x16x32_bf16 a[196:199], v[196:199], v[88:91], a[196:199]
v_mul_f32 v137, s96, v137
v_mul_f32 v138, s96, v138
v_mfma_f32_16x16x32_bf16 a[200:203], v[196:199], v[92:95], a[200:203]
s_waitcnt lgkmcnt(6)
v_rcp_f32 v132, v132
v_mfma_f32_16x16x32_bf16 v[4:7], v[200:203], v[80:83], v[4:7]
ds_read_b64_tr_b16 v[196:197], v239 offset:9216
ds_read_b64_tr_b16 v[198:199], v239 offset:9472
v_mfma_f32_16x16x32_bf16 a[204:207], v[200:203], v[84:87], a[204:207]
v_rcp_f32 v133, v133
v_mfma_f32_16x16x32_bf16 a[208:211], v[200:203], v[88:91], a[208:211]
v_rcp_f32 v134, v134
v_mfma_f32_16x16x32_bf16 a[212:215], v[200:203], v[92:95], a[212:215]
s_waitcnt lgkmcnt(6)
v_rcp_f32 v135, v135
v_mfma_f32_16x16x32_bf16 v[8:11], v[204:207], v[80:83], v[8:11]
s_add_u32 m0, s49, 36864
ds_read_b64_tr_b16 v[200:201], v239 offset:10240
ds_read_b64_tr_b16 v[202:203], v239 offset:10496
v_mfma_f32_16x16x32_bf16 a[216:219], v[204:207], v[84:87], a[216:219]
s_add_u32 s50, s84, 4294921216
buffer_load_dwordx4 v238, s[28:31], s50 offen sc1 lds
v_mul_f32 v139, s96, v139
v_mfma_f32_16x16x32_bf16 a[220:223], v[204:207], v[88:91], a[220:223]
v_exp_f32 v136, v136
v_mfma_f32_16x16x32_bf16 a[224:227], v[204:207], v[92:95], a[224:227]
s_waitcnt lgkmcnt(6)
v_exp_f32 v137, v137
v_mfma_f32_16x16x32_bf16 v[12:15], v[208:211], v[80:83], v[12:15]
ds_read_b64_tr_b16 v[204:205], v239 offset:11264
ds_read_b64_tr_b16 v[206:207], v239 offset:11520
v_mfma_f32_16x16x32_bf16 a[228:231], v[208:211], v[84:87], a[228:231]
v_mul_f32 v148, v132, v148
v_mul_f32 v149, v133, v149
v_mfma_f32_16x16x32_bf16 a[232:235], v[208:211], v[88:91], a[232:235]
v_exp_f32 v138, v138
v_mfma_f32_16x16x32_bf16 a[236:239], v[208:211], v[92:95], a[236:239]
s_waitcnt lgkmcnt(6)
v_exp_f32 v139, v139
v_mfma_f32_16x16x32_bf16 v[16:19], v[192:195], v[80:83], v[16:19]
s_add_u32 m0, s49, 40960
ds_read_b64_tr_b16 v[208:209], v239 offset:12288
ds_read_b64_tr_b16 v[210:211], v239 offset:12544
v_mfma_f32_16x16x32_bf16 a[240:243], v[192:195], v[84:87], a[240:243]
s_add_u32 s50, s84, 4294921216
buffer_load_dwordx4 v243, s[28:31], s50 offen sc1 lds
v_mul_f32 v150, v134, v150
v_mfma_f32_16x16x32_bf16 a[244:247], v[192:195], v[88:91], a[244:247]
v_mul_f32 v151, v135, v151
v_cvt_pk_bf16_f32 v216, v148, v149
v_mfma_f32_16x16x32_bf16 a[248:251], v[192:195], v[92:95], a[248:251]
s_waitcnt vmcnt(63) lgkmcnt(6)
v_add_f32 v136, 1.0, v136
v_add_f32 v137, 1.0, v137
v_mfma_f32_16x16x32_bf16 v[0:3], v[196:199], a[0:3], v[0:3]
s_waitcnt vmcnt(10)
ds_read_b64_tr_b16 v[192:193], v240 offset:13312
ds_read_b64_tr_b16 v[194:195], v240 offset:13568
v_mfma_f32_16x16x32_bf16 a[192:195], v[196:199], a[4:7], a[192:195]
buffer_store_dword v242, off, s[28:31], s11 sc1
v_add_f32 v138, 1.0, v138
v_mfma_f32_16x16x32_bf16 a[196:199], v[196:199], a[8:11], a[196:199]
v_cvt_pk_bf16_f32 v217, v150, v151
v_mul_f32 v140, s96, v140
v_mfma_f32_16x16x32_bf16 a[200:203], v[196:199], a[12:15], a[200:203]
s_waitcnt lgkmcnt(6)
v_mul_f32 v141, s96, v141
v_add_f32 v139, 1.0, v139
v_mfma_f32_16x16x32_bf16 v[4:7], v[200:203], a[0:3], v[4:7]
s_add_u32 m0, s49, 45056
ds_read_b64_tr_b16 v[196:197], v239 offset:13824
ds_read_b64_tr_b16 v[198:199], v239 offset:14080
v_mfma_f32_16x16x32_bf16 a[204:207], v[200:203], a[4:7], a[204:207]
s_add_u32 s50, s84, 4294921216
buffer_load_dwordx4 v247, s[28:31], s50 offen sc1 lds
v_mul_f32 v142, s96, v142
v_mfma_f32_16x16x32_bf16 a[208:211], v[200:203], a[8:11], a[208:211]
v_rcp_f32 v136, v136
v_mfma_f32_16x16x32_bf16 a[212:215], v[200:203], a[12:15], a[212:215]
s_waitcnt lgkmcnt(6)
v_mul_f32 v143, s96, v143
v_lshrrev_b32 v229, 4, v237
v_mfma_f32_16x16x32_bf16 v[8:11], v[204:207], a[0:3], v[8:11]
s_add_u32 s52, s79, 106496
ds_read_b64_tr_b16 v[200:201], v239 offset:14848
ds_read_b64_tr_b16 v[202:203], v239 offset:15104
v_mfma_f32_16x16x32_bf16 a[216:219], v[204:207], a[4:7], a[216:219]
buffer_load_dwordx4 v[64:67], v237, s[28:31], s52 offen offset:0 sc1
v_sub_u32 v229, s76, v229
v_mfma_f32_16x16x32_bf16 a[220:223], v[204:207], a[8:11], a[220:223]
v_exp_f32 v140, v140
v_mfma_f32_16x16x32_bf16 a[224:227], v[204:207], a[12:15], a[224:227]
s_waitcnt lgkmcnt(6)
v_rcp_f32 v137, v137
v_mfma_f32_16x16x32_bf16 v[12:15], v[208:211], a[0:3], v[12:15]
ds_read_b64_tr_b16 v[204:205], v239 offset:15872
ds_read_b64_tr_b16 v[206:207], v239 offset:16128
v_mfma_f32_16x16x32_bf16 a[228:231], v[208:211], a[4:7], a[228:231]
buffer_load_dwordx4 v[68:71], v237, s[28:31], s52 offen offset:2048 sc1
v_add_u32 v229, 3, v229
v_mfma_f32_16x16x32_bf16 a[232:235], v[208:211], a[8:11], a[232:235]
v_rcp_f32 v138, v138
v_mfma_f32_16x16x32_bf16 a[236:239], v[208:211], a[12:15], a[236:239]
s_waitcnt lgkmcnt(6)
v_exp_f32 v141, v141
v_mfma_f32_16x16x32_bf16 v[16:19], v[192:195], a[0:3], v[16:19]
ds_read_b64_tr_b16 v[208:209], v239 offset:16896
ds_read_b64_tr_b16 v[210:211], v239 offset:17152
v_mfma_f32_16x16x32_bf16 a[240:243], v[192:195], a[4:7], a[240:243]
buffer_load_dwordx4 v[72:75], v237, s[28:31], s52 offen offset:1024 sc1
v_and_b32 v229, 3, v229
v_mfma_f32_16x16x32_bf16 a[244:247], v[192:195], a[8:11], a[244:247]
v_rcp_f32 v139, v139
v_mfma_f32_16x16x32_bf16 a[248:251], v[192:195], a[12:15], a[248:251]
s_waitcnt vmcnt(63) lgkmcnt(6)
v_exp_f32 v142, v142
v_mfma_f32_16x16x32_bf16 v[0:3], v[196:199], a[16:19], v[0:3]
ds_read_b64_tr_b16 v[192:193], v240 offset:17920
ds_read_b64_tr_b16 v[194:195], v240 offset:18176
v_mfma_f32_16x16x32_bf16 a[192:195], v[196:199], a[20:23], a[192:195]
buffer_load_dwordx4 v[76:79], v237, s[28:31], s52 offen offset:3072 sc1
v_mul_f32 v152, v136, v152
v_mfma_f32_16x16x32_bf16 a[196:199], v[196:199], a[24:27], a[196:199]
s_waitcnt vmcnt(53)
s_barrier
v_mfma_f32_16x16x32_bf16 a[200:203], v[196:199], a[28:31], a[200:203]
s_waitcnt lgkmcnt(6)
v_exp_f32 v143, v143
v_mfma_f32_16x16x32_bf16 v[4:7], v[200:203], a[16:19], v[4:7]
ds_read_b64_tr_b16 v[196:197], v239 offset:18432
ds_read_b64_tr_b16 v[198:199], v239 offset:18688
v_mfma_f32_16x16x32_bf16 a[204:207], v[200:203], a[20:23], a[204:207]
v_mul_f32 v153, v137, v153
v_mul_f32 v154, v138, v154
v_mfma_f32_16x16x32_bf16 a[208:211], v[200:203], a[24:27], a[208:211]
v_add_f32 v140, 1.0, v140
v_add_f32 v141, 1.0, v141
v_mfma_f32_16x16x32_bf16 a[212:215], v[200:203], a[28:31], a[212:215]
s_waitcnt lgkmcnt(6)
v_add_f32 v142, 1.0, v142
v_mul_f32 v155, v139, v155
v_mfma_f32_16x16x32_bf16 v[8:11], v[204:207], a[16:19], v[8:11]
s_add_u32 s52, s79, 110592
ds_read_b64_tr_b16 v[200:201], v239 offset:19456
ds_read_b64_tr_b16 v[202:203], v239 offset:19712
v_mfma_f32_16x16x32_bf16 a[216:219], v[204:207], a[20:23], a[216:219]
buffer_load_dwordx4 v[80:83], v237, s[28:31], s52 offen offset:0 sc1
v_cvt_pk_bf16_f32 v220, v152, v153
v_mfma_f32_16x16x32_bf16 a[220:223], v[204:207], a[24:27], a[220:223]
v_cvt_pk_bf16_f32 v221, v154, v155
v_add_f32 v143, 1.0, v143
v_mfma_f32_16x16x32_bf16 a[224:227], v[204:207], a[28:31], a[224:227]
s_waitcnt lgkmcnt(6)
v_rcp_f32 v140, v140
v_mfma_f32_16x16x32_bf16 v[12:15], v[208:211], a[16:19], v[12:15]
ds_read_b64_tr_b16 v[204:205], v239 offset:20480
ds_read_b64_tr_b16 v[206:207], v239 offset:20736
v_mfma_f32_16x16x32_bf16 a[228:231], v[208:211], a[20:23], a[228:231]
buffer_load_dwordx4 v[84:87], v237, s[28:31], s52 offen offset:2048 sc1
v_lshl_add_u32 v229, v229, 2, s93
v_mfma_f32_16x16x32_bf16 a[232:235], v[208:211], a[24:27], a[232:235]
v_rcp_f32 v141, v141
v_mfma_f32_16x16x32_bf16 a[236:239], v[208:211], a[28:31], a[236:239]
s_waitcnt lgkmcnt(6)
v_rcp_f32 v142, v142
v_mfma_f32_16x16x32_bf16 v[16:19], v[192:195], a[16:19], v[16:19]
ds_read_b64_tr_b16 v[208:209], v239 offset:21504
ds_read_b64_tr_b16 v[210:211], v239 offset:21760
v_mfma_f32_16x16x32_bf16 a[240:243], v[192:195], a[20:23], a[240:243]
buffer_load_dwordx4 v[88:91], v237, s[28:31], s52 offen offset:1024 sc1
v_lshrrev_b32 v228, 8, v237
v_mfma_f32_16x16x32_bf16 a[244:247], v[192:195], a[24:27], a[244:247]
v_rcp_f32 v143, v143
v_mfma_f32_16x16x32_bf16 a[248:251], v[192:195], a[28:31], a[248:251]
s_waitcnt vmcnt(63) lgkmcnt(6)
v_mul_f32 v156, v140, v156
v_mul_f32 v157, v141, v157
v_mfma_f32_16x16x32_bf16 v[0:3], v[196:199], a[32:35], v[0:3]
ds_read_b64_tr_b16 v[192:193], v240 offset:22528
ds_read_b64_tr_b16 v[194:195], v240 offset:22784
v_mfma_f32_16x16x32_bf16 a[192:195], v[196:199], a[36:39], a[192:195]
buffer_load_dwordx4 v[92:95], v237, s[28:31], s52 offen offset:3072 sc1
v_mul_f32 v158, v142, v158
v_mfma_f32_16x16x32_bf16 a[196:199], v[196:199], a[40:43], a[196:199]
v_mul_f32 v159, v143, v159
v_cvt_pk_bf16_f32 v224, v156, v157
v_mfma_f32_16x16x32_bf16 a[200:203], v[196:199], a[44:47], a[200:203]
s_waitcnt lgkmcnt(6)
v_cvt_pk_bf16_f32 v225, v158, v159
v_mul_f32 v32, s96, v32
v_mfma_f32_16x16x32_bf16 v[4:7], v[200:203], a[32:35], v[4:7]
s_add_u32 m0, s49, 98304
ds_read_b64_tr_b16 v[196:197], v239 offset:23040
ds_read_b64_tr_b16 v[198:199], v239 offset:23296
v_mfma_f32_16x16x32_bf16 a[204:207], v[200:203], a[36:39], a[204:207]
s_add_u32 s50, s81, 65536
buffer_load_dwordx4 v237, s[28:31], s50 offen sc1 lds
v_mul_f32 v33, s96, v33
v_mfma_f32_16x16x32_bf16 a[208:211], v[200:203], a[40:43], a[208:211]
v_mul_f32 v34, s96, v34
v_mul_f32 v35, s96, v35
v_mfma_f32_16x16x32_bf16 a[212:215], v[200:203], a[44:47], a[212:215]
s_waitcnt lgkmcnt(6)
v_exp_f32 v32, v32
v_mfma_f32_16x16x32_bf16 v[8:11], v[204:207], a[32:35], v[8:11]
s_add_u32 m0, s49, 102400
ds_read_b64_tr_b16 v[200:201], v239 offset:24064
ds_read_b64_tr_b16 v[202:203], v239 offset:24320
v_mfma_f32_16x16x32_bf16 a[216:219], v[204:207], a[36:39], a[216:219]
s_add_u32 s50, s81, 69632
buffer_load_dwordx4 v237, s[28:31], s50 offen sc1 lds
v_lshl_add_u32 v228, v228, 7, s90
v_mfma_f32_16x16x32_bf16 a[220:223], v[204:207], a[40:43], a[220:223]
v_exp_f32 v33, v33
v_mfma_f32_16x16x32_bf16 a[224:227], v[204:207], a[44:47], a[224:227]
s_waitcnt lgkmcnt(6)
v_exp_f32 v34, v34
v_mfma_f32_16x16x32_bf16 v[12:15], v[208:211], a[32:35], v[12:15]
s_add_u32 m0, s49, 106496
ds_read_b64_tr_b16 v[204:205], v239 offset:25088
ds_read_b64_tr_b16 v[206:207], v239 offset:25344
v_mfma_f32_16x16x32_bf16 a[228:231], v[208:211], a[36:39], a[228:231]
s_add_u32 s50, s81, 73728
buffer_load_dwordx4 v237, s[28:31], s50 offen sc1 lds
v_bfe_u32 v30, v237, 2, 5
v_mfma_f32_16x16x32_bf16 a[232:235], v[208:211], a[40:43], a[232:235]
v_exp_f32 v35, v35
v_mfma_f32_16x16x32_bf16 a[236:239], v[208:211], a[44:47], a[236:239]
s_waitcnt lgkmcnt(6)
v_add_f32 v32, 1.0, v32
v_add_f32 v33, 1.0, v33
v_mfma_f32_16x16x32_bf16 v[16:19], v[192:195], a[32:35], v[16:19]
s_waitcnt vmcnt(33)
ds_read_b64_tr_b16 v[208:209], v239 offset:26112
ds_read_b64_tr_b16 v[210:211], v239 offset:26368
v_mfma_f32_16x16x32_bf16 a[240:243], v[192:195], a[36:39], a[240:243]
s_add_u32 m0, s49, 110592
v_swap_b32 v162, v164
v_swap_b32 v163, v165
v_mfma_f32_16x16x32_bf16 a[244:247], v[192:195], a[40:43], a[244:247]
s_add_u32 s50, s81, 77824
buffer_load_dwordx4 v237, s[28:31], s50 offen sc1 lds
v_swap_b32 v170, v172
v_mfma_f32_16x16x32_bf16 a[248:251], v[192:195], a[44:47], a[248:251]
s_waitcnt vmcnt(63) lgkmcnt(6)
v_swap_b32 v171, v173
v_add_f32 v34, 1.0, v34
v_mfma_f32_16x16x32_bf16 v[0:3], v[196:199], a[48:51], v[0:3]
s_add_u32 s52, s79, 77824
ds_read_b64_tr_b16 v[192:193], v240 offset:27136
ds_read_b64_tr_b16 v[194:195], v240 offset:27392
v_mfma_f32_16x16x32_bf16 a[192:195], v[196:199], a[52:55], a[192:195]
buffer_load_dwordx4 a[160:163], v237, s[28:31], s52 offen offset:0 sc1
v_add_f32 v35, 1.0, v35
v_mfma_f32_16x16x32_bf16 a[196:199], v[196:199], a[56:59], a[196:199]
v_rcp_f32 v32, v32
v_mfma_f32_16x16x32_bf16 a[200:203], v[196:199], a[60:63], a[200:203]
s_waitcnt lgkmcnt(6)
v_mul_f32 v36, s96, v36
v_mul_f32 v37, s96, v37
v_mfma_f32_16x16x32_bf16 v[4:7], v[200:203], a[48:51], v[4:7]
ds_read_b64_tr_b16 v[196:197], v239 offset:27648
ds_read_b64_tr_b16 v[198:199], v239 offset:27904
v_mfma_f32_16x16x32_bf16 a[204:207], v[200:203], a[52:55], a[204:207]
v_mul_f32 v38, s96, v38
v_mul_f32 v39, s96, v39
v_mfma_f32_16x16x32_bf16 a[208:211], v[200:203], a[56:59], a[208:211]
v_add_u32 v228, v228, v30
v_and_b32 v30, 0xff, v237
v_mfma_f32_16x16x32_bf16 a[212:215], v[200:203], a[60:63], a[212:215]
s_waitcnt lgkmcnt(6)
v_rcp_f32 v33, v33
v_mfma_f32_16x16x32_bf16 v[8:11], v[204:207], a[48:51], v[8:11]
ds_read_b64_tr_b16 v[200:201], v239 offset:28672
ds_read_b64_tr_b16 v[202:203], v239 offset:28928
v_mfma_f32_16x16x32_bf16 a[216:219], v[204:207], a[52:55], a[216:219]
buffer_load_dwordx4 a[164:167], v237, s[28:31], s52 offen offset:1024 sc1
v_lshl_add_u32 v230, s80, 2, v30
v_mfma_f32_16x16x32_bf16 a[220:223], v[204:207], a[56:59], a[220:223]
v_exp_f32 v36, v36
v_mfma_f32_16x16x32_bf16 a[224:227], v[204:207], a[60:63], a[224:227]
s_waitcnt lgkmcnt(6)
v_exp_f32 v37, v37
v_mfma_f32_16x16x32_bf16 v[12:15], v[208:211], a[48:51], v[12:15]
ds_read_b64_tr_b16 v[204:205], v239 offset:29696
ds_read_b64_tr_b16 v[206:207], v239 offset:29952
v_mfma_f32_16x16x32_bf16 a[228:231], v[208:211], a[52:55], a[228:231]
buffer_load_dwordx4 a[168:171], v237, s[28:31], s52 offen offset:2048 sc1
v_lshrrev_b32 v31, 8, v237
v_mfma_f32_16x16x32_bf16 a[232:235], v[208:211], a[56:59], a[232:235]
v_rcp_f32 v34, v34
v_mfma_f32_16x16x32_bf16 a[236:239], v[208:211], a[60:63], a[236:239]
s_waitcnt lgkmcnt(6)
v_rcp_f32 v35, v35
v_mfma_f32_16x16x32_bf16 v[16:19], v[192:195], a[48:51], v[16:19]
s_waitcnt vmcnt(32)
ds_read_b64_tr_b16 v[208:209], v239 offset:30720
ds_read_b64_tr_b16 v[210:211], v239 offset:30976
v_mfma_f32_16x16x32_bf16 a[240:243], v[192:195], a[52:55], a[240:243]
v_swap_b32 v178, v180
v_swap_b32 v179, v181
v_mfma_f32_16x16x32_bf16 a[244:247], v[192:195], a[56:59], a[244:247]
v_swap_b32 v186, v188
v_swap_b32 v187, v189
v_mfma_f32_16x16x32_bf16 a[248:251], v[192:195], a[60:63], a[248:251]
s_waitcnt vmcnt(37) lgkmcnt(6)
v_exp_f32 v38, v38
v_mfma_f32_16x16x32_bf16 v[0:3], v[196:199], v[160:163], v[0:3]
ds_read_b64_tr_b16 v[192:193], v240 offset:31744
ds_read_b64_tr_b16 v[194:195], v240 offset:32000
v_mfma_f32_16x16x32_bf16 a[192:195], v[196:199], v[164:167], a[192:195]
v_mul_f32 v48, v32, v48
v_mul_f32 v49, v33, v49
v_mfma_f32_16x16x32_bf16 a[196:199], v[196:199], v[168:171], a[196:199]
v_mul_f32 v50, v34, v50
v_mul_f32 v51, v35, v51
v_mfma_f32_16x16x32_bf16 a[200:203], v[196:199], v[172:175], a[200:203]
s_waitcnt lgkmcnt(6)
v_exp_f32 v39, v39
v_mfma_f32_16x16x32_bf16 v[4:7], v[200:203], v[160:163], v[4:7]
s_add_u32 s51, s55, 45056
ds_read_b64_tr_b16 v[196:197], v239 offset:32256
ds_read_b64_tr_b16 v[198:199], v239 offset:32512
v_mfma_f32_16x16x32_bf16 a[204:207], v[200:203], v[164:167], a[204:207]
buffer_load_dwordx4 a[172:175], v237, s[28:31], s52 offen offset:3072 sc1
v_add_f32 v36, 1.0, v36
v_mfma_f32_16x16x32_bf16 a[208:211], v[200:203], v[168:171], a[208:211]
v_add_f32 v37, 1.0, v37
v_cvt_pk_bf16_f32 v214, v48, v49
v_mfma_f32_16x16x32_bf16 a[212:215], v[200:203], v[172:175], a[212:215]
s_waitcnt lgkmcnt(6)
v_cvt_pk_bf16_f32 v215, v50, v51
v_add_f32 v38, 1.0, v38
v_mfma_f32_16x16x32_bf16 v[8:11], v[204:207], v[160:163], v[8:11]
s_add_u32 s52, s79, 86016
ds_read_b64_tr_b16 v[200:201], v239 offset:33280
ds_read_b64_tr_b16 v[202:203], v239 offset:33536
v_mfma_f32_16x16x32_bf16 a[216:219], v[204:207], v[164:167], a[216:219]
buffer_store_dwordx4 v[212:215], v237, s[28:31], s51 offen offset:0 sc1
buffer_load_dwordx4 a[176:179], v237, s[28:31], s52 offen offset:0 sc1
v_mfma_f32_16x16x32_bf16 a[220:223], v[204:207], v[168:171], a[220:223]
v_add_f32 v39, 1.0, v39
v_mul_f32 v40, s96, v40
v_mfma_f32_16x16x32_bf16 a[224:227], v[204:207], v[172:175], a[224:227]
s_waitcnt lgkmcnt(6)
v_rcp_f32 v36, v36
v_mfma_f32_16x16x32_bf16 v[12:15], v[208:211], v[160:163], v[12:15]
ds_read_b64_tr_b16 v[204:205], v239 offset:34304
ds_read_b64_tr_b16 v[206:207], v239 offset:34560
v_mfma_f32_16x16x32_bf16 a[228:231], v[208:211], v[164:167], a[228:231]
buffer_load_dwordx4 a[180:183], v237, s[28:31], s52 offen offset:1024 sc1
v_mul_f32 v41, s96, v41
v_mfma_f32_16x16x32_bf16 a[232:235], v[208:211], v[168:171], a[232:235]
v_rcp_f32 v37, v37
v_mfma_f32_16x16x32_bf16 a[236:239], v[208:211], v[172:175], a[236:239]
s_waitcnt lgkmcnt(6)
v_mul_f32 v42, s96, v42
v_mul_f32 v43, s96, v43
v_mfma_f32_16x16x32_bf16 v[16:19], v[192:195], v[160:163], v[16:19]
s_waitcnt vmcnt(15)
ds_read_b64_tr_b16 v[208:209], v239 offset:35328
ds_read_b64_tr_b16 v[210:211], v239 offset:35584
v_mfma_f32_16x16x32_bf16 a[240:243], v[192:195], v[164:167], a[240:243]
TCH_8_v0:
s_cbranch_execz TCH_12_v0
buffer_load_dwordx4 a[184:187], v237, s[28:31], s52 offen offset:2048 sc1
v_swap_b32 v66, v68
v_mfma_f32_16x16x32_bf16 a[244:247], v[192:195], v[168:171], a[244:247]
v_swap_b32 v67, v69
v_swap_b32 v74, v76
v_mfma_f32_16x16x32_bf16 a[248:251], v[192:195], v[172:175], a[248:251]
s_waitcnt vmcnt(37) lgkmcnt(6)
v_swap_b32 v75, v77
v_lshl_add_u32 v231, v31, 28, v30
v_mfma_f32_16x16x32_bf16 v[0:3], v[196:199], v[176:179], v[0:3]
s_lshr_b32 s80, s80, 4
ds_read_b64_tr_b16 v[192:193], v240 offset:36352
ds_read_b64_tr_b16 v[194:195], v240 offset:36608
v_mfma_f32_16x16x32_bf16 a[192:195], v[196:199], v[180:183], a[192:195]
v_exp_f32 v40, v40
v_mfma_f32_16x16x32_bf16 a[196:199], v[196:199], v[184:187], a[196:199]
s_waitcnt vmcnt(20)
s_barrier
v_mfma_f32_16x16x32_bf16 a[200:203], v[196:199], v[188:191], a[200:203]
s_waitcnt lgkmcnt(6)
v_rcp_f32 v38, v38
v_mfma_f32_16x16x32_bf16 v[4:7], v[200:203], v[176:179], v[4:7]
ds_read_b64_tr_b16 v[196:197], v239 offset:36864
ds_read_b64_tr_b16 v[198:199], v239 offset:37120
v_mfma_f32_16x16x32_bf16 a[204:207], v[200:203], v[180:183], a[204:207]
buffer_load_dwordx4 a[188:191], v237, s[28:31], s52 offen offset:3072 sc1
v_mul_u32_u24 v238, 13, v237
v_mfma_f32_16x16x32_bf16 a[208:211], v[200:203], v[184:187], a[208:211]
v_rcp_f32 v39, v39
v_mfma_f32_16x16x32_bf16 a[212:215], v[200:203], v[188:191], a[212:215]
s_waitcnt lgkmcnt(6)
v_exp_f32 v41, v41
v_mfma_f32_16x16x32_bf16 v[8:11], v[204:207], v[176:179], v[8:11]
s_add_u32 s52, s79, 94208
ds_read_b64_tr_b16 v[200:201], v239 offset:37888
ds_read_b64_tr_b16 v[202:203], v239 offset:38144
v_mfma_f32_16x16x32_bf16 a[216:219], v[204:207], v[180:183], a[216:219]
buffer_load_dwordx4 a[0:3], v237, s[28:31], s52 offen offset:0 sc1
v_mul_f32 v52, v36, v52
v_mfma_f32_16x16x32_bf16 a[220:223], v[204:207], v[184:187], a[220:223]
v_exp_f32 v42, v42
v_mfma_f32_16x16x32_bf16 a[224:227], v[204:207], v[188:191], a[224:227]
s_waitcnt lgkmcnt(6)
v_mul_f32 v53, v37, v53
v_mul_f32 v54, v38, v54
v_mfma_f32_16x16x32_bf16 v[12:15], v[208:211], v[176:179], v[12:15]
ds_read_b64_tr_b16 v[204:205], v239 offset:38912
ds_read_b64_tr_b16 v[206:207], v239 offset:39168
v_mfma_f32_16x16x32_bf16 a[228:231], v[208:211], v[180:183], a[228:231]
v_exp_f32 v43, v43
v_mfma_f32_16x16x32_bf16 a[232:235], v[208:211], v[184:187], a[232:235]
v_mul_f32 v55, v39, v55
v_add_f32 v40, 1.0, v40
v_mfma_f32_16x16x32_bf16 a[236:239], v[208:211], v[188:191], a[236:239]
s_waitcnt lgkmcnt(6)
v_add_f32 v41, 1.0, v41
v_add_f32 v42, 1.0, v42
v_mfma_f32_16x16x32_bf16 v[16:19], v[192:195], v[176:179], v[16:19]
s_add_u32 s66, s55, 45056
ds_read_b64_tr_b16 v[208:209], v239 offset:39936
ds_read_b64_tr_b16 v[210:211], v239 offset:40192
v_mfma_f32_16x16x32_bf16 a[240:243], v[192:195], v[180:183], a[240:243]
s_waitcnt vmcnt(14)
v_cvt_pk_bf16_f32 v218, v52, v53
v_cvt_pk_bf16_f32 v219, v54, v55
v_mfma_f32_16x16x32_bf16 a[244:247], v[192:195], v[184:187], a[244:247]
buffer_store_dwordx4 v[216:219], v237, s[28:31], s66 offen offset:1024 sc1
v_mul_f32 v44, s96, v44
v_mfma_f32_16x16x32_bf16 a[248:251], v[192:195], v[188:191], a[248:251]
s_waitcnt vmcnt(19) lgkmcnt(6)
v_mul_f32 v45, s96, v45
v_add_f32 v43, 1.0, v43
v_mfma_f32_16x16x32_bf16 v[0:3], v[196:199], v[64:67], v[0:3]
s_add_u32 s11, s97, 49152
ds_read_b64_tr_b16 v[192:193], v240 offset:40960
ds_read_b64_tr_b16 v[194:195], v240 offset:41216
v_mfma_f32_16x16x32_bf16 a[192:195], v[196:199], v[68:71], a[192:195]
buffer_load_dword v246, v241, s[28:31], s7 offen sc1
v_mul_f32 v46, s96, v46
v_mfma_f32_16x16x32_bf16 a[196:199], v[196:199], v[72:75], a[196:199]
v_rcp_f32 v40, v40
v_mfma_f32_16x16x32_bf16 a[200:203], v[196:199], v[76:79], a[200:203]
s_waitcnt lgkmcnt(6)
v_mul_f32 v47, s96, v47
v_swap_b32 v82, v84
v_mfma_f32_16x16x32_bf16 v[4:7], v[200:203], v[64:67], v[4:7]
ds_read_b64_tr_b16 v[196:197], v239 offset:41472
ds_read_b64_tr_b16 v[198:199], v239 offset:41728
v_mfma_f32_16x16x32_bf16 a[204:207], v[200:203], v[68:71], a[204:207]
buffer_load_dwordx4 a[4:7], v237, s[28:31], s52 offen offset:1024 sc1
v_swap_b32 v83, v85
v_mfma_f32_16x16x32_bf16 a[208:211], v[200:203], v[72:75], a[208:211]
v_exp_f32 v44, v44
v_mfma_f32_16x16x32_bf16 a[212:215], v[200:203], v[76:79], a[212:215]
s_waitcnt lgkmcnt(6)
v_swap_b32 v90, v92
v_swap_b32 v91, v93
v_mfma_f32_16x16x32_bf16 v[8:11], v[204:207], v[64:67], v[8:11]
ds_read_b64_tr_b16 v[200:201], v239 offset:42496
ds_read_b64_tr_b16 v[202:203], v239 offset:42752
v_mfma_f32_16x16x32_bf16 a[216:219], v[204:207], v[68:71], a[216:219]
buffer_load_dwordx4 a[8:11], v237, s[28:31], s52 offen offset:2048 sc1
v_add_u32 v238, s86, v238
v_mfma_f32_16x16x32_bf16 a[220:223], v[204:207], v[72:75], a[220:223]
ds_read_b128 v[96:99], v238 offset:0
ds_read_b128 v[100:103], v238 offset:16
v_mfma_f32_16x16x32_bf16 a[224:227], v[204:207], v[76:79], a[224:227]
s_waitcnt lgkmcnt(8)
ds_read_b64 v[104:105], v238 offset:32
ds_read_b128 v[106:109], v238 offset:19296
v_mfma_f32_16x16x32_bf16 v[12:15], v[208:211], v[64:67], v[12:15]
ds_read_b64_tr_b16 v[204:205], v239 offset:43520
ds_read_b64_tr_b16 v[206:207], v239 offset:43776
v_mfma_f32_16x16x32_bf16 a[228:231], v[208:211], v[68:71], a[228:231]
ds_read_b128 v[110:113], v238 offset:19312
buffer_load_dwordx4 a[12:15], v237, s[28:31], s52 offen offset:3072 sc1
v_mfma_f32_16x16x32_bf16 a[232:235], v[208:211], v[72:75], a[232:235]
v_rcp_f32 v41, v41
v_mfma_f32_16x16x32_bf16 a[236:239], v[208:211], v[76:79], a[236:239]
s_waitcnt lgkmcnt(11)
ds_read_b64 v[114:115], v238 offset:19328
ds_read_b128 v[116:119], v238 offset:18880
v_mfma_f32_16x16x32_bf16 v[16:19], v[192:195], v[64:67], v[16:19]
s_add_u32 m0, s49, 114688
ds_read_b64_tr_b16 v[208:209], v239 offset:44544
ds_read_b64_tr_b16 v[210:211], v239 offset:44800
v_mfma_f32_16x16x32_bf16 a[240:243], v[192:195], v[68:71], a[240:243]
s_add_u32 s50, s81, 81920
v_rcp_f32 v42, v42
v_mfma_f32_16x16x32_bf16 a[244:247], v[192:195], v[72:75], a[244:247]
v_exp_f32 v45, v45
v_mfma_f32_16x16x32_bf16 a[248:251], v[192:195], v[76:79], a[248:251]
s_waitcnt vmcnt(19) lgkmcnt(13)
v_exp_f32 v46, v46
v_mfma_f32_16x16x32_bf16 v[0:3], v[196:199], v[80:83], v[0:3]
ds_read_b64_tr_b16 v[192:193], v240 offset:45568
ds_read_b64_tr_b16 v[194:195], v240 offset:45824
v_mfma_f32_16x16x32_bf16 a[192:195], v[196:199], v[84:87], a[192:195]
buffer_load_dwordx4 v237, s[28:31], s50 offen sc1 lds
v_mfma_f32_16x16x32_bf16 a[196:199], v[196:199], v[88:91], a[196:199]
s_add_u32 m0, s49, 118784
v_rcp_f32 v43, v43
v_mfma_f32_16x16x32_bf16 a[200:203], v[196:199], v[92:95], a[200:203]
s_waitcnt lgkmcnt(13)
v_mul_f32 v56, v40, v56
v_mul_f32 v57, v41, v57
v_mfma_f32_16x16x32_bf16 v[4:7], v[200:203], v[80:83], v[4:7]
s_add_u32 s50, s81, 86016
ds_read_b64_tr_b16 v[196:197], v239 offset:46080
ds_read_b64_tr_b16 v[198:199], v239 offset:46336
v_mfma_f32_16x16x32_bf16 a[204:207], v[200:203], v[84:87], a[204:207]
buffer_load_dwordx4 v237, s[28:31], s50 offen sc1 lds
v_mul_f32 v58, v42, v58
v_mfma_f32_16x16x32_bf16 a[208:211], v[200:203], v[88:91], a[208:211]
s_add_u32 m0, s49, 122880
v_exp_f32 v47, v47
v_mfma_f32_16x16x32_bf16 a[212:215], v[200:203], v[92:95], a[212:215]
s_waitcnt lgkmcnt(9)
ds_read_b128 v[120:123], v238 offset:18896
ds_read_b64 v[124:125], v238 offset:18912
v_mfma_f32_16x16x32_bf16 v[8:11], v[204:207], v[80:83], v[8:11]
s_add_u32 s50, s81, 90112
ds_read_b64_tr_b16 v[200:201], v239 offset:47104
ds_read_b64_tr_b16 v[202:203], v239 offset:47360
v_mfma_f32_16x16x32_bf16 a[216:219], v[204:207], v[84:87], a[216:219]
buffer_load_dwordx4 v237, s[28:31], s50 offen sc1 lds
v_mul_f32 v59, v43, v59
v_mfma_f32_16x16x32_bf16 a[220:223], v[204:207], v[88:91], a[220:223]
s_add_u32 s52, s79, 102400
buffer_load_dwordx4 a[16:19], v237, s[28:31], s52 offen offset:0 sc1
v_add_f32 v44, 1.0, v44
v_mfma_f32_16x16x32_bf16 a[224:227], v[204:207], v[92:95], a[224:227]
s_waitcnt lgkmcnt(8)
ds_read_b128 v[126:129], v238 offset:18464
ds_read_b128 v[130:133], v238 offset:18480
v_mfma_f32_16x16x32_bf16 v[12:15], v[208:211], v[80:83], v[12:15]
ds_read_b64_tr_b16 v[204:205], v239 offset:48128
ds_read_b64_tr_b16 v[206:207], v239 offset:48384
v_mfma_f32_16x16x32_bf16 a[228:231], v[208:211], v[84:87], a[228:231]
ds_read_b64 v[134:135], v238 offset:18496
buffer_load_dwordx4 a[20:23], v237, s[28:31], s52 offen offset:1024 sc1
v_mfma_f32_16x16x32_bf16 a[232:235], v[208:211], v[88:91], a[232:235]
v_add_f32 v45, 1.0, v45
v_add_f32 v46, 1.0, v46
v_mfma_f32_16x16x32_bf16 a[236:239], v[208:211], v[92:95], a[236:239]
s_waitcnt lgkmcnt(11)
ds_read_b128 v[136:139], v238 offset:18048
ds_read_b128 v[140:143], v238 offset:18064
v_cvt_pk_bf16_f32 v222, v56, v57
v_cvt_pk_bf16_f32 v223, v58, v59
buffer_store_dwordx4 v[220:223], v237, s[28:31], s51 offen offset:2048 sc1
v_add_f32 v47, 1.0, v47
v_rcp_f32 v44, v44
v_rcp_f32 v45, v45
v_rcp_f32 v46, v46
v_rcp_f32 v47, v47
v_mul_f32 v60, v44, v60
v_mul_f32 v61, v45, v61
v_mul_f32 v62, v46, v62
v_mul_f32 v63, v47, v63
v_cvt_pk_bf16_f32 v226, v60, v61
v_cvt_pk_bf16_f32 v227, v62, v63
buffer_store_dwordx4 v[224:227], v237, s[28:31], s66 offen offset:3072 sc1
v_mfma_f32_16x16x32_bf16 v[16:19], v[192:195], v[80:83], v[16:19]
ds_read_b64_tr_b16 v[208:209], v239 offset:49152
ds_read_b64_tr_b16 v[210:211], v239 offset:49408
v_mfma_f32_16x16x32_bf16 a[240:243], v[192:195], v[84:87], a[240:243]
buffer_load_dwordx4 a[24:27], v237, s[28:31], s52 offen offset:2048 sc1
v_mfma_f32_16x16x32_bf16 a[244:247], v[192:195], v[88:91], a[244:247]
v_mfma_f32_16x16x32_bf16 a[248:251], v[192:195], v[92:95], a[248:251]
s_waitcnt vmcnt(63) lgkmcnt(13)
v_mfma_f32_16x16x32_bf16 v[0:3], v[196:199], a[64:67], v[0:3]
ds_read_b64_tr_b16 v[192:193], v240 offset:50176
ds_read_b64_tr_b16 v[194:195], v240 offset:50432
v_mfma_f32_16x16x32_bf16 a[192:195], v[196:199], a[68:71], a[192:195]
buffer_load_dwordx4 a[28:31], v237, s[28:31], s52 offen offset:3072 sc1
v_mfma_f32_16x16x32_bf16 a[196:199], v[196:199], a[72:75], a[196:199]
v_mfma_f32_16x16x32_bf16 a[200:203], v[196:199], a[76:79], a[200:203]
s_waitcnt lgkmcnt(11)
ds_read_b64 v[144:145], v238 offset:18080
ds_read_b128 v[146:149], v238 offset:17632
v_mfma_f32_16x16x32_bf16 v[4:7], v[200:203], a[64:67], v[4:7]
ds_read_b64_tr_b16 v[196:197], v239 offset:50688
ds_read_b64_tr_b16 v[198:199], v239 offset:50944
v_mfma_f32_16x16x32_bf16 a[204:207], v[200:203], a[68:71], a[204:207]
v_mfma_f32_16x16x32_bf16 a[208:211], v[200:203], a[72:75], a[208:211]
v_mfma_f32_16x16x32_bf16 a[212:215], v[200:203], a[76:79], a[212:215]
s_waitcnt lgkmcnt(11)
ds_read_b128 v[150:153], v238 offset:17648
ds_read_b64 v[154:155], v238 offset:17664
v_mfma_f32_16x16x32_bf16 v[8:11], v[204:207], a[64:67], v[8:11]
s_add_u32 m0, s49, 126976
ds_read_b64_tr_b16 v[200:201], v239 offset:51712
ds_read_b64_tr_b16 v[202:203], v239 offset:51968
v_mfma_f32_16x16x32_bf16 a[216:219], v[204:207], a[68:71], a[216:219]
s_add_u32 s50, s81, 94208
buffer_load_dwordx4 v237, s[28:31], s50 offen sc1 lds
v_mfma_f32_16x16x32_bf16 a[220:223], v[204:207], a[72:75], a[220:223]
s_add_u32 m0, s49, 131072
v_mfma_f32_16x16x32_bf16 a[224:227], v[204:207], a[76:79], a[224:227]
s_waitcnt lgkmcnt(10)
ds_read_b128 v[156:159], v238 offset:17216
ds_read_b128 v[160:163], v238 offset:17232
v_mfma_f32_16x16x32_bf16 v[12:15], v[208:211], a[64:67], v[12:15]
s_add_u32 s50, s81, 98304
ds_read_b64_tr_b16 v[204:205], v239 offset:52736
ds_read_b64_tr_b16 v[206:207], v239 offset:52992
v_mfma_f32_16x16x32_bf16 a[228:231], v[208:211], a[68:71], a[228:231]
buffer_load_dwordx4 v237, s[28:31], s50 offen sc1 lds
v_mfma_f32_16x16x32_bf16 a[232:235], v[208:211], a[72:75], a[232:235]
s_add_u32 m0, s49, 49152
v_mfma_f32_16x16x32_bf16 a[236:239], v[208:211], a[76:79], a[236:239]
s_waitcnt lgkmcnt(12)
ds_read_b64 v[164:165], v238 offset:17248
v_mfma_f32_16x16x32_bf16 v[16:19], v[192:195], a[64:67], v[16:19]
s_add_u32 s50, s82, 0
ds_read_b64_tr_b16 v[208:209], v239 offset:53760
ds_read_b64_tr_b16 v[210:211], v239 offset:54016
v_mfma_f32_16x16x32_bf16 a[240:243], v[192:195], a[68:71], a[240:243]
buffer_load_dwordx4 v237, s[28:31], s50 offen sc1 lds
s_add_u32 m0, s49, 53248
v_mfma_f32_16x16x32_bf16 a[244:247], v[192:195], a[72:75], a[244:247]
s_add_u32 s50, s82, 4096
buffer_load_dwordx4 v237, s[28:31], s50 offen sc1 lds
s_add_u32 m0, s49, 57344
v_mfma_f32_16x16x32_bf16 a[248:251], v[192:195], a[76:79], a[248:251]
s_waitcnt vmcnt(63) lgkmcnt(11)
ds_read_b128 v[166:169], v238 offset:16800
ds_read_b128 v[170:173], v238 offset:16816
v_mfma_f32_16x16x32_bf16 v[0:3], v[196:199], a[80:83], v[0:3]
s_add_u32 s50, s82, 8192
ds_read_b64_tr_b16 v[192:193], v240 offset:54784
ds_read_b64_tr_b16 v[194:195], v240 offset:55040
v_mfma_f32_16x16x32_bf16 a[192:195], v[196:199], a[84:87], a[192:195]
buffer_load_dwordx4 v237, s[28:31], s50 offen sc1 lds
s_add_u32 m0, s49, 61440
v_mfma_f32_16x16x32_bf16 a[196:199], v[196:199], a[88:91], a[196:199]
s_waitcnt vmcnt(31)
s_barrier
v_mfma_f32_16x16x32_bf16 a[200:203], v[196:199], a[92:95], a[200:203]
s_waitcnt lgkmcnt(11)
ds_read_b64 v[174:175], v238 offset:16832
ds_read_b128 v[176:179], v238 offset:16384
v_mfma_f32_16x16x32_bf16 v[4:7], v[200:203], a[80:83], v[4:7]
s_add_u32 s50, s82, 12288
ds_read_b64_tr_b16 v[196:197], v239 offset:55296
ds_read_b64_tr_b16 v[198:199], v239 offset:55552
v_mfma_f32_16x16x32_bf16 a[204:207], v[200:203], a[84:87], a[204:207]
buffer_load_dwordx4 v237, s[28:31], s50 offen sc1 lds
s_add_u32 m0, s49, 65536
v_mfma_f32_16x16x32_bf16 a[208:211], v[200:203], a[88:91], a[208:211]
s_add_u32 s50, s82, 16384
buffer_load_dwordx4 v237, s[28:31], s50 offen sc1 lds
v_mfma_f32_16x16x32_bf16 a[212:215], v[200:203], a[92:95], a[212:215]
s_waitcnt lgkmcnt(11)
ds_read_b128 v[180:183], v238 offset:16400
ds_read_b64 v[184:185], v238 offset:16416
v_mfma_f32_16x16x32_bf16 v[8:11], v[204:207], a[80:83], v[8:11]
s_waitcnt vmcnt(19)
ds_read_b64_tr_b16 v[200:201], v239 offset:56320
ds_read_b64_tr_b16 v[202:203], v239 offset:56576
v_mfma_f32_16x16x32_bf16 a[216:219], v[204:207], a[84:87], a[216:219]
v_cmp_gt_u32 vcc, 1, v246
v_lshrrev_b32 v186, 4, v237
v_mfma_f32_16x16x32_bf16 a[220:223], v[204:207], a[88:91], a[220:223]
s_cbranch_vccnz spin_14_v0
ok_13_v0:
v_mfma_f32_16x16x32_bf16 a[224:227], v[204:207], a[92:95], a[224:227]
s_waitcnt lgkmcnt(12)
v_mov_b32 v189, 0xf149f2ca
v_mfma_f32_16x16x32_bf16 v[12:15], v[208:211], a[80:83], v[12:15]
s_add_u32 m0, s49, 69632
ds_read_b64_tr_b16 v[204:205], v239 offset:57344
ds_read_b64_tr_b16 v[206:207], v239 offset:57600
v_mfma_f32_16x16x32_bf16 a[228:231], v[208:211], a[84:87], a[228:231]
s_add_u32 s50, s82, 20480
buffer_load_dwordx4 v237, s[28:31], s50 offen sc1 lds
v_mfma_f32_16x16x32_bf16 a[232:235], v[208:211], a[88:91], a[232:235]
s_add_u32 s52, s79, 40960
buffer_load_dwordx4 a[32:35], v237, s[28:31], s52 offen offset:0 sc1
buffer_load_dwordx4 a[36:39], v237, s[28:31], s52 offen offset:1024 sc1
v_mfma_f32_16x16x32_bf16 a[236:239], v[208:211], a[92:95], a[236:239]
s_waitcnt lgkmcnt(10)
v_dot2_f32_bf16 v32, v96, v106, 0
v_dot2_f32_bf16 v33, v96, v116, 0
v_dot2_f32_bf16 v34, v96, v126, 0
v_dot2_f32_bf16 v35, v96, v136, 0
v_dot2c_f32_bf16 v32, v97, v107
v_dot2c_f32_bf16 v33, v97, v117
v_dot2c_f32_bf16 v34, v97, v127
v_dot2c_f32_bf16 v35, v97, v137
v_dot2c_f32_bf16 v32, v98, v108
buffer_load_dwordx4 a[40:43], v237, s[28:31], s52 offen offset:2048 sc1
v_dot2c_f32_bf16 v33, v98, v118
v_dot2c_f32_bf16 v34, v98, v128
v_dot2c_f32_bf16 v35, v98, v138
v_dot2c_f32_bf16 v32, v99, v109
v_dot2c_f32_bf16 v33, v99, v119
v_dot2c_f32_bf16 v34, v99, v129
v_dot2c_f32_bf16 v35, v99, v139
v_dot2c_f32_bf16 v32, v100, v110
v_dot2c_f32_bf16 v33, v100, v120
buffer_load_dwordx4 a[44:47], v237, s[28:31], s52 offen offset:3072 sc1
v_dot2c_f32_bf16 v34, v100, v130
v_dot2c_f32_bf16 v35, v100, v140
v_dot2c_f32_bf16 v32, v101, v111
v_dot2c_f32_bf16 v33, v101, v121
v_dot2c_f32_bf16 v34, v101, v131
v_dot2c_f32_bf16 v35, v101, v141
v_dot2c_f32_bf16 v32, v102, v112
v_dot2c_f32_bf16 v33, v102, v122
v_dot2c_f32_bf16 v34, v102, v132
v_dot2c_f32_bf16 v35, v102, v142
v_dot2c_f32_bf16 v32, v103, v113
v_dot2c_f32_bf16 v33, v103, v123
v_dot2c_f32_bf16 v34, v103, v133
v_dot2c_f32_bf16 v35, v103, v143
v_dot2c_f32_bf16 v32, v104, v114
v_dot2c_f32_bf16 v33, v104, v124
v_dot2c_f32_bf16 v34, v104, v134
v_dot2c_f32_bf16 v35, v104, v144
s_nop 1
v_mfma_f32_16x16x32_bf16 v[16:19], v[192:195], a[80:83], v[16:19]
ds_read_b64_tr_b16 v[208:209], v239 offset:58368
ds_read_b64_tr_b16 v[210:211], v239 offset:58624
v_mfma_f32_16x16x32_bf16 a[240:243], v[192:195], a[84:87], a[240:243]
v_mfma_f32_16x16x32_bf16 a[244:247], v[192:195], a[88:91], a[244:247]
v_mfma_f32_16x16x32_bf16 a[248:251], v[192:195], a[92:95], a[248:251]
s_waitcnt vmcnt(63) lgkmcnt(8)
v_mfma_f32_16x16x32_bf16 v[0:3], v[196:199], a[96:99], v[0:3]
ds_read_b64_tr_b16 v[192:193], v240 offset:59392
ds_read_b64_tr_b16 v[194:195], v240 offset:59648
v_mfma_f32_16x16x32_bf16 a[192:195], v[196:199], a[100:103], a[192:195]
v_mfma_f32_16x16x32_bf16 a[196:199], v[196:199], a[104:107], a[196:199]
v_mfma_f32_16x16x32_bf16 a[200:203], v[196:199], a[108:111], a[200:203]
s_waitcnt lgkmcnt(6)
v_dot2_f32_bf16 v36, v96, v146, 0
v_dot2_f32_bf16 v37, v96, v156, 0
v_dot2_f32_bf16 v38, v96, v166, 0
v_dot2_f32_bf16 v39, v96, v176, 0
v_dot2c_f32_bf16 v36, v97, v147
v_dot2c_f32_bf16 v37, v97, v157
v_dot2c_f32_bf16 v38, v97, v167
v_dot2c_f32_bf16 v39, v97, v177
v_dot2c_f32_bf16 v36, v98, v148
s_add_u32 m0, s49, 135168
s_add_u32 s50, s81, 102400
buffer_load_dwordx4 v237, s[28:31], s50 offen sc1 lds
v_dot2c_f32_bf16 v37, v98, v158
v_dot2c_f32_bf16 v38, v98, v168
v_dot2c_f32_bf16 v39, v98, v178
v_dot2c_f32_bf16 v36, v99, v149
v_dot2c_f32_bf16 v37, v99, v159
v_dot2c_f32_bf16 v38, v99, v169
v_dot2c_f32_bf16 v39, v99, v179
v_dot2c_f32_bf16 v36, v100, v150
v_dot2c_f32_bf16 v37, v100, v160
s_add_u32 m0, s49, 139264
s_add_u32 s50, s81, 106496
buffer_load_dwordx4 v237, s[28:31], s50 offen sc1 lds
v_dot2c_f32_bf16 v38, v100, v170
v_dot2c_f32_bf16 v39, v100, v180
v_dot2c_f32_bf16 v36, v101, v151
v_dot2c_f32_bf16 v37, v101, v161
v_dot2c_f32_bf16 v38, v101, v171
v_dot2c_f32_bf16 v39, v101, v181
v_dot2c_f32_bf16 v36, v102, v152
v_dot2c_f32_bf16 v37, v102, v162
v_dot2c_f32_bf16 v38, v102, v172
s_add_u32 s52, s79, 49152
buffer_load_dwordx4 a[48:51], v237, s[28:31], s52 offen offset:0 sc1
v_dot2c_f32_bf16 v39, v102, v182
v_dot2c_f32_bf16 v36, v103, v153
v_dot2c_f32_bf16 v37, v103, v163
v_dot2c_f32_bf16 v38, v103, v173
v_dot2c_f32_bf16 v39, v103, v183
v_dot2c_f32_bf16 v36, v104, v154
v_dot2c_f32_bf16 v37, v104, v164
v_dot2c_f32_bf16 v38, v104, v174
v_dot2c_f32_bf16 v39, v104, v184
s_nop 1
v_mfma_f32_16x16x32_bf16 v[4:7], v[200:203], a[96:99], v[4:7]
s_mul_i32 s4, s78, 2
ds_read_b64_tr_b16 v[196:197], v239 offset:59904
ds_read_b64_tr_b16 v[198:199], v239 offset:60160
v_mfma_f32_16x16x32_bf16 a[204:207], v[200:203], a[100:103], a[204:207]
s_lshl_b64 s[4:5], -1, s4
v_cndmask_b32 v33, v189, v33, s[4:5]
s_mul_i32 s4, s78, 4
v_mfma_f32_16x16x32_bf16 a[208:211], v[200:203], a[104:107], a[208:211]
s_lshl_b64 s[4:5], -1, s4
ds_read_b128 v[106:109], v238 offset:35680
v_cndmask_b32 v34, v189, v34, s[4:5]
v_mfma_f32_16x16x32_bf16 a[212:215], v[200:203], a[108:111], a[212:215]
s_waitcnt lgkmcnt(7)
s_mul_i32 s4, s78, 6
s_lshl_b64 s[4:5], -1, s4
v_mfma_f32_16x16x32_bf16 v[8:11], v[204:207], a[96:99], v[8:11]
s_waitcnt vmcnt(17)
ds_read_b64_tr_b16 v[200:201], v239 offset:60928
ds_read_b64_tr_b16 v[202:203], v239 offset:61184
v_mfma_f32_16x16x32_bf16 a[216:219], v[204:207], a[100:103], a[216:219]
buffer_store_dword v242, off, s[28:31], s11 sc1
v_cndmask_b32 v35, v189, v35, s[4:5]
v_mfma_f32_16x16x32_bf16 a[220:223], v[204:207], a[104:107], a[220:223]
s_mul_i32 s4, s78, 8
ds_read_b128 v[110:113], v238 offset:35696
s_lshl_b64 s[4:5], -1, s4
v_mfma_f32_16x16x32_bf16 a[224:227], v[204:207], a[108:111], a[224:227]
s_waitcnt lgkmcnt(8)
v_cndmask_b32 v36, v189, v36, s[4:5]
s_mul_i32 s4, s78, 10
v_mfma_f32_16x16x32_bf16 v[12:15], v[208:211], a[96:99], v[12:15]
s_lshl_b64 s[4:5], -1, s4
ds_read_b64_tr_b16 v[204:205], v239 offset:61952
ds_read_b64_tr_b16 v[206:207], v239 offset:62208
v_mfma_f32_16x16x32_bf16 a[228:231], v[208:211], a[100:103], a[228:231]
ds_read_b64 v[114:115], v238 offset:35712
v_cndmask_b32 v37, v189, v37, s[4:5]
v_mfma_f32_16x16x32_bf16 a[232:235], v[208:211], a[104:107], a[232:235]
s_mul_i32 s4, s78, 12
s_lshl_b64 s[4:5], -1, s4
v_cndmask_b32 v38, v189, v38, s[4:5]
v_mfma_f32_16x16x32_bf16 a[236:239], v[208:211], a[108:111], a[236:239]
s_waitcnt lgkmcnt(9)
s_mul_i32 s4, s78, 14
ds_read_b128 v[116:119], v238 offset:35264
v_mfma_f32_16x16x32_bf16 v[16:19], v[192:195], a[96:99], v[16:19]
s_lshl_b64 s[4:5], -1, s4
ds_read_b64_tr_b16 v[208:209], v239 offset:62976
ds_read_b64_tr_b16 v[210:211], v239 offset:63232
v_mfma_f32_16x16x32_bf16 a[240:243], v[192:195], a[100:103], a[240:243]
buffer_load_dwordx4 a[52:55], v237, s[28:31], s52 offen offset:1024 sc1
v_cndmask_b32 v39, v189, v39, s[4:5]
v_mfma_f32_16x16x32_bf16 a[244:247], v[192:195], a[104:107], a[244:247]
v_max3_f32 v189, v32, v33, v34
v_max3_f32 v189, v189, v35, v36
v_mfma_f32_16x16x32_bf16 a[248:251], v[192:195], a[108:111], a[248:251]
s_waitcnt vmcnt(63) lgkmcnt(10)
v_max3_f32 v189, v189, v37, v38
v_mfma_f32_16x16x32_bf16 v[0:3], v[196:199], a[112:115], v[0:3]
ds_read_b64_tr_b16 v[192:193], v240 offset:64000
ds_read_b64_tr_b16 v[194:195], v240 offset:64256
v_mfma_f32_16x16x32_bf16 a[192:195], v[196:199], a[116:119], a[192:195]
ds_read_b128 v[120:123], v238 offset:35280
buffer_load_dwordx4 a[56:59], v237, s[28:31], s52 offen offset:2048 sc1
v_mfma_f32_16x16x32_bf16 a[196:199], v[196:199], a[120:123], a[196:199]
v_max_f32 v189, v189, v39
v_sub_f32 v32, v32, v189
v_mfma_f32_16x16x32_bf16 a[200:203], v[196:199], a[124:127], a[200:203]
s_waitcnt lgkmcnt(10)
v_sub_f32 v33, v33, v189
v_sub_f32 v34, v34, v189
v_mfma_f32_16x16x32_bf16 v[4:7], v[200:203], a[112:115], v[4:7]
ds_read_b64_tr_b16 v[196:197], v239 offset:64512
ds_read_b64_tr_b16 v[198:199], v239 offset:64768
v_mfma_f32_16x16x32_bf16 a[204:207], v[200:203], a[116:119], a[204:207]
ds_read_b64 v[124:125], v238 offset:35296
buffer_load_dwordx4 a[60:63], v237, s[28:31], s52 offen offset:3072 sc1
v_mfma_f32_16x16x32_bf16 a[208:211], v[200:203], a[120:123], a[208:211]
v_sub_f32 v35, v35, v189
v_sub_f32 v36, v36, v189
v_mfma_f32_16x16x32_bf16 a[212:215], v[200:203], a[124:127], a[212:215]
s_waitcnt lgkmcnt(10)
v_sub_f32 v37, v37, v189
v_sub_f32 v38, v38, v189
v_mfma_f32_16x16x32_bf16 v[8:11], v[204:207], a[112:115], v[8:11]
s_add_u32 s52, s79, 57344
ds_read_b64_tr_b16 v[200:201], v239 offset:0
ds_read_b64_tr_b16 v[202:203], v239 offset:256
v_mfma_f32_16x16x32_bf16 a[216:219], v[204:207], a[116:119], a[216:219]
buffer_load_dwordx4 a[64:67], v237, s[28:31], s52 offen offset:0 sc1
v_sub_f32 v39, v39, v189
v_mfma_f32_16x16x32_bf16 a[220:223], v[204:207], a[120:123], a[220:223]
ds_read_b128 v[126:129], v238 offset:34848
v_mul_f32 v32, 0x3eae1a93, v32
v_mfma_f32_16x16x32_bf16 a[224:227], v[204:207], a[124:127], a[224:227]
s_waitcnt lgkmcnt(9)
v_mul_f32 v33, 0x3eae1a93, v33
v_mul_f32 v34, 0x3eae1a93, v34
v_mfma_f32_16x16x32_bf16 v[12:15], v[208:211], a[112:115], v[12:15]
ds_read_b64_tr_b16 v[204:205], v239 offset:1024
ds_read_b64_tr_b16 v[206:207], v239 offset:1280
v_mfma_f32_16x16x32_bf16 a[228:231], v[208:211], a[116:119], a[228:231]
buffer_load_dwordx4 a[68:71], v237, s[28:31], s52 offen offset:1024 sc1
v_mul_f32 v35, 0x3eae1a93, v35
v_mfma_f32_16x16x32_bf16 a[232:235], v[208:211], a[120:123], a[232:235]
v_mul_f32 v36, 0x3eae1a93, v36
v_mfma_f32_16x16x32_bf16 a[236:239], v[208:211], a[124:127], a[236:239]
s_waitcnt lgkmcnt(9)
ds_read_b128 v[130:133], v238 offset:34864
v_mul_f32 v37, 0x3eae1a93, v37
v_mfma_f32_16x16x32_bf16 v[16:19], v[192:195], a[112:115], v[16:19]
ds_read_b64_tr_b16 v[208:209], v239 offset:2048
ds_read_b64_tr_b16 v[210:211], v239 offset:2304
v_mfma_f32_16x16x32_bf16 a[240:243], v[192:195], a[116:119], a[240:243]
buffer_load_dwordx4 a[72:75], v237, s[28:31], s52 offen offset:2048 sc1
v_mul_f32 v38, 0x3eae1a93, v38
v_mfma_f32_16x16x32_bf16 a[244:247], v[192:195], a[120:123], a[244:247]
v_mul_f32 v39, 0x3eae1a93, v39
v_mfma_f32_16x16x32_bf16 a[248:251], v[192:195], a[124:127], a[248:251]
s_waitcnt vmcnt(63) lgkmcnt(9)
v_exp_f32 v32, v32
v_mfma_f32_16x16x32_bf16 v[0:3], v[196:199], a[128:131], v[0:3]
ds_read_b64_tr_b16 v[192:193], v240 offset:3072
ds_read_b64_tr_b16 v[194:195], v240 offset:3328
v_mfma_f32_16x16x32_bf16 a[192:195], v[196:199], a[132:135], a[192:195]
ds_read_b64 v[134:135], v238 offset:34880
buffer_load_dwordx4 a[76:79], v237, s[28:31], s52 offen offset:3072 sc1
v_mfma_f32_16x16x32_bf16 a[196:199], v[196:199], a[136:139], a[196:199]
v_exp_f32 v33, v33
v_mfma_f32_16x16x32_bf16 a[200:203], v[196:199], a[140:143], a[200:203]
s_waitcnt lgkmcnt(9)
v_exp_f32 v34, v34
v_mfma_f32_16x16x32_bf16 v[4:7], v[200:203], a[128:131], v[4:7]
s_add_u32 s52, s79, 65536
ds_read_b64_tr_b16 v[196:197], v239 offset:3584
ds_read_b64_tr_b16 v[198:199], v239 offset:3840
v_mfma_f32_16x16x32_bf16 a[204:207], v[200:203], a[132:135], a[204:207]
v_exp_f32 v35, v35
v_mfma_f32_16x16x32_bf16 a[208:211], v[200:203], a[136:139], a[208:211]
v_exp_f32 v36, v36
v_mfma_f32_16x16x32_bf16 a[212:215], v[200:203], a[140:143], a[212:215]
s_waitcnt lgkmcnt(8)
v_exp_f32 v37, v37
v_mfma_f32_16x16x32_bf16 v[8:11], v[204:207], a[128:131], v[8:11]
ds_read_b64_tr_b16 v[200:201], v239 offset:4608
ds_read_b64_tr_b16 v[202:203], v239 offset:4864
v_mfma_f32_16x16x32_bf16 a[216:219], v[204:207], a[132:135], a[216:219]
ds_read_b128 v[136:139], v238 offset:34432
buffer_load_dwordx4 a[80:83], v237, s[28:31], s52 offen offset:0 sc1
v_mfma_f32_16x16x32_bf16 a[220:223], v[204:207], a[136:139], a[220:223]
v_exp_f32 v38, v38
v_mfma_f32_16x16x32_bf16 a[224:227], v[204:207], a[140:143], a[224:227]
s_waitcnt lgkmcnt(8)
v_exp_f32 v39, v39
v_mfma_f32_16x16x32_bf16 v[12:15], v[208:211], a[128:131], v[12:15]
ds_read_b64_tr_b16 v[204:205], v239 offset:5632
ds_read_b64_tr_b16 v[206:207], v239 offset:5888
v_mfma_f32_16x16x32_bf16 a[228:231], v[208:211], a[132:135], a[228:231]
buffer_load_dwordx4 a[84:87], v237, s[28:31], s52 offen offset:1024 sc1
v_add_f32 v189, v32, v33
v_mfma_f32_16x16x32_bf16 a[232:235], v[208:211], a[136:139], a[232:235]
v_add_f32 v189, v189, v34
v_add_f32 v189, v189, v35
v_mfma_f32_16x16x32_bf16 a[236:239], v[208:211], a[140:143], a[236:239]
s_waitcnt lgkmcnt(8)
ds_read_b128 v[140:143], v238 offset:34448
v_add_f32 v189, v189, v36
v_mfma_f32_16x16x32_bf16 v[16:19], v[192:195], a[128:131], v[16:19]
ds_read_b64_tr_b16 v[208:209], v239 offset:6656
ds_read_b64_tr_b16 v[210:211], v239 offset:6912
v_mfma_f32_16x16x32_bf16 a[240:243], v[192:195], a[132:135], a[240:243]
buffer_load_dwordx4 a[88:91], v237, s[28:31], s52 offen offset:2048 sc1
v_add_f32 v189, v189, v37
v_mfma_f32_16x16x32_bf16 a[244:247], v[192:195], a[136:139], a[244:247]
v_add_f32 v189, v189, v38
v_add_f32 v189, v189, v39
v_mfma_f32_16x16x32_bf16 a[248:251], v[192:195], a[140:143], a[248:251]
s_waitcnt vmcnt(63) lgkmcnt(8)
ds_read_b64 v[144:145], v238 offset:34464
v_mfma_f32_16x16x32_bf16 v[0:3], v[196:199], a[144:147], v[0:3]
ds_read_b64_tr_b16 v[192:193], v240 offset:7680
ds_read_b64_tr_b16 v[194:195], v240 offset:7936
v_mfma_f32_16x16x32_bf16 a[192:195], v[196:199], a[148:151], a[192:195]
v_rcp_f32 v189, v189
v_mfma_f32_16x16x32_bf16 a[196:199], v[196:199], a[152:155], a[196:199]
s_waitcnt vmcnt(32)
s_barrier
v_mfma_f32_16x16x32_bf16 a[200:203], v[196:199], a[156:159], a[200:203]
s_waitcnt lgkmcnt(9)
buffer_load_dwordx4 a[92:95], v237, s[28:31], s52 offen offset:3072 sc1
s_mov_b32 s4, 0x05040100
v_mfma_f32_16x16x32_bf16 v[4:7], v[200:203], a[144:147], v[4:7]
s_mov_b32 s5, 0x07060302
ds_read_b64_tr_b16 v[196:197], v239 offset:8192
ds_read_b64_tr_b16 v[198:199], v239 offset:8448
v_mfma_f32_16x16x32_bf16 a[204:207], v[200:203], a[148:151], a[204:207]
TCH_9_v0:
s_cbranch_execz TCH_back
s_add_u32 m0, s49, 143360
v_mul_f32 v32, v189, v32
v_mul_f32 v33, v189, v33
v_mfma_f32_16x16x32_bf16 a[208:211], v[200:203], a[152:155], a[208:211]
s_add_u32 s50, s81, 110592
buffer_load_dwordx4 v237, s[28:31], s50 offen sc1 lds
v_mul_f32 v34, v189, v34
v_mfma_f32_16x16x32_bf16 a[212:215], v[200:203], a[156:159], a[212:215]
s_waitcnt lgkmcnt(8)
v_mul_f32 v35, v189, v35
v_mul_f32 v36, v189, v36
v_mfma_f32_16x16x32_bf16 v[8:11], v[204:207], a[144:147], v[8:11]
s_add_u32 m0, s49, 147456
ds_read_b64_tr_b16 v[200:201], v239 offset:9216
ds_read_b64_tr_b16 v[202:203], v239 offset:9472
v_mfma_f32_16x16x32_bf16 a[216:219], v[204:207], a[148:151], a[216:219]
s_add_u32 s50, s81, 114688
buffer_load_dwordx4 v237, s[28:31], s50 offen sc1 lds
v_mul_f32 v37, v189, v37
v_mfma_f32_16x16x32_bf16 a[220:223], v[204:207], a[152:155], a[220:223]
v_mul_f32 v38, v189, v38
v_mul_f32 v39, v189, v39
v_mfma_f32_16x16x32_bf16 a[224:227], v[204:207], a[156:159], a[224:227]
s_waitcnt lgkmcnt(7)
v_cvt_pk_bf16_f32 v32, v32, v33
v_cvt_pk_bf16_f32 v33, v34, v35
v_mfma_f32_16x16x32_bf16 v[12:15], v[208:211], a[144:147], v[12:15]
s_add_u32 s52, s79, 114688
ds_read_b64_tr_b16 v[204:205], v239 offset:10240
ds_read_b64_tr_b16 v[206:207], v239 offset:10496
v_mfma_f32_16x16x32_bf16 a[228:231], v[208:211], a[148:151], a[228:231]
buffer_load_dwordx4 a[96:99], v237, s[28:31], s52 offen offset:0 sc1
v_cvt_pk_bf16_f32 v34, v36, v37
v_mfma_f32_16x16x32_bf16 a[232:235], v[208:211], a[152:155], a[232:235]
v_cvt_pk_bf16_f32 v35, v38, v39
v_perm_b32 v96, v116, v106, s4
v_mfma_f32_16x16x32_bf16 a[236:239], v[208:211], a[156:159], a[236:239]
s_waitcnt lgkmcnt(6)
v_perm_b32 v106, v116, v106, s5
v_perm_b32 v97, v117, v107, s4
v_mfma_f32_16x16x32_bf16 v[16:19], v[192:195], a[144:147], v[16:19]
ds_read_b64_tr_b16 v[208:209], v239 offset:11264
ds_read_b64_tr_b16 v[210:211], v239 offset:11520
v_mfma_f32_16x16x32_bf16 a[240:243], v[192:195], a[148:151], a[240:243]
buffer_load_dwordx4 a[100:103], v237, s[28:31], s52 offen offset:1024 sc1
ds_read_b128 v[146:149], v238 offset:34016
v_mfma_f32_16x16x32_bf16 a[244:247], v[192:195], a[152:155], a[244:247]
v_perm_b32 v107, v117, v107, s5
v_perm_b32 v98, v118, v108, s4
v_mfma_f32_16x16x32_bf16 a[248:251], v[192:195], a[156:159], a[248:251]
s_waitcnt vmcnt(51) lgkmcnt(7)
v_perm_b32 v108, v118, v108, s5
v_mfma_f32_16x16x32_bf16 v[0:3], v[196:199], a[160:163], v[0:3]
ds_read_b64_tr_b16 v[192:193], v240 offset:12288
ds_read_b64_tr_b16 v[194:195], v240 offset:12544
v_mfma_f32_16x16x32_bf16 a[192:195], v[196:199], a[164:167], a[192:195]
buffer_load_dwordx4 a[104:107], v237, s[28:31], s52 offen offset:2048 sc1
ds_read_b128 v[150:153], v238 offset:34032
v_mfma_f32_16x16x32_bf16 a[196:199], v[196:199], a[168:171], a[196:199]
v_perm_b32 v99, v119, v109, s4
v_perm_b32 v109, v119, v109, s5
v_mfma_f32_16x16x32_bf16 a[200:203], v[196:199], a[172:175], a[200:203]
s_waitcnt lgkmcnt(8)
v_perm_b32 v100, v120, v110, s4
v_mfma_f32_16x16x32_bf16 v[4:7], v[200:203], a[160:163], v[4:7]
ds_read_b64_tr_b16 v[196:197], v239 offset:12800
ds_read_b64_tr_b16 v[198:199], v239 offset:13056
v_mfma_f32_16x16x32_bf16 a[204:207], v[200:203], a[164:167], a[204:207]
buffer_load_dwordx4 a[108:111], v237, s[28:31], s52 offen offset:3072 sc1
ds_read_b64 v[154:155], v238 offset:34048
v_mfma_f32_16x16x32_bf16 a[208:211], v[200:203], a[168:171], a[208:211]
v_perm_b32 v110, v120, v110, s5
v_perm_b32 v101, v121, v111, s4
v_mfma_f32_16x16x32_bf16 a[212:215], v[200:203], a[172:175], a[212:215]
s_waitcnt lgkmcnt(9)
v_perm_b32 v111, v121, v111, s5
v_mfma_f32_16x16x32_bf16 v[8:11], v[204:207], a[160:163], v[8:11]
s_add_u32 m0, s49, 151552
ds_read_b64_tr_b16 v[200:201], v239 offset:13824
ds_read_b64_tr_b16 v[202:203], v239 offset:14080
v_mfma_f32_16x16x32_bf16 a[216:219], v[204:207], a[164:167], a[216:219]
s_add_u32 s50, s81, 118784
buffer_load_dwordx4 v237, s[28:31], s50 offen sc1 lds
ds_read_b128 v[156:159], v238 offset:33600
v_mfma_f32_16x16x32_bf16 a[220:223], v[204:207], a[168:171], a[220:223]
v_perm_b32 v102, v122, v112, s4
v_perm_b32 v112, v122, v112, s5
v_mfma_f32_16x16x32_bf16 a[224:227], v[204:207], a[172:175], a[224:227]
s_waitcnt lgkmcnt(10)
v_perm_b32 v103, v123, v113, s4
v_mfma_f32_16x16x32_bf16 v[12:15], v[208:211], a[160:163], v[12:15]
s_add_u32 m0, s49, 155648
ds_read_b64_tr_b16 v[204:205], v239 offset:14848
ds_read_b64_tr_b16 v[206:207], v239 offset:15104
v_mfma_f32_16x16x32_bf16 a[228:231], v[208:211], a[164:167], a[228:231]
s_add_u32 s50, s81, 122880
buffer_load_dwordx4 v237, s[28:31], s50 offen sc1 lds
ds_read_b128 v[160:163], v238 offset:33616
v_mfma_f32_16x16x32_bf16 a[232:235], v[208:211], a[168:171], a[232:235]
v_perm_b32 v113, v123, v113, s5
v_perm_b32 v104, v124, v114, s4
v_mfma_f32_16x16x32_bf16 a[236:239], v[208:211], a[172:175], a[236:239]
s_waitcnt lgkmcnt(10)
v_perm_b32 v114, v124, v114, s5
v_mfma_f32_16x16x32_bf16 v[16:19], v[192:195], a[160:163], v[16:19]
s_add_u32 m0, s49, 159744
ds_read_b64_tr_b16 v[208:209], v239 offset:15872
ds_read_b64_tr_b16 v[210:211], v239 offset:16128
v_mfma_f32_16x16x32_bf16 a[240:243], v[192:195], a[164:167], a[240:243]
s_add_u32 s50, s81, 126976
buffer_load_dwordx4 v237, s[28:31], s50 offen sc1 lds
ds_read_b64 v[164:165], v238 offset:33632
v_mfma_f32_16x16x32_bf16 a[244:247], v[192:195], a[168:171], a[244:247]
s_add_u32 s52, s79, 122880
buffer_load_dwordx4 a[112:115], v237, s[28:31], s52 offen offset:0 sc1
v_mfma_f32_16x16x32_bf16 a[248:251], v[192:195], a[172:175], a[248:251]
s_waitcnt vmcnt(52) lgkmcnt(10)
v_dot2_f32_bf16 v40, v96, v32, 0
v_dot2_f32_bf16 v41, v106, v32, 0
v_dot2_f32_bf16 v42, v97, v32, 0
v_dot2_f32_bf16 v43, v107, v32, 0
v_dot2_f32_bf16 v44, v98, v32, 0
v_dot2_f32_bf16 v45, v108, v32, 0
v_dot2_f32_bf16 v46, v99, v32, 0
v_dot2_f32_bf16 v47, v109, v32, 0
v_dot2_f32_bf16 v48, v100, v32, 0
buffer_load_dwordx4 a[116:119], v237, s[28:31], s52 offen offset:1024 sc1
v_dot2_f32_bf16 v49, v110, v32, 0
v_dot2_f32_bf16 v50, v101, v32, 0
v_dot2_f32_bf16 v51, v111, v32, 0
v_dot2_f32_bf16 v52, v102, v32, 0
v_dot2_f32_bf16 v53, v112, v32, 0
v_dot2_f32_bf16 v54, v103, v32, 0
v_dot2_f32_bf16 v55, v113, v32, 0
v_dot2_f32_bf16 v56, v104, v32, 0
v_dot2_f32_bf16 v57, v114, v32, 0
s_nop 1
v_mfma_f32_16x16x32_bf16 v[0:3], v[196:199], a[176:179], v[0:3]
ds_read_b64_tr_b16 v[192:193], v240 offset:16896
ds_read_b64_tr_b16 v[194:195], v240 offset:17152
v_mfma_f32_16x16x32_bf16 a[192:195], v[196:199], a[180:183], a[192:195]
v_perm_b32 v96, v136, v126, s4
v_perm_b32 v126, v136, v126, s5
v_mfma_f32_16x16x32_bf16 a[196:199], v[196:199], a[184:187], a[196:199]
v_perm_b32 v97, v137, v127, s4
v_mfma_f32_16x16x32_bf16 a[200:203], v[196:199], a[188:191], a[200:203]
s_waitcnt lgkmcnt(9)
ds_read_b128 v[166:169], v238 offset:33184
v_perm_b32 v127, v137, v127, s5
v_mfma_f32_16x16x32_bf16 v[4:7], v[200:203], a[176:179], v[4:7]
ds_read_b64_tr_b16 v[196:197], v239 offset:17408
ds_read_b64_tr_b16 v[198:199], v239 offset:17664
v_mfma_f32_16x16x32_bf16 a[204:207], v[200:203], a[180:183], a[204:207]
buffer_load_dword v246, v241, s[28:31], s83 offen sc1
v_perm_b32 v98, v138, v128, s4
v_mfma_f32_16x16x32_bf16 a[208:211], v[200:203], a[184:187], a[208:211]
v_perm_b32 v128, v138, v128, s5
v_mfma_f32_16x16x32_bf16 a[212:215], v[200:203], a[188:191], a[212:215]
s_waitcnt lgkmcnt(9)
ds_read_b128 v[170:173], v238 offset:33200
v_perm_b32 v99, v139, v129, s4
v_mfma_f32_16x16x32_bf16 v[8:11], v[204:207], a[176:179], v[8:11]
ds_read_b64_tr_b16 v[200:201], v239 offset:18432
ds_read_b64_tr_b16 v[202:203], v239 offset:18688
v_mfma_f32_16x16x32_bf16 a[216:219], v[204:207], a[180:183], a[216:219]
buffer_load_dwordx4 a[120:123], v237, s[28:31], s52 offen offset:2048 sc1
v_perm_b32 v129, v139, v129, s5
v_mfma_f32_16x16x32_bf16 a[220:223], v[204:207], a[184:187], a[220:223]
v_perm_b32 v100, v140, v130, s4
v_mfma_f32_16x16x32_bf16 a[224:227], v[204:207], a[188:191], a[224:227]
s_waitcnt lgkmcnt(9)
ds_read_b64 v[174:175], v238 offset:33216
v_perm_b32 v130, v140, v130, s5
v_mfma_f32_16x16x32_bf16 v[12:15], v[208:211], a[176:179], v[12:15]
ds_read_b64_tr_b16 v[204:205], v239 offset:19456
ds_read_b64_tr_b16 v[206:207], v239 offset:19712
v_mfma_f32_16x16x32_bf16 a[228:231], v[208:211], a[180:183], a[228:231]
buffer_load_dwordx4 a[124:127], v237, s[28:31], s52 offen offset:3072 sc1
v_perm_b32 v101, v141, v131, s4
v_mfma_f32_16x16x32_bf16 a[232:235], v[208:211], a[184:187], a[232:235]
v_perm_b32 v131, v141, v131, s5
v_mfma_f32_16x16x32_bf16 a[236:239], v[208:211], a[188:191], a[236:239]
s_waitcnt lgkmcnt(9)
ds_read_b128 v[176:179], v238 offset:32768
v_mfma_f32_16x16x32_bf16 v[16:19], v[192:195], a[176:179], v[16:19]
s_add_u32 s52, s79, 131072
ds_read_b64_tr_b16 v[208:209], v239 offset:20480
ds_read_b64_tr_b16 v[210:211], v239 offset:20736
v_mfma_f32_16x16x32_bf16 a[240:243], v[192:195], a[180:183], a[240:243]
buffer_load_dwordx4 a[128:131], v237, s[28:31], s52 offen offset:0 sc1
v_perm_b32 v102, v142, v132, s4
v_mfma_f32_16x16x32_bf16 a[244:247], v[192:195], a[184:187], a[244:247]
v_perm_b32 v132, v142, v132, s5
v_perm_b32 v103, v143, v133, s4
v_mfma_f32_16x16x32_bf16 a[248:251], v[192:195], a[188:191], a[248:251]
s_waitcnt vmcnt(51) lgkmcnt(9)
ds_read_b128 v[180:183], v238 offset:32784
v_mfma_f32_16x16x32_bf16 v[0:3], v[196:199], a[0:3], v[0:3]
ds_read_b64_tr_b16 v[192:193], v240 offset:21504
ds_read_b64_tr_b16 v[194:195], v240 offset:21760
v_mfma_f32_16x16x32_bf16 a[192:195], v[196:199], a[4:7], a[192:195]
buffer_load_dwordx4 a[132:135], v237, s[28:31], s52 offen offset:1024 sc1
v_perm_b32 v133, v143, v133, s5
v_mfma_f32_16x16x32_bf16 a[196:199], v[196:199], a[8:11], a[196:199]
v_perm_b32 v104, v144, v134, s4
v_perm_b32 v134, v144, v134, s5
v_mfma_f32_16x16x32_bf16 a[200:203], v[196:199], a[12:15], a[200:203]
s_waitcnt lgkmcnt(9)
v_mfma_f32_16x16x32_bf16 v[4:7], v[200:203], a[0:3], v[4:7]
ds_read_b64_tr_b16 v[196:197], v239 offset:22016
ds_read_b64_tr_b16 v[198:199], v239 offset:22272
v_mfma_f32_16x16x32_bf16 a[204:207], v[200:203], a[4:7], a[204:207]
buffer_load_dwordx4 a[136:139], v237, s[28:31], s52 offen offset:2048 sc1
buffer_load_dwordx4 a[140:143], v237, s[28:31], s52 offen offset:3072 sc1
v_mfma_f32_16x16x32_bf16 a[208:211], v[200:203], a[8:11], a[208:211]
ds_read_b64 v[184:185], v238 offset:32800
v_mfma_f32_16x16x32_bf16 a[212:215], v[200:203], a[12:15], a[212:215]
s_waitcnt lgkmcnt(9)
v_dot2c_f32_bf16 v40, v96, v33
v_dot2c_f32_bf16 v41, v126, v33
v_dot2c_f32_bf16 v42, v97, v33
v_dot2c_f32_bf16 v43, v127, v33
v_dot2c_f32_bf16 v44, v98, v33
v_dot2c_f32_bf16 v45, v128, v33
v_dot2c_f32_bf16 v46, v99, v33
v_dot2c_f32_bf16 v47, v129, v33
v_dot2c_f32_bf16 v48, v100, v33
s_add_u32 s52, s79, 139264
buffer_load_dwordx4 a[144:147], v237, s[28:31], s52 offen offset:0 sc1
v_dot2c_f32_bf16 v49, v130, v33
v_dot2c_f32_bf16 v50, v101, v33
v_dot2c_f32_bf16 v51, v131, v33
v_dot2c_f32_bf16 v52, v102, v33
v_dot2c_f32_bf16 v53, v132, v33
v_dot2c_f32_bf16 v54, v103, v33
v_dot2c_f32_bf16 v55, v133, v33
v_dot2c_f32_bf16 v56, v104, v33
v_dot2c_f32_bf16 v57, v134, v33
s_nop 1
v_mfma_f32_16x16x32_bf16 v[8:11], v[204:207], a[0:3], v[8:11]
ds_read_b64_tr_b16 v[200:201], v239 offset:23040
ds_read_b64_tr_b16 v[202:203], v239 offset:23296
v_mfma_f32_16x16x32_bf16 a[216:219], v[204:207], a[4:7], a[216:219]
v_perm_b32 v96, v156, v146, s4
v_perm_b32 v146, v156, v146, s5
v_mfma_f32_16x16x32_bf16 a[220:223], v[204:207], a[8:11], a[220:223]
v_perm_b32 v97, v157, v147, s4
v_perm_b32 v147, v157, v147, s5
v_mfma_f32_16x16x32_bf16 a[224:227], v[204:207], a[12:15], a[224:227]
s_waitcnt lgkmcnt(8)
v_perm_b32 v98, v158, v148, s4
v_mfma_f32_16x16x32_bf16 v[12:15], v[208:211], a[0:3], v[12:15]
ds_read_b64_tr_b16 v[204:205], v239 offset:24064
ds_read_b64_tr_b16 v[206:207], v239 offset:24320
v_mfma_f32_16x16x32_bf16 a[228:231], v[208:211], a[4:7], a[228:231]
buffer_load_dwordx4 a[148:151], v237, s[28:31], s52 offen offset:1024 sc1
v_perm_b32 v148, v158, v148, s5
v_mfma_f32_16x16x32_bf16 a[232:235], v[208:211], a[8:11], a[232:235]
v_perm_b32 v99, v159, v149, s4
v_perm_b32 v149, v159, v149, s5
v_mfma_f32_16x16x32_bf16 a[236:239], v[208:211], a[12:15], a[236:239]
s_waitcnt lgkmcnt(7)
v_mfma_f32_16x16x32_bf16 v[16:19], v[192:195], a[0:3], v[16:19]
ds_read_b64_tr_b16 v[208:209], v239 offset:25088
ds_read_b64_tr_b16 v[210:211], v239 offset:25344
v_mfma_f32_16x16x32_bf16 a[240:243], v[192:195], a[4:7], a[240:243]
v_perm_b32 v100, v160, v150, s4
v_perm_b32 v150, v160, v150, s5
v_mfma_f32_16x16x32_bf16 a[244:247], v[192:195], a[8:11], a[244:247]
v_perm_b32 v101, v161, v151, s4
v_mfma_f32_16x16x32_bf16 a[248:251], v[192:195], a[12:15], a[248:251]
s_waitcnt vmcnt(47) lgkmcnt(7)
v_mfma_f32_16x16x32_bf16 v[0:3], v[196:199], a[16:19], v[0:3]
ds_read_b64_tr_b16 v[192:193], v240 offset:26112
ds_read_b64_tr_b16 v[194:195], v240 offset:26368
v_mfma_f32_16x16x32_bf16 a[192:195], v[196:199], a[20:23], a[192:195]
buffer_load_dwordx4 a[152:155], v237, s[28:31], s52 offen offset:2048 sc1
v_perm_b32 v151, v161, v151, s5
v_mfma_f32_16x16x32_bf16 a[196:199], v[196:199], a[24:27], a[196:199]
s_waitcnt vmcnt(34)
s_barrier
v_mfma_f32_16x16x32_bf16 a[200:203], v[196:199], a[28:31], a[200:203]
s_waitcnt lgkmcnt(6)
v_perm_b32 v102, v162, v152, s4
v_perm_b32 v152, v162, v152, s5
v_mfma_f32_16x16x32_bf16 v[4:7], v[200:203], a[16:19], v[4:7]
ds_read_b64_tr_b16 v[196:197], v239 offset:26624
ds_read_b64_tr_b16 v[198:199], v239 offset:26880
v_mfma_f32_16x16x32_bf16 a[204:207], v[200:203], a[20:23], a[204:207]
buffer_load_dwordx4 a[156:159], v237, s[28:31], s52 offen offset:3072 sc1
v_perm_b32 v103, v163, v153, s4
v_mfma_f32_16x16x32_bf16 a[208:211], v[200:203], a[24:27], a[208:211]
v_perm_b32 v153, v163, v153, s5
v_perm_b32 v104, v164, v154, s4
v_mfma_f32_16x16x32_bf16 a[212:215], v[200:203], a[28:31], a[212:215]
s_waitcnt lgkmcnt(6)
v_perm_b32 v154, v164, v154, s5
v_mfma_f32_16x16x32_bf16 v[8:11], v[204:207], a[16:19], v[8:11]
s_add_u32 m0, s49, 98304
ds_read_b64_tr_b16 v[200:201], v239 offset:27648
ds_read_b64_tr_b16 v[202:203], v239 offset:27904
v_mfma_f32_16x16x32_bf16 a[216:219], v[204:207], a[20:23], a[216:219]
s_add_u32 s50, s81, 131072
buffer_load_dwordx4 v237, s[28:31], s50 offen sc1 lds
v_mfma_f32_16x16x32_bf16 a[220:223], v[204:207], a[24:27], a[220:223]
s_add_u32 m0, s49, 102400
v_dot2c_f32_bf16 v40, v96, v34
v_dot2c_f32_bf16 v41, v146, v34
v_dot2c_f32_bf16 v42, v97, v34
v_dot2c_f32_bf16 v43, v147, v34
v_dot2c_f32_bf16 v44, v98, v34
v_dot2c_f32_bf16 v45, v148, v34
v_dot2c_f32_bf16 v46, v99, v34
v_dot2c_f32_bf16 v47, v149, v34
v_dot2c_f32_bf16 v48, v100, v34
s_add_u32 s50, s81, 135168
buffer_load_dwordx4 v237, s[28:31], s50 offen sc1 lds
v_dot2c_f32_bf16 v49, v150, v34
v_dot2c_f32_bf16 v50, v101, v34
v_dot2c_f32_bf16 v51, v151, v34
v_dot2c_f32_bf16 v52, v102, v34
v_dot2c_f32_bf16 v53, v152, v34
v_dot2c_f32_bf16 v54, v103, v34
v_dot2c_f32_bf16 v55, v153, v34
v_dot2c_f32_bf16 v56, v104, v34
v_dot2c_f32_bf16 v57, v154, v34
s_nop 1
v_mfma_f32_16x16x32_bf16 a[224:227], v[204:207], a[28:31], a[224:227]
s_waitcnt lgkmcnt(6)
v_perm_b32 v96, v176, v166, s4
v_perm_b32 v166, v176, v166, s5
v_mfma_f32_16x16x32_bf16 v[12:15], v[208:211], a[16:19], v[12:15]
s_add_u32 m0, s49, 73728
ds_read_b64_tr_b16 v[204:205], v239 offset:28672
ds_read_b64_tr_b16 v[206:207], v239 offset:28928
v_mfma_f32_16x16x32_bf16 a[228:231], v[208:211], a[20:23], a[228:231]
s_add_u32 s50, s82, 24576
buffer_load_dwordx4 v237, s[28:31], s50 offen sc1 lds
v_perm_b32 v97, v177, v167, s4
v_mfma_f32_16x16x32_bf16 a[232:235], v[208:211], a[24:27], a[232:235]
v_perm_b32 v167, v177, v167, s5
v_perm_b32 v98, v178, v168, s4
v_mfma_f32_16x16x32_bf16 a[236:239], v[208:211], a[28:31], a[236:239]
s_waitcnt lgkmcnt(6)
v_perm_b32 v168, v178, v168, s5
v_mfma_f32_16x16x32_bf16 v[16:19], v[192:195], a[16:19], v[16:19]
s_add_u32 m0, s49, 77824
ds_read_b64_tr_b16 v[208:209], v239 offset:29696
ds_read_b64_tr_b16 v[210:211], v239 offset:29952
v_mfma_f32_16x16x32_bf16 a[240:243], v[192:195], a[20:23], a[240:243]
s_add_u32 s50, s82, 28672
buffer_load_dwordx4 v237, s[28:31], s50 offen sc1 lds
v_perm_b32 v99, v179, v169, s4
v_mfma_f32_16x16x32_bf16 a[244:247], v[192:195], a[24:27], a[244:247]
v_perm_b32 v169, v179, v169, s5
v_perm_b32 v100, v180, v170, s4
v_mfma_f32_16x16x32_bf16 a[248:251], v[192:195], a[28:31], a[248:251]
s_waitcnt vmcnt(41) lgkmcnt(6)
v_mfma_f32_16x16x32_bf16 v[0:3], v[196:199], a[32:35], v[0:3]
s_add_u32 m0, s49, 81920
ds_read_b64_tr_b16 v[192:193], v240 offset:30720
ds_read_b64_tr_b16 v[194:195], v240 offset:30976
v_mfma_f32_16x16x32_bf16 a[192:195], v[196:199], a[36:39], a[192:195]
s_add_u32 s50, s82, 32768
buffer_load_dwordx4 v237, s[28:31], s50 offen sc1 lds
v_perm_b32 v170, v180, v170, s5
v_mfma_f32_16x16x32_bf16 a[196:199], v[196:199], a[40:43], a[196:199]
v_perm_b32 v101, v181, v171, s4
v_perm_b32 v171, v181, v171, s5
v_mfma_f32_16x16x32_bf16 a[200:203], v[196:199], a[44:47], a[200:203]
s_waitcnt lgkmcnt(6)
v_perm_b32 v102, v182, v172, s4
v_mfma_f32_16x16x32_bf16 v[4:7], v[200:203], a[32:35], v[4:7]
s_waitcnt vmcnt(15)
ds_read_b64_tr_b16 v[196:197], v239 offset:31232
ds_read_b64_tr_b16 v[198:199], v239 offset:31488
v_mfma_f32_16x16x32_bf16 a[204:207], v[200:203], a[36:39], a[204:207]
v_cmp_gt_u32 vcc, 1, v246
v_perm_b32 v172, v182, v172, s5
v_mfma_f32_16x16x32_bf16 a[208:211], v[200:203], a[40:43], a[208:211]
s_cbranch_vccnz spin_16_v0
ok_15_v0:
v_mfma_f32_16x16x32_bf16 a[212:215], v[200:203], a[44:47], a[212:215]
s_waitcnt lgkmcnt(6)
v_perm_b32 v103, v183, v173, s4
v_perm_b32 v173, v183, v173, s5
v_mfma_f32_16x16x32_bf16 v[8:11], v[204:207], a[32:35], v[8:11]
s_add_u32 m0, s49, 106496
ds_read_b64_tr_b16 v[200:201], v239 offset:32256
ds_read_b64_tr_b16 v[202:203], v239 offset:32512
v_mfma_f32_16x16x32_bf16 a[216:219], v[204:207], a[36:39], a[216:219]
s_add_u32 s50, s81, 139264
buffer_load_dwordx4 v237, s[28:31], s50 offen sc1 lds
v_perm_b32 v104, v184, v174, s4
v_mfma_f32_16x16x32_bf16 a[220:223], v[204:207], a[40:43], a[220:223]
s_add_u32 m0, s49, 110592
v_perm_b32 v174, v184, v174, s5
v_mfma_f32_16x16x32_bf16 a[224:227], v[204:207], a[44:47], a[224:227]
s_waitcnt lgkmcnt(6)
v_dot2c_f32_bf16 v40, v96, v35
v_dot2c_f32_bf16 v41, v166, v35
v_dot2c_f32_bf16 v42, v97, v35
v_dot2c_f32_bf16 v43, v167, v35
v_dot2c_f32_bf16 v44, v98, v35
v_dot2c_f32_bf16 v45, v168, v35
v_dot2c_f32_bf16 v46, v99, v35
v_dot2c_f32_bf16 v47, v169, v35
v_dot2c_f32_bf16 v48, v100, v35
s_add_u32 s50, s81, 143360
buffer_load_dwordx4 v237, s[28:31], s50 offen sc1 lds
v_dot2c_f32_bf16 v49, v170, v35
v_dot2c_f32_bf16 v50, v101, v35
v_dot2c_f32_bf16 v51, v171, v35
v_dot2c_f32_bf16 v52, v102, v35
v_dot2c_f32_bf16 v53, v172, v35
v_dot2c_f32_bf16 v54, v103, v35
v_dot2c_f32_bf16 v55, v173, v35
v_dot2c_f32_bf16 v56, v104, v35
v_dot2c_f32_bf16 v57, v174, v35
s_nop 1
v_mfma_f32_16x16x32_bf16 v[12:15], v[208:211], a[32:35], v[12:15]
s_add_u32 s52, s79, 45056
ds_read_b64_tr_b16 v[204:205], v239 offset:33280
ds_read_b64_tr_b16 v[206:207], v239 offset:33536
v_mfma_f32_16x16x32_bf16 a[228:231], v[208:211], a[36:39], a[228:231]
buffer_load_dwordx4 a[160:163], v237, s[28:31], s52 offen offset:0 sc1
buffer_load_dwordx4 a[164:167], v237, s[28:31], s52 offen offset:1024 sc1
v_mfma_f32_16x16x32_bf16 a[232:235], v[208:211], a[40:43], a[232:235]
v_lshrrev_b32 v187, 4, v186
v_lshlrev_b32 v187, 10, v187
v_mfma_f32_16x16x32_bf16 a[236:239], v[208:211], a[44:47], a[236:239]
s_waitcnt lgkmcnt(6)
v_and_b32 v188, 15, v186
v_lshl_add_u32 v187, v188, 4, v187
v_mfma_f32_16x16x32_bf16 v[16:19], v[192:195], a[32:35], v[16:19]
ds_read_b64_tr_b16 v[208:209], v239 offset:34304
ds_read_b64_tr_b16 v[210:211], v239 offset:34560
v_mfma_f32_16x16x32_bf16 a[240:243], v[192:195], a[36:39], a[240:243]
buffer_load_dwordx4 a[168:171], v237, s[28:31], s52 offen offset:2048 sc1
v_lshl_add_u32 v188, v186, 4, s80
v_mfma_f32_16x16x32_bf16 a[244:247], v[192:195], a[40:43], a[244:247]
v_cvt_pk_bf16_f32 v68, v56, v57
v_mfma_f32_16x16x32_bf16 a[248:251], v[192:195], a[44:47], a[248:251]
s_waitcnt vmcnt(40) lgkmcnt(6)
ds_write_b32 v188, v68 offset:13312
v_mfma_f32_16x16x32_bf16 v[0:3], v[196:199], a[48:51], v[0:3]
ds_read_b64_tr_b16 v[192:193], v240 offset:35328
ds_read_b64_tr_b16 v[194:195], v240 offset:35584
v_mfma_f32_16x16x32_bf16 a[192:195], v[196:199], a[52:55], a[192:195]
buffer_load_dwordx4 a[172:175], v237, s[28:31], s52 offen offset:3072 sc1
v_cvt_pk_bf16_f32 v60, v40, v41
v_mfma_f32_16x16x32_bf16 a[196:199], v[196:199], a[56:59], a[196:199]
v_cvt_pk_bf16_f32 v61, v42, v43
v_cvt_pk_bf16_f32 v62, v44, v45
v_mfma_f32_16x16x32_bf16 a[200:203], v[196:199], a[60:63], a[200:203]
s_waitcnt lgkmcnt(7)
v_cvt_pk_bf16_f32 v63, v46, v47
v_mfma_f32_16x16x32_bf16 v[4:7], v[200:203], a[48:51], v[4:7]
ds_read_b64_tr_b16 v[196:197], v239 offset:35840
ds_read_b64_tr_b16 v[198:199], v239 offset:36096
v_mfma_f32_16x16x32_bf16 a[204:207], v[200:203], a[52:55], a[204:207]
v_cvt_pk_bf16_f32 v64, v48, v49
v_cvt_pk_bf16_f32 v65, v50, v51
v_mfma_f32_16x16x32_bf16 a[208:211], v[200:203], a[56:59], a[208:211]
v_cvt_pk_bf16_f32 v66, v52, v53
v_mfma_f32_16x16x32_bf16 a[212:215], v[200:203], a[60:63], a[212:215]
s_waitcnt lgkmcnt(7)
v_mfma_f32_16x16x32_bf16 v[8:11], v[204:207], a[48:51], v[8:11]
ds_read_b64_tr_b16 v[200:201], v239 offset:36864
ds_read_b64_tr_b16 v[202:203], v239 offset:37120
v_mfma_f32_16x16x32_bf16 a[216:219], v[204:207], a[52:55], a[216:219]
v_cvt_pk_bf16_f32 v67, v54, v55
v_mfma_f32_16x16x32_bf16 a[220:223], v[204:207], a[56:59], a[220:223]
buffer_store_dwordx4 v[60:63], v187, s[28:31], s87 offen sc1
buffer_store_dwordx4 v[64:67], v187, s[28:31], s87 offen offset:256 sc1
v_mfma_f32_16x16x32_bf16 a[224:227], v[204:207], a[60:63], a[224:227]
s_waitcnt lgkmcnt(7)
v_mfma_f32_16x16x32_bf16 v[12:15], v[208:211], a[48:51], v[12:15]
ds_read_b64_tr_b16 v[204:205], v239 offset:37888
ds_read_b64_tr_b16 v[206:207], v239 offset:38144
v_mfma_f32_16x16x32_bf16 a[228:231], v[208:211], a[52:55], a[228:231]
v_mfma_f32_16x16x32_bf16 a[232:235], v[208:211], a[56:59], a[232:235]
v_mfma_f32_16x16x32_bf16 a[236:239], v[208:211], a[60:63], a[236:239]
s_waitcnt lgkmcnt(6)
v_mfma_f32_16x16x32_bf16 v[16:19], v[192:195], a[48:51], v[16:19]
s_add_u32 s52, s79, 53248
ds_read_b64_tr_b16 v[208:209], v239 offset:38912
ds_read_b64_tr_b16 v[210:211], v239 offset:39168
v_mfma_f32_16x16x32_bf16 a[240:243], v[192:195], a[52:55], a[240:243]
buffer_load_dwordx4 a[176:179], v237, s[28:31], s52 offen offset:0 sc1
v_mfma_f32_16x16x32_bf16 a[244:247], v[192:195], a[56:59], a[244:247]
v_mfma_f32_16x16x32_bf16 a[248:251], v[192:195], a[60:63], a[248:251]
s_waitcnt vmcnt(40) lgkmcnt(6)
v_mfma_f32_16x16x32_bf16 v[0:3], v[196:199], a[64:67], v[0:3]
ds_read_b64_tr_b16 v[192:193], v240 offset:39936
ds_read_b64_tr_b16 v[194:195], v240 offset:40192
v_mfma_f32_16x16x32_bf16 a[192:195], v[196:199], a[68:71], a[192:195]
buffer_load_dwordx4 a[180:183], v237, s[28:31], s52 offen offset:1024 sc1
v_mfma_f32_16x16x32_bf16 a[196:199], v[196:199], a[72:75], a[196:199]
v_mfma_f32_16x16x32_bf16 a[200:203], v[196:199], a[76:79], a[200:203]
s_waitcnt lgkmcnt(6)
v_mfma_f32_16x16x32_bf16 v[4:7], v[200:203], a[64:67], v[4:7]
ds_read_b64_tr_b16 v[196:197], v239 offset:40448
ds_read_b64_tr_b16 v[198:199], v239 offset:40704
v_mfma_f32_16x16x32_bf16 a[204:207], v[200:203], a[68:71], a[204:207]
buffer_load_dwordx4 a[184:187], v237, s[28:31], s52 offen offset:2048 sc1
v_mfma_f32_16x16x32_bf16 a[208:211], v[200:203], a[72:75], a[208:211]
v_mfma_f32_16x16x32_bf16 a[212:215], v[200:203], a[76:79], a[212:215]
s_waitcnt lgkmcnt(6)
v_mfma_f32_16x16x32_bf16 v[8:11], v[204:207], a[64:67], v[8:11]
ds_read_b64_tr_b16 v[200:201], v239 offset:41472
ds_read_b64_tr_b16 v[202:203], v239 offset:41728
v_mfma_f32_16x16x32_bf16 a[216:219], v[204:207], a[68:71], a[216:219]
buffer_load_dwordx4 a[188:191], v237, s[28:31], s52 offen offset:3072 sc1
v_mfma_f32_16x16x32_bf16 a[220:223], v[204:207], a[72:75], a[220:223]
v_mfma_f32_16x16x32_bf16 a[224:227], v[204:207], a[76:79], a[224:227]
s_waitcnt lgkmcnt(6)
v_mfma_f32_16x16x32_bf16 v[12:15], v[208:211], a[64:67], v[12:15]
s_add_u32 s52, s79, 61440
ds_read_b64_tr_b16 v[204:205], v239 offset:42496
ds_read_b64_tr_b16 v[206:207], v239 offset:42752
v_mfma_f32_16x16x32_bf16 a[228:231], v[208:211], a[68:71], a[228:231]
buffer_load_dwordx4 a[0:3], v237, s[28:31], s52 offen offset:0 sc1
v_mfma_f32_16x16x32_bf16 a[232:235], v[208:211], a[72:75], a[232:235]
v_mfma_f32_16x16x32_bf16 a[236:239], v[208:211], a[76:79], a[236:239]
s_waitcnt lgkmcnt(6)
v_mfma_f32_16x16x32_bf16 v[16:19], v[192:195], a[64:67], v[16:19]
ds_read_b64_tr_b16 v[208:209], v239 offset:43520
ds_read_b64_tr_b16 v[210:211], v239 offset:43776
v_mfma_f32_16x16x32_bf16 a[240:243], v[192:195], a[68:71], a[240:243]
buffer_load_dwordx4 a[4:7], v237, s[28:31], s52 offen offset:1024 sc1
v_mfma_f32_16x16x32_bf16 a[244:247], v[192:195], a[72:75], a[244:247]
v_mfma_f32_16x16x32_bf16 a[248:251], v[192:195], a[76:79], a[248:251]
s_waitcnt vmcnt(41) lgkmcnt(6)
v_mfma_f32_16x16x32_bf16 v[0:3], v[196:199], a[80:83], v[0:3]
ds_read_b64_tr_b16 v[192:193], v240 offset:44544
ds_read_b64_tr_b16 v[194:195], v240 offset:44800
v_mfma_f32_16x16x32_bf16 a[192:195], v[196:199], a[84:87], a[192:195]
v_mfma_f32_16x16x32_bf16 a[196:199], v[196:199], a[88:91], a[196:199]
s_waitcnt vmcnt(32)
s_barrier
v_mfma_f32_16x16x32_bf16 a[200:203], v[196:199], a[92:95], a[200:203]
s_waitcnt lgkmcnt(6)
v_mfma_f32_16x16x32_bf16 v[4:7], v[200:203], a[80:83], v[4:7]
ds_read_b64_tr_b16 v[196:197], v239 offset:45056
ds_read_b64_tr_b16 v[198:199], v239 offset:45312
v_mfma_f32_16x16x32_bf16 a[204:207], v[200:203], a[84:87], a[204:207]
ds_read_b128 v[56:59], v230 offset:13312
v_mfma_f32_16x16x32_bf16 a[208:211], v[200:203], a[88:91], a[208:211]
v_mfma_f32_16x16x32_bf16 a[212:215], v[200:203], a[92:95], a[212:215]
s_waitcnt lgkmcnt(7)
v_mfma_f32_16x16x32_bf16 v[8:11], v[204:207], a[80:83], v[8:11]
ds_read_b64_tr_b16 v[200:201], v239 offset:46080
ds_read_b64_tr_b16 v[202:203], v239 offset:46336
v_mfma_f32_16x16x32_bf16 a[216:219], v[204:207], a[84:87], a[216:219]
buffer_load_dwordx4 a[8:11], v237, s[28:31], s52 offen offset:2048 sc1
v_mfma_f32_16x16x32_bf16 a[220:223], v[204:207], a[88:91], a[220:223]
v_mfma_f32_16x16x32_bf16 a[224:227], v[204:207], a[92:95], a[224:227]
s_waitcnt lgkmcnt(7)
v_mfma_f32_16x16x32_bf16 v[12:15], v[208:211], a[80:83], v[12:15]
ds_read_b64_tr_b16 v[204:205], v239 offset:47104
ds_read_b64_tr_b16 v[206:207], v239 offset:47360
v_mfma_f32_16x16x32_bf16 a[228:231], v[208:211], a[84:87], a[228:231]
buffer_load_dwordx4 a[12:15], v237, s[28:31], s52 offen offset:3072 sc1
v_mfma_f32_16x16x32_bf16 a[232:235], v[208:211], a[88:91], a[232:235]
v_mfma_f32_16x16x32_bf16 a[236:239], v[208:211], a[92:95], a[236:239]
s_waitcnt lgkmcnt(7)
v_mfma_f32_16x16x32_bf16 v[16:19], v[192:195], a[80:83], v[16:19]
s_add_u32 s52, s79, 69632
ds_read_b64_tr_b16 v[208:209], v239 offset:48128
ds_read_b64_tr_b16 v[210:211], v239 offset:48384
v_mfma_f32_16x16x32_bf16 a[240:243], v[192:195], a[84:87], a[240:243]
TCH_10_v0:
s_cbranch_execz TCH_back
buffer_load_dwordx4 a[16:19], v237, s[28:31], s52 offen offset:0 sc1
v_mfma_f32_16x16x32_bf16 a[244:247], v[192:195], a[88:91], a[244:247]
v_mfma_f32_16x16x32_bf16 a[248:251], v[192:195], a[92:95], a[248:251]
s_waitcnt vmcnt(38) lgkmcnt(7)
v_mfma_f32_16x16x32_bf16 v[0:3], v[196:199], a[96:99], v[0:3]
ds_read_b64_tr_b16 v[192:193], v240 offset:49152
ds_read_b64_tr_b16 v[194:195], v240 offset:49408
v_mfma_f32_16x16x32_bf16 a[192:195], v[196:199], a[100:103], a[192:195]
buffer_load_dwordx4 a[20:23], v237, s[28:31], s52 offen offset:1024 sc1
v_mfma_f32_16x16x32_bf16 a[196:199], v[196:199], a[104:107], a[196:199]
v_mfma_f32_16x16x32_bf16 a[200:203], v[196:199], a[108:111], a[200:203]
s_waitcnt lgkmcnt(6)
buffer_store_dwordx4 v[56:59], v231, s[28:31], s88 offen sc1
v_mfma_f32_16x16x32_bf16 v[4:7], v[200:203], a[96:99], v[4:7]
ds_read_b64_tr_b16 v[196:197], v239 offset:49664
ds_read_b64_tr_b16 v[198:199], v239 offset:49920
v_mfma_f32_16x16x32_bf16 a[204:207], v[200:203], a[100:103], a[204:207]
buffer_load_dwordx4 a[24:27], v237, s[28:31], s52 offen offset:2048 sc1
v_mfma_f32_16x16x32_bf16 a[208:211], v[200:203], a[104:107], a[208:211]
v_mfma_f32_16x16x32_bf16 a[212:215], v[200:203], a[108:111], a[212:215]
s_waitcnt lgkmcnt(6)
v_mfma_f32_16x16x32_bf16 v[8:11], v[204:207], a[96:99], v[8:11]
ds_read_b64_tr_b16 v[200:201], v239 offset:50688
ds_read_b64_tr_b16 v[202:203], v239 offset:50944
v_mfma_f32_16x16x32_bf16 a[216:219], v[204:207], a[100:103], a[216:219]
buffer_load_dwordx4 a[28:31], v237, s[28:31], s52 offen offset:3072 sc1
v_mfma_f32_16x16x32_bf16 a[220:223], v[204:207], a[104:107], a[220:223]
v_mfma_f32_16x16x32_bf16 a[224:227], v[204:207], a[108:111], a[224:227]
s_waitcnt lgkmcnt(6)
v_mfma_f32_16x16x32_bf16 v[12:15], v[208:211], a[96:99], v[12:15]
s_add_u32 m0, s49, 114688
ds_read_b64_tr_b16 v[204:205], v239 offset:51712
ds_read_b64_tr_b16 v[206:207], v239 offset:51968
v_mfma_f32_16x16x32_bf16 a[228:231], v[208:211], a[100:103], a[228:231]
s_add_u32 s50, s81, 147456
buffer_load_dwordx4 v237, s[28:31], s50 offen sc1 lds
v_mfma_f32_16x16x32_bf16 a[232:235], v[208:211], a[104:107], a[232:235]
v_mfma_f32_16x16x32_bf16 a[236:239], v[208:211], a[108:111], a[236:239]
s_waitcnt lgkmcnt(6)
v_mfma_f32_16x16x32_bf16 v[16:19], v[192:195], a[96:99], v[16:19]
s_add_u32 m0, s49, 118784
ds_read_b64_tr_b16 v[208:209], v239 offset:52736
ds_read_b64_tr_b16 v[210:211], v239 offset:52992
v_mfma_f32_16x16x32_bf16 a[240:243], v[192:195], a[100:103], a[240:243]
s_add_u32 s50, s81, 151552
buffer_load_dwordx4 v237, s[28:31], s50 offen sc1 lds
v_mfma_f32_16x16x32_bf16 a[244:247], v[192:195], a[104:107], a[244:247]
v_mfma_f32_16x16x32_bf16 a[248:251], v[192:195], a[108:111], a[248:251]
s_waitcnt vmcnt(36) lgkmcnt(6)
v_mfma_f32_16x16x32_bf16 v[0:3], v[196:199], a[112:115], v[0:3]
s_add_u32 m0, s49, 122880
ds_read_b64_tr_b16 v[192:193], v240 offset:53760
ds_read_b64_tr_b16 v[194:195], v240 offset:54016
v_mfma_f32_16x16x32_bf16 a[192:195], v[196:199], a[116:119], a[192:195]
s_add_u32 s50, s81, 155648
buffer_load_dwordx4 v237, s[28:31], s50 offen sc1 lds
v_mfma_f32_16x16x32_bf16 a[196:199], v[196:199], a[120:123], a[196:199]
v_mfma_f32_16x16x32_bf16 a[200:203], v[196:199], a[124:127], a[200:203]
s_waitcnt lgkmcnt(6)
v_mfma_f32_16x16x32_bf16 v[4:7], v[200:203], a[112:115], v[4:7]
s_add_u32 m0, s49, 126976
ds_read_b64_tr_b16 v[196:197], v239 offset:54272
ds_read_b64_tr_b16 v[198:199], v239 offset:54528
v_mfma_f32_16x16x32_bf16 a[204:207], v[200:203], a[116:119], a[204:207]
s_add_u32 s50, s81, 159744
buffer_load_dwordx4 v237, s[28:31], s50 offen sc1 lds
v_mfma_f32_16x16x32_bf16 a[208:211], v[200:203], a[120:123], a[208:211]
v_mfma_f32_16x16x32_bf16 a[212:215], v[200:203], a[124:127], a[212:215]
s_waitcnt lgkmcnt(6)
v_mfma_f32_16x16x32_bf16 v[8:11], v[204:207], a[112:115], v[8:11]
s_add_u32 m0, s49, 131072
ds_read_b64_tr_b16 v[200:201], v239 offset:55296
ds_read_b64_tr_b16 v[202:203], v239 offset:55552
v_mfma_f32_16x16x32_bf16 a[216:219], v[204:207], a[116:119], a[216:219]
s_add_u32 s50, s81, 163840
buffer_load_dwordx4 v237, s[28:31], s50 offen sc1 lds
v_mfma_f32_16x16x32_bf16 a[220:223], v[204:207], a[120:123], a[220:223]
v_mfma_f32_16x16x32_bf16 a[224:227], v[204:207], a[124:127], a[224:227]
s_waitcnt lgkmcnt(6)
v_mfma_f32_16x16x32_bf16 v[12:15], v[208:211], a[112:115], v[12:15]
ds_read_b64_tr_b16 v[204:205], v239 offset:56320
ds_read_b64_tr_b16 v[206:207], v239 offset:56576
v_mfma_f32_16x16x32_bf16 a[228:231], v[208:211], a[116:119], a[228:231]
v_mfma_f32_16x16x32_bf16 a[232:235], v[208:211], a[120:123], a[232:235]
v_mfma_f32_16x16x32_bf16 a[236:239], v[208:211], a[124:127], a[236:239]
s_waitcnt lgkmcnt(6)
v_mfma_f32_16x16x32_bf16 v[16:19], v[192:195], a[112:115], v[16:19]
s_add_u32 s52, s79, 118784
ds_read_b64_tr_b16 v[208:209], v239 offset:57344
ds_read_b64_tr_b16 v[210:211], v239 offset:57600
v_mfma_f32_16x16x32_bf16 a[240:243], v[192:195], a[116:119], a[240:243]
buffer_load_dwordx4 a[32:35], v237, s[28:31], s52 offen offset:0 sc1
v_mfma_f32_16x16x32_bf16 a[244:247], v[192:195], a[120:123], a[244:247]
v_mfma_f32_16x16x32_bf16 a[248:251], v[192:195], a[124:127], a[248:251]
s_waitcnt vmcnt(36) lgkmcnt(6)
v_mfma_f32_16x16x32_bf16 v[0:3], v[196:199], a[128:131], v[0:3]
ds_read_b64_tr_b16 v[192:193], v240 offset:58368
ds_read_b64_tr_b16 v[194:195], v240 offset:58624
v_mfma_f32_16x16x32_bf16 a[192:195], v[196:199], a[132:135], a[192:195]
buffer_load_dwordx4 a[36:39], v237, s[28:31], s52 offen offset:1024 sc1
v_mfma_f32_16x16x32_bf16 a[196:199], v[196:199], a[136:139], a[196:199]
v_mfma_f32_16x16x32_bf16 a[200:203], v[196:199], a[140:143], a[200:203]
s_waitcnt lgkmcnt(6)
v_mfma_f32_16x16x32_bf16 v[4:7], v[200:203], a[128:131], v[4:7]
ds_read_b64_tr_b16 v[196:197], v239 offset:58880
ds_read_b64_tr_b16 v[198:199], v239 offset:59136
v_mfma_f32_16x16x32_bf16 a[204:207], v[200:203], a[132:135], a[204:207]
buffer_load_dwordx4 a[40:43], v237, s[28:31], s52 offen offset:2048 sc1
v_mfma_f32_16x16x32_bf16 a[208:211], v[200:203], a[136:139], a[208:211]
v_mfma_f32_16x16x32_bf16 a[212:215], v[200:203], a[140:143], a[212:215]
s_waitcnt lgkmcnt(6)
v_mfma_f32_16x16x32_bf16 v[8:11], v[204:207], a[128:131], v[8:11]
s_waitcnt vmcnt(10)
ds_read_b64_tr_b16 v[200:201], v239 offset:59904
ds_read_b64_tr_b16 v[202:203], v239 offset:60160
v_mfma_f32_16x16x32_bf16 a[216:219], v[204:207], a[132:135], a[216:219]
buffer_store_dword v242, off, s[28:31], s89 sc1
buffer_load_dwordx4 a[44:47], v237, s[28:31], s52 offen offset:3072 sc1
v_mfma_f32_16x16x32_bf16 a[220:223], v[204:207], a[136:139], a[220:223]
v_mfma_f32_16x16x32_bf16 a[224:227], v[204:207], a[140:143], a[224:227]
s_waitcnt lgkmcnt(6)
v_mfma_f32_16x16x32_bf16 v[12:15], v[208:211], a[128:131], v[12:15]
s_add_u32 s52, s79, 126976
ds_read_b64_tr_b16 v[204:205], v239 offset:60928
ds_read_b64_tr_b16 v[206:207], v239 offset:61184
v_mfma_f32_16x16x32_bf16 a[228:231], v[208:211], a[132:135], a[228:231]
buffer_load_dwordx4 a[48:51], v237, s[28:31], s52 offen offset:0 sc1
v_mfma_f32_16x16x32_bf16 a[232:235], v[208:211], a[136:139], a[232:235]
v_mfma_f32_16x16x32_bf16 a[236:239], v[208:211], a[140:143], a[236:239]
s_waitcnt lgkmcnt(6)
v_mfma_f32_16x16x32_bf16 v[16:19], v[192:195], a[128:131], v[16:19]
ds_read_b64_tr_b16 v[208:209], v239 offset:61952
ds_read_b64_tr_b16 v[210:211], v239 offset:62208
v_mfma_f32_16x16x32_bf16 a[240:243], v[192:195], a[132:135], a[240:243]
buffer_load_dwordx4 a[52:55], v237, s[28:31], s52 offen offset:1024 sc1
v_mfma_f32_16x16x32_bf16 a[244:247], v[192:195], a[136:139], a[244:247]
v_mfma_f32_16x16x32_bf16 a[248:251], v[192:195], a[140:143], a[248:251]
s_waitcnt vmcnt(38) lgkmcnt(6)
v_mfma_f32_16x16x32_bf16 v[0:3], v[196:199], a[144:147], v[0:3]
ds_read_b64_tr_b16 v[192:193], v240 offset:62976
ds_read_b64_tr_b16 v[194:195], v240 offset:63232
v_mfma_f32_16x16x32_bf16 a[192:195], v[196:199], a[148:151], a[192:195]
buffer_load_dwordx4 a[56:59], v237, s[28:31], s52 offen offset:2048 sc1
v_lshrrev_b32 v243, 9, v237
v_mfma_f32_16x16x32_bf16 a[196:199], v[196:199], a[152:155], a[196:199]
s_waitcnt vmcnt(32)
s_barrier
v_mfma_f32_16x16x32_bf16 a[200:203], v[196:199], a[156:159], a[200:203]
s_waitcnt lgkmcnt(6)
v_lshrrev_b32 v96, 1, v237
v_lshl_add_u32 v243, v243, 30, v96
v_mfma_f32_16x16x32_bf16 v[4:7], v[200:203], a[144:147], v[4:7]
s_mov_b32 s6, 0xffff0000
ds_read_b64_tr_b16 v[196:197], v239 offset:63488
ds_read_b64_tr_b16 v[198:199], v239 offset:63744
v_mfma_f32_16x16x32_bf16 a[204:207], v[200:203], a[148:151], a[204:207]
buffer_load_dwordx4 a[60:63], v237, s[28:31], s52 offen offset:3072 sc1
v_lshlrev_b32 v116, 16, v248
v_mfma_f32_16x16x32_bf16 a[208:211], v[200:203], a[152:155], a[208:211]
v_and_b32 v117, s6, v248
v_mfma_f32_16x16x32_bf16 a[212:215], v[200:203], a[156:159], a[212:215]
s_waitcnt lgkmcnt(6)
v_mfma_f32_16x16x32_bf16 v[8:11], v[204:207], a[144:147], v[8:11]
ds_read_b64_tr_b16 v[200:201], v239 offset:64512
ds_read_b64_tr_b16 v[202:203], v239 offset:64768
v_mfma_f32_16x16x32_bf16 a[216:219], v[204:207], a[148:151], a[216:219]
v_lshlrev_b32 v118, 16, v249
v_and_b32 v119, s6, v249
v_mfma_f32_16x16x32_bf16 a[220:223], v[204:207], a[152:155], a[220:223]
v_mfma_f32_16x16x32_bf16 a[224:227], v[204:207], a[156:159], a[224:227]
s_waitcnt lgkmcnt(6)
v_mfma_f32_16x16x32_bf16 v[12:15], v[208:211], a[144:147], v[12:15]
s_add_u32 s52, s79, 135168
ds_read_b64_tr_b16 v[204:205], v239 offset:0
ds_read_b64_tr_b16 v[206:207], v239 offset:256
v_mfma_f32_16x16x32_bf16 a[228:231], v[208:211], a[148:151], a[228:231]
buffer_load_dwordx4 a[64:67], v237, s[28:31], s52 offen offset:0 sc1
v_lshlrev_b32 v120, 16, v250
v_mfma_f32_16x16x32_bf16 a[232:235], v[208:211], a[152:155], a[232:235]
v_and_b32 v121, s6, v250
v_mfma_f32_16x16x32_bf16 a[236:239], v[208:211], a[156:159], a[236:239]
s_waitcnt lgkmcnt(6)
v_mfma_f32_16x16x32_bf16 v[16:19], v[192:195], a[144:147], v[16:19]
ds_read_b64_tr_b16 v[208:209], v239 offset:1024
ds_read_b64_tr_b16 v[210:211], v239 offset:1280
v_mfma_f32_16x16x32_bf16 a[240:243], v[192:195], a[148:151], a[240:243]
buffer_load_dwordx4 a[68:71], v237, s[28:31], s52 offen offset:1024 sc1
v_lshlrev_b32 v122, 16, v251
v_mfma_f32_16x16x32_bf16 a[244:247], v[192:195], a[152:155], a[244:247]
v_and_b32 v123, s6, v251
v_mfma_f32_16x16x32_bf16 a[248:251], v[192:195], a[156:159], a[248:251]
s_waitcnt vmcnt(31) lgkmcnt(6)
v_mfma_f32_16x16x32_bf16 v[0:3], v[196:199], a[160:163], v[0:3]
ds_read_b64_tr_b16 v[192:193], v240 offset:2048
ds_read_b64_tr_b16 v[194:195], v240 offset:2304
v_mfma_f32_16x16x32_bf16 a[192:195], v[196:199], a[164:167], a[192:195]
buffer_load_dwordx4 a[72:75], v237, s[28:31], s52 offen offset:2048 sc1
v_lshlrev_b32 v124, 16, v252
v_mfma_f32_16x16x32_bf16 a[196:199], v[196:199], a[168:171], a[196:199]
v_and_b32 v125, s6, v252
v_lshlrev_b32 v126, 16, v253
v_mfma_f32_16x16x32_bf16 a[200:203], v[196:199], a[172:175], a[200:203]
s_waitcnt lgkmcnt(6)
v_mfma_f32_16x16x32_bf16 v[4:7], v[200:203], a[160:163], v[4:7]
ds_read_b64_tr_b16 v[196:197], v239 offset:2560
ds_read_b64_tr_b16 v[198:199], v239 offset:2816
v_mfma_f32_16x16x32_bf16 a[204:207], v[200:203], a[164:167], a[204:207]
buffer_load_dwordx4 a[76:79], v237, s[28:31], s52 offen offset:3072 sc1
v_and_b32 v127, s6, v253
v_mfma_f32_16x16x32_bf16 a[208:211], v[200:203], a[168:171], a[208:211]
v_lshlrev_b32 v128, 16, v254
v_mfma_f32_16x16x32_bf16 a[212:215], v[200:203], a[172:175], a[212:215]
s_waitcnt lgkmcnt(6)
v_mfma_f32_16x16x32_bf16 v[8:11], v[204:207], a[160:163], v[8:11]
s_add_u32 s52, s79, 143360
ds_read_b64_tr_b16 v[200:201], v239 offset:3584
ds_read_b64_tr_b16 v[202:203], v239 offset:3840
v_mfma_f32_16x16x32_bf16 a[216:219], v[204:207], a[164:167], a[216:219]
buffer_load_dwordx4 a[80:83], v237, s[28:31], s52 offen offset:0 sc1
v_and_b32 v129, s6, v254
v_mfma_f32_16x16x32_bf16 a[220:223], v[204:207], a[168:171], a[220:223]
v_lshlrev_b32 v130, 16, v255
v_mfma_f32_16x16x32_bf16 a[224:227], v[204:207], a[172:175], a[224:227]
s_waitcnt lgkmcnt(6)
v_mfma_f32_16x16x32_bf16 v[12:15], v[208:211], a[160:163], v[12:15]
ds_read_b64_tr_b16 v[204:205], v239 offset:4608
ds_read_b64_tr_b16 v[206:207], v239 offset:4864
v_mfma_f32_16x16x32_bf16 a[228:231], v[208:211], a[164:167], a[228:231]
buffer_load_dwordx4 a[84:87], v237, s[28:31], s52 offen offset:1024 sc1
v_and_b32 v131, s6, v255
v_mfma_f32_16x16x32_bf16 a[232:235], v[208:211], a[168:171], a[232:235]
v_lshlrev_b32 v132, 16, v244
v_mfma_f32_16x16x32_bf16 a[236:239], v[208:211], a[172:175], a[236:239]
s_waitcnt lgkmcnt(6)
v_mfma_f32_16x16x32_bf16 v[16:19], v[192:195], a[160:163], v[16:19]
ds_read_b64_tr_b16 v[208:209], v239 offset:5632
ds_read_b64_tr_b16 v[210:211], v239 offset:5888
v_mfma_f32_16x16x32_bf16 a[240:243], v[192:195], a[164:167], a[240:243]
buffer_load_dwordx4 a[88:91], v237, s[28:31], s52 offen offset:2048 sc1
v_and_b32 v133, s6, v244
v_mfma_f32_16x16x32_bf16 a[244:247], v[192:195], a[168:171], a[244:247]
v_lshlrev_b32 v134, 16, v245
v_and_b32 v135, s6, v245
v_mfma_f32_16x16x32_bf16 a[248:251], v[192:195], a[172:175], a[248:251]
s_waitcnt vmcnt(30) lgkmcnt(6)
v_mfma_f32_16x16x32_bf16 v[0:3], v[196:199], a[176:179], v[0:3]
ds_read_b64_tr_b16 v[192:193], v240 offset:6656
ds_read_b64_tr_b16 v[194:195], v240 offset:6912
v_mfma_f32_16x16x32_bf16 a[192:195], v[196:199], a[180:183], a[192:195]
buffer_load_dwordx4 a[92:95], v237, s[28:31], s52 offen offset:3072 sc1
v_mov_b32 v136, 0
v_mfma_f32_16x16x32_bf16 a[196:199], v[196:199], a[184:187], a[196:199]
v_mov_b32 v137, 0
v_mfma_f32_16x16x32_bf16 a[200:203], v[196:199], a[188:191], a[200:203]
s_waitcnt lgkmcnt(6)
v_mfma_f32_16x16x32_bf16 v[4:7], v[200:203], a[176:179], v[4:7]
s_add_u32 m0, s49, 86016
ds_read_b64_tr_b16 v[196:197], v239 offset:7168
ds_read_b64_tr_b16 v[198:199], v239 offset:7424
v_mfma_f32_16x16x32_bf16 a[204:207], v[200:203], a[180:183], a[204:207]
s_add_u32 s50, s82, 36864
buffer_load_dwordx4 v237, s[28:31], s50 offen sc1 lds
v_mov_b32 v140, 0
v_mfma_f32_16x16x32_bf16 a[208:211], v[200:203], a[184:187], a[208:211]
v_mov_b32 v141, 0
v_mfma_f32_16x16x32_bf16 a[212:215], v[200:203], a[188:191], a[212:215]
s_waitcnt lgkmcnt(6)
v_mfma_f32_16x16x32_bf16 v[8:11], v[204:207], a[176:179], v[8:11]
s_add_u32 m0, s49, 90112
ds_read_b64_tr_b16 v[200:201], v239 offset:8192
ds_read_b64_tr_b16 v[202:203], v239 offset:8448
v_mfma_f32_16x16x32_bf16 a[216:219], v[204:207], a[180:183], a[216:219]
s_add_u32 s50, s82, 40960
buffer_load_dwordx4 v237, s[28:31], s50 offen sc1 lds
v_mov_b32 v62, 0
v_mfma_f32_16x16x32_bf16 a[220:223], v[204:207], a[184:187], a[220:223]
v_mov_b32 v63, 0
v_mfma_f32_16x16x32_bf16 a[224:227], v[204:207], a[188:191], a[224:227]
s_waitcnt lgkmcnt(6)
v_mfma_f32_16x16x32_bf16 v[12:15], v[208:211], a[176:179], v[12:15]
s_add_u32 m0, s49, 94208
ds_read_b64_tr_b16 v[204:205], v239 offset:9216
ds_read_b64_tr_b16 v[206:207], v239 offset:9472
v_mfma_f32_16x16x32_bf16 a[228:231], v[208:211], a[180:183], a[228:231]
s_add_u32 s50, s82, 45056
buffer_load_dwordx4 v237, s[28:31], s50 offen sc1 lds
v_mov_b32 v74, 0
v_mfma_f32_16x16x32_bf16 a[232:235], v[208:211], a[184:187], a[232:235]
v_mov_b32 v75, 0
v_mfma_f32_16x16x32_bf16 a[236:239], v[208:211], a[188:191], a[236:239]
s_waitcnt lgkmcnt(6)
v_mfma_f32_16x16x32_bf16 v[16:19], v[192:195], a[176:179], v[16:19]
s_add_u32 m0, s49, 0
ds_read_b64_tr_b16 v[208:209], v239 offset:10240
ds_read_b64_tr_b16 v[210:211], v239 offset:10496
v_mfma_f32_16x16x32_bf16 a[240:243], v[192:195], a[180:183], a[240:243]
s_add_u32 s50, s82, 49152
buffer_load_dwordx4 v237, s[28:31], s50 offen sc1 lds
v_mov_b32 v86, 0
v_mfma_f32_16x16x32_bf16 a[244:247], v[192:195], a[184:187], a[244:247]
v_mov_b32 v87, 0
v_bfe_u32 v96, v237, 6, 2
v_mfma_f32_16x16x32_bf16 a[248:251], v[192:195], a[188:191], a[248:251]
s_waitcnt vmcnt(31) lgkmcnt(6)
v_mfma_f32_16x16x32_bf16 v[0:3], v[196:199], a[0:3], v[0:3]
s_add_u32 m0, s49, 4096
ds_read_b64_tr_b16 v[192:193], v240 offset:11264
ds_read_b64_tr_b16 v[194:195], v240 offset:11520
v_mfma_f32_16x16x32_bf16 a[192:195], v[196:199], a[4:7], a[192:195]
s_add_u32 s50, s82, 53248
buffer_load_dwordx4 v237, s[28:31], s50 offen sc1 lds
v_lshrrev_b32 v97, 8, v237
v_mfma_f32_16x16x32_bf16 a[196:199], v[196:199], a[8:11], a[196:199]
v_bfe_u32 v98, v237, 5, 1
v_mfma_f32_16x16x32_bf16 a[200:203], v[196:199], a[12:15], a[200:203]
s_waitcnt lgkmcnt(6)
v_mfma_f32_16x16x32_bf16 v[4:7], v[200:203], a[0:3], v[4:7]
s_add_u32 m0, s49, 8192
ds_read_b64_tr_b16 v[196:197], v239 offset:11776
ds_read_b64_tr_b16 v[198:199], v239 offset:12032
v_mfma_f32_16x16x32_bf16 a[204:207], v[200:203], a[4:7], a[204:207]
s_add_u32 s50, s82, 57344
buffer_load_dwordx4 v237, s[28:31], s50 offen sc1 lds
v_lshl_add_u32 v96, v96, 1, v98
v_mfma_f32_16x16x32_bf16 a[208:211], v[200:203], a[8:11], a[208:211]
v_lshlrev_b32 v97, 1, v97
v_mfma_f32_16x16x32_bf16 a[212:215], v[200:203], a[12:15], a[212:215]
s_waitcnt lgkmcnt(6)
v_mfma_f32_16x16x32_bf16 v[8:11], v[204:207], a[0:3], v[8:11]
s_add_u32 m0, s49, 12288
ds_read_b64_tr_b16 v[200:201], v239 offset:12800
ds_read_b64_tr_b16 v[202:203], v239 offset:13056
v_mfma_f32_16x16x32_bf16 a[216:219], v[204:207], a[4:7], a[216:219]
s_add_u32 s50, s82, 61440
buffer_load_dwordx4 v237, s[28:31], s50 offen sc1 lds
v_and_b32 v98, 16, v237
v_mfma_f32_16x16x32_bf16 a[220:223], v[204:207], a[8:11], a[220:223]
v_mov_b32 v99, 0x3f80
v_mfma_f32_16x16x32_bf16 a[224:227], v[204:207], a[12:15], a[224:227]
s_waitcnt lgkmcnt(6)
v_mfma_f32_16x16x32_bf16 v[12:15], v[208:211], a[0:3], v[12:15]
s_add_u32 m0, s49, 16384
ds_read_b64_tr_b16 v[204:205], v239 offset:13824
ds_read_b64_tr_b16 v[206:207], v239 offset:14080
v_mfma_f32_16x16x32_bf16 a[228:231], v[208:211], a[4:7], a[228:231]
s_add_u32 s50, s82, 65536
buffer_load_dwordx4 v237, s[28:31], s50 offen sc1 lds
v_lshlrev_b32 v98, v98, v99
v_mfma_f32_16x16x32_bf16 a[232:235], v[208:211], a[8:11], a[232:235]
v_cmp_eq_u32 s[4:5], v96, v97
v_add_u32 v97, 1, v97
v_mfma_f32_16x16x32_bf16 a[236:239], v[208:211], a[12:15], a[236:239]
s_waitcnt lgkmcnt(6)
v_mfma_f32_16x16x32_bf16 v[16:19], v[192:195], a[0:3], v[16:19]
s_nop 0
ds_read_b64_tr_b16 v[208:209], v239 offset:14848
ds_read_b64_tr_b16 v[210:211], v239 offset:15104
v_mfma_f32_16x16x32_bf16 a[240:243], v[192:195], a[4:7], a[240:243]
v_cndmask_b32 v138, 0, v98, s[4:5]
v_cmp_eq_u32 s[4:5], v96, v97
v_mfma_f32_16x16x32_bf16 a[244:247], v[192:195], a[8:11], a[244:247]
v_mfma_f32_16x16x32_bf16 a[248:251], v[192:195], a[12:15], a[248:251]
s_waitcnt vmcnt(30) lgkmcnt(6)
v_mfma_f32_16x16x32_bf16 v[0:3], v[196:199], a[16:19], v[0:3]
s_nop 1
ds_read_b64_tr_b16 v[192:193], v240 offset:15872
ds_read_b64_tr_b16 v[194:195], v240 offset:16128
v_mfma_f32_16x16x32_bf16 a[192:195], v[196:199], a[20:23], a[192:195]
s_add_u32 m0, s49, 20480
v_cndmask_b32 v139, 0, v98, s[4:5]
v_mfma_f32_16x16x32_bf16 a[196:199], v[196:199], a[24:27], a[196:199]
s_waitcnt vmcnt(25)
s_barrier
v_mfma_f32_16x16x32_bf16 a[200:203], v[196:199], a[28:31], a[200:203]
s_waitcnt lgkmcnt(6)
v_mfma_f32_16x16x32_bf16 v[4:7], v[200:203], a[16:19], v[4:7]
s_add_u32 s50, s82, 69632
ds_read_b64_tr_b16 v[196:197], v240 offset:20480
ds_read_b64_tr_b16 v[198:199], v240 offset:20736
v_mfma_f32_16x16x32_bf16 a[204:207], v[200:203], a[20:23], a[204:207]
buffer_load_dwordx4 v237, s[28:31], s50 offen sc1 lds
v_mfma_f32_16x16x32_bf16 a[208:211], v[200:203], a[24:27], a[208:211]
s_add_u32 m0, s49, 24576
v_mfma_f32_16x16x32_bf16 a[212:215], v[200:203], a[28:31], a[212:215]
s_waitcnt lgkmcnt(6)
v_mfma_f32_16x16x32_bf16 v[8:11], v[204:207], a[16:19], v[8:11]
s_add_u32 s50, s82, 73728
ds_read_b64_tr_b16 v[200:201], v240 offset:25088
ds_read_b64_tr_b16 v[202:203], v240 offset:25344
v_mfma_f32_16x16x32_bf16 a[216:219], v[204:207], a[20:23], a[216:219]
buffer_load_dwordx4 v237, s[28:31], s50 offen sc1 lds
v_mfma_f32_16x16x32_bf16 a[220:223], v[204:207], a[24:27], a[220:223]
s_add_u32 m0, s49, 28672
v_mfma_f32_16x16x32_bf16 a[224:227], v[204:207], a[28:31], a[224:227]
s_waitcnt lgkmcnt(6)
v_mfma_f32_16x16x32_bf16 v[12:15], v[208:211], a[16:19], v[12:15]
s_add_u32 s50, s82, 77824
ds_read_b64_tr_b16 v[204:205], v240 offset:29696
ds_read_b64_tr_b16 v[206:207], v240 offset:29952
v_mfma_f32_16x16x32_bf16 a[228:231], v[208:211], a[20:23], a[228:231]
buffer_load_dwordx4 v237, s[28:31], s50 offen sc1 lds
v_mfma_f32_16x16x32_bf16 a[232:235], v[208:211], a[24:27], a[232:235]
s_add_u32 m0, s49, 32768
v_mfma_f32_16x16x32_bf16 a[236:239], v[208:211], a[28:31], a[236:239]
s_waitcnt lgkmcnt(6)
v_mfma_f32_16x16x32_bf16 v[16:19], v[192:195], a[16:19], v[16:19]
s_add_u32 s50, s82, 81920
ds_read_b64_tr_b16 v[208:209], v240 offset:34304
ds_read_b64_tr_b16 v[210:211], v240 offset:34560
v_mfma_f32_16x16x32_bf16 a[240:243], v[192:195], a[20:23], a[240:243]
buffer_load_dwordx4 v237, s[28:31], s50 offen sc1 lds
v_mfma_f32_16x16x32_bf16 a[244:247], v[192:195], a[24:27], a[244:247]
v_mfma_f32_16x16x32_bf16 a[248:251], v[192:195], a[28:31], a[248:251]
s_waitcnt vmcnt(24) lgkmcnt(6)
v_mfma_f32_16x16x32_bf16 a[240:243], v[196:199], a[36:39], a[240:243]
ds_read_b64_tr_b16 v[192:193], v239 offset:16384
ds_read_b64_tr_b16 v[194:195], v239 offset:16640
v_mfma_f32_16x16x32_bf16 a[244:247], v[196:199], a[40:43], a[244:247]
v_mfma_f32_16x16x32_bf16 a[248:251], v[196:199], a[44:47], a[248:251]
s_waitcnt vmcnt(20) lgkmcnt(6)
v_mfma_f32_16x16x32_bf16 a[240:243], v[200:203], a[52:55], a[240:243]
ds_read_b64_tr_b16 v[196:197], v239 offset:20992
ds_read_b64_tr_b16 v[198:199], v239 offset:21248
v_mfma_f32_16x16x32_bf16 a[244:247], v[200:203], a[56:59], a[244:247]
v_mfma_f32_16x16x32_bf16 a[248:251], v[200:203], a[60:63], a[248:251]
s_waitcnt vmcnt(16) lgkmcnt(6)
v_mfma_f32_16x16x32_bf16 a[240:243], v[204:207], a[68:71], a[240:243]
ds_read_b64_tr_b16 v[200:201], v239 offset:25600
ds_read_b64_tr_b16 v[202:203], v239 offset:25856
v_mfma_f32_16x16x32_bf16 a[244:247], v[204:207], a[72:75], a[244:247]
v_mfma_f32_16x16x32_bf16 a[248:251], v[204:207], a[76:79], a[248:251]
s_waitcnt vmcnt(12) lgkmcnt(6)
v_mfma_f32_16x16x32_bf16 a[240:243], v[208:211], a[84:87], a[240:243]
ds_read_b64_tr_b16 v[204:205], v239 offset:30208
ds_read_b64_tr_b16 v[206:207], v239 offset:30464
v_mfma_f32_16x16x32_bf16 a[244:247], v[208:211], a[88:91], a[244:247]
v_mfma_f32_16x16x32_bf16 a[248:251], v[208:211], a[92:95], a[248:251]
s_waitcnt lgkmcnt(6)
v_mfma_f32_16x16x32_bf16 a[192:195], v[192:195], a[36:39], a[192:195]
ds_read_b64_tr_b16 v[208:209], v239 offset:17408
ds_read_b64_tr_b16 v[210:211], v239 offset:17664
v_mfma_f32_16x16x32_bf16 a[196:199], v[192:195], a[40:43], a[196:199]
v_mfma_f32_16x16x32_bf16 a[200:203], v[192:195], a[44:47], a[200:203]
s_waitcnt lgkmcnt(6)
v_mfma_f32_16x16x32_bf16 a[192:195], v[196:199], a[52:55], a[192:195]
ds_read_b64_tr_b16 v[192:193], v239 offset:22016
ds_read_b64_tr_b16 v[194:195], v239 offset:22272
v_mfma_f32_16x16x32_bf16 a[196:199], v[196:199], a[56:59], a[196:199]
v_accvgpr_read_b32 v92, a240
v_accvgpr_read_b32 v93, a241
v_mfma_f32_16x16x32_bf16 a[200:203], v[196:199], a[60:63], a[200:203]
s_waitcnt lgkmcnt(6)
v_accvgpr_read_b32 v94, a242
v_accvgpr_read_b32 v95, a243
v_mfma_f32_16x16x32_bf16 a[192:195], v[200:203], a[68:71], a[192:195]
ds_read_b64_tr_b16 v[196:197], v239 offset:26624
ds_read_b64_tr_b16 v[198:199], v239 offset:26880
v_mfma_f32_16x16x32_bf16 a[196:199], v[200:203], a[72:75], a[196:199]
v_cvt_pk_bf16_f32 v60, v92, v93
v_cvt_pk_bf16_f32 v61, v94, v95
v_mfma_f32_16x16x32_bf16 a[200:203], v[200:203], a[76:79], a[200:203]
s_waitcnt lgkmcnt(6)
buffer_store_dwordx2 v[60:61], v243, s[28:31], s8 offen offset:2048 sc1
v_accvgpr_read_b32 v88, a244
v_mfma_f32_16x16x32_bf16 a[192:195], v[204:207], a[84:87], a[192:195]
ds_read_b64_tr_b16 v[200:201], v239 offset:31232
ds_read_b64_tr_b16 v[202:203], v239 offset:31488
v_mfma_f32_16x16x32_bf16 a[196:199], v[204:207], a[88:91], a[196:199]
v_accvgpr_read_b32 v89, a245
v_accvgpr_read_b32 v90, a246
v_mfma_f32_16x16x32_bf16 a[200:203], v[204:207], a[92:95], a[200:203]
s_waitcnt lgkmcnt(6)
v_accvgpr_read_b32 v91, a247
v_cvt_pk_bf16_f32 v72, v88, v89
v_mfma_f32_16x16x32_bf16 a[204:207], v[208:211], a[36:39], a[204:207]
ds_read_b64_tr_b16 v[204:205], v239 offset:18432
ds_read_b64_tr_b16 v[206:207], v239 offset:18688
v_mfma_f32_16x16x32_bf16 a[208:211], v[208:211], a[40:43], a[208:211]
v_cvt_pk_bf16_f32 v73, v90, v91
v_mfma_f32_16x16x32_bf16 a[212:215], v[208:211], a[44:47], a[212:215]
s_waitcnt lgkmcnt(6)
buffer_store_dwordx2 v[72:73], v243, s[28:31], s9 offen offset:2048 sc1
v_accvgpr_read_b32 v92, a248
v_mfma_f32_16x16x32_bf16 a[204:207], v[192:195], a[52:55], a[204:207]
ds_read_b64_tr_b16 v[208:209], v239 offset:23040
ds_read_b64_tr_b16 v[210:211], v239 offset:23296
v_mfma_f32_16x16x32_bf16 a[208:211], v[192:195], a[56:59], a[208:211]
v_accvgpr_read_b32 v93, a249
v_accvgpr_read_b32 v94, a250
v_mfma_f32_16x16x32_bf16 a[212:215], v[192:195], a[60:63], a[212:215]
s_waitcnt lgkmcnt(6)
v_accvgpr_read_b32 v95, a251
v_cvt_pk_bf16_f32 v84, v92, v93
v_mfma_f32_16x16x32_bf16 a[204:207], v[196:199], a[68:71], a[204:207]
ds_read_b64_tr_b16 v[192:193], v239 offset:27648
ds_read_b64_tr_b16 v[194:195], v239 offset:27904
v_mfma_f32_16x16x32_bf16 a[208:211], v[196:199], a[72:75], a[208:211]
buffer_load_dword v246, v228, s[28:31], 0 offen sc1
v_cvt_pk_bf16_f32 v85, v94, v95
v_mfma_f32_16x16x32_bf16 a[212:215], v[196:199], a[76:79], a[212:215]
s_waitcnt lgkmcnt(6)
buffer_store_dwordx2 v[84:85], v243, s[28:31], s10 offen offset:2048 sc1
v_accvgpr_read_b32 v92, a192
v_mfma_f32_16x16x32_bf16 a[204:207], v[200:203], a[84:87], a[204:207]
ds_read_b64_tr_b16 v[196:197], v239 offset:32256
ds_read_b64_tr_b16 v[198:199], v239 offset:32512
v_mfma_f32_16x16x32_bf16 a[208:211], v[200:203], a[88:91], a[208:211]
v_accvgpr_read_b32 v93, a193
v_accvgpr_read_b32 v94, a194
v_mfma_f32_16x16x32_bf16 a[212:215], v[200:203], a[92:95], a[212:215]
s_waitcnt lgkmcnt(6)
v_accvgpr_read_b32 v95, a195
v_cvt_pk_bf16_f32 v52, v92, v93
v_mfma_f32_16x16x32_bf16 a[216:219], v[204:207], a[36:39], a[216:219]
ds_read_b64_tr_b16 v[200:201], v239 offset:19456
ds_read_b64_tr_b16 v[202:203], v239 offset:19712
v_mfma_f32_16x16x32_bf16 a[220:223], v[204:207], a[40:43], a[220:223]
v_cvt_pk_bf16_f32 v53, v94, v95
v_accvgpr_read_b32 v88, a196
v_mfma_f32_16x16x32_bf16 a[224:227], v[204:207], a[44:47], a[224:227]
s_waitcnt lgkmcnt(6)
v_accvgpr_read_b32 v89, a197
v_accvgpr_read_b32 v90, a198
v_mfma_f32_16x16x32_bf16 a[216:219], v[208:211], a[52:55], a[216:219]
ds_read_b64_tr_b16 v[204:205], v239 offset:24064
ds_read_b64_tr_b16 v[206:207], v239 offset:24320
v_mfma_f32_16x16x32_bf16 a[220:223], v[208:211], a[56:59], a[220:223]
v_accvgpr_read_b32 v91, a199
v_cvt_pk_bf16_f32 v64, v88, v89
v_mfma_f32_16x16x32_bf16 a[224:227], v[208:211], a[60:63], a[224:227]
s_waitcnt lgkmcnt(6)
v_cvt_pk_bf16_f32 v65, v90, v91
v_accvgpr_read_b32 v92, a200
v_mfma_f32_16x16x32_bf16 a[216:219], v[192:195], a[68:71], a[216:219]
ds_read_b64_tr_b16 v[208:209], v239 offset:28672
ds_read_b64_tr_b16 v[210:211], v239 offset:28928
v_mfma_f32_16x16x32_bf16 a[220:223], v[192:195], a[72:75], a[220:223]
v_accvgpr_read_b32 v93, a201
v_accvgpr_read_b32 v94, a202
v_mfma_f32_16x16x32_bf16 a[224:227], v[192:195], a[76:79], a[224:227]
s_waitcnt lgkmcnt(6)
v_accvgpr_read_b32 v95, a203
v_cvt_pk_bf16_f32 v76, v92, v93
v_mfma_f32_16x16x32_bf16 a[216:219], v[196:199], a[84:87], a[216:219]
ds_read_b64_tr_b16 v[192:193], v239 offset:33280
ds_read_b64_tr_b16 v[194:195], v239 offset:33536
v_mfma_f32_16x16x32_bf16 a[220:223], v[196:199], a[88:91], a[220:223]
v_cvt_pk_bf16_f32 v77, v94, v95
v_accvgpr_read_b32 v92, a204
v_mfma_f32_16x16x32_bf16 a[224:227], v[196:199], a[92:95], a[224:227]
s_waitcnt lgkmcnt(6)
v_accvgpr_read_b32 v93, a205
v_accvgpr_read_b32 v94, a206
v_mfma_f32_16x16x32_bf16 a[228:231], v[200:203], a[36:39], a[228:231]
v_accvgpr_read_b32 v95, a207
v_cvt_pk_bf16_f32 v54, v92, v93
v_mfma_f32_16x16x32_bf16 a[232:235], v[200:203], a[40:43], a[232:235]
v_cvt_pk_bf16_f32 v55, v94, v95
v_accvgpr_read_b32 v88, a208
v_mfma_f32_16x16x32_bf16 a[236:239], v[200:203], a[44:47], a[236:239]
s_waitcnt lgkmcnt(4)
v_accvgpr_read_b32 v89, a209
v_accvgpr_read_b32 v90, a210
v_mfma_f32_16x16x32_bf16 a[228:231], v[204:207], a[52:55], a[228:231]
TCH_11_v0:
s_cbranch_execz TCH_back
v_accvgpr_read_b32 v91, a211
v_cvt_pk_bf16_f32 v66, v88, v89
v_mfma_f32_16x16x32_bf16 a[232:235], v[204:207], a[56:59], a[232:235]
v_cvt_pk_bf16_f32 v67, v90, v91
v_permlane16_swap_b32 v52, v54
v_mfma_f32_16x16x32_bf16 a[236:239], v[204:207], a[60:63], a[236:239]
s_waitcnt lgkmcnt(2)
v_permlane16_swap_b32 v53, v55
v_mfma_f32_16x16x32_bf16 a[228:231], v[208:211], a[68:71], a[228:231]
buffer_store_dwordx4 v[52:55], v237, s[28:31], s8 offen offset:0 sc1
v_accvgpr_read_b32 v92, a212
v_mfma_f32_16x16x32_bf16 a[232:235], v[208:211], a[72:75], a[232:235]
v_accvgpr_read_b32 v93, a213
v_accvgpr_read_b32 v94, a214
v_mfma_f32_16x16x32_bf16 a[236:239], v[208:211], a[76:79], a[236:239]
s_waitcnt lgkmcnt(0)
v_accvgpr_read_b32 v95, a215
v_cvt_pk_bf16_f32 v78, v92, v93
v_mfma_f32_16x16x32_bf16 a[228:231], v[192:195], a[84:87], a[228:231]
v_cvt_pk_bf16_f32 v79, v94, v95
v_permlane16_swap_b32 v64, v66
v_mfma_f32_16x16x32_bf16 a[232:235], v[192:195], a[88:91], a[232:235]
v_permlane16_swap_b32 v65, v67
v_mfma_f32_16x16x32_bf16 a[236:239], v[192:195], a[92:95], a[236:239]
buffer_store_dwordx4 v[64:67], v237, s[28:31], s9 offen offset:0 sc1
s_nop 1
v_permlane16_swap_b32 v76, v78
v_permlane16_swap_b32 v77, v79
buffer_store_dwordx4 v[76:79], v237, s[28:31], s10 offen offset:0 sc1
v_accvgpr_read_b32 v92, a216
v_accvgpr_read_b32 v93, a217
v_accvgpr_read_b32 v94, a218
v_accvgpr_read_b32 v95, a219
v_cvt_pk_bf16_f32 v56, v92, v93
v_cvt_pk_bf16_f32 v57, v94, v95
v_accvgpr_read_b32 v88, a220
v_accvgpr_read_b32 v89, a221
v_accvgpr_read_b32 v90, a222
v_accvgpr_read_b32 v91, a223
v_cvt_pk_bf16_f32 v68, v88, v89
v_cvt_pk_bf16_f32 v69, v90, v91
v_accvgpr_read_b32 v92, a224
v_accvgpr_read_b32 v93, a225
v_accvgpr_read_b32 v94, a226
v_accvgpr_read_b32 v95, a227
v_cvt_pk_bf16_f32 v80, v92, v93
v_cvt_pk_bf16_f32 v81, v94, v95
s_nop 7
v_accvgpr_read_b32 v92, a228
v_accvgpr_read_b32 v93, a229
v_accvgpr_read_b32 v94, a230
v_accvgpr_read_b32 v95, a231
v_cvt_pk_bf16_f32 v58, v92, v93
v_cvt_pk_bf16_f32 v59, v94, v95
v_accvgpr_read_b32 v88, a232
v_accvgpr_read_b32 v89, a233
v_accvgpr_read_b32 v90, a234
v_accvgpr_read_b32 v91, a235
v_cvt_pk_bf16_f32 v70, v88, v89
v_cvt_pk_bf16_f32 v71, v90, v91
v_permlane16_swap_b32 v56, v58
v_permlane16_swap_b32 v57, v59
buffer_store_dwordx4 v[56:59], v237, s[28:31], s8 offen offset:1024 sc1
v_accvgpr_read_b32 v92, a236
v_accvgpr_read_b32 v93, a237
v_accvgpr_read_b32 v94, a238
v_accvgpr_read_b32 v95, a239
v_cvt_pk_bf16_f32 v82, v92, v93
v_cvt_pk_bf16_f32 v83, v94, v95
v_permlane16_swap_b32 v68, v70
v_permlane16_swap_b32 v69, v71
buffer_store_dwordx4 v[68:71], v237, s[28:31], s9 offen offset:1024 sc1
s_nop 1
v_permlane16_swap_b32 v80, v82
v_permlane16_swap_b32 v81, v83
buffer_store_dwordx4 v[80:83], v237, s[28:31], s10 offen offset:1024 sc1
s_waitcnt vmcnt(7)
v_cmp_gt_u32 vcc, 1, v246
s_cbranch_vccnz spin_18_v0
ok_17_v0:
s_add_u32 s53, s61, 0
buffer_load_dwordx4 a[96:99], v237, s[28:31], s53 offen sc1
s_add_u32 s53, s61, 4096
buffer_load_dwordx4 a[100:103], v237, s[28:31], s53 offen sc1
s_add_u32 s53, s61, 8192
buffer_load_dwordx4 a[104:107], v237, s[28:31], s53 offen sc1
s_add_u32 s53, s61, 12288
buffer_load_dwordx4 a[108:111], v237, s[28:31], s53 offen sc1
s_add_u32 s53, s61, 16384
buffer_load_dwordx4 a[112:115], v237, s[28:31], s53 offen sc1
s_add_u32 s53, s61, 20480
buffer_load_dwordx4 a[116:119], v237, s[28:31], s53 offen sc1
ds_read_b64_tr_b16 v[160:161], v239 offset:16384
ds_read_b64_tr_b16 v[162:163], v239 offset:16640
ds_read_b64_tr_b16 v[164:165], v239 offset:17408
ds_read_b64_tr_b16 v[166:167], v239 offset:17664
ds_read_b64_tr_b16 v[168:169], v239 offset:18432
ds_read_b64_tr_b16 v[170:171], v239 offset:18688
ds_read_b64_tr_b16 v[172:173], v239 offset:19456
ds_read_b64_tr_b16 v[174:175], v239 offset:19712
ds_read_b64_tr_b16 v[176:177], v240 offset:20480
ds_read_b64_tr_b16 v[178:179], v240 offset:20736
ds_read_b64_tr_b16 v[180:181], v239 offset:20992
ds_read_b64_tr_b16 v[182:183], v239 offset:21248
ds_read_b64_tr_b16 v[184:185], v239 offset:22016
ds_read_b64_tr_b16 v[186:187], v239 offset:22272
s_waitcnt lgkmcnt(12)
v_mfma_f32_16x16x32_bf16 v[0:3], v[160:163], a[32:35], v[0:3]
s_waitcnt lgkmcnt(10)
ds_read_b64_tr_b16 v[188:189], v239 offset:23040
ds_read_b64_tr_b16 v[190:191], v239 offset:23296
v_mfma_f32_16x16x32_bf16 v[4:7], v[164:167], a[32:35], v[4:7]
s_waitcnt lgkmcnt(10)
ds_read_b64_tr_b16 v[160:161], v239 offset:24064
ds_read_b64_tr_b16 v[162:163], v239 offset:24320
v_mfma_f32_16x16x32_bf16 v[8:11], v[168:171], a[32:35], v[8:11]
s_waitcnt lgkmcnt(10)
ds_read_b64_tr_b16 v[164:165], v240 offset:25088
ds_read_b64_tr_b16 v[166:167], v240 offset:25344
v_mfma_f32_16x16x32_bf16 v[12:15], v[172:175], a[32:35], v[12:15]
s_waitcnt lgkmcnt(10)
ds_read_b64_tr_b16 v[168:169], v239 offset:25600
ds_read_b64_tr_b16 v[170:171], v239 offset:25856
v_mfma_f32_16x16x32_bf16 v[16:19], v[176:179], a[32:35], v[16:19]
s_waitcnt lgkmcnt(10)
ds_read_b64_tr_b16 v[172:173], v239 offset:26624
ds_read_b64_tr_b16 v[174:175], v239 offset:26880
v_mfma_f32_16x16x32_bf16 v[0:3], v[180:183], a[48:51], v[0:3]
s_waitcnt lgkmcnt(10)
ds_read_b64_tr_b16 v[176:177], v239 offset:27648
ds_read_b64_tr_b16 v[178:179], v239 offset:27904
v_mfma_f32_16x16x32_bf16 v[4:7], v[184:187], a[48:51], v[4:7]
s_waitcnt lgkmcnt(10)
ds_read_b64_tr_b16 v[180:181], v239 offset:28672
ds_read_b64_tr_b16 v[182:183], v239 offset:28928
v_mfma_f32_16x16x32_bf16 v[8:11], v[188:191], a[48:51], v[8:11]
s_waitcnt lgkmcnt(10)
ds_read_b64_tr_b16 v[184:185], v240 offset:29696
ds_read_b64_tr_b16 v[186:187], v240 offset:29952
v_mfma_f32_16x16x32_bf16 v[12:15], v[160:163], a[48:51], v[12:15]
s_waitcnt lgkmcnt(10)
ds_read_b64_tr_b16 v[188:189], v239 offset:30208
ds_read_b64_tr_b16 v[190:191], v239 offset:30464
v_mfma_f32_16x16x32_bf16 v[16:19], v[164:167], a[48:51], v[16:19]
s_waitcnt lgkmcnt(10)
ds_read_b64_tr_b16 v[160:161], v239 offset:31232
ds_read_b64_tr_b16 v[162:163], v239 offset:31488
v_mfma_f32_16x16x32_bf16 v[0:3], v[168:171], a[64:67], v[0:3]
s_waitcnt lgkmcnt(10)
ds_read_b64_tr_b16 v[164:165], v239 offset:32256
ds_read_b64_tr_b16 v[166:167], v239 offset:32512
v_mfma_f32_16x16x32_bf16 v[4:7], v[172:175], a[64:67], v[4:7]
s_waitcnt lgkmcnt(10)
ds_read_b64_tr_b16 v[168:169], v239 offset:33280
ds_read_b64_tr_b16 v[170:171], v239 offset:33536
v_mfma_f32_16x16x32_bf16 v[8:11], v[176:179], a[64:67], v[8:11]
s_waitcnt lgkmcnt(10)
ds_read_b64_tr_b16 v[172:173], v240 offset:34304
ds_read_b64_tr_b16 v[174:175], v240 offset:34560
v_add_u32 v239, 4294901760, v239
s_waitcnt vmcnt(16)
s_barrier
v_mfma_f32_16x16x32_bf16 v[12:15], v[180:183], a[64:67], v[12:15]
s_waitcnt lgkmcnt(10)
ds_read_b64_tr_b16 v[176:177], v239 offset:16384
ds_read_b64_tr_b16 v[178:179], v239 offset:16640
v_mfma_f32_16x16x32_bf16 v[16:19], v[184:187], a[64:67], v[16:19]
s_waitcnt lgkmcnt(10)
ds_read_b64_tr_b16 v[180:181], v239 offset:17408
ds_read_b64_tr_b16 v[182:183], v239 offset:17664
s_waitcnt vmcnt(6)
buffer_store_dword v242, off, s[28:31], s94 sc1
v_mfma_f32_16x16x32_bf16 v[0:3], v[188:191], a[80:83], v[0:3]
s_waitcnt lgkmcnt(10)
ds_read_b64_tr_b16 v[184:185], v239 offset:18432
ds_read_b64_tr_b16 v[186:187], v239 offset:18688
v_mfma_f32_16x16x32_bf16 v[4:7], v[160:163], a[80:83], v[4:7]
s_waitcnt lgkmcnt(10)
ds_read_b64_tr_b16 v[188:189], v239 offset:19456
ds_read_b64_tr_b16 v[190:191], v239 offset:19712
v_add_u32 v240, 4294901760, v240
v_mfma_f32_16x16x32_bf16 v[8:11], v[164:167], a[80:83], v[8:11]
s_waitcnt lgkmcnt(10)
ds_read_b64_tr_b16 v[160:161], v240 offset:20480
ds_read_b64_tr_b16 v[162:163], v240 offset:20736
v_mfma_f32_16x16x32_bf16 v[12:15], v[168:171], a[80:83], v[12:15]
s_waitcnt lgkmcnt(10)
ds_read_b64_tr_b16 v[164:165], v239 offset:20992
ds_read_b64_tr_b16 v[166:167], v239 offset:21248
v_mfma_f32_16x16x32_bf16 v[16:19], v[172:175], a[80:83], v[16:19]
s_waitcnt vmcnt(5) lgkmcnt(10)
ds_read_b64_tr_b16 v[168:169], v239 offset:22016
ds_read_b64_tr_b16 v[170:171], v239 offset:22272
s_add_u32 s53, s61, 24576
buffer_load_dwordx4 a[120:123], v237, s[28:31], s53 offen sc1
v_mfma_f32_16x16x32_bf16 v[32:35], v[176:179], a[96:99], 0
s_waitcnt lgkmcnt(10)
ds_read_b64_tr_b16 v[172:173], v239 offset:23040
ds_read_b64_tr_b16 v[174:175], v239 offset:23296
v_mfma_f32_16x16x32_bf16 v[36:39], v[180:183], a[96:99], 0
s_waitcnt lgkmcnt(10)
ds_read_b64_tr_b16 v[176:177], v239 offset:24064
ds_read_b64_tr_b16 v[178:179], v239 offset:24320
s_add_u32 s53, s61, 28672
buffer_load_dwordx4 a[124:127], v237, s[28:31], s53 offen sc1
v_mfma_f32_16x16x32_bf16 v[40:43], v[184:187], a[96:99], 0
s_waitcnt lgkmcnt(10)
ds_read_b64_tr_b16 v[180:181], v240 offset:25088
ds_read_b64_tr_b16 v[182:183], v240 offset:25344
v_mfma_f32_16x16x32_bf16 v[44:47], v[188:191], a[96:99], 0
s_waitcnt lgkmcnt(10)
ds_read_b64_tr_b16 v[184:185], v239 offset:25600
ds_read_b64_tr_b16 v[186:187], v239 offset:25856
s_add_u32 s53, s61, 32768
buffer_load_dwordx4 a[128:131], v237, s[28:31], s53 offen sc1
v_mfma_f32_16x16x32_bf16 v[48:51], v[160:163], a[96:99], 0
s_waitcnt lgkmcnt(10)
ds_read_b64_tr_b16 v[188:189], v239 offset:26624
ds_read_b64_tr_b16 v[190:191], v239 offset:26880
v_mfma_f32_16x16x32_bf16 v[32:35], v[164:167], a[100:103], v[32:35]
s_waitcnt lgkmcnt(10)
ds_read_b64_tr_b16 v[160:161], v239 offset:27648
ds_read_b64_tr_b16 v[162:163], v239 offset:27904
s_add_u32 s53, s61, 36864
buffer_load_dwordx4 a[132:135], v237, s[28:31], s53 offen sc1
v_mfma_f32_16x16x32_bf16 v[36:39], v[168:171], a[100:103], v[36:39]
s_waitcnt lgkmcnt(10)
ds_read_b64_tr_b16 v[164:165], v239 offset:28672
ds_read_b64_tr_b16 v[166:167], v239 offset:28928
v_mfma_f32_16x16x32_bf16 v[40:43], v[172:175], a[100:103], v[40:43]
s_waitcnt lgkmcnt(10)
ds_read_b64_tr_b16 v[168:169], v240 offset:29696
ds_read_b64_tr_b16 v[170:171], v240 offset:29952
s_add_u32 s53, s61, 40960
buffer_load_dwordx4 a[136:139], v237, s[28:31], s53 offen sc1
v_mfma_f32_16x16x32_bf16 v[44:47], v[176:179], a[100:103], v[44:47]
s_waitcnt lgkmcnt(10)
ds_read_b64_tr_b16 v[172:173], v239 offset:30208
ds_read_b64_tr_b16 v[174:175], v239 offset:30464
v_mfma_f32_16x16x32_bf16 v[48:51], v[180:183], a[100:103], v[48:51]
s_waitcnt vmcnt(8) lgkmcnt(10)
ds_read_b64_tr_b16 v[176:177], v239 offset:31232
ds_read_b64_tr_b16 v[178:179], v239 offset:31488
s_add_u32 s53, s61, 45056
buffer_load_dwordx4 a[140:143], v237, s[28:31], s53 offen sc1
v_mfma_f32_16x16x32_bf16 v[32:35], v[184:187], a[104:107], v[32:35]
s_waitcnt lgkmcnt(10)
ds_read_b64_tr_b16 v[180:181], v239 offset:32256
ds_read_b64_tr_b16 v[182:183], v239 offset:32512
v_mfma_f32_16x16x32_bf16 v[36:39], v[188:191], a[104:107], v[36:39]
s_waitcnt lgkmcnt(10)
ds_read_b64_tr_b16 v[184:185], v239 offset:33280
ds_read_b64_tr_b16 v[186:187], v239 offset:33536
s_add_u32 s53, s61, 49152
buffer_load_dwordx4 a[144:147], v237, s[28:31], s53 offen sc1
v_mfma_f32_16x16x32_bf16 v[40:43], v[160:163], a[104:107], v[40:43]
s_waitcnt lgkmcnt(10)
ds_read_b64_tr_b16 v[188:189], v240 offset:34304
ds_read_b64_tr_b16 v[190:191], v240 offset:34560
v_mfma_f32_16x16x32_bf16 v[44:47], v[164:167], a[104:107], v[44:47]
s_waitcnt lgkmcnt(10)
ds_read_b64_tr_b16 v[160:161], v239 offset:34816
ds_read_b64_tr_b16 v[162:163], v239 offset:35072
s_add_u32 s53, s61, 53248
buffer_load_dwordx4 a[148:151], v237, s[28:31], s53 offen sc1
v_mfma_f32_16x16x32_bf16 v[48:51], v[168:171], a[104:107], v[48:51]
s_waitcnt lgkmcnt(10)
ds_read_b64_tr_b16 v[164:165], v239 offset:35840
ds_read_b64_tr_b16 v[166:167], v239 offset:36096
v_mfma_f32_16x16x32_bf16 v[32:35], v[172:175], a[108:111], v[32:35]
s_waitcnt lgkmcnt(10)
ds_read_b64_tr_b16 v[168:169], v239 offset:36864
ds_read_b64_tr_b16 v[170:171], v239 offset:37120
s_add_u32 s53, s61, 57344
buffer_load_dwordx4 a[152:155], v237, s[28:31], s53 offen sc1
v_mfma_f32_16x16x32_bf16 v[36:39], v[176:179], a[108:111], v[36:39]
s_waitcnt lgkmcnt(10)
ds_read_b64_tr_b16 v[172:173], v239 offset:37888
ds_read_b64_tr_b16 v[174:175], v239 offset:38144
v_mfma_f32_16x16x32_bf16 v[40:43], v[180:183], a[108:111], v[40:43]
s_waitcnt lgkmcnt(10)
ds_read_b64_tr_b16 v[176:177], v240 offset:38912
ds_read_b64_tr_b16 v[178:179], v240 offset:39168
s_add_u32 s53, s61, 61440
buffer_load_dwordx4 a[156:159], v237, s[28:31], s53 offen sc1
v_mfma_f32_16x16x32_bf16 v[44:47], v[184:187], a[108:111], v[44:47]
s_waitcnt lgkmcnt(10)
ds_read_b64_tr_b16 v[180:181], v239 offset:39424
ds_read_b64_tr_b16 v[182:183], v239 offset:39680
v_mfma_f32_16x16x32_bf16 v[48:51], v[188:191], a[108:111], v[48:51]
s_waitcnt vmcnt(11) lgkmcnt(10)
ds_read_b64_tr_b16 v[184:185], v239 offset:40448
ds_read_b64_tr_b16 v[186:187], v239 offset:40704
s_add_u32 s53, s61, 65536
buffer_load_dwordx4 a[160:163], v237, s[28:31], s53 offen sc1
v_mfma_f32_16x16x32_bf16 v[32:35], v[160:163], a[112:115], v[32:35]
s_waitcnt lgkmcnt(10)
ds_read_b64_tr_b16 v[188:189], v239 offset:41472
ds_read_b64_tr_b16 v[190:191], v239 offset:41728
v_mfma_f32_16x16x32_bf16 v[36:39], v[164:167], a[112:115], v[36:39]
s_waitcnt lgkmcnt(10)
ds_read_b64_tr_b16 v[160:161], v239 offset:42496
ds_read_b64_tr_b16 v[162:163], v239 offset:42752
s_add_u32 s53, s61, 69632
buffer_load_dwordx4 a[164:167], v237, s[28:31], s53 offen sc1
v_mfma_f32_16x16x32_bf16 v[40:43], v[168:171], a[112:115], v[40:43]
s_waitcnt lgkmcnt(10)
ds_read_b64_tr_b16 v[164:165], v240 offset:43520
ds_read_b64_tr_b16 v[166:167], v240 offset:43776
v_mfma_f32_16x16x32_bf16 v[44:47], v[172:175], a[112:115], v[44:47]
s_waitcnt lgkmcnt(10)
ds_read_b64_tr_b16 v[168:169], v239 offset:44032
ds_read_b64_tr_b16 v[170:171], v239 offset:44288
buffer_load_dword v246, v229, s[28:31], 0 offen sc1
v_mfma_f32_16x16x32_bf16 v[48:51], v[176:179], a[112:115], v[48:51]
s_waitcnt lgkmcnt(10)
ds_read_b64_tr_b16 v[172:173], v239 offset:45056
ds_read_b64_tr_b16 v[174:175], v239 offset:45312
v_mfma_f32_16x16x32_bf16 v[32:35], v[180:183], a[116:119], v[32:35]
s_waitcnt lgkmcnt(10)
ds_read_b64_tr_b16 v[176:177], v239 offset:46080
ds_read_b64_tr_b16 v[178:179], v239 offset:46336
v_mfma_f32_16x16x32_bf16 v[36:39], v[184:187], a[116:119], v[36:39]
s_waitcnt lgkmcnt(10)
ds_read_b64_tr_b16 v[180:181], v239 offset:47104
ds_read_b64_tr_b16 v[182:183], v239 offset:47360
v_mfma_f32_16x16x32_bf16 v[40:43], v[188:191], a[116:119], v[40:43]
s_waitcnt lgkmcnt(10)
ds_read_b64_tr_b16 v[184:185], v240 offset:48128
ds_read_b64_tr_b16 v[186:187], v240 offset:48384
v_mfma_f32_16x16x32_bf16 v[44:47], v[160:163], a[116:119], v[44:47]
s_waitcnt lgkmcnt(10)
ds_read_b64_tr_b16 v[188:189], v239 offset:48640
ds_read_b64_tr_b16 v[190:191], v239 offset:48896
v_mfma_f32_16x16x32_bf16 v[48:51], v[164:167], a[116:119], v[48:51]
s_waitcnt vmcnt(11) lgkmcnt(10)
ds_read_b64_tr_b16 v[160:161], v239 offset:49664
ds_read_b64_tr_b16 v[162:163], v239 offset:49920
v_mfma_f32_16x16x32_bf16 v[32:35], v[168:171], a[120:123], v[32:35]
s_waitcnt lgkmcnt(10)
ds_read_b64_tr_b16 v[164:165], v239 offset:50688
ds_read_b64_tr_b16 v[166:167], v239 offset:50944
v_mfma_f32_16x16x32_bf16 v[36:39], v[172:175], a[120:123], v[36:39]
s_waitcnt lgkmcnt(10)
ds_read_b64_tr_b16 v[168:169], v239 offset:51712
ds_read_b64_tr_b16 v[170:171], v239 offset:51968
v_mfma_f32_16x16x32_bf16 v[40:43], v[176:179], a[120:123], v[40:43]
s_waitcnt lgkmcnt(10)
ds_read_b64_tr_b16 v[172:173], v240 offset:52736
ds_read_b64_tr_b16 v[174:175], v240 offset:52992
v_mfma_f32_16x16x32_bf16 v[44:47], v[180:183], a[120:123], v[44:47]
s_waitcnt lgkmcnt(10)
ds_read_b64_tr_b16 v[176:177], v239 offset:53248
ds_read_b64_tr_b16 v[178:179], v239 offset:53504
v_mfma_f32_16x16x32_bf16 v[48:51], v[184:187], a[120:123], v[48:51]
s_waitcnt lgkmcnt(10)
ds_read_b64_tr_b16 v[180:181], v239 offset:54272
ds_read_b64_tr_b16 v[182:183], v239 offset:54528
v_mfma_f32_16x16x32_bf16 v[32:35], v[188:191], a[124:127], v[32:35]
s_waitcnt lgkmcnt(10)
ds_read_b64_tr_b16 v[184:185], v239 offset:55296
ds_read_b64_tr_b16 v[186:187], v239 offset:55552
v_mfma_f32_16x16x32_bf16 v[36:39], v[160:163], a[124:127], v[36:39]
s_waitcnt lgkmcnt(10)
ds_read_b64_tr_b16 v[188:189], v239 offset:56320
ds_read_b64_tr_b16 v[190:191], v239 offset:56576
v_mfma_f32_16x16x32_bf16 v[40:43], v[164:167], a[124:127], v[40:43]
s_waitcnt lgkmcnt(10)
ds_read_b64_tr_b16 v[160:161], v240 offset:57344
ds_read_b64_tr_b16 v[162:163], v240 offset:57600
v_mfma_f32_16x16x32_bf16 v[44:47], v[168:171], a[124:127], v[44:47]
s_waitcnt lgkmcnt(10)
ds_read_b64_tr_b16 v[164:165], v239 offset:57856
ds_read_b64_tr_b16 v[166:167], v239 offset:58112
v_mfma_f32_16x16x32_bf16 v[48:51], v[172:175], a[124:127], v[48:51]
s_waitcnt vmcnt(9) lgkmcnt(10)
ds_read_b64_tr_b16 v[168:169], v239 offset:58880
ds_read_b64_tr_b16 v[170:171], v239 offset:59136
v_mfma_f32_16x16x32_bf16 v[32:35], v[176:179], a[128:131], v[32:35]
s_waitcnt lgkmcnt(10)
ds_read_b64_tr_b16 v[172:173], v239 offset:59904
ds_read_b64_tr_b16 v[174:175], v239 offset:60160
v_mfma_f32_16x16x32_bf16 v[36:39], v[180:183], a[128:131], v[36:39]
s_waitcnt lgkmcnt(10)
ds_read_b64_tr_b16 v[176:177], v239 offset:60928
ds_read_b64_tr_b16 v[178:179], v239 offset:61184
v_mfma_f32_16x16x32_bf16 v[40:43], v[184:187], a[128:131], v[40:43]
s_waitcnt lgkmcnt(10)
ds_read_b64_tr_b16 v[180:181], v240 offset:61952
ds_read_b64_tr_b16 v[182:183], v240 offset:62208
v_mfma_f32_16x16x32_bf16 v[44:47], v[188:191], a[128:131], v[44:47]
s_waitcnt lgkmcnt(10)
ds_read_b64_tr_b16 v[184:185], v239 offset:62464
ds_read_b64_tr_b16 v[186:187], v239 offset:62720
v_mfma_f32_16x16x32_bf16 v[48:51], v[160:163], a[128:131], v[48:51]
s_waitcnt lgkmcnt(10)
ds_read_b64_tr_b16 v[188:189], v239 offset:63488
ds_read_b64_tr_b16 v[190:191], v239 offset:63744
v_mfma_f32_16x16x32_bf16 v[32:35], v[164:167], a[132:135], v[32:35]
s_waitcnt lgkmcnt(10)
ds_read_b64_tr_b16 v[160:161], v239 offset:64512
ds_read_b64_tr_b16 v[162:163], v239 offset:64768
v_add_u32 v239, 4294934528, v239
v_mfma_f32_16x16x32_bf16 v[36:39], v[168:171], a[132:135], v[36:39]
s_waitcnt lgkmcnt(10)
ds_read_b64_tr_b16 v[164:165], v239 offset:0
ds_read_b64_tr_b16 v[166:167], v239 offset:256
v_add_u32 v240, 4294934528, v240
v_mfma_f32_16x16x32_bf16 v[40:43], v[172:175], a[132:135], v[40:43]
s_waitcnt lgkmcnt(10)
ds_read_b64_tr_b16 v[168:169], v240 offset:1024
ds_read_b64_tr_b16 v[170:171], v240 offset:1280
v_mfma_f32_16x16x32_bf16 v[44:47], v[176:179], a[132:135], v[44:47]
s_waitcnt lgkmcnt(10)
ds_read_b64_tr_b16 v[172:173], v239 offset:1536
ds_read_b64_tr_b16 v[174:175], v239 offset:1792
v_mfma_f32_16x16x32_bf16 v[48:51], v[180:183], a[132:135], v[48:51]
s_waitcnt vmcnt(7) lgkmcnt(10)
ds_read_b64_tr_b16 v[176:177], v239 offset:2560
ds_read_b64_tr_b16 v[178:179], v239 offset:2816
v_mfma_f32_16x16x32_bf16 v[32:35], v[184:187], a[136:139], v[32:35]
s_waitcnt lgkmcnt(10)
ds_read_b64_tr_b16 v[180:181], v239 offset:3584
ds_read_b64_tr_b16 v[182:183], v239 offset:3840
v_mfma_f32_16x16x32_bf16 v[36:39], v[188:191], a[136:139], v[36:39]
s_waitcnt lgkmcnt(10)
ds_read_b64_tr_b16 v[184:185], v239 offset:4608
ds_read_b64_tr_b16 v[186:187], v239 offset:4864
v_mfma_f32_16x16x32_bf16 v[40:43], v[160:163], a[136:139], v[40:43]
s_waitcnt lgkmcnt(10)
ds_read_b64_tr_b16 v[188:189], v240 offset:5632
ds_read_b64_tr_b16 v[190:191], v240 offset:5888
v_mfma_f32_16x16x32_bf16 v[44:47], v[164:167], a[136:139], v[44:47]
s_waitcnt lgkmcnt(10)
ds_read_b64_tr_b16 v[160:161], v239 offset:6144
ds_read_b64_tr_b16 v[162:163], v239 offset:6400
v_mfma_f32_16x16x32_bf16 v[48:51], v[168:171], a[136:139], v[48:51]
s_waitcnt lgkmcnt(10)
ds_read_b64_tr_b16 v[164:165], v239 offset:7168
ds_read_b64_tr_b16 v[166:167], v239 offset:7424
v_mfma_f32_16x16x32_bf16 v[32:35], v[172:175], a[140:143], v[32:35]
s_waitcnt lgkmcnt(10)
ds_read_b64_tr_b16 v[168:169], v239 offset:8192
ds_read_b64_tr_b16 v[170:171], v239 offset:8448
v_mfma_f32_16x16x32_bf16 v[36:39], v[176:179], a[140:143], v[36:39]
s_waitcnt lgkmcnt(10)
ds_read_b64_tr_b16 v[172:173], v239 offset:9216
ds_read_b64_tr_b16 v[174:175], v239 offset:9472
v_mfma_f32_16x16x32_bf16 v[40:43], v[180:183], a[140:143], v[40:43]
s_waitcnt lgkmcnt(10)
ds_read_b64_tr_b16 v[176:177], v240 offset:10240
ds_read_b64_tr_b16 v[178:179], v240 offset:10496
v_mfma_f32_16x16x32_bf16 v[44:47], v[184:187], a[140:143], v[44:47]
s_waitcnt lgkmcnt(10)
ds_read_b64_tr_b16 v[180:181], v239 offset:10752
ds_read_b64_tr_b16 v[182:183], v239 offset:11008
v_permlane16_swap_b32 v0, v4
v_permlane16_swap_b32 v1, v5
v_permlane16_swap_b32 v2, v6
v_permlane16_swap_b32 v3, v7
v_permlane16_swap_b32 v8, v12
v_permlane16_swap_b32 v9, v13
v_permlane16_swap_b32 v10, v14
v_permlane16_swap_b32 v11, v15
v_mfma_f32_16x16x32_bf16 v[48:51], v[188:191], a[140:143], v[48:51]
s_waitcnt vmcnt(0) lgkmcnt(10)
ds_read_b64_tr_b16 v[184:185], v239 offset:11776
ds_read_b64_tr_b16 v[186:187], v239 offset:12032
v_cmp_eq_u32 vcc, 1, v246
s_mul_i32 s50, s76, 7680
s_add_u32 s50, s50, s92
s_and_b32 s66, vcc_lo, 7
s_cmp_eq_u32 s66, 7
s_cbranch_scc0 sk_19_v0
s_add_u32 s51, s50, 2560
s_add_u32 s52, s50, 5120
buffer_load_dwordx4 v[52:55], v237, s[28:31], s50 offen offset:0 sc1
buffer_load_dwordx4 v[64:67], v237, s[28:31], s51 offen offset:0 sc1
buffer_load_dwordx4 v[76:79], v237, s[28:31], s52 offen offset:0 sc1
buffer_load_dwordx4 v[56:59], v237, s[28:31], s50 offen offset:1024 sc1
buffer_load_dwordx4 v[68:71], v237, s[28:31], s51 offen offset:1024 sc1
buffer_load_dwordx4 v[80:83], v237, s[28:31], s52 offen offset:1024 sc1
buffer_load_dwordx2 v[60:61], v243, s[28:31], s50 offen offset:2048 sc1
buffer_load_dwordx2 v[72:73], v243, s[28:31], s51 offen offset:2048 sc1
buffer_load_dwordx2 v[84:85], v243, s[28:31], s52 offen offset:2048 sc1
s_branch sk_20_v0
sk_19_v0:
s_bitcmp1_b32 s66, 0
s_cbranch_scc0 sk_21_v0
s_add_u32 s51, s50, 0
buffer_load_dwordx4 v[52:55], v237, s[28:31], s51 offen offset:0 sc1
buffer_load_dwordx4 v[56:59], v237, s[28:31], s51 offen offset:1024 sc1
buffer_load_dwordx2 v[60:61], v243, s[28:31], s51 offen offset:2048 sc1
sk_21_v0:
s_bitcmp1_b32 s66, 1
s_cbranch_scc0 sk_22_v0
s_add_u32 s51, s50, 2560
buffer_load_dwordx4 v[64:67], v237, s[28:31], s51 offen offset:0 sc1
buffer_load_dwordx4 v[68:71], v237, s[28:31], s51 offen offset:1024 sc1
buffer_load_dwordx2 v[72:73], v243, s[28:31], s51 offen offset:2048 sc1
sk_22_v0:
s_bitcmp1_b32 s66, 2
s_cbranch_scc0 sk_23_v0
s_add_u32 s51, s50, 5120
buffer_load_dwordx4 v[76:79], v237, s[28:31], s51 offen offset:0 sc1
buffer_load_dwordx4 v[80:83], v237, s[28:31], s51 offen offset:1024 sc1
buffer_load_dwordx2 v[84:85], v243, s[28:31], s51 offen offset:2048 sc1
sk_23_v0:
sk_20_v0:
v_mfma_f32_16x16x32_bf16 v[32:35], v[160:163], a[144:147], v[32:35]
s_waitcnt lgkmcnt(10)
ds_read_b64_tr_b16 v[188:189], v239 offset:12800
ds_read_b64_tr_b16 v[190:191], v239 offset:13056
s_cmp_eq_u32 s66, 7
s_cbranch_scc1 sk_24_v0
buffer_load_dword v246, v229, s[28:31], 0 offen sc1
sk_24_v0:
v_mfma_f32_16x16x32_bf16 v[36:39], v[164:167], a[144:147], v[36:39]
s_waitcnt lgkmcnt(10)
ds_read_b64_tr_b16 v[160:161], v239 offset:13824
ds_read_b64_tr_b16 v[162:163], v239 offset:14080
v_mfma_f32_16x16x32_bf16 v[40:43], v[168:171], a[144:147], v[40:43]
s_waitcnt lgkmcnt(10)
ds_read_b64_tr_b16 v[164:165], v240 offset:14848
ds_read_b64_tr_b16 v[166:167], v240 offset:15104
v_mfma_f32_16x16x32_bf16 v[44:47], v[172:175], a[144:147], v[44:47]
s_waitcnt lgkmcnt(10)
ds_read_b64_tr_b16 v[168:169], v239 offset:15360
ds_read_b64_tr_b16 v[170:171], v239 offset:15616
v_mfma_f32_16x16x32_bf16 v[48:51], v[176:179], a[144:147], v[48:51]
s_waitcnt lgkmcnt(10)
ds_read_b64_tr_b16 v[172:173], v239 offset:16384
ds_read_b64_tr_b16 v[174:175], v239 offset:16640
v_mfma_f32_16x16x32_bf16 v[32:35], v[180:183], a[148:151], v[32:35]
s_waitcnt lgkmcnt(10)
ds_read_b64_tr_b16 v[176:177], v239 offset:17408
ds_read_b64_tr_b16 v[178:179], v239 offset:17664
v_mfma_f32_16x16x32_bf16 v[36:39], v[184:187], a[148:151], v[36:39]
s_waitcnt lgkmcnt(10)
ds_read_b64_tr_b16 v[180:181], v239 offset:18432
ds_read_b64_tr_b16 v[182:183], v239 offset:18688
v_mfma_f32_16x16x32_bf16 v[40:43], v[188:191], a[148:151], v[40:43]
s_waitcnt lgkmcnt(10)
ds_read_b64_tr_b16 v[184:185], v240 offset:19456
ds_read_b64_tr_b16 v[186:187], v240 offset:19712
v_mfma_f32_16x16x32_bf16 v[44:47], v[160:163], a[148:151], v[44:47]
s_waitcnt lgkmcnt(10)
ds_read_b64_tr_b16 v[188:189], v239 offset:19968
ds_read_b64_tr_b16 v[190:191], v239 offset:20224
v_mfma_f32_16x16x32_bf16 v[48:51], v[164:167], a[148:151], v[48:51]
s_waitcnt lgkmcnt(10)
ds_read_b64_tr_b16 v[160:161], v239 offset:20992
ds_read_b64_tr_b16 v[162:163], v239 offset:21248
v_mfma_f32_16x16x32_bf16 v[32:35], v[168:171], a[152:155], v[32:35]
s_waitcnt lgkmcnt(10)
ds_read_b64_tr_b16 v[164:165], v239 offset:22016
ds_read_b64_tr_b16 v[166:167], v239 offset:22272
v_mfma_f32_16x16x32_bf16 v[36:39], v[172:175], a[152:155], v[36:39]
s_waitcnt lgkmcnt(10)
ds_read_b64_tr_b16 v[168:169], v239 offset:23040
ds_read_b64_tr_b16 v[170:171], v239 offset:23296
v_mfma_f32_16x16x32_bf16 v[40:43], v[176:179], a[152:155], v[40:43]
s_waitcnt lgkmcnt(10)
ds_read_b64_tr_b16 v[172:173], v240 offset:24064
ds_read_b64_tr_b16 v[174:175], v240 offset:24320
v_mfma_f32_16x16x32_bf16 v[44:47], v[180:183], a[152:155], v[44:47]
s_waitcnt lgkmcnt(10)
ds_read_b64_tr_b16 v[176:177], v239 offset:24576
ds_read_b64_tr_b16 v[178:179], v239 offset:24832
v_mfma_f32_16x16x32_bf16 v[48:51], v[184:187], a[152:155], v[48:51]
s_waitcnt lgkmcnt(10)
ds_read_b64_tr_b16 v[180:181], v239 offset:25600
ds_read_b64_tr_b16 v[182:183], v239 offset:25856
v_mfma_f32_16x16x32_bf16 v[32:35], v[188:191], a[156:159], v[32:35]
s_waitcnt lgkmcnt(10)
ds_read_b64_tr_b16 v[184:185], v239 offset:26624
ds_read_b64_tr_b16 v[186:187], v239 offset:26880
v_mfma_f32_16x16x32_bf16 v[36:39], v[160:163], a[156:159], v[36:39]
s_waitcnt lgkmcnt(10)
ds_read_b64_tr_b16 v[188:189], v239 offset:27648
ds_read_b64_tr_b16 v[190:191], v239 offset:27904
v_mfma_f32_16x16x32_bf16 v[40:43], v[164:167], a[156:159], v[40:43]
s_waitcnt lgkmcnt(10)
ds_read_b64_tr_b16 v[160:161], v240 offset:28672
ds_read_b64_tr_b16 v[162:163], v240 offset:28928
v_mfma_f32_16x16x32_bf16 v[44:47], v[168:171], a[156:159], v[44:47]
s_waitcnt lgkmcnt(10)
ds_read_b64_tr_b16 v[164:165], v239 offset:29184
ds_read_b64_tr_b16 v[166:167], v239 offset:29440
v_mfma_f32_16x16x32_bf16 v[48:51], v[172:175], a[156:159], v[48:51]
TCH_12_v0:
s_cbranch_execz TCH_back
s_waitcnt lgkmcnt(10)
ds_read_b64_tr_b16 v[168:169], v239 offset:30208
ds_read_b64_tr_b16 v[170:171], v239 offset:30464
v_mfma_f32_16x16x32_bf16 v[32:35], v[176:179], a[160:163], v[32:35]
s_waitcnt lgkmcnt(10)
ds_read_b64_tr_b16 v[172:173], v239 offset:31232
ds_read_b64_tr_b16 v[174:175], v239 offset:31488
v_mfma_f32_16x16x32_bf16 v[36:39], v[180:183], a[160:163], v[36:39]
s_waitcnt lgkmcnt(10)
ds_read_b64_tr_b16 v[176:177], v239 offset:32256
ds_read_b64_tr_b16 v[178:179], v239 offset:32512
v_mfma_f32_16x16x32_bf16 v[40:43], v[184:187], a[160:163], v[40:43]
s_waitcnt lgkmcnt(10)
ds_read_b64_tr_b16 v[180:181], v240 offset:33280
ds_read_b64_tr_b16 v[182:183], v240 offset:33536
v_mfma_f32_16x16x32_bf16 v[44:47], v[188:191], a[160:163], v[44:47]
s_waitcnt lgkmcnt(10)
v_mfma_f32_16x16x32_bf16 v[48:51], v[160:163], a[160:163], v[48:51]
s_waitcnt lgkmcnt(8)
v_mfma_f32_16x16x32_bf16 v[32:35], v[164:167], a[164:167], v[32:35]
s_waitcnt lgkmcnt(6)
v_mfma_f32_16x16x32_bf16 v[36:39], v[168:171], a[164:167], v[36:39]
s_waitcnt lgkmcnt(4)
v_mfma_f32_16x16x32_bf16 v[40:43], v[172:175], a[164:167], v[40:43]
s_waitcnt lgkmcnt(2)
v_mfma_f32_16x16x32_bf16 v[44:47], v[176:179], a[164:167], v[44:47]
s_waitcnt lgkmcnt(0)
v_mfma_f32_16x16x32_bf16 v[48:51], v[180:183], a[164:167], v[48:51]
s_mov_b32 s4, 0xffff0000
s_mov_b32 s65, 0
s_nop 5
v_permlane16_swap_b32 v32, v36
v_permlane16_swap_b32 v33, v37
v_permlane16_swap_b32 v34, v38
v_permlane16_swap_b32 v35, v39
v_permlane16_swap_b32 v40, v44
v_permlane16_swap_b32 v41, v45
v_permlane16_swap_b32 v42, v46
v_permlane16_swap_b32 v43, v47
s_cmp_eq_u32 s66, 7
s_cbranch_scc1 K_x4_v0
K_x1_v0:
s_waitcnt vmcnt(0)
v_cmp_eq_u32 vcc, 1, v246
s_add_u32 s65, s65, 1
s_andn2_b32 s64, vcc_lo, s66
s_and_b32 s64, s64, 7
s_cmp_eq_u32 s64, 7
s_cbranch_scc0 sk_25_v0
s_add_u32 s51, s50, 2560
s_add_u32 s52, s50, 5120
buffer_load_dwordx4 v[52:55], v237, s[28:31], s50 offen offset:0 sc1
buffer_load_dwordx4 v[64:67], v237, s[28:31], s51 offen offset:0 sc1
buffer_load_dwordx4 v[76:79], v237, s[28:31], s52 offen offset:0 sc1
buffer_load_dwordx4 v[56:59], v237, s[28:31], s50 offen offset:1024 sc1
buffer_load_dwordx4 v[68:71], v237, s[28:31], s51 offen offset:1024 sc1
buffer_load_dwordx4 v[80:83], v237, s[28:31], s52 offen offset:1024 sc1
buffer_load_dwordx2 v[60:61], v243, s[28:31], s50 offen offset:2048 sc1
buffer_load_dwordx2 v[72:73], v243, s[28:31], s51 offen offset:2048 sc1
buffer_load_dwordx2 v[84:85], v243, s[28:31], s52 offen offset:2048 sc1
s_branch K_x4_v0
sk_25_v0:
s_bitcmp1_b32 s64, 0
s_cbranch_scc0 sk_27_v0
s_add_u32 s51, s50, 0
buffer_load_dwordx4 v[52:55], v237, s[28:31], s51 offen offset:0 sc1
buffer_load_dwordx4 v[56:59], v237, s[28:31], s51 offen offset:1024 sc1
buffer_load_dwordx2 v[60:61], v243, s[28:31], s51 offen offset:2048 sc1
sk_27_v0:
s_bitcmp1_b32 s64, 1
s_cbranch_scc0 sk_28_v0
s_add_u32 s51, s50, 2560
buffer_load_dwordx4 v[64:67], v237, s[28:31], s51 offen offset:0 sc1
buffer_load_dwordx4 v[68:71], v237, s[28:31], s51 offen offset:1024 sc1
buffer_load_dwordx2 v[72:73], v243, s[28:31], s51 offen offset:2048 sc1
sk_28_v0:
s_bitcmp1_b32 s64, 2
s_cbranch_scc0 sk_29_v0
s_add_u32 s51, s50, 5120
buffer_load_dwordx4 v[76:79], v237, s[28:31], s51 offen offset:0 sc1
buffer_load_dwordx4 v[80:83], v237, s[28:31], s51 offen offset:1024 sc1
buffer_load_dwordx2 v[84:85], v243, s[28:31], s51 offen offset:2048 sc1
sk_29_v0:
sk_26_v0:
s_or_b32 s66, s66, s64
s_cmp_eq_u32 s66, 7
s_cbranch_scc1 K_x3_v0
buffer_load_dword v246, v229, s[28:31], 0 offen sc1
s_cmp_le_u32 s65, 100000
s_cbranch_scc1 K_x1_v0
K_x3_v0:
s_waitcnt vmcnt(0)
K_x4_v0:
s_mov_b32 s6, s96
s_mov_b32 s7, s96
s_waitcnt vmcnt(6)
v_mfma_f32_16x16x32_bf16 v[0:3], v[138:141], v[52:55], v[0:3]
v_mfma_f32_16x16x32_bf16 v[4:7], v[136:139], v[52:55], v[4:7]
v_mfma_f32_16x16x32_bf16 v[0:3], v[138:141], v[64:67], v[0:3]
v_mfma_f32_16x16x32_bf16 v[4:7], v[136:139], v[64:67], v[4:7]
v_mfma_f32_16x16x32_bf16 v[0:3], v[138:141], v[76:79], v[0:3]
v_mfma_f32_16x16x32_bf16 v[4:7], v[136:139], v[76:79], v[4:7]
s_nop 7
v_pk_mul_f32 v[96:97], v[0:1], s[6:7]
v_pk_mul_f32 v[98:99], v[2:3], s[6:7]
v_pk_mul_f32 v[100:101], v[4:5], s[6:7]
v_pk_mul_f32 v[102:103], v[6:7], s[6:7]
v_exp_f32 v96, v96
v_exp_f32 v97, v97
v_exp_f32 v98, v98
v_exp_f32 v99, v99
v_exp_f32 v100, v100
v_exp_f32 v101, v101
v_exp_f32 v102, v102
v_exp_f32 v103, v103
v_pk_add_f32 v[96:97], v[96:97], 1.0 op_sel_hi:[1,0]
v_pk_add_f32 v[98:99], v[98:99], 1.0 op_sel_hi:[1,0]
v_pk_add_f32 v[100:101], v[100:101], 1.0 op_sel_hi:[1,0]
v_pk_add_f32 v[102:103], v[102:103], 1.0 op_sel_hi:[1,0]
v_rcp_f32 v96, v96
v_rcp_f32 v97, v97
v_rcp_f32 v98, v98
v_rcp_f32 v99, v99
v_rcp_f32 v100, v100
v_rcp_f32 v101, v101
v_rcp_f32 v102, v102
v_rcp_f32 v103, v103
s_waitcnt vmcnt(3)
v_mfma_f32_16x16x32_bf16 v[8:11], v[138:141], v[56:59], v[8:11]
v_mfma_f32_16x16x32_bf16 v[12:15], v[136:139], v[56:59], v[12:15]
v_mfma_f32_16x16x32_bf16 v[8:11], v[138:141], v[68:71], v[8:11]
v_mfma_f32_16x16x32_bf16 v[12:15], v[136:139], v[68:71], v[12:15]
v_mfma_f32_16x16x32_bf16 v[8:11], v[138:141], v[80:83], v[8:11]
v_mfma_f32_16x16x32_bf16 v[12:15], v[136:139], v[80:83], v[12:15]
v_pk_mul_f32 v[0:1], v[0:1], v[32:33]
v_pk_mul_f32 v[2:3], v[2:3], v[34:35]
v_pk_mul_f32 v[4:5], v[4:5], v[36:37]
v_pk_mul_f32 v[6:7], v[6:7], v[38:39]
v_pk_fma_f32 v[0:1], v[0:1], v[96:97], v[116:117]
v_pk_fma_f32 v[2:3], v[2:3], v[98:99], v[118:119]
v_pk_fma_f32 v[4:5], v[4:5], v[100:101], v[120:121]
v_pk_fma_f32 v[6:7], v[6:7], v[102:103], v[122:123]
v_cvt_pk_bf16_f32 v20, v0, v1
v_cvt_pk_bf16_f32 v21, v2, v3
v_cvt_pk_bf16_f32 v22, v4, v5
v_cvt_pk_bf16_f32 v23, v6, v7
buffer_store_dwordx4 v[20:23], v232, s[24:27], 0 offen offset:0
v_pk_mul_f32 v[96:97], v[8:9], s[6:7]
v_pk_mul_f32 v[98:99], v[10:11], s[6:7]
v_pk_mul_f32 v[100:101], v[12:13], s[6:7]
v_pk_mul_f32 v[102:103], v[14:15], s[6:7]
v_exp_f32 v96, v96
v_exp_f32 v97, v97
v_exp_f32 v98, v98
v_exp_f32 v99, v99
v_exp_f32 v100, v100
v_exp_f32 v101, v101
v_exp_f32 v102, v102
v_exp_f32 v103, v103
v_pk_add_f32 v[96:97], v[96:97], 1.0 op_sel_hi:[1,0]
v_pk_add_f32 v[98:99], v[98:99], 1.0 op_sel_hi:[1,0]
v_pk_add_f32 v[100:101], v[100:101], 1.0 op_sel_hi:[1,0]
v_pk_add_f32 v[102:103], v[102:103], 1.0 op_sel_hi:[1,0]
v_rcp_f32 v96, v96
v_rcp_f32 v97, v97
v_rcp_f32 v98, v98
v_rcp_f32 v99, v99
v_rcp_f32 v100, v100
v_rcp_f32 v101, v101
v_rcp_f32 v102, v102
v_rcp_f32 v103, v103
s_waitcnt vmcnt(1)
v_mfma_f32_16x16x32_bf16 v[16:19], v[138:141], v[60:63], v[16:19]
v_mfma_f32_16x16x32_bf16 v[16:19], v[138:141], v[72:75], v[16:19]
v_mfma_f32_16x16x32_bf16 v[16:19], v[138:141], v[84:87], v[16:19]
v_pk_mul_f32 v[8:9], v[8:9], v[40:41]
v_pk_mul_f32 v[10:11], v[10:11], v[42:43]
v_pk_mul_f32 v[12:13], v[12:13], v[44:45]
v_pk_mul_f32 v[14:15], v[14:15], v[46:47]
v_pk_fma_f32 v[8:9], v[8:9], v[96:97], v[124:125]
v_pk_fma_f32 v[10:11], v[10:11], v[98:99], v[126:127]
v_pk_fma_f32 v[12:13], v[12:13], v[100:101], v[128:129]
v_pk_fma_f32 v[14:15], v[14:15], v[102:103], v[130:131]
v_cvt_pk_bf16_f32 v24, v8, v9
v_cvt_pk_bf16_f32 v25, v10, v11
v_cvt_pk_bf16_f32 v26, v12, v13
v_cvt_pk_bf16_f32 v27, v14, v15
buffer_store_dwordx4 v[24:27], v232, s[24:27], 0 offen offset:64
v_pk_mul_f32 v[96:97], v[16:17], s[6:7]
v_pk_mul_f32 v[98:99], v[18:19], s[6:7]
v_exp_f32 v96, v96
v_exp_f32 v97, v97
v_exp_f32 v98, v98
v_exp_f32 v99, v99
v_pk_add_f32 v[96:97], v[96:97], 1.0 op_sel_hi:[1,0]
v_pk_add_f32 v[98:99], v[98:99], 1.0 op_sel_hi:[1,0]
v_rcp_f32 v96, v96
v_rcp_f32 v97, v97
v_rcp_f32 v98, v98
v_rcp_f32 v99, v99
v_pk_mul_f32 v[16:17], v[16:17], v[48:49]
v_pk_mul_f32 v[18:19], v[18:19], v[50:51]
v_pk_fma_f32 v[16:17], v[16:17], v[96:97], v[132:133]
v_pk_fma_f32 v[18:19], v[18:19], v[98:99], v[134:135]
v_cvt_pk_bf16_f32 v28, v16, v17
v_cvt_pk_bf16_f32 v29, v18, v19
buffer_store_dwordx2 v[28:29], v233, s[24:27], 0 offen offset:128
s_branch K_end
spin_2_v0:
s_mov_b32 s65, 0
spin_2_l_v0:
s_sleep 2
global_load_dword v246, v245, s[62:63] sc1
s_add_u32 s65, s65, 1
s_waitcnt vmcnt(0)
v_cmp_gt_u32 vcc, 32, v246
s_cmp_gt_u32 s65, 100000
s_cbranch_scc1 ok_1_v0
s_cbranch_vccnz spin_2_l_v0
s_branch ok_1_v0
spin_4_v0:
s_mov_b32 s65, 0
spin_4_l_v0:
s_sleep 2
buffer_load_dword v246, v247, s[28:31], s67 offen offset:0 sc1
s_add_u32 s65, s65, 1
s_waitcnt vmcnt(0)
v_cmp_gt_u32 vcc, 1, v246
s_cmp_gt_u32 s65, 100000
s_cbranch_scc1 ok_3_v0
s_cbranch_vccnz spin_4_l_v0
s_branch ok_3_v0
spin_6_v0:
s_mov_b32 s65, 0
spin_6_l_v0:
s_sleep 2
buffer_load_dword v246, v247, s[28:31], s67 offen offset:1024 sc1
s_add_u32 s65, s65, 1
s_waitcnt vmcnt(0)
v_cmp_gt_u32 vcc, 1, v246
s_cmp_gt_u32 s65, 100000
s_cbranch_scc1 ok_5_v0
s_cbranch_vccnz spin_6_l_v0
s_branch ok_5_v0
spin_8_v0:
s_mov_b32 s65, 0
spin_8_l_v0:
s_sleep 2
buffer_load_dword v246, v241, s[28:31], 0 offen sc1
s_add_u32 s65, s65, 1
s_waitcnt vmcnt(0)
v_cmp_gt_u32 vcc, 1, v246
s_cmp_gt_u32 s65, 100000
s_cbranch_scc1 ok_7_v0
s_cbranch_vccnz spin_8_l_v0
s_branch ok_7_v0
spin_10_v0:
s_mov_b32 s65, 0
spin_10_l_v0:
s_sleep 2
buffer_load_dword v246, v241, s[28:31], s68 offen sc1
s_add_u32 s65, s65, 1
s_waitcnt vmcnt(0)
v_cmp_gt_u32 vcc, 1, v246
s_cmp_gt_u32 s65, 100000
s_cbranch_scc1 ok_9_v0
s_cbranch_vccnz spin_10_l_v0
s_branch ok_9_v0
spin_12_v0:
s_mov_b32 s65, 0
spin_12_l_v0:
s_sleep 2
buffer_load_dword v246, v234, s[28:31], 0 offen sc1
s_add_u32 s65, s65, 1
s_waitcnt vmcnt(0)
v_cmp_gt_u32 vcc, 1, v246
s_cmp_gt_u32 s65, 100000
s_cbranch_scc1 ok_11_v0
s_cbranch_vccnz spin_12_l_v0
s_branch ok_11_v0
spin_14_v0:
s_mov_b32 s65, 0
spin_14_l_v0:
s_sleep 2
buffer_load_dword v246, v241, s[28:31], s7 offen sc1
s_add_u32 s65, s65, 1
s_waitcnt vmcnt(0)
v_cmp_gt_u32 vcc, 1, v246
s_cmp_gt_u32 s65, 100000
s_cbranch_scc1 ok_13_v0
s_cbranch_vccnz spin_14_l_v0
s_branch ok_13_v0
spin_16_v0:
s_mov_b32 s65, 0
spin_16_l_v0:
s_sleep 2
buffer_load_dword v246, v241, s[28:31], s83 offen sc1
s_add_u32 s65, s65, 1
s_waitcnt vmcnt(0)
v_cmp_gt_u32 vcc, 1, v246
s_cmp_gt_u32 s65, 100000
s_cbranch_scc1 ok_15_v0
s_cbranch_vccnz spin_16_l_v0
s_branch ok_15_v0
spin_18_v0:
s_mov_b32 s65, 0
spin_18_l_v0:
s_sleep 2
buffer_load_dword v246, v228, s[28:31], 0 offen sc1
s_add_u32 s65, s65, 1
s_waitcnt vmcnt(0)
v_cmp_gt_u32 vcc, 1, v246
s_cmp_gt_u32 s65, 100000
s_cbranch_scc1 ok_17_v0
s_cbranch_vccnz spin_18_l_v0
s_branch ok_17_v0
.p2align 12
K_main_1:
TCH_0_v1:
s_cbranch_execz TCH_4_v1
ds_read_b64_tr_b16 v[192:193], v228 offset:0
ds_read_b64_tr_b16 v[194:195], v228 offset:512
ds_read_b64_tr_b16 v[196:197], v228 offset:4096
ds_read_b64_tr_b16 v[198:199], v228 offset:4608
ds_read_b64_tr_b16 v[200:201], v229 offset:0
ds_read_b64_tr_b16 v[202:203], v229 offset:512
ds_read_b64_tr_b16 v[204:205], v229 offset:4096
ds_read_b64_tr_b16 v[206:207], v229 offset:4608
s_waitcnt vmcnt(4) lgkmcnt(6)
v_mfma_f32_16x16x32_bf16 v[32:35], v[192:195], a[0:3], 0
s_add_u32 s52, s54, 8192
ds_read_b64_tr_b16 v[208:209], v230 offset:0
ds_read_b64_tr_b16 v[210:211], v230 offset:512
v_mfma_f32_16x16x32_bf16 v[36:39], v[192:195], a[4:7], 0
buffer_load_dwordx4 a[32:35], v250, s[28:31], s52 offen sc1
v_mfma_f32_16x16x32_bf16 v[40:43], v[192:195], a[8:11], 0
v_mfma_f32_16x16x32_bf16 v[44:47], v[192:195], a[12:15], 0
s_waitcnt lgkmcnt(6)
v_mfma_f32_16x16x32_bf16 v[48:51], v[196:199], a[0:3], 0
ds_read_b64_tr_b16 v[192:193], v230 offset:4096
ds_read_b64_tr_b16 v[194:195], v230 offset:4608
v_mfma_f32_16x16x32_bf16 v[52:55], v[196:199], a[4:7], 0
buffer_load_dwordx4 a[36:39], v251, s[28:31], s52 offen sc1
v_mfma_f32_16x16x32_bf16 v[56:59], v[196:199], a[8:11], 0
v_mfma_f32_16x16x32_bf16 v[60:63], v[196:199], a[12:15], 0
s_waitcnt lgkmcnt(6)
v_mfma_f32_16x16x32_bf16 v[64:67], v[200:203], a[0:3], 0
s_add_u32 s4, s59, 0
ds_read_b64_tr_b16 v[196:197], v231 offset:0
ds_read_b64_tr_b16 v[198:199], v231 offset:512
v_mfma_f32_16x16x32_bf16 v[68:71], v[200:203], a[4:7], 0
s_lshr_b32 s5, s4, 6
buffer_load_dwordx4 a[40:43], v252, s[28:31], s52 offen sc1
v_mfma_f32_16x16x32_bf16 v[72:75], v[200:203], a[8:11], 0
v_mfma_f32_16x16x32_bf16 v[76:79], v[200:203], a[12:15], 0
s_waitcnt lgkmcnt(6)
v_mfma_f32_16x16x32_bf16 v[80:83], v[204:207], a[0:3], 0
s_mul_i32 s6, s5, 57
ds_read_b64_tr_b16 v[200:201], v231 offset:4096
ds_read_b64_tr_b16 v[202:203], v231 offset:4608
v_mfma_f32_16x16x32_bf16 v[84:87], v[204:207], a[4:7], 0
buffer_load_dwordx4 a[44:47], v253, s[28:31], s52 offen sc1
v_mfma_f32_16x16x32_bf16 v[88:91], v[204:207], a[8:11], 0
v_mfma_f32_16x16x32_bf16 v[92:95], v[204:207], a[12:15], 0
s_waitcnt lgkmcnt(6)
v_mfma_f32_16x16x32_bf16 v[96:99], v[208:211], a[0:3], 0
s_lshr_b32 s6, s6, 9
ds_read_b64_tr_b16 v[204:205], v228 offset:8192
ds_read_b64_tr_b16 v[206:207], v228 offset:8704
v_mfma_f32_16x16x32_bf16 v[100:103], v[208:211], a[4:7], 0
v_mfma_f32_16x16x32_bf16 v[104:107], v[208:211], a[8:11], 0
v_mfma_f32_16x16x32_bf16 v[108:111], v[208:211], a[12:15], 0
s_waitcnt lgkmcnt(6)
v_mfma_f32_16x16x32_bf16 v[112:115], v[192:195], a[0:3], 0
s_add_u32 s52, s54, 12288
ds_read_b64_tr_b16 v[208:209], v228 offset:12288
ds_read_b64_tr_b16 v[210:211], v228 offset:12800
v_mfma_f32_16x16x32_bf16 v[116:119], v[192:195], a[4:7], 0
s_mul_i32 s7, s6, 9
buffer_load_dwordx4 a[48:51], v250, s[28:31], s52 offen sc1
v_mfma_f32_16x16x32_bf16 v[120:123], v[192:195], a[8:11], 0
v_mfma_f32_16x16x32_bf16 v[124:127], v[192:195], a[12:15], 0
s_waitcnt lgkmcnt(6)
v_mfma_f32_16x16x32_bf16 v[128:131], v[196:199], a[0:3], 0
s_sub_u32 s5, s5, s7
ds_read_b64_tr_b16 v[192:193], v229 offset:8192
ds_read_b64_tr_b16 v[194:195], v229 offset:8704
v_mfma_f32_16x16x32_bf16 v[132:135], v[196:199], a[4:7], 0
buffer_load_dwordx4 a[52:55], v251, s[28:31], s52 offen sc1
v_mfma_f32_16x16x32_bf16 v[136:139], v[196:199], a[8:11], 0
v_mfma_f32_16x16x32_bf16 v[140:143], v[196:199], a[12:15], 0
s_waitcnt lgkmcnt(6)
v_mfma_f32_16x16x32_bf16 v[144:147], v[200:203], a[0:3], 0
s_bfe_u32 s7, s4, 0x10005
ds_read_b64_tr_b16 v[196:197], v229 offset:12288
ds_read_b64_tr_b16 v[198:199], v229 offset:12800
v_mfma_f32_16x16x32_bf16 v[148:151], v[200:203], a[4:7], 0
buffer_load_dwordx4 a[56:59], v252, s[28:31], s52 offen sc1
v_mfma_f32_16x16x32_bf16 v[152:155], v[200:203], a[8:11], 0
v_mfma_f32_16x16x32_bf16 v[156:159], v[200:203], a[12:15], 0
s_waitcnt vmcnt(7) lgkmcnt(6)
v_mfma_f32_16x16x32_bf16 v[32:35], v[204:207], a[16:19], v[32:35]
s_and_b32 s8, s6, 1
ds_read_b64_tr_b16 v[200:201], v230 offset:8192
ds_read_b64_tr_b16 v[202:203], v230 offset:8704
v_mfma_f32_16x16x32_bf16 v[36:39], v[204:207], a[20:23], v[36:39]
s_lshl_b32 s9, s8, 2
buffer_load_dwordx4 a[60:63], v253, s[28:31], s52 offen sc1
v_mfma_f32_16x16x32_bf16 v[40:43], v[204:207], a[24:27], v[40:43]
v_mfma_f32_16x16x32_bf16 v[44:47], v[204:207], a[28:31], v[44:47]
s_waitcnt lgkmcnt(6)
v_mfma_f32_16x16x32_bf16 v[48:51], v[208:211], a[16:19], v[48:51]
s_add_u32 s9, s9, s5
ds_read_b64_tr_b16 v[204:205], v230 offset:12288
ds_read_b64_tr_b16 v[206:207], v230 offset:12800
v_mfma_f32_16x16x32_bf16 v[52:55], v[208:211], a[20:23], v[52:55]
v_mfma_f32_16x16x32_bf16 v[56:59], v[208:211], a[24:27], v[56:59]
v_mfma_f32_16x16x32_bf16 v[60:63], v[208:211], a[28:31], v[60:63]
s_waitcnt lgkmcnt(6)
v_mfma_f32_16x16x32_bf16 v[64:67], v[192:195], a[16:19], v[64:67]
s_add_u32 s52, s54, 16384
ds_read_b64_tr_b16 v[208:209], v231 offset:8192
ds_read_b64_tr_b16 v[210:211], v231 offset:8704
v_mfma_f32_16x16x32_bf16 v[68:71], v[192:195], a[20:23], v[68:71]
s_waitcnt vmcnt(46)
buffer_load_dwordx4 a[64:67], v250, s[28:31], s52 offen sc1
buffer_store_dwordx4 v[184:187], v248, s[28:31], 0 offen sc1
v_mfma_f32_16x16x32_bf16 v[72:75], v[192:195], a[24:27], v[72:75]
s_lshl_b32 s10, s7, 3
v_mfma_f32_16x16x32_bf16 v[76:79], v[192:195], a[28:31], v[76:79]
s_waitcnt lgkmcnt(6)
v_mfma_f32_16x16x32_bf16 v[80:83], v[196:199], a[16:19], v[80:83]
s_add_u32 s9, s9, s10
ds_read_b64_tr_b16 v[192:193], v231 offset:12288
ds_read_b64_tr_b16 v[194:195], v231 offset:12800
v_mfma_f32_16x16x32_bf16 v[84:87], v[196:199], a[20:23], v[84:87]
buffer_load_dwordx4 a[68:71], v251, s[28:31], s52 offen sc1
v_mfma_f32_16x16x32_bf16 v[88:91], v[196:199], a[24:27], v[88:91]
v_mfma_f32_16x16x32_bf16 v[92:95], v[196:199], a[28:31], v[92:95]
s_waitcnt lgkmcnt(6)
v_mfma_f32_16x16x32_bf16 v[96:99], v[200:203], a[16:19], v[96:99]
ds_read_b64_tr_b16 v[196:197], v228 offset:16384
ds_read_b64_tr_b16 v[198:199], v228 offset:16896
v_mfma_f32_16x16x32_bf16 v[100:103], v[200:203], a[20:23], v[100:103]
s_cmp_ge_u32 s9, 6
s_cselect_b32 s10, 4, 0
buffer_load_dwordx4 a[72:75], v252, s[28:31], s52 offen sc1
v_mfma_f32_16x16x32_bf16 v[104:107], v[200:203], a[24:27], v[104:107]
v_mfma_f32_16x16x32_bf16 v[108:111], v[200:203], a[28:31], v[108:111]
s_waitcnt lgkmcnt(6)
v_mfma_f32_16x16x32_bf16 v[112:115], v[204:207], a[16:19], v[112:115]
ds_read_b64_tr_b16 v[200:201], v228 offset:20480
ds_read_b64_tr_b16 v[202:203], v228 offset:20992
v_mfma_f32_16x16x32_bf16 v[116:119], v[204:207], a[20:23], v[116:119]
buffer_load_dwordx4 a[76:79], v253, s[28:31], s52 offen sc1
v_mfma_f32_16x16x32_bf16 v[120:123], v[204:207], a[24:27], v[120:123]
v_mfma_f32_16x16x32_bf16 v[124:127], v[204:207], a[28:31], v[124:127]
s_waitcnt lgkmcnt(6)
v_mfma_f32_16x16x32_bf16 v[128:131], v[208:211], a[16:19], v[128:131]
ds_read_b64_tr_b16 v[204:205], v229 offset:16384
ds_read_b64_tr_b16 v[206:207], v229 offset:16896
v_mfma_f32_16x16x32_bf16 v[132:135], v[208:211], a[20:23], v[132:135]
s_cmp_gt_u32 s5, 4
s_cselect_b32 s10, 15, s10
v_mfma_f32_16x16x32_bf16 v[136:139], v[208:211], a[24:27], v[136:139]
v_mfma_f32_16x16x32_bf16 v[140:143], v[208:211], a[28:31], v[140:143]
s_waitcnt lgkmcnt(6)
v_mfma_f32_16x16x32_bf16 v[144:147], v[192:195], a[16:19], v[144:147]
s_add_u32 s52, s54, 20480
ds_read_b64_tr_b16 v[208:209], v229 offset:20480
ds_read_b64_tr_b16 v[210:211], v229 offset:20992
v_mfma_f32_16x16x32_bf16 v[148:151], v[192:195], a[20:23], v[148:151]
s_add_u32 s9, s9, s10
buffer_load_dwordx4 a[80:83], v250, s[28:31], s52 offen sc1
v_mfma_f32_16x16x32_bf16 v[152:155], v[192:195], a[24:27], v[152:155]
v_mfma_f32_16x16x32_bf16 v[156:159], v[192:195], a[28:31], v[156:159]
s_waitcnt vmcnt(10) lgkmcnt(6)
v_mfma_f32_16x16x32_bf16 v[32:35], v[196:199], a[32:35], v[32:35]
s_lshl_b32 s8, s8, 1
ds_read_b64_tr_b16 v[192:193], v230 offset:16384
ds_read_b64_tr_b16 v[194:195], v230 offset:16896
v_mfma_f32_16x16x32_bf16 v[36:39], v[196:199], a[36:39], v[36:39]
buffer_load_dwordx4 a[84:87], v251, s[28:31], s52 offen sc1
v_mfma_f32_16x16x32_bf16 v[40:43], v[196:199], a[40:43], v[40:43]
v_mfma_f32_16x16x32_bf16 v[44:47], v[196:199], a[44:47], v[44:47]
s_waitcnt lgkmcnt(6)
v_mfma_f32_16x16x32_bf16 v[48:51], v[200:203], a[32:35], v[48:51]
s_add_u32 s8, s8, s7
ds_read_b64_tr_b16 v[196:197], v230 offset:20480
ds_read_b64_tr_b16 v[198:199], v230 offset:20992
v_mfma_f32_16x16x32_bf16 v[52:55], v[200:203], a[36:39], v[52:55]
buffer_load_dwordx4 a[88:91], v252, s[28:31], s52 offen sc1
v_mfma_f32_16x16x32_bf16 v[56:59], v[200:203], a[40:43], v[56:59]
v_mfma_f32_16x16x32_bf16 v[60:63], v[200:203], a[44:47], v[60:63]
s_waitcnt lgkmcnt(6)
v_mfma_f32_16x16x32_bf16 v[64:67], v[204:207], a[32:35], v[64:67]
s_waitcnt vmcnt(54)
ds_read_b64_tr_b16 v[200:201], v231 offset:16384
ds_read_b64_tr_b16 v[202:203], v231 offset:16896
v_mfma_f32_16x16x32_bf16 v[68:71], v[204:207], a[36:39], v[68:71]
s_add_u32 s8, s8, 6
buffer_load_dwordx4 a[92:95], v253, s[28:31], s52 offen sc1
buffer_store_dwordx4 v[188:191], v249, s[28:31], 0 offen sc1
v_mfma_f32_16x16x32_bf16 v[72:75], v[204:207], a[40:43], v[72:75]
v_mfma_f32_16x16x32_bf16 v[76:79], v[204:207], a[44:47], v[76:79]
s_waitcnt lgkmcnt(6)
v_mfma_f32_16x16x32_bf16 v[80:83], v[208:211], a[32:35], v[80:83]
ds_read_b64_tr_b16 v[204:205], v231 offset:20480
ds_read_b64_tr_b16 v[206:207], v231 offset:20992
v_mfma_f32_16x16x32_bf16 v[84:87], v[208:211], a[36:39], v[84:87]
s_cmp_eq_u32 s5, 4
s_cselect_b32 s9, s8, s9
v_mfma_f32_16x16x32_bf16 v[88:91], v[208:211], a[40:43], v[88:91]
v_mfma_f32_16x16x32_bf16 v[92:95], v[208:211], a[44:47], v[92:95]
s_waitcnt lgkmcnt(6)
v_mfma_f32_16x16x32_bf16 v[96:99], v[192:195], a[32:35], v[96:99]
s_add_u32 s52, s54, 24576
ds_read_b64_tr_b16 v[208:209], v228 offset:24576
ds_read_b64_tr_b16 v[210:211], v228 offset:25088
v_mfma_f32_16x16x32_bf16 v[100:103], v[192:195], a[36:39], v[100:103]
buffer_load_dwordx4 a[96:99], v250, s[28:31], s52 offen sc1
v_bfe_u32 v222, v237, 4, 4
v_mfma_f32_16x16x32_bf16 v[104:107], v[192:195], a[40:43], v[104:107]
v_mfma_f32_16x16x32_bf16 v[108:111], v[192:195], a[44:47], v[108:111]
s_waitcnt lgkmcnt(6)
v_mfma_f32_16x16x32_bf16 v[112:115], v[196:199], a[32:35], v[112:115]
s_lshr_b32 s6, s6, 1
ds_read_b64_tr_b16 v[192:193], v228 offset:28672
ds_read_b64_tr_b16 v[194:195], v228 offset:29184
v_mfma_f32_16x16x32_bf16 v[116:119], v[196:199], a[36:39], v[116:119]
s_mul_i32 s6, s6, 36
buffer_load_dwordx4 a[100:103], v251, s[28:31], s52 offen sc1
v_mfma_f32_16x16x32_bf16 v[120:123], v[196:199], a[40:43], v[120:123]
v_mfma_f32_16x16x32_bf16 v[124:127], v[196:199], a[44:47], v[124:127]
s_waitcnt lgkmcnt(6)
v_mfma_f32_16x16x32_bf16 v[128:131], v[200:203], a[32:35], v[128:131]
s_add_u32 s9, s9, s6
ds_read_b64_tr_b16 v[196:197], v229 offset:24576
ds_read_b64_tr_b16 v[198:199], v229 offset:25088
v_mfma_f32_16x16x32_bf16 v[132:135], v[200:203], a[36:39], v[132:135]
buffer_load_dwordx4 a[104:107], v252, s[28:31], s52 offen sc1
v_lshrrev_b32 v223, 8, v237
v_mfma_f32_16x16x32_bf16 v[136:139], v[200:203], a[40:43], v[136:139]
v_mfma_f32_16x16x32_bf16 v[140:143], v[200:203], a[44:47], v[140:143]
s_waitcnt lgkmcnt(6)
v_mfma_f32_16x16x32_bf16 v[144:147], v[204:207], a[32:35], v[144:147]
s_mul_i32 s9, s9, 4608
ds_read_b64_tr_b16 v[200:201], v229 offset:28672
ds_read_b64_tr_b16 v[202:203], v229 offset:29184
v_mfma_f32_16x16x32_bf16 v[148:151], v[204:207], a[36:39], v[148:151]
buffer_load_dwordx4 a[108:111], v253, s[28:31], s52 offen sc1
v_mfma_f32_16x16x32_bf16 v[152:155], v[204:207], a[40:43], v[152:155]
v_mfma_f32_16x16x32_bf16 v[156:159], v[204:207], a[44:47], v[156:159]
s_waitcnt vmcnt(14) lgkmcnt(6)
v_mfma_f32_16x16x32_bf16 v[32:35], v[208:211], a[48:51], v[32:35]
s_add_u32 s9, s9, 21495808
ds_read_b64_tr_b16 v[204:205], v230 offset:24576
ds_read_b64_tr_b16 v[206:207], v230 offset:25088
v_mfma_f32_16x16x32_bf16 v[36:39], v[208:211], a[52:55], v[36:39]
v_mul_u32_u24 v222, 1152, v222
v_mfma_f32_16x16x32_bf16 v[40:43], v[208:211], a[56:59], v[40:43]
v_mfma_f32_16x16x32_bf16 v[44:47], v[208:211], a[60:63], v[44:47]
s_waitcnt lgkmcnt(6)
v_mfma_f32_16x16x32_bf16 v[48:51], v[192:195], a[48:51], v[48:51]
s_add_u32 s52, s54, 28672
ds_read_b64_tr_b16 v[208:209], v230 offset:28672
ds_read_b64_tr_b16 v[210:211], v230 offset:29184
v_mfma_f32_16x16x32_bf16 v[52:55], v[192:195], a[52:55], v[52:55]
s_cmp_lt_u32 s4, 4608
s_cselect_b32 s9, s9, 0x40000000
buffer_load_dwordx4 a[112:115], v250, s[28:31], s52 offen sc1
v_mfma_f32_16x16x32_bf16 v[56:59], v[192:195], a[56:59], v[56:59]
v_mfma_f32_16x16x32_bf16 v[60:63], v[192:195], a[60:63], v[60:63]
s_waitcnt lgkmcnt(6)
v_mfma_f32_16x16x32_bf16 v[64:67], v[196:199], a[48:51], v[64:67]
ds_read_b64_tr_b16 v[192:193], v231 offset:24576
ds_read_b64_tr_b16 v[194:195], v231 offset:25088
v_mfma_f32_16x16x32_bf16 v[68:71], v[196:199], a[52:55], v[68:71]
buffer_load_dwordx4 a[116:119], v251, s[28:31], s52 offen sc1
v_add_u32 v222, s85, v222
v_mfma_f32_16x16x32_bf16 v[72:75], v[196:199], a[56:59], v[72:75]
v_mfma_f32_16x16x32_bf16 v[76:79], v[196:199], a[60:63], v[76:79]
s_waitcnt lgkmcnt(6)
v_mfma_f32_16x16x32_bf16 v[80:83], v[200:203], a[48:51], v[80:83]
s_and_b32 s4, s4, 31
ds_read_b64_tr_b16 v[196:197], v231 offset:28672
ds_read_b64_tr_b16 v[198:199], v231 offset:29184
v_mfma_f32_16x16x32_bf16 v[84:87], v[200:203], a[52:55], v[84:87]
buffer_load_dwordx4 a[120:123], v252, s[28:31], s52 offen sc1
v_mfma_f32_16x16x32_bf16 v[88:91], v[200:203], a[56:59], v[88:91]
v_mfma_f32_16x16x32_bf16 v[92:95], v[200:203], a[60:63], v[92:95]
s_waitcnt lgkmcnt(6)
v_mfma_f32_16x16x32_bf16 v[96:99], v[204:207], a[48:51], v[96:99]
s_lshl_b32 s4, s4, 4
ds_read_b64_tr_b16 v[200:201], v228 offset:32768
ds_read_b64_tr_b16 v[202:203], v228 offset:33280
v_mfma_f32_16x16x32_bf16 v[100:103], v[204:207], a[52:55], v[100:103]
buffer_load_dwordx4 a[124:127], v253, s[28:31], s52 offen sc1
v_xor_b32 v212, s4, v241
v_mfma_f32_16x16x32_bf16 v[104:107], v[204:207], a[56:59], v[104:107]
v_lshl_add_u32 v221, v223, 3, v222
v_mfma_f32_16x16x32_bf16 v[108:111], v[204:207], a[60:63], v[108:111]
s_waitcnt lgkmcnt(6)
v_mfma_f32_16x16x32_bf16 v[112:115], v[208:211], a[48:51], v[112:115]
ds_read_b64_tr_b16 v[204:205], v228 offset:36864
ds_read_b64_tr_b16 v[206:207], v228 offset:37376
v_mfma_f32_16x16x32_bf16 v[116:119], v[208:211], a[52:55], v[116:119]
v_mfma_f32_16x16x32_bf16 v[120:123], v[208:211], a[56:59], v[120:123]
v_mfma_f32_16x16x32_bf16 v[124:127], v[208:211], a[60:63], v[124:127]
s_waitcnt lgkmcnt(6)
v_mfma_f32_16x16x32_bf16 v[128:131], v[192:195], a[48:51], v[128:131]
s_add_u32 s52, s54, 32768
ds_read_b64_tr_b16 v[208:209], v229 offset:32768
ds_read_b64_tr_b16 v[210:211], v229 offset:33280
v_mfma_f32_16x16x32_bf16 v[132:135], v[192:195], a[52:55], v[132:135]
buffer_load_dwordx4 a[128:131], v250, s[28:31], s52 offen sc1
v_and_b32 v220, 1, v223
v_mfma_f32_16x16x32_bf16 v[136:139], v[192:195], a[56:59], v[136:139]
v_mfma_f32_16x16x32_bf16 v[140:143], v[192:195], a[60:63], v[140:143]
s_waitcnt lgkmcnt(6)
v_mfma_f32_16x16x32_bf16 v[144:147], v[196:199], a[48:51], v[144:147]
ds_read_b64_tr_b16 v[192:193], v229 offset:36864
ds_read_b64_tr_b16 v[194:195], v229 offset:37376
v_mfma_f32_16x16x32_bf16 v[148:151], v[196:199], a[52:55], v[148:151]
buffer_load_dwordx4 a[132:135], v251, s[28:31], s52 offen sc1
v_add_u32 v212, s9, v212
v_mfma_f32_16x16x32_bf16 v[152:155], v[196:199], a[56:59], v[152:155]
v_mfma_f32_16x16x32_bf16 v[156:159], v[196:199], a[60:63], v[156:159]
s_waitcnt vmcnt(15) lgkmcnt(6)
v_mfma_f32_16x16x32_bf16 v[32:35], v[200:203], a[64:67], v[32:35]
ds_read_b64_tr_b16 v[196:197], v230 offset:32768
ds_read_b64_tr_b16 v[198:199], v230 offset:33280
v_mfma_f32_16x16x32_bf16 v[36:39], v[200:203], a[68:71], v[36:39]
buffer_load_dwordx4 a[136:139], v252, s[28:31], s52 offen sc1
v_lshl_add_u32 v222, v220, 5, v222
v_mfma_f32_16x16x32_bf16 v[40:43], v[200:203], a[72:75], v[40:43]
v_mfma_f32_16x16x32_bf16 v[44:47], v[200:203], a[76:79], v[44:47]
s_waitcnt lgkmcnt(6)
v_mfma_f32_16x16x32_bf16 v[48:51], v[204:207], a[64:67], v[48:51]
ds_read_b64_tr_b16 v[200:201], v230 offset:36864
ds_read_b64_tr_b16 v[202:203], v230 offset:37376
v_mfma_f32_16x16x32_bf16 v[52:55], v[204:207], a[68:71], v[52:55]
buffer_load_dwordx4 a[140:143], v253, s[28:31], s52 offen sc1
v_mfma_f32_16x16x32_bf16 v[56:59], v[204:207], a[72:75], v[56:59]
v_mfma_f32_16x16x32_bf16 v[60:63], v[204:207], a[76:79], v[60:63]
s_waitcnt lgkmcnt(6)
v_mfma_f32_16x16x32_bf16 v[64:67], v[208:211], a[64:67], v[64:67]
s_add_u32 s4, s59, 8
ds_read_b64_tr_b16 v[204:205], v231 offset:32768
ds_read_b64_tr_b16 v[206:207], v231 offset:33280
v_mfma_f32_16x16x32_bf16 v[68:71], v[208:211], a[68:71], v[68:71]
v_lshrrev_b32 v223, 1, v223
v_mfma_f32_16x16x32_bf16 v[72:75], v[208:211], a[72:75], v[72:75]
v_mfma_f32_16x16x32_bf16 v[76:79], v[208:211], a[76:79], v[76:79]
s_waitcnt lgkmcnt(6)
v_mfma_f32_16x16x32_bf16 v[80:83], v[192:195], a[64:67], v[80:83]
s_add_u32 s52, s54, 36864
ds_read_b64_tr_b16 v[208:209], v231 offset:36864
ds_read_b64_tr_b16 v[210:211], v231 offset:37376
v_mfma_f32_16x16x32_bf16 v[84:87], v[192:195], a[68:71], v[84:87]
s_lshr_b32 s5, s4, 6
buffer_load_dwordx4 a[144:147], v250, s[28:31], s52 offen sc1
v_mfma_f32_16x16x32_bf16 v[88:91], v[192:195], a[72:75], v[88:91]
v_mfma_f32_16x16x32_bf16 v[92:95], v[192:195], a[76:79], v[92:95]
s_waitcnt lgkmcnt(6)
v_mfma_f32_16x16x32_bf16 v[96:99], v[196:199], a[64:67], v[96:99]
s_mul_i32 s6, s5, 57
ds_read_b64_tr_b16 v[192:193], v228 offset:40960
ds_read_b64_tr_b16 v[194:195], v228 offset:41472
v_mfma_f32_16x16x32_bf16 v[100:103], v[196:199], a[68:71], v[100:103]
buffer_load_dwordx4 a[148:151], v251, s[28:31], s52 offen sc1
v_lshl_add_u32 v220, v223, 4, v222
v_mfma_f32_16x16x32_bf16 v[104:107], v[196:199], a[72:75], v[104:107]
v_mfma_f32_16x16x32_bf16 v[108:111], v[196:199], a[76:79], v[108:111]
s_waitcnt lgkmcnt(6)
v_mfma_f32_16x16x32_bf16 v[112:115], v[200:203], a[64:67], v[112:115]
s_lshr_b32 s6, s6, 9
ds_read_b64_tr_b16 v[196:197], v228 offset:45056
ds_read_b64_tr_b16 v[198:199], v228 offset:45568
v_mfma_f32_16x16x32_bf16 v[116:119], v[200:203], a[68:71], v[116:119]
buffer_load_dwordx4 a[152:155], v252, s[28:31], s52 offen sc1
v_mfma_f32_16x16x32_bf16 v[120:123], v[200:203], a[72:75], v[120:123]
v_mfma_f32_16x16x32_bf16 v[124:127], v[200:203], a[76:79], v[124:127]
s_waitcnt lgkmcnt(6)
v_mfma_f32_16x16x32_bf16 v[128:131], v[204:207], a[64:67], v[128:131]
s_mul_i32 s7, s6, 9
ds_read_b64_tr_b16 v[200:201], v229 offset:40960
ds_read_b64_tr_b16 v[202:203], v229 offset:41472
v_mfma_f32_16x16x32_bf16 v[132:135], v[204:207], a[68:71], v[132:135]
buffer_load_dwordx4 a[156:159], v253, s[28:31], s52 offen sc1
v_lshl_add_u32 v221, v223, 30, v221
v_mfma_f32_16x16x32_bf16 v[136:139], v[204:207], a[72:75], v[136:139]
v_mfma_f32_16x16x32_bf16 v[140:143], v[204:207], a[76:79], v[140:143]
s_waitcnt lgkmcnt(6)
v_mfma_f32_16x16x32_bf16 v[144:147], v[208:211], a[64:67], v[144:147]
s_sub_u32 s5, s5, s7
ds_read_b64_tr_b16 v[204:205], v229 offset:45056
ds_read_b64_tr_b16 v[206:207], v229 offset:45568
v_mfma_f32_16x16x32_bf16 v[148:151], v[208:211], a[68:71], v[148:151]
s_bfe_u32 s7, s4, 0x10005
v_mfma_f32_16x16x32_bf16 v[152:155], v[208:211], a[72:75], v[152:155]
v_mfma_f32_16x16x32_bf16 v[156:159], v[208:211], a[76:79], v[156:159]
s_waitcnt vmcnt(17) lgkmcnt(6)
v_mfma_f32_16x16x32_bf16 v[32:35], v[192:195], a[80:83], v[32:35]
s_add_u32 s52, s54, 40960
ds_read_b64_tr_b16 v[208:209], v230 offset:40960
ds_read_b64_tr_b16 v[210:211], v230 offset:41472
v_mfma_f32_16x16x32_bf16 v[36:39], v[192:195], a[84:87], v[36:39]
s_and_b32 s8, s6, 1
buffer_load_dwordx4 a[160:163], v250, s[28:31], s52 offen sc1
v_mfma_f32_16x16x32_bf16 v[40:43], v[192:195], a[88:91], v[40:43]
v_mfma_f32_16x16x32_bf16 v[44:47], v[192:195], a[92:95], v[44:47]
s_waitcnt lgkmcnt(6)
v_mfma_f32_16x16x32_bf16 v[48:51], v[196:199], a[80:83], v[48:51]
s_lshl_b32 s9, s8, 2
ds_read_b64_tr_b16 v[192:193], v230 offset:45056
ds_read_b64_tr_b16 v[194:195], v230 offset:45568
v_mfma_f32_16x16x32_bf16 v[52:55], v[196:199], a[84:87], v[52:55]
buffer_load_dwordx4 a[164:167], v251, s[28:31], s52 offen sc1
v_mfma_f32_16x16x32_bf16 v[56:59], v[196:199], a[88:91], v[56:59]
v_mfma_f32_16x16x32_bf16 v[60:63], v[196:199], a[92:95], v[60:63]
s_waitcnt lgkmcnt(6)
v_mfma_f32_16x16x32_bf16 v[64:67], v[200:203], a[80:83], v[64:67]
s_add_u32 s9, s9, s5
ds_read_b64_tr_b16 v[196:197], v231 offset:40960
ds_read_b64_tr_b16 v[198:199], v231 offset:41472
v_mfma_f32_16x16x32_bf16 v[68:71], v[200:203], a[84:87], v[68:71]
buffer_load_dwordx4 a[168:171], v252, s[28:31], s52 offen sc1
v_mfma_f32_16x16x32_bf16 v[72:75], v[200:203], a[88:91], v[72:75]
v_mfma_f32_16x16x32_bf16 v[76:79], v[200:203], a[92:95], v[76:79]
s_waitcnt lgkmcnt(6)
v_mfma_f32_16x16x32_bf16 v[80:83], v[204:207], a[80:83], v[80:83]
s_lshl_b32 s10, s7, 3
ds_read_b64_tr_b16 v[200:201], v231 offset:45056
ds_read_b64_tr_b16 v[202:203], v231 offset:45568
v_mfma_f32_16x16x32_bf16 v[84:87], v[204:207], a[84:87], v[84:87]
buffer_load_dwordx4 a[172:175], v253, s[28:31], s52 offen sc1
v_mfma_f32_16x16x32_bf16 v[88:91], v[204:207], a[88:91], v[88:91]
v_mfma_f32_16x16x32_bf16 v[92:95], v[204:207], a[92:95], v[92:95]
s_waitcnt lgkmcnt(6)
v_mfma_f32_16x16x32_bf16 v[96:99], v[208:211], a[80:83], v[96:99]
s_add_u32 s9, s9, s10
ds_read_b64_tr_b16 v[204:205], v228 offset:49152
ds_read_b64_tr_b16 v[206:207], v228 offset:49664
v_mfma_f32_16x16x32_bf16 v[100:103], v[208:211], a[84:87], v[100:103]
v_mfma_f32_16x16x32_bf16 v[104:107], v[208:211], a[88:91], v[104:107]
v_mfma_f32_16x16x32_bf16 v[108:111], v[208:211], a[92:95], v[108:111]
s_waitcnt lgkmcnt(6)
v_mfma_f32_16x16x32_bf16 v[112:115], v[192:195], a[80:83], v[112:115]
s_add_u32 s52, s54, 45056
ds_read_b64_tr_b16 v[208:209], v228 offset:53248
ds_read_b64_tr_b16 v[210:211], v228 offset:53760
v_mfma_f32_16x16x32_bf16 v[116:119], v[192:195], a[84:87], v[116:119]
s_cmp_ge_u32 s9, 6
s_cselect_b32 s10, 4, 0
buffer_load_dwordx4 a[176:179], v250, s[28:31], s52 offen sc1
v_mfma_f32_16x16x32_bf16 v[120:123], v[192:195], a[88:91], v[120:123]
v_mfma_f32_16x16x32_bf16 v[124:127], v[192:195], a[92:95], v[124:127]
s_waitcnt lgkmcnt(6)
v_mfma_f32_16x16x32_bf16 v[128:131], v[196:199], a[80:83], v[128:131]
ds_read_b64_tr_b16 v[192:193], v229 offset:49152
ds_read_b64_tr_b16 v[194:195], v229 offset:49664
v_mfma_f32_16x16x32_bf16 v[132:135], v[196:199], a[84:87], v[132:135]
s_cmp_gt_u32 s5, 4
s_cselect_b32 s10, 15, s10
buffer_load_dwordx4 a[180:183], v251, s[28:31], s52 offen sc1
v_mfma_f32_16x16x32_bf16 v[136:139], v[196:199], a[88:91], v[136:139]
v_mfma_f32_16x16x32_bf16 v[140:143], v[196:199], a[92:95], v[140:143]
s_waitcnt lgkmcnt(6)
v_mfma_f32_16x16x32_bf16 v[144:147], v[200:203], a[80:83], v[144:147]
ds_read_b64_tr_b16 v[196:197], v229 offset:53248
ds_read_b64_tr_b16 v[198:199], v229 offset:53760
v_mfma_f32_16x16x32_bf16 v[148:151], v[200:203], a[84:87], v[148:151]
buffer_load_dwordx4 a[184:187], v252, s[28:31], s52 offen sc1
v_mfma_f32_16x16x32_bf16 v[152:155], v[200:203], a[88:91], v[152:155]
v_mfma_f32_16x16x32_bf16 v[156:159], v[200:203], a[92:95], v[156:159]
s_waitcnt vmcnt(19) lgkmcnt(6)
v_mfma_f32_16x16x32_bf16 v[32:35], v[204:207], a[96:99], v[32:35]
s_add_u32 s9, s9, s10
ds_read_b64_tr_b16 v[200:201], v230 offset:49152
ds_read_b64_tr_b16 v[202:203], v230 offset:49664
v_mfma_f32_16x16x32_bf16 v[36:39], v[204:207], a[100:103], v[36:39]
buffer_load_dwordx4 a[188:191], v253, s[28:31], s52 offen sc1
v_mfma_f32_16x16x32_bf16 v[40:43], v[204:207], a[104:107], v[40:43]
v_mfma_f32_16x16x32_bf16 v[44:47], v[204:207], a[108:111], v[44:47]
s_waitcnt lgkmcnt(6)
v_mfma_f32_16x16x32_bf16 v[48:51], v[208:211], a[96:99], v[48:51]
s_lshl_b32 s8, s8, 1
ds_read_b64_tr_b16 v[204:205], v230 offset:53248
ds_read_b64_tr_b16 v[206:207], v230 offset:53760
v_mfma_f32_16x16x32_bf16 v[52:55], v[208:211], a[100:103], v[52:55]
v_mfma_f32_16x16x32_bf16 v[56:59], v[208:211], a[104:107], v[56:59]
v_mfma_f32_16x16x32_bf16 v[60:63], v[208:211], a[108:111], v[60:63]
s_waitcnt lgkmcnt(6)
v_mfma_f32_16x16x32_bf16 v[64:67], v[192:195], a[96:99], v[64:67]
s_add_u32 s52, s54, 49152
ds_read_b64_tr_b16 v[208:209], v231 offset:49152
ds_read_b64_tr_b16 v[210:211], v231 offset:49664
v_mfma_f32_16x16x32_bf16 v[68:71], v[192:195], a[100:103], v[68:71]
s_add_u32 s8, s8, s7
buffer_load_dwordx4 a[192:195], v250, s[28:31], s52 offen sc1
v_mfma_f32_16x16x32_bf16 v[72:75], v[192:195], a[104:107], v[72:75]
v_mfma_f32_16x16x32_bf16 v[76:79], v[192:195], a[108:111], v[76:79]
s_waitcnt lgkmcnt(6)
v_mfma_f32_16x16x32_bf16 v[80:83], v[196:199], a[96:99], v[80:83]
s_add_u32 s8, s8, 6
ds_read_b64_tr_b16 v[192:193], v231 offset:53248
ds_read_b64_tr_b16 v[194:195], v231 offset:53760
v_mfma_f32_16x16x32_bf16 v[84:87], v[196:199], a[100:103], v[84:87]
buffer_load_dwordx4 a[196:199], v251, s[28:31], s52 offen sc1
v_mfma_f32_16x16x32_bf16 v[88:91], v[196:199], a[104:107], v[88:91]
v_mfma_f32_16x16x32_bf16 v[92:95], v[196:199], a[108:111], v[92:95]
s_waitcnt lgkmcnt(6)
v_mfma_f32_16x16x32_bf16 v[96:99], v[200:203], a[96:99], v[96:99]
ds_read_b64_tr_b16 v[196:197], v228 offset:57344
ds_read_b64_tr_b16 v[198:199], v228 offset:57856
v_mfma_f32_16x16x32_bf16 v[100:103], v[200:203], a[100:103], v[100:103]
s_cmp_eq_u32 s5, 4
s_cselect_b32 s9, s8, s9
buffer_load_dwordx4 a[200:203], v252, s[28:31], s52 offen sc1
v_mfma_f32_16x16x32_bf16 v[104:107], v[200:203], a[104:107], v[104:107]
global_load_dword v246, v245, s[62:63] sc1
v_mfma_f32_16x16x32_bf16 v[108:111], v[200:203], a[108:111], v[108:111]
s_waitcnt lgkmcnt(6)
v_mfma_f32_16x16x32_bf16 v[112:115], v[204:207], a[96:99], v[112:115]
s_lshr_b32 s6, s6, 1
ds_read_b64_tr_b16 v[200:201], v228 offset:61440
ds_read_b64_tr_b16 v[202:203], v228 offset:61952
v_mfma_f32_16x16x32_bf16 v[116:119], v[204:207], a[100:103], v[116:119]
buffer_load_dwordx4 a[204:207], v253, s[28:31], s52 offen sc1
v_mfma_f32_16x16x32_bf16 v[120:123], v[204:207], a[104:107], v[120:123]
v_mfma_f32_16x16x32_bf16 v[124:127], v[204:207], a[108:111], v[124:127]
s_waitcnt lgkmcnt(6)
v_mfma_f32_16x16x32_bf16 v[128:131], v[208:211], a[96:99], v[128:131]
s_mul_i32 s6, s6, 36
ds_read_b64_tr_b16 v[204:205], v229 offset:57344
ds_read_b64_tr_b16 v[206:207], v229 offset:57856
v_mfma_f32_16x16x32_bf16 v[132:135], v[208:211], a[100:103], v[132:135]
v_mfma_f32_16x16x32_bf16 v[136:139], v[208:211], a[104:107], v[136:139]
v_mfma_f32_16x16x32_bf16 v[140:143], v[208:211], a[108:111], v[140:143]
s_waitcnt lgkmcnt(6)
v_mfma_f32_16x16x32_bf16 v[144:147], v[192:195], a[96:99], v[144:147]
s_add_u32 s52, s54, 53248
ds_read_b64_tr_b16 v[208:209], v229 offset:61440
ds_read_b64_tr_b16 v[210:211], v229 offset:61952
v_mfma_f32_16x16x32_bf16 v[148:151], v[192:195], a[100:103], v[148:151]
s_add_u32 s9, s9, s6
buffer_load_dwordx4 a[208:211], v250, s[28:31], s52 offen sc1
v_mfma_f32_16x16x32_bf16 v[152:155], v[192:195], a[104:107], v[152:155]
v_mfma_f32_16x16x32_bf16 v[156:159], v[192:195], a[108:111], v[156:159]
s_waitcnt vmcnt(22) lgkmcnt(6)
v_mfma_f32_16x16x32_bf16 v[32:35], v[196:199], a[112:115], v[32:35]
s_mul_i32 s9, s9, 4608
ds_read_b64_tr_b16 v[192:193], v230 offset:57344
ds_read_b64_tr_b16 v[194:195], v230 offset:57856
v_mfma_f32_16x16x32_bf16 v[36:39], v[196:199], a[116:119], v[36:39]
buffer_load_dwordx4 a[212:215], v251, s[28:31], s52 offen sc1
v_mfma_f32_16x16x32_bf16 v[40:43], v[196:199], a[120:123], v[40:43]
v_mfma_f32_16x16x32_bf16 v[44:47], v[196:199], a[124:127], v[44:47]
s_waitcnt lgkmcnt(6)
v_mfma_f32_16x16x32_bf16 v[48:51], v[200:203], a[112:115], v[48:51]
s_add_u32 s9, s9, 21495808
ds_read_b64_tr_b16 v[196:197], v230 offset:61440
ds_read_b64_tr_b16 v[198:199], v230 offset:61952
v_mfma_f32_16x16x32_bf16 v[52:55], v[200:203], a[116:119], v[52:55]
buffer_load_dwordx4 a[216:219], v252, s[28:31], s52 offen sc1
v_mfma_f32_16x16x32_bf16 v[56:59], v[200:203], a[120:123], v[56:59]
v_mfma_f32_16x16x32_bf16 v[60:63], v[200:203], a[124:127], v[60:63]
s_waitcnt lgkmcnt(6)
v_mfma_f32_16x16x32_bf16 v[64:67], v[204:207], a[112:115], v[64:67]
ds_read_b64_tr_b16 v[200:201], v231 offset:57344
ds_read_b64_tr_b16 v[202:203], v231 offset:57856
v_mfma_f32_16x16x32_bf16 v[68:71], v[204:207], a[116:119], v[68:71]
s_cmp_lt_u32 s4, 4608
s_cselect_b32 s9, s9, 0x40000000
buffer_load_dwordx4 a[220:223], v253, s[28:31], s52 offen sc1
v_mfma_f32_16x16x32_bf16 v[72:75], v[204:207], a[120:123], v[72:75]
v_mfma_f32_16x16x32_bf16 v[76:79], v[204:207], a[124:127], v[76:79]
s_waitcnt lgkmcnt(6)
v_mfma_f32_16x16x32_bf16 v[80:83], v[208:211], a[112:115], v[80:83]
s_and_b32 s4, s4, 31
ds_read_b64_tr_b16 v[204:205], v231 offset:61440
ds_read_b64_tr_b16 v[206:207], v231 offset:61952
v_mfma_f32_16x16x32_bf16 v[84:87], v[208:211], a[116:119], v[84:87]
v_add_u32 v228, 65536, v228
v_mfma_f32_16x16x32_bf16 v[88:91], v[208:211], a[120:123], v[88:91]
v_mfma_f32_16x16x32_bf16 v[92:95], v[208:211], a[124:127], v[92:95]
s_waitcnt lgkmcnt(6)
v_mfma_f32_16x16x32_bf16 v[96:99], v[192:195], a[112:115], v[96:99]
s_add_u32 s52, s54, 57344
ds_read_b64_tr_b16 v[208:209], v228 offset:0
ds_read_b64_tr_b16 v[210:211], v228 offset:512
v_mfma_f32_16x16x32_bf16 v[100:103], v[192:195], a[116:119], v[100:103]
TCH_1_v1:
s_cbranch_execz TCH_5_v1
s_lshl_b32 s4, s4, 4
buffer_load_dwordx4 a[224:227], v250, s[28:31], s52 offen sc1
v_mfma_f32_16x16x32_bf16 v[104:107], v[192:195], a[120:123], v[104:107]
v_mfma_f32_16x16x32_bf16 v[108:111], v[192:195], a[124:127], v[108:111]
s_waitcnt lgkmcnt(6)
v_mfma_f32_16x16x32_bf16 v[112:115], v[196:199], a[112:115], v[112:115]
ds_read_b64_tr_b16 v[192:193], v228 offset:4096
ds_read_b64_tr_b16 v[194:195], v228 offset:4608
v_mfma_f32_16x16x32_bf16 v[116:119], v[196:199], a[116:119], v[116:119]
v_add_u32 v229, 65536, v229
v_xor_b32 v213, s4, v241
v_mfma_f32_16x16x32_bf16 v[120:123], v[196:199], a[120:123], v[120:123]
buffer_load_dwordx4 a[228:231], v251, s[28:31], s52 offen sc1
v_mfma_f32_16x16x32_bf16 v[124:127], v[196:199], a[124:127], v[124:127]
s_waitcnt lgkmcnt(6)
v_mfma_f32_16x16x32_bf16 v[128:131], v[200:203], a[112:115], v[128:131]
ds_read_b64_tr_b16 v[196:197], v229 offset:0
ds_read_b64_tr_b16 v[198:199], v229 offset:512
v_mfma_f32_16x16x32_bf16 v[132:135], v[200:203], a[116:119], v[132:135]
buffer_load_dwordx4 a[232:235], v252, s[28:31], s52 offen sc1
v_mfma_f32_16x16x32_bf16 v[136:139], v[200:203], a[120:123], v[136:139]
v_mfma_f32_16x16x32_bf16 v[140:143], v[200:203], a[124:127], v[140:143]
s_waitcnt lgkmcnt(6)
v_mfma_f32_16x16x32_bf16 v[144:147], v[204:207], a[112:115], v[144:147]
ds_read_b64_tr_b16 v[200:201], v229 offset:4096
ds_read_b64_tr_b16 v[202:203], v229 offset:4608
v_mfma_f32_16x16x32_bf16 v[148:151], v[204:207], a[116:119], v[148:151]
v_add_u32 v230, 65536, v230
v_mfma_f32_16x16x32_bf16 v[152:155], v[204:207], a[120:123], v[152:155]
buffer_load_dwordx4 a[236:239], v253, s[28:31], s52 offen sc1
v_mfma_f32_16x16x32_bf16 v[156:159], v[204:207], a[124:127], v[156:159]
s_waitcnt vmcnt(25) lgkmcnt(6)
v_mfma_f32_16x16x32_bf16 v[32:35], v[208:211], a[128:131], v[32:35]
ds_read_b64_tr_b16 v[204:205], v230 offset:0
ds_read_b64_tr_b16 v[206:207], v230 offset:512
v_mfma_f32_16x16x32_bf16 v[36:39], v[208:211], a[132:135], v[36:39]
v_add_u32 v213, s9, v213
v_mfma_f32_16x16x32_bf16 v[40:43], v[208:211], a[136:139], v[40:43]
v_mfma_f32_16x16x32_bf16 v[44:47], v[208:211], a[140:143], v[44:47]
s_waitcnt lgkmcnt(6)
v_mfma_f32_16x16x32_bf16 v[48:51], v[192:195], a[128:131], v[48:51]
s_add_u32 s52, s54, 61440
ds_read_b64_tr_b16 v[208:209], v230 offset:4096
ds_read_b64_tr_b16 v[210:211], v230 offset:4608
v_mfma_f32_16x16x32_bf16 v[52:55], v[192:195], a[132:135], v[52:55]
v_add_u32 v231, 65536, v231
v_mfma_f32_16x16x32_bf16 v[56:59], v[192:195], a[136:139], v[56:59]
buffer_load_dwordx4 a[240:243], v250, s[28:31], s52 offen sc1
v_mfma_f32_16x16x32_bf16 v[60:63], v[192:195], a[140:143], v[60:63]
s_waitcnt lgkmcnt(6)
v_mfma_f32_16x16x32_bf16 v[64:67], v[196:199], a[128:131], v[64:67]
ds_read_b64_tr_b16 v[192:193], v231 offset:0
ds_read_b64_tr_b16 v[194:195], v231 offset:512
v_mfma_f32_16x16x32_bf16 v[68:71], v[196:199], a[132:135], v[68:71]
buffer_load_dwordx4 a[244:247], v251, s[28:31], s52 offen sc1
v_mfma_f32_16x16x32_bf16 v[72:75], v[196:199], a[136:139], v[72:75]
v_mfma_f32_16x16x32_bf16 v[76:79], v[196:199], a[140:143], v[76:79]
s_waitcnt lgkmcnt(6)
v_mfma_f32_16x16x32_bf16 v[80:83], v[200:203], a[128:131], v[80:83]
s_add_u32 s4, s59, 16
ds_read_b64_tr_b16 v[196:197], v231 offset:4096
ds_read_b64_tr_b16 v[198:199], v231 offset:4608
v_mfma_f32_16x16x32_bf16 v[84:87], v[200:203], a[132:135], v[84:87]
buffer_load_dwordx4 a[248:251], v252, s[28:31], s52 offen sc1
v_mfma_f32_16x16x32_bf16 v[88:91], v[200:203], a[136:139], v[88:91]
s_waitcnt vmcnt(12)
v_cmp_gt_u32 vcc, 32, v246
v_mfma_f32_16x16x32_bf16 v[92:95], v[200:203], a[140:143], v[92:95]
s_waitcnt lgkmcnt(6)
v_mfma_f32_16x16x32_bf16 v[96:99], v[204:207], a[128:131], v[96:99]
s_lshr_b32 s5, s4, 6
ds_read_b64_tr_b16 v[200:201], v228 offset:8192
ds_read_b64_tr_b16 v[202:203], v228 offset:8704
v_mfma_f32_16x16x32_bf16 v[100:103], v[204:207], a[132:135], v[100:103]
s_cbranch_vccnz spin_2_v1
ok_1_v1:
v_mfma_f32_16x16x32_bf16 v[104:107], v[204:207], a[136:139], v[104:107]
buffer_load_dwordx4 a[252:255], v253, s[28:31], s52 offen sc1
v_mfma_f32_16x16x32_bf16 v[108:111], v[204:207], a[140:143], v[108:111]
s_waitcnt lgkmcnt(6)
v_mfma_f32_16x16x32_bf16 v[112:115], v[208:211], a[128:131], v[112:115]
s_mul_i32 s6, s5, 57
ds_read_b64_tr_b16 v[204:205], v228 offset:12288
ds_read_b64_tr_b16 v[206:207], v228 offset:12800
v_mfma_f32_16x16x32_bf16 v[116:119], v[208:211], a[132:135], v[116:119]
s_lshr_b32 s6, s6, 9
v_mfma_f32_16x16x32_bf16 v[120:123], v[208:211], a[136:139], v[120:123]
v_mfma_f32_16x16x32_bf16 v[124:127], v[208:211], a[140:143], v[124:127]
s_waitcnt lgkmcnt(6)
v_mfma_f32_16x16x32_bf16 v[128:131], v[192:195], a[128:131], v[128:131]
s_add_u32 s52, s54, 65536
ds_read_b64_tr_b16 v[208:209], v229 offset:8192
ds_read_b64_tr_b16 v[210:211], v229 offset:8704
v_mfma_f32_16x16x32_bf16 v[132:135], v[192:195], a[132:135], v[132:135]
s_mul_i32 s7, s6, 9
buffer_load_dwordx4 v[0:3], v250, s[28:31], s52 offen sc1
v_mfma_f32_16x16x32_bf16 v[136:139], v[192:195], a[136:139], v[136:139]
v_mfma_f32_16x16x32_bf16 v[140:143], v[192:195], a[140:143], v[140:143]
s_waitcnt lgkmcnt(6)
v_mfma_f32_16x16x32_bf16 v[144:147], v[196:199], a[128:131], v[144:147]
s_sub_u32 s5, s5, s7
ds_read_b64_tr_b16 v[192:193], v229 offset:12288
ds_read_b64_tr_b16 v[194:195], v229 offset:12800
v_mfma_f32_16x16x32_bf16 v[148:151], v[196:199], a[132:135], v[148:151]
buffer_load_dwordx4 v[4:7], v251, s[28:31], s52 offen sc1
v_mfma_f32_16x16x32_bf16 v[152:155], v[196:199], a[136:139], v[152:155]
v_mfma_f32_16x16x32_bf16 v[156:159], v[196:199], a[140:143], v[156:159]
s_waitcnt vmcnt(27) lgkmcnt(6)
v_mfma_f32_16x16x32_bf16 v[32:35], v[200:203], a[144:147], v[32:35]
s_bfe_u32 s7, s4, 0x10005
ds_read_b64_tr_b16 v[196:197], v230 offset:8192
ds_read_b64_tr_b16 v[198:199], v230 offset:8704
v_mfma_f32_16x16x32_bf16 v[36:39], v[200:203], a[148:151], v[36:39]
buffer_load_dwordx4 v[8:11], v252, s[28:31], s52 offen sc1
v_mfma_f32_16x16x32_bf16 v[40:43], v[200:203], a[152:155], v[40:43]
v_mfma_f32_16x16x32_bf16 v[44:47], v[200:203], a[156:159], v[44:47]
s_waitcnt lgkmcnt(6)
v_mfma_f32_16x16x32_bf16 v[48:51], v[204:207], a[144:147], v[48:51]
s_and_b32 s8, s6, 1
ds_read_b64_tr_b16 v[200:201], v230 offset:12288
ds_read_b64_tr_b16 v[202:203], v230 offset:12800
v_mfma_f32_16x16x32_bf16 v[52:55], v[204:207], a[148:151], v[52:55]
buffer_load_dwordx4 v[12:15], v253, s[28:31], s52 offen sc1
v_mfma_f32_16x16x32_bf16 v[56:59], v[204:207], a[152:155], v[56:59]
v_mfma_f32_16x16x32_bf16 v[60:63], v[204:207], a[156:159], v[60:63]
s_waitcnt lgkmcnt(6)
v_mfma_f32_16x16x32_bf16 v[64:67], v[208:211], a[144:147], v[64:67]
s_lshl_b32 s9, s8, 2
ds_read_b64_tr_b16 v[204:205], v231 offset:8192
ds_read_b64_tr_b16 v[206:207], v231 offset:8704
v_mfma_f32_16x16x32_bf16 v[68:71], v[208:211], a[148:151], v[68:71]
v_mfma_f32_16x16x32_bf16 v[72:75], v[208:211], a[152:155], v[72:75]
v_mfma_f32_16x16x32_bf16 v[76:79], v[208:211], a[156:159], v[76:79]
s_waitcnt lgkmcnt(6)
v_mfma_f32_16x16x32_bf16 v[80:83], v[192:195], a[144:147], v[80:83]
s_add_u32 s52, s54, 69632
ds_read_b64_tr_b16 v[208:209], v231 offset:12288
ds_read_b64_tr_b16 v[210:211], v231 offset:12800
v_mfma_f32_16x16x32_bf16 v[84:87], v[192:195], a[148:151], v[84:87]
s_add_u32 s9, s9, s5
buffer_load_dwordx4 v[16:19], v250, s[28:31], s52 offen sc1
v_mfma_f32_16x16x32_bf16 v[88:91], v[192:195], a[152:155], v[88:91]
s_waitcnt vmcnt(46)
s_barrier
v_mov_b32 v238, 1
buffer_store_dword v238, off, s[40:43], s60 offset:0 sc1
v_mfma_f32_16x16x32_bf16 v[92:95], v[192:195], a[156:159], v[92:95]
s_waitcnt lgkmcnt(6)
v_mfma_f32_16x16x32_bf16 v[96:99], v[196:199], a[144:147], v[96:99]
s_lshl_b32 s10, s7, 3
ds_read_b64_tr_b16 v[192:193], v228 offset:16384
ds_read_b64_tr_b16 v[194:195], v228 offset:16896
v_mfma_f32_16x16x32_bf16 v[100:103], v[196:199], a[148:151], v[100:103]
s_add_u32 s9, s9, s10
buffer_load_dwordx4 v[20:23], v251, s[28:31], s52 offen sc1
v_mfma_f32_16x16x32_bf16 v[104:107], v[196:199], a[152:155], v[104:107]
v_mfma_f32_16x16x32_bf16 v[108:111], v[196:199], a[156:159], v[108:111]
s_waitcnt lgkmcnt(6)
v_mfma_f32_16x16x32_bf16 v[112:115], v[200:203], a[144:147], v[112:115]
ds_read_b64_tr_b16 v[196:197], v228 offset:20480
ds_read_b64_tr_b16 v[198:199], v228 offset:20992
v_mfma_f32_16x16x32_bf16 v[116:119], v[200:203], a[148:151], v[116:119]
s_cmp_ge_u32 s9, 6
s_cselect_b32 s10, 4, 0
buffer_load_dwordx4 v[24:27], v252, s[28:31], s52 offen sc1
v_mfma_f32_16x16x32_bf16 v[120:123], v[200:203], a[152:155], v[120:123]
v_mfma_f32_16x16x32_bf16 v[124:127], v[200:203], a[156:159], v[124:127]
s_waitcnt lgkmcnt(6)
v_mfma_f32_16x16x32_bf16 v[128:131], v[204:207], a[144:147], v[128:131]
ds_read_b64_tr_b16 v[200:201], v229 offset:16384
ds_read_b64_tr_b16 v[202:203], v229 offset:16896
v_mfma_f32_16x16x32_bf16 v[132:135], v[204:207], a[148:151], v[132:135]
buffer_load_dwordx4 v[28:31], v253, s[28:31], s52 offen sc1
v_mfma_f32_16x16x32_bf16 v[136:139], v[204:207], a[152:155], v[136:139]
v_mfma_f32_16x16x32_bf16 v[140:143], v[204:207], a[156:159], v[140:143]
s_waitcnt lgkmcnt(6)
v_mfma_f32_16x16x32_bf16 v[144:147], v[208:211], a[144:147], v[144:147]
ds_read_b64_tr_b16 v[204:205], v229 offset:20480
ds_read_b64_tr_b16 v[206:207], v229 offset:20992
v_mfma_f32_16x16x32_bf16 v[148:151], v[208:211], a[148:151], v[148:151]
s_cmp_gt_u32 s5, 4
s_cselect_b32 s10, 15, s10
v_mfma_f32_16x16x32_bf16 v[152:155], v[208:211], a[152:155], v[152:155]
v_mfma_f32_16x16x32_bf16 v[156:159], v[208:211], a[156:159], v[156:159]
s_waitcnt vmcnt(30) lgkmcnt(6)
v_mfma_f32_16x16x32_bf16 v[32:35], v[192:195], a[160:163], v[32:35]
ds_read_b64_tr_b16 v[208:209], v230 offset:16384
ds_read_b64_tr_b16 v[210:211], v230 offset:16896
v_mfma_f32_16x16x32_bf16 v[36:39], v[192:195], a[164:167], v[36:39]
v_mfma_f32_16x16x32_bf16 v[40:43], v[192:195], a[168:171], v[40:43]
v_mfma_f32_16x16x32_bf16 v[44:47], v[192:195], a[172:175], v[44:47]
s_waitcnt lgkmcnt(6)
v_mfma_f32_16x16x32_bf16 v[48:51], v[196:199], a[160:163], v[48:51]
s_add_u32 s9, s9, s10
ds_read_b64_tr_b16 v[192:193], v230 offset:20480
ds_read_b64_tr_b16 v[194:195], v230 offset:20992
v_mfma_f32_16x16x32_bf16 v[52:55], v[196:199], a[164:167], v[52:55]
buffer_load_dword v243, v243, s[20:23], 0 offen
v_mfma_f32_16x16x32_bf16 v[56:59], v[196:199], a[168:171], v[56:59]
v_mfma_f32_16x16x32_bf16 v[60:63], v[196:199], a[172:175], v[60:63]
s_waitcnt lgkmcnt(6)
v_mfma_f32_16x16x32_bf16 v[64:67], v[200:203], a[160:163], v[64:67]
s_lshl_b32 s8, s8, 1
ds_read_b64_tr_b16 v[196:197], v231 offset:16384
ds_read_b64_tr_b16 v[198:199], v231 offset:16896
v_mfma_f32_16x16x32_bf16 v[68:71], v[200:203], a[164:167], v[68:71]
s_add_u32 s8, s8, s7
v_mfma_f32_16x16x32_bf16 v[72:75], v[200:203], a[168:171], v[72:75]
v_mfma_f32_16x16x32_bf16 v[76:79], v[200:203], a[172:175], v[76:79]
s_waitcnt lgkmcnt(6)
v_mfma_f32_16x16x32_bf16 v[80:83], v[204:207], a[160:163], v[80:83]
s_add_u32 s8, s8, 6
ds_read_b64_tr_b16 v[200:201], v231 offset:20480
ds_read_b64_tr_b16 v[202:203], v231 offset:20992
v_mfma_f32_16x16x32_bf16 v[84:87], v[204:207], a[164:167], v[84:87]
v_mfma_f32_16x16x32_bf16 v[88:91], v[204:207], a[168:171], v[88:91]
v_mfma_f32_16x16x32_bf16 v[92:95], v[204:207], a[172:175], v[92:95]
s_waitcnt lgkmcnt(6)
v_mfma_f32_16x16x32_bf16 v[96:99], v[208:211], a[160:163], v[96:99]
s_add_u32 m0, s49, 147456
ds_read_b64_tr_b16 v[204:205], v228 offset:24576
ds_read_b64_tr_b16 v[206:207], v228 offset:25088
v_mfma_f32_16x16x32_bf16 v[100:103], v[208:211], a[164:167], v[100:103]
s_add_u32 s50, s95, 0
buffer_load_dwordx4 v240, s[24:27], s50 offen lds
v_mfma_f32_16x16x32_bf16 v[104:107], v[208:211], a[168:171], v[104:107]
s_cmp_eq_u32 s5, 4
s_cselect_b32 s9, s8, s9
v_mfma_f32_16x16x32_bf16 v[108:111], v[208:211], a[172:175], v[108:111]
s_waitcnt lgkmcnt(6)
v_mfma_f32_16x16x32_bf16 v[112:115], v[192:195], a[160:163], v[112:115]
ds_read_b64_tr_b16 v[208:209], v228 offset:28672
ds_read_b64_tr_b16 v[210:211], v228 offset:29184
v_mfma_f32_16x16x32_bf16 v[116:119], v[192:195], a[164:167], v[116:119]
v_mfma_f32_16x16x32_bf16 v[120:123], v[192:195], a[168:171], v[120:123]
v_mfma_f32_16x16x32_bf16 v[124:127], v[192:195], a[172:175], v[124:127]
s_waitcnt lgkmcnt(6)
v_mfma_f32_16x16x32_bf16 v[128:131], v[196:199], a[160:163], v[128:131]
s_lshr_b32 s6, s6, 1
ds_read_b64_tr_b16 v[192:193], v229 offset:24576
ds_read_b64_tr_b16 v[194:195], v229 offset:25088
v_mfma_f32_16x16x32_bf16 v[132:135], v[196:199], a[164:167], v[132:135]
v_mfma_f32_16x16x32_bf16 v[136:139], v[196:199], a[168:171], v[136:139]
v_mfma_f32_16x16x32_bf16 v[140:143], v[196:199], a[172:175], v[140:143]
s_waitcnt lgkmcnt(6)
v_mfma_f32_16x16x32_bf16 v[144:147], v[200:203], a[160:163], v[144:147]
s_mul_i32 s6, s6, 36
ds_read_b64_tr_b16 v[196:197], v229 offset:28672
ds_read_b64_tr_b16 v[198:199], v229 offset:29184
v_mfma_f32_16x16x32_bf16 v[148:151], v[200:203], a[164:167], v[148:151]
v_mfma_f32_16x16x32_bf16 v[152:155], v[200:203], a[168:171], v[152:155]
v_mfma_f32_16x16x32_bf16 v[156:159], v[200:203], a[172:175], v[156:159]
s_waitcnt vmcnt(28) lgkmcnt(6)
v_mfma_f32_16x16x32_bf16 v[32:35], v[204:207], a[176:179], v[32:35]
s_add_u32 m0, s49, 151552
ds_read_b64_tr_b16 v[200:201], v230 offset:24576
ds_read_b64_tr_b16 v[202:203], v230 offset:25088
v_mfma_f32_16x16x32_bf16 v[36:39], v[204:207], a[180:183], v[36:39]
s_add_u32 s50, s95, 9216
buffer_load_dwordx4 v240, s[24:27], s50 offen lds
v_mfma_f32_16x16x32_bf16 v[40:43], v[204:207], a[184:187], v[40:43]
s_add_u32 s9, s9, s6
v_mfma_f32_16x16x32_bf16 v[44:47], v[204:207], a[188:191], v[44:47]
s_waitcnt lgkmcnt(6)
v_mfma_f32_16x16x32_bf16 v[48:51], v[208:211], a[176:179], v[48:51]
s_mul_i32 s9, s9, 4608
ds_read_b64_tr_b16 v[204:205], v230 offset:28672
ds_read_b64_tr_b16 v[206:207], v230 offset:29184
v_mfma_f32_16x16x32_bf16 v[52:55], v[208:211], a[180:183], v[52:55]
s_add_u32 s9, s9, 21495808
v_mfma_f32_16x16x32_bf16 v[56:59], v[208:211], a[184:187], v[56:59]
v_mfma_f32_16x16x32_bf16 v[60:63], v[208:211], a[188:191], v[60:63]
s_waitcnt lgkmcnt(6)
v_mfma_f32_16x16x32_bf16 v[64:67], v[192:195], a[176:179], v[64:67]
ds_read_b64_tr_b16 v[208:209], v231 offset:24576
ds_read_b64_tr_b16 v[210:211], v231 offset:25088
v_mfma_f32_16x16x32_bf16 v[68:71], v[192:195], a[180:183], v[68:71]
s_cmp_lt_u32 s4, 4608
s_cselect_b32 s9, s9, 0x40000000
v_mfma_f32_16x16x32_bf16 v[72:75], v[192:195], a[184:187], v[72:75]
v_mfma_f32_16x16x32_bf16 v[76:79], v[192:195], a[188:191], v[76:79]
s_waitcnt lgkmcnt(6)
v_mfma_f32_16x16x32_bf16 v[80:83], v[196:199], a[176:179], v[80:83]
s_add_u32 m0, s49, 155648
ds_read_b64_tr_b16 v[192:193], v231 offset:28672
ds_read_b64_tr_b16 v[194:195], v231 offset:29184
v_mfma_f32_16x16x32_bf16 v[84:87], v[196:199], a[180:183], v[84:87]
s_add_u32 s50, s95, 18432
buffer_load_dwordx4 v240, s[24:27], s50 offen lds
v_mfma_f32_16x16x32_bf16 v[88:91], v[196:199], a[184:187], v[88:91]
v_mfma_f32_16x16x32_bf16 v[92:95], v[196:199], a[188:191], v[92:95]
s_waitcnt lgkmcnt(6)
v_mfma_f32_16x16x32_bf16 v[96:99], v[200:203], a[176:179], v[96:99]
s_and_b32 s4, s4, 31
ds_read_b64_tr_b16 v[196:197], v228 offset:32768
ds_read_b64_tr_b16 v[198:199], v228 offset:33280
v_mfma_f32_16x16x32_bf16 v[100:103], v[200:203], a[180:183], v[100:103]
v_mfma_f32_16x16x32_bf16 v[104:107], v[200:203], a[184:187], v[104:107]
v_mfma_f32_16x16x32_bf16 v[108:111], v[200:203], a[188:191], v[108:111]
s_waitcnt lgkmcnt(6)
v_mfma_f32_16x16x32_bf16 v[112:115], v[204:207], a[176:179], v[112:115]
s_lshl_b32 s4, s4, 4
ds_read_b64_tr_b16 v[200:201], v228 offset:36864
ds_read_b64_tr_b16 v[202:203], v228 offset:37376
v_mfma_f32_16x16x32_bf16 v[116:119], v[204:207], a[180:183], v[116:119]
v_mfma_f32_16x16x32_bf16 v[120:123], v[204:207], a[184:187], v[120:123]
v_mfma_f32_16x16x32_bf16 v[124:127], v[204:207], a[188:191], v[124:127]
s_waitcnt lgkmcnt(6)
v_mfma_f32_16x16x32_bf16 v[128:131], v[208:211], a[176:179], v[128:131]
ds_read_b64_tr_b16 v[204:205], v229 offset:32768
ds_read_b64_tr_b16 v[206:207], v229 offset:33280
v_mfma_f32_16x16x32_bf16 v[132:135], v[208:211], a[180:183], v[132:135]
v_xor_b32 v214, s4, v241
v_mfma_f32_16x16x32_bf16 v[136:139], v[208:211], a[184:187], v[136:139]
v_mfma_f32_16x16x32_bf16 v[140:143], v[208:211], a[188:191], v[140:143]
s_waitcnt lgkmcnt(6)
v_mfma_f32_16x16x32_bf16 v[144:147], v[192:195], a[176:179], v[144:147]
ds_read_b64_tr_b16 v[208:209], v229 offset:36864
ds_read_b64_tr_b16 v[210:211], v229 offset:37376
v_mfma_f32_16x16x32_bf16 v[148:151], v[192:195], a[180:183], v[148:151]
v_mfma_f32_16x16x32_bf16 v[152:155], v[192:195], a[184:187], v[152:155]
v_mfma_f32_16x16x32_bf16 v[156:159], v[192:195], a[188:191], v[156:159]
s_waitcnt vmcnt(25) lgkmcnt(6)
v_mfma_f32_16x16x32_bf16 v[32:35], v[196:199], a[192:195], v[32:35]
ds_read_b64_tr_b16 v[192:193], v230 offset:32768
ds_read_b64_tr_b16 v[194:195], v230 offset:33280
v_mfma_f32_16x16x32_bf16 v[36:39], v[196:199], a[196:199], v[36:39]
buffer_load_dwordx4 v[248:251], v220, s[36:39], 0 offen
v_mfma_f32_16x16x32_bf16 v[40:43], v[196:199], a[200:203], v[40:43]
v_mfma_f32_16x16x32_bf16 v[44:47], v[196:199], a[204:207], v[44:47]
s_waitcnt lgkmcnt(6)
v_mfma_f32_16x16x32_bf16 v[48:51], v[200:203], a[192:195], v[48:51]
ds_read_b64_tr_b16 v[196:197], v230 offset:36864
ds_read_b64_tr_b16 v[198:199], v230 offset:37376
v_mfma_f32_16x16x32_bf16 v[52:55], v[200:203], a[196:199], v[52:55]
v_add_u32 v214, s9, v214
v_mfma_f32_16x16x32_bf16 v[56:59], v[200:203], a[200:203], v[56:59]
v_mfma_f32_16x16x32_bf16 v[60:63], v[200:203], a[204:207], v[60:63]
s_waitcnt lgkmcnt(6)
v_mfma_f32_16x16x32_bf16 v[64:67], v[204:207], a[192:195], v[64:67]
ds_read_b64_tr_b16 v[200:201], v231 offset:32768
ds_read_b64_tr_b16 v[202:203], v231 offset:33280
v_mfma_f32_16x16x32_bf16 v[68:71], v[204:207], a[196:199], v[68:71]
v_mfma_f32_16x16x32_bf16 v[72:75], v[204:207], a[200:203], v[72:75]
v_mfma_f32_16x16x32_bf16 v[76:79], v[204:207], a[204:207], v[76:79]
s_waitcnt lgkmcnt(6)
v_mfma_f32_16x16x32_bf16 v[80:83], v[208:211], a[192:195], v[80:83]
ds_read_b64_tr_b16 v[204:205], v231 offset:36864
ds_read_b64_tr_b16 v[206:207], v231 offset:37376
v_mfma_f32_16x16x32_bf16 v[84:87], v[208:211], a[196:199], v[84:87]
v_mfma_f32_16x16x32_bf16 v[88:91], v[208:211], a[200:203], v[88:91]
v_mfma_f32_16x16x32_bf16 v[92:95], v[208:211], a[204:207], v[92:95]
s_waitcnt lgkmcnt(6)
v_mfma_f32_16x16x32_bf16 v[96:99], v[192:195], a[192:195], v[96:99]
ds_read_b64_tr_b16 v[208:209], v228 offset:40960
ds_read_b64_tr_b16 v[210:211], v228 offset:41472
v_mfma_f32_16x16x32_bf16 v[100:103], v[192:195], a[196:199], v[100:103]
buffer_load_dwordx4 v[252:255], v220, s[36:39], 0 offen offset:64
v_mfma_f32_16x16x32_bf16 v[104:107], v[192:195], a[200:203], v[104:107]
v_mfma_f32_16x16x32_bf16 v[108:111], v[192:195], a[204:207], v[108:111]
s_waitcnt lgkmcnt(6)
v_mfma_f32_16x16x32_bf16 v[112:115], v[196:199], a[192:195], v[112:115]
ds_read_b64_tr_b16 v[192:193], v228 offset:45056
ds_read_b64_tr_b16 v[194:195], v228 offset:45568
v_mfma_f32_16x16x32_bf16 v[116:119], v[196:199], a[196:199], v[116:119]
v_mfma_f32_16x16x32_bf16 v[120:123], v[196:199], a[200:203], v[120:123]
v_mfma_f32_16x16x32_bf16 v[124:127], v[196:199], a[204:207], v[124:127]
s_waitcnt lgkmcnt(6)
v_mfma_f32_16x16x32_bf16 v[128:131], v[200:203], a[192:195], v[128:131]
ds_read_b64_tr_b16 v[196:197], v229 offset:40960
ds_read_b64_tr_b16 v[198:199], v229 offset:41472
v_mfma_f32_16x16x32_bf16 v[132:135], v[200:203], a[196:199], v[132:135]
v_mfma_f32_16x16x32_bf16 v[136:139], v[200:203], a[200:203], v[136:139]
v_mfma_f32_16x16x32_bf16 v[140:143], v[200:203], a[204:207], v[140:143]
s_waitcnt lgkmcnt(6)
v_mfma_f32_16x16x32_bf16 v[144:147], v[204:207], a[192:195], v[144:147]
ds_read_b64_tr_b16 v[200:201], v229 offset:45056
ds_read_b64_tr_b16 v[202:203], v229 offset:45568
v_mfma_f32_16x16x32_bf16 v[148:151], v[204:207], a[196:199], v[148:151]
v_mfma_f32_16x16x32_bf16 v[152:155], v[204:207], a[200:203], v[152:155]
v_mfma_f32_16x16x32_bf16 v[156:159], v[204:207], a[204:207], v[156:159]
s_waitcnt vmcnt(23) lgkmcnt(6)
v_mfma_f32_16x16x32_bf16 v[32:35], v[208:211], a[208:211], v[32:35]
ds_read_b64_tr_b16 v[204:205], v230 offset:40960
ds_read_b64_tr_b16 v[206:207], v230 offset:41472
v_mfma_f32_16x16x32_bf16 v[36:39], v[208:211], a[212:215], v[36:39]
buffer_load_dwordx2 v[244:245], v221, s[36:39], 0 offen offset:128
v_mfma_f32_16x16x32_bf16 v[40:43], v[208:211], a[216:219], v[40:43]
v_mfma_f32_16x16x32_bf16 v[44:47], v[208:211], a[220:223], v[44:47]
s_waitcnt lgkmcnt(6)
v_mfma_f32_16x16x32_bf16 v[48:51], v[192:195], a[208:211], v[48:51]
ds_read_b64_tr_b16 v[208:209], v230 offset:45056
ds_read_b64_tr_b16 v[210:211], v230 offset:45568
v_mfma_f32_16x16x32_bf16 v[52:55], v[192:195], a[212:215], v[52:55]
v_mfma_f32_16x16x32_bf16 v[56:59], v[192:195], a[216:219], v[56:59]
v_mfma_f32_16x16x32_bf16 v[60:63], v[192:195], a[220:223], v[60:63]
s_waitcnt lgkmcnt(6)
v_mfma_f32_16x16x32_bf16 v[64:67], v[196:199], a[208:211], v[64:67]
ds_read_b64_tr_b16 v[192:193], v231 offset:40960
ds_read_b64_tr_b16 v[194:195], v231 offset:41472
v_mfma_f32_16x16x32_bf16 v[68:71], v[196:199], a[212:215], v[68:71]
v_mfma_f32_16x16x32_bf16 v[72:75], v[196:199], a[216:219], v[72:75]
v_mfma_f32_16x16x32_bf16 v[76:79], v[196:199], a[220:223], v[76:79]
s_waitcnt lgkmcnt(6)
v_mfma_f32_16x16x32_bf16 v[80:83], v[200:203], a[208:211], v[80:83]
ds_read_b64_tr_b16 v[196:197], v231 offset:45056
ds_read_b64_tr_b16 v[198:199], v231 offset:45568
v_mfma_f32_16x16x32_bf16 v[84:87], v[200:203], a[212:215], v[84:87]
v_mfma_f32_16x16x32_bf16 v[88:91], v[200:203], a[216:219], v[88:91]
v_mfma_f32_16x16x32_bf16 v[92:95], v[200:203], a[220:223], v[92:95]
s_waitcnt lgkmcnt(6)
v_mfma_f32_16x16x32_bf16 v[96:99], v[204:207], a[208:211], v[96:99]
ds_read_b64_tr_b16 v[200:201], v228 offset:49152
ds_read_b64_tr_b16 v[202:203], v228 offset:49664
v_mfma_f32_16x16x32_bf16 v[100:103], v[204:207], a[212:215], v[100:103]
v_mfma_f32_16x16x32_bf16 v[104:107], v[204:207], a[216:219], v[104:107]
v_mfma_f32_16x16x32_bf16 v[108:111], v[204:207], a[220:223], v[108:111]
s_waitcnt lgkmcnt(6)
v_mfma_f32_16x16x32_bf16 v[112:115], v[208:211], a[208:211], v[112:115]
ds_read_b64_tr_b16 v[204:205], v228 offset:53248
ds_read_b64_tr_b16 v[206:207], v228 offset:53760
v_mfma_f32_16x16x32_bf16 v[116:119], v[208:211], a[212:215], v[116:119]
v_mfma_f32_16x16x32_bf16 v[120:123], v[208:211], a[216:219], v[120:123]
v_mfma_f32_16x16x32_bf16 v[124:127], v[208:211], a[220:223], v[124:127]
s_waitcnt lgkmcnt(6)
v_mfma_f32_16x16x32_bf16 v[128:131], v[192:195], a[208:211], v[128:131]
ds_read_b64_tr_b16 v[208:209], v229 offset:49152
ds_read_b64_tr_b16 v[210:211], v229 offset:49664
v_mfma_f32_16x16x32_bf16 v[132:135], v[192:195], a[212:215], v[132:135]
v_mfma_f32_16x16x32_bf16 v[136:139], v[192:195], a[216:219], v[136:139]
v_mfma_f32_16x16x32_bf16 v[140:143], v[192:195], a[220:223], v[140:143]
s_waitcnt lgkmcnt(6)
v_mfma_f32_16x16x32_bf16 v[144:147], v[196:199], a[208:211], v[144:147]
ds_read_b64_tr_b16 v[192:193], v229 offset:53248
ds_read_b64_tr_b16 v[194:195], v229 offset:53760
v_mfma_f32_16x16x32_bf16 v[148:151], v[196:199], a[212:215], v[148:151]
v_mfma_f32_16x16x32_bf16 v[152:155], v[196:199], a[216:219], v[152:155]
v_mfma_f32_16x16x32_bf16 v[156:159], v[196:199], a[220:223], v[156:159]
s_waitcnt vmcnt(20) lgkmcnt(6)
v_mfma_f32_16x16x32_bf16 v[32:35], v[200:203], a[224:227], v[32:35]
s_add_u32 m0, s49, 0
ds_read_b64_tr_b16 v[196:197], v230 offset:49152
ds_read_b64_tr_b16 v[198:199], v230 offset:49664
v_mfma_f32_16x16x32_bf16 v[36:39], v[200:203], a[228:231], v[36:39]
s_mov_b32 s50, 0
buffer_load_dwordx4 v236, s[20:23], s50 offen lds
v_mfma_f32_16x16x32_bf16 v[40:43], v[200:203], a[232:235], v[40:43]
s_waitcnt vmcnt(6)
ds_read_b128 v[160:163], v242 offset:16384
v_mfma_f32_16x16x32_bf16 v[44:47], v[200:203], a[236:239], v[44:47]
s_waitcnt lgkmcnt(7)
v_mfma_f32_16x16x32_bf16 v[48:51], v[204:207], a[224:227], v[48:51]
s_waitcnt vmcnt(5)
ds_read_b64_tr_b16 v[200:201], v230 offset:53248
ds_read_b64_tr_b16 v[202:203], v230 offset:53760
v_mfma_f32_16x16x32_bf16 v[52:55], v[204:207], a[228:231], v[52:55]
ds_read_b128 v[164:167], v242 offset:20480
v_mfma_f32_16x16x32_bf16 v[56:59], v[204:207], a[232:235], v[56:59]
s_waitcnt vmcnt(4)
ds_read_b128 v[168:171], v242 offset:24576
v_mfma_f32_16x16x32_bf16 v[60:63], v[204:207], a[236:239], v[60:63]
s_waitcnt lgkmcnt(9)
v_mfma_f32_16x16x32_bf16 v[64:67], v[208:211], a[224:227], v[64:67]
s_add_u32 m0, s49, 4096
ds_read_b64_tr_b16 v[204:205], v231 offset:49152
ds_read_b64_tr_b16 v[206:207], v231 offset:49664
v_mfma_f32_16x16x32_bf16 v[68:71], v[208:211], a[228:231], v[68:71]
s_mov_b32 s50, 110592
buffer_load_dwordx4 v236, s[20:23], s50 offen lds
buffer_load_dword v246, v247, s[28:31], s67 offen offset:0 sc1
v_mfma_f32_16x16x32_bf16 v[72:75], v[208:211], a[232:235], v[72:75]
v_mfma_f32_16x16x32_bf16 v[76:79], v[208:211], a[236:239], v[76:79]
s_waitcnt lgkmcnt(9)
v_mfma_f32_16x16x32_bf16 v[80:83], v[192:195], a[224:227], v[80:83]
ds_read_b64_tr_b16 v[208:209], v231 offset:53248
ds_read_b64_tr_b16 v[210:211], v231 offset:53760
v_mfma_f32_16x16x32_bf16 v[84:87], v[192:195], a[228:231], v[84:87]
v_mfma_f32_16x16x32_bf16 v[88:91], v[192:195], a[232:235], v[88:91]
v_mfma_f32_16x16x32_bf16 v[92:95], v[192:195], a[236:239], v[92:95]
s_waitcnt lgkmcnt(9)
v_mfma_f32_16x16x32_bf16 v[96:99], v[196:199], a[224:227], v[96:99]
s_add_u32 m0, s49, 8192
ds_read_b64_tr_b16 v[192:193], v228 offset:57344
ds_read_b64_tr_b16 v[194:195], v228 offset:57856
v_mfma_f32_16x16x32_bf16 v[100:103], v[196:199], a[228:231], v[100:103]
s_mov_b32 s50, 221184
buffer_load_dwordx4 v236, s[20:23], s50 offen lds
v_mfma_f32_16x16x32_bf16 v[104:107], v[196:199], a[232:235], v[104:107]
v_mfma_f32_16x16x32_bf16 v[108:111], v[196:199], a[236:239], v[108:111]
s_waitcnt lgkmcnt(8)
v_mfma_f32_16x16x32_bf16 v[112:115], v[200:203], a[224:227], v[112:115]
ds_read_b64_tr_b16 v[196:197], v228 offset:61440
ds_read_b64_tr_b16 v[198:199], v228 offset:61952
v_mfma_f32_16x16x32_bf16 v[116:119], v[200:203], a[228:231], v[116:119]
v_mfma_f32_16x16x32_bf16 v[120:123], v[200:203], a[232:235], v[120:123]
v_mfma_f32_16x16x32_bf16 v[124:127], v[200:203], a[236:239], v[124:127]
s_waitcnt lgkmcnt(6)
v_mfma_f32_16x16x32_bf16 v[128:131], v[204:207], a[224:227], v[128:131]
ds_read_b64_tr_b16 v[200:201], v229 offset:57344
ds_read_b64_tr_b16 v[202:203], v229 offset:57856
v_mfma_f32_16x16x32_bf16 v[132:135], v[204:207], a[228:231], v[132:135]
v_mfma_f32_16x16x32_bf16 v[136:139], v[204:207], a[232:235], v[136:139]
v_mfma_f32_16x16x32_bf16 v[140:143], v[204:207], a[236:239], v[140:143]
s_waitcnt lgkmcnt(6)
v_mfma_f32_16x16x32_bf16 v[144:147], v[208:211], a[224:227], v[144:147]
s_add_u32 m0, s49, 12288
ds_read_b64_tr_b16 v[204:205], v229 offset:61440
ds_read_b64_tr_b16 v[206:207], v229 offset:61952
v_mfma_f32_16x16x32_bf16 v[148:151], v[208:211], a[228:231], v[148:151]
s_mov_b32 s50, 331776
buffer_load_dwordx4 v236, s[20:23], s50 offen lds
buffer_store_dwordx4 v[160:163], v212, s[28:31], 0 offen sc1
v_mfma_f32_16x16x32_bf16 v[152:155], v[208:211], a[232:235], v[152:155]
v_mfma_f32_16x16x32_bf16 v[156:159], v[208:211], a[236:239], v[156:159]
s_waitcnt vmcnt(22) lgkmcnt(6)
v_mfma_f32_16x16x32_bf16 v[32:35], v[192:195], a[240:243], v[32:35]
ds_read_b64_tr_b16 v[208:209], v230 offset:57344
ds_read_b64_tr_b16 v[210:211], v230 offset:57856
v_mfma_f32_16x16x32_bf16 v[36:39], v[192:195], a[244:247], v[36:39]
v_mfma_f32_16x16x32_bf16 v[40:43], v[192:195], a[248:251], v[40:43]
v_mfma_f32_16x16x32_bf16 v[44:47], v[192:195], a[252:255], v[44:47]
s_waitcnt lgkmcnt(6)
v_mfma_f32_16x16x32_bf16 v[48:51], v[196:199], a[240:243], v[48:51]
s_add_u32 m0, s49, 16384
ds_read_b64_tr_b16 v[192:193], v230 offset:61440
ds_read_b64_tr_b16 v[194:195], v230 offset:61952
v_mfma_f32_16x16x32_bf16 v[52:55], v[196:199], a[244:247], v[52:55]
s_mov_b32 s50, 442368
buffer_load_dwordx4 v236, s[20:23], s50 offen lds
v_mfma_f32_16x16x32_bf16 v[56:59], v[196:199], a[248:251], v[56:59]
v_mfma_f32_16x16x32_bf16 v[60:63], v[196:199], a[252:255], v[60:63]
s_waitcnt lgkmcnt(6)
v_mfma_f32_16x16x32_bf16 v[64:67], v[200:203], a[240:243], v[64:67]
ds_read_b64_tr_b16 v[196:197], v231 offset:57344
ds_read_b64_tr_b16 v[198:199], v231 offset:57856
v_mfma_f32_16x16x32_bf16 v[68:71], v[200:203], a[244:247], v[68:71]
v_mfma_f32_16x16x32_bf16 v[72:75], v[200:203], a[248:251], v[72:75]
v_mfma_f32_16x16x32_bf16 v[76:79], v[200:203], a[252:255], v[76:79]
s_waitcnt lgkmcnt(6)
v_mfma_f32_16x16x32_bf16 v[80:83], v[204:207], a[240:243], v[80:83]
s_add_u32 m0, s49, 20480
ds_read_b64_tr_b16 v[200:201], v231 offset:61440
ds_read_b64_tr_b16 v[202:203], v231 offset:61952
v_mfma_f32_16x16x32_bf16 v[84:87], v[204:207], a[244:247], v[84:87]
s_mov_b32 s50, 552960
v_add_u32 v228, 65536, v228
v_mfma_f32_16x16x32_bf16 v[88:91], v[204:207], a[248:251], v[88:91]
buffer_load_dwordx4 v236, s[20:23], s50 offen lds
v_mfma_f32_16x16x32_bf16 v[92:95], v[204:207], a[252:255], v[92:95]
s_waitcnt lgkmcnt(6)
v_mfma_f32_16x16x32_bf16 v[96:99], v[208:211], a[240:243], v[96:99]
ds_read_b64_tr_b16 v[204:205], v228 offset:0
ds_read_b64_tr_b16 v[206:207], v228 offset:512
v_mfma_f32_16x16x32_bf16 v[100:103], v[208:211], a[244:247], v[100:103]
v_mfma_f32_16x16x32_bf16 v[104:107], v[208:211], a[248:251], v[104:107]
v_mfma_f32_16x16x32_bf16 v[108:111], v[208:211], a[252:255], v[108:111]
s_waitcnt lgkmcnt(6)
v_mfma_f32_16x16x32_bf16 v[112:115], v[192:195], a[240:243], v[112:115]
ds_read_b64_tr_b16 v[208:209], v228 offset:4096
ds_read_b64_tr_b16 v[210:211], v228 offset:4608
v_mfma_f32_16x16x32_bf16 v[116:119], v[192:195], a[244:247], v[116:119]
v_add_u32 v229, 65536, v229
v_mfma_f32_16x16x32_bf16 v[120:123], v[192:195], a[248:251], v[120:123]
v_mfma_f32_16x16x32_bf16 v[124:127], v[192:195], a[252:255], v[124:127]
s_waitcnt lgkmcnt(6)
v_mfma_f32_16x16x32_bf16 v[128:131], v[196:199], a[240:243], v[128:131]
s_add_u32 m0, s49, 24576
ds_read_b64_tr_b16 v[192:193], v229 offset:0
ds_read_b64_tr_b16 v[194:195], v229 offset:512
v_mfma_f32_16x16x32_bf16 v[132:135], v[196:199], a[244:247], v[132:135]
TCH_2_v1:
s_cbranch_execz TCH_6_v1
s_mov_b32 s50, 663552
buffer_load_dwordx4 v236, s[20:23], s50 offen lds
v_mfma_f32_16x16x32_bf16 v[136:139], v[196:199], a[248:251], v[136:139]
v_mfma_f32_16x16x32_bf16 v[140:143], v[196:199], a[252:255], v[140:143]
s_waitcnt lgkmcnt(6)
v_mfma_f32_16x16x32_bf16 v[144:147], v[200:203], a[240:243], v[144:147]
ds_read_b64_tr_b16 v[196:197], v229 offset:4096
ds_read_b64_tr_b16 v[198:199], v229 offset:4608
v_mfma_f32_16x16x32_bf16 v[148:151], v[200:203], a[244:247], v[148:151]
v_add_u32 v230, 65536, v230
v_mfma_f32_16x16x32_bf16 v[152:155], v[200:203], a[248:251], v[152:155]
buffer_store_dwordx4 v[164:167], v213, s[28:31], 0 offen sc1
v_mfma_f32_16x16x32_bf16 v[156:159], v[200:203], a[252:255], v[156:159]
s_waitcnt vmcnt(22) lgkmcnt(6)
v_mfma_f32_16x16x32_bf16 v[32:35], v[204:207], v[0:3], v[32:35]
s_add_u32 m0, s49, 28672
ds_read_b64_tr_b16 v[200:201], v230 offset:0
ds_read_b64_tr_b16 v[202:203], v230 offset:512
v_mfma_f32_16x16x32_bf16 v[36:39], v[204:207], v[4:7], v[36:39]
s_mov_b32 s50, 774144
v_mfma_f32_16x16x32_bf16 v[40:43], v[204:207], v[8:11], v[40:43]
v_mfma_f32_16x16x32_bf16 v[44:47], v[204:207], v[12:15], v[44:47]
s_waitcnt lgkmcnt(6)
v_mfma_f32_16x16x32_bf16 v[48:51], v[208:211], v[0:3], v[48:51]
ds_read_b64_tr_b16 v[204:205], v230 offset:4096
ds_read_b64_tr_b16 v[206:207], v230 offset:4608
v_mfma_f32_16x16x32_bf16 v[52:55], v[208:211], v[4:7], v[52:55]
v_add_u32 v231, 65536, v231
v_mfma_f32_16x16x32_bf16 v[56:59], v[208:211], v[8:11], v[56:59]
v_mfma_f32_16x16x32_bf16 v[60:63], v[208:211], v[12:15], v[60:63]
s_waitcnt lgkmcnt(6)
v_mfma_f32_16x16x32_bf16 v[64:67], v[192:195], v[0:3], v[64:67]
ds_read_b64_tr_b16 v[208:209], v231 offset:0
ds_read_b64_tr_b16 v[210:211], v231 offset:512
v_mfma_f32_16x16x32_bf16 v[68:71], v[192:195], v[4:7], v[68:71]
buffer_load_dwordx4 v236, s[20:23], s50 offen lds
v_mfma_f32_16x16x32_bf16 v[72:75], v[192:195], v[8:11], v[72:75]
s_add_u32 m0, s49, 32768
v_mfma_f32_16x16x32_bf16 v[76:79], v[192:195], v[12:15], v[76:79]
s_waitcnt lgkmcnt(6)
v_mfma_f32_16x16x32_bf16 v[80:83], v[196:199], v[0:3], v[80:83]
s_mov_b32 s50, 884736
ds_read_b64_tr_b16 v[192:193], v231 offset:4096
ds_read_b64_tr_b16 v[194:195], v231 offset:4608
v_mfma_f32_16x16x32_bf16 v[84:87], v[196:199], v[4:7], v[84:87]
buffer_load_dwordx4 v236, s[20:23], s50 offen lds
v_mfma_f32_16x16x32_bf16 v[88:91], v[196:199], v[8:11], v[88:91]
s_waitcnt vmcnt(9)
v_cmp_gt_u32 vcc, 1, v246
v_mfma_f32_16x16x32_bf16 v[92:95], v[196:199], v[12:15], v[92:95]
s_waitcnt lgkmcnt(6)
v_mfma_f32_16x16x32_bf16 v[96:99], v[200:203], v[0:3], v[96:99]
ds_read_b64_tr_b16 v[196:197], v228 offset:8192
ds_read_b64_tr_b16 v[198:199], v228 offset:8704
v_mfma_f32_16x16x32_bf16 v[100:103], v[200:203], v[4:7], v[100:103]
s_cbranch_vccnz spin_4_v1
ok_3_v1:
v_mfma_f32_16x16x32_bf16 v[104:107], v[200:203], v[8:11], v[104:107]
v_mfma_f32_16x16x32_bf16 v[108:111], v[200:203], v[12:15], v[108:111]
s_waitcnt lgkmcnt(6)
v_mfma_f32_16x16x32_bf16 v[112:115], v[204:207], v[0:3], v[112:115]
s_add_u32 m0, s49, 36864
ds_read_b64_tr_b16 v[200:201], v228 offset:12288
ds_read_b64_tr_b16 v[202:203], v228 offset:12800
v_mfma_f32_16x16x32_bf16 v[116:119], v[204:207], v[4:7], v[116:119]
s_mov_b32 s50, 995328
v_mfma_f32_16x16x32_bf16 v[120:123], v[204:207], v[8:11], v[120:123]
v_mfma_f32_16x16x32_bf16 v[124:127], v[204:207], v[12:15], v[124:127]
s_waitcnt lgkmcnt(6)
v_mfma_f32_16x16x32_bf16 v[128:131], v[208:211], v[0:3], v[128:131]
ds_read_b64_tr_b16 v[204:205], v229 offset:8192
ds_read_b64_tr_b16 v[206:207], v229 offset:8704
v_mfma_f32_16x16x32_bf16 v[132:135], v[208:211], v[4:7], v[132:135]
buffer_store_dwordx4 v[168:171], v214, s[28:31], 0 offen sc1
v_mfma_f32_16x16x32_bf16 v[136:139], v[208:211], v[8:11], v[136:139]
v_mfma_f32_16x16x32_bf16 v[140:143], v[208:211], v[12:15], v[140:143]
s_waitcnt lgkmcnt(6)
v_mfma_f32_16x16x32_bf16 v[144:147], v[192:195], v[0:3], v[144:147]
ds_read_b64_tr_b16 v[208:209], v229 offset:12288
ds_read_b64_tr_b16 v[210:211], v229 offset:12800
v_mfma_f32_16x16x32_bf16 v[148:151], v[192:195], v[4:7], v[148:151]
v_mfma_f32_16x16x32_bf16 v[152:155], v[192:195], v[8:11], v[152:155]
v_mfma_f32_16x16x32_bf16 v[156:159], v[192:195], v[12:15], v[156:159]
s_waitcnt vmcnt(20) lgkmcnt(6)
v_mfma_f32_16x16x32_bf16 v[32:35], v[196:199], v[16:19], v[32:35]
ds_read_b64_tr_b16 v[192:193], v230 offset:8192
ds_read_b64_tr_b16 v[194:195], v230 offset:8704
v_mfma_f32_16x16x32_bf16 v[36:39], v[196:199], v[20:23], v[36:39]
v_mfma_f32_16x16x32_bf16 v[40:43], v[196:199], v[24:27], v[40:43]
v_mfma_f32_16x16x32_bf16 v[44:47], v[196:199], v[28:31], v[44:47]
s_waitcnt lgkmcnt(6)
buffer_load_dwordx4 v236, s[20:23], s50 offen lds
v_mfma_f32_16x16x32_bf16 v[48:51], v[200:203], v[16:19], v[48:51]
s_add_u32 m0, s49, 40960
ds_read_b64_tr_b16 v[196:197], v230 offset:12288
ds_read_b64_tr_b16 v[198:199], v230 offset:12800
v_mfma_f32_16x16x32_bf16 v[52:55], v[200:203], v[20:23], v[52:55]
s_mov_b32 s50, 1105920
v_mfma_f32_16x16x32_bf16 v[56:59], v[200:203], v[24:27], v[56:59]
v_mfma_f32_16x16x32_bf16 v[60:63], v[200:203], v[28:31], v[60:63]
s_waitcnt lgkmcnt(6)
v_mfma_f32_16x16x32_bf16 v[64:67], v[204:207], v[16:19], v[64:67]
ds_read_b64_tr_b16 v[200:201], v231 offset:8192
ds_read_b64_tr_b16 v[202:203], v231 offset:8704
v_mfma_f32_16x16x32_bf16 v[68:71], v[204:207], v[20:23], v[68:71]
v_mfma_f32_16x16x32_bf16 v[72:75], v[204:207], v[24:27], v[72:75]
v_mfma_f32_16x16x32_bf16 v[76:79], v[204:207], v[28:31], v[76:79]
s_waitcnt lgkmcnt(6)
buffer_load_dwordx4 v236, s[20:23], s50 offen lds
v_mfma_f32_16x16x32_bf16 v[80:83], v[208:211], v[16:19], v[80:83]
s_add_u32 m0, s49, 45056
ds_read_b64_tr_b16 v[204:205], v231 offset:12288
ds_read_b64_tr_b16 v[206:207], v231 offset:12800
v_mfma_f32_16x16x32_bf16 v[84:87], v[208:211], v[20:23], v[84:87]
s_mov_b32 s50, 1216512
v_mfma_f32_16x16x32_bf16 v[88:91], v[208:211], v[24:27], v[88:91]
s_waitcnt vmcnt(10)
s_barrier
v_mfma_f32_16x16x32_bf16 v[92:95], v[208:211], v[28:31], v[92:95]
s_waitcnt lgkmcnt(6)
v_mfma_f32_16x16x32_bf16 v[96:99], v[192:195], v[16:19], v[96:99]
ds_read_b64_tr_b16 v[208:209], v233 offset:0
ds_read_b64_tr_b16 v[210:211], v233 offset:512
v_mfma_f32_16x16x32_bf16 v[100:103], v[192:195], v[20:23], v[100:103]
v_mfma_f32_16x16x32_bf16 v[104:107], v[192:195], v[24:27], v[104:107]
v_mfma_f32_16x16x32_bf16 v[108:111], v[192:195], v[28:31], v[108:111]
s_waitcnt lgkmcnt(6)
buffer_load_dwordx4 v236, s[20:23], s50 offen lds
v_mfma_f32_16x16x32_bf16 v[112:115], v[196:199], v[16:19], v[112:115]
s_add_u32 m0, s49, 49152
ds_read_b64_tr_b16 v[192:193], v233 offset:8
ds_read_b64_tr_b16 v[194:195], v233 offset:520
v_mfma_f32_16x16x32_bf16 v[116:119], v[196:199], v[20:23], v[116:119]
s_mov_b32 s50, 1327104
v_mfma_f32_16x16x32_bf16 v[120:123], v[196:199], v[24:27], v[120:123]
v_mfma_f32_16x16x32_bf16 v[124:127], v[196:199], v[28:31], v[124:127]
s_waitcnt lgkmcnt(6)
v_mfma_f32_16x16x32_bf16 v[128:131], v[200:203], v[16:19], v[128:131]
ds_read_b64_tr_b16 v[196:197], v233 offset:4096
ds_read_b64_tr_b16 v[198:199], v233 offset:4608
v_mfma_f32_16x16x32_bf16 v[132:135], v[200:203], v[20:23], v[132:135]
v_mfma_f32_16x16x32_bf16 v[136:139], v[200:203], v[24:27], v[136:139]
v_mfma_f32_16x16x32_bf16 v[140:143], v[200:203], v[28:31], v[140:143]
s_waitcnt lgkmcnt(6)
v_mfma_f32_16x16x32_bf16 v[144:147], v[204:207], v[16:19], v[144:147]
ds_read_b64_tr_b16 v[200:201], v233 offset:4104
ds_read_b64_tr_b16 v[202:203], v233 offset:4616
v_mfma_f32_16x16x32_bf16 v[148:151], v[204:207], v[20:23], v[148:151]
buffer_load_dwordx4 v236, s[20:23], s50 offen lds
v_mfma_f32_16x16x32_bf16 v[152:155], v[204:207], v[24:27], v[152:155]
s_add_u32 m0, s49, 53248
v_mfma_f32_16x16x32_bf16 v[156:159], v[204:207], v[28:31], v[156:159]
s_waitcnt lgkmcnt(6)
v_mfma_f32_16x16x32_bf16 v[160:163], v[208:211], a[0:3], 0
s_mov_b32 s50, 1437696
ds_read_b64_tr_b16 v[204:205], v233 offset:8192
ds_read_b64_tr_b16 v[206:207], v233 offset:8704
v_mfma_f32_16x16x32_bf16 v[164:167], v[208:211], a[4:7], 0
v_mfma_f32_16x16x32_bf16 v[168:171], v[208:211], a[8:11], 0
v_mfma_f32_16x16x32_bf16 v[172:175], v[208:211], a[12:15], 0
s_waitcnt lgkmcnt(6)
v_mfma_f32_16x16x32_bf16 v[176:179], v[192:195], a[0:3], 0
ds_read_b64_tr_b16 v[208:209], v233 offset:8200
ds_read_b64_tr_b16 v[210:211], v233 offset:8712
v_mfma_f32_16x16x32_bf16 v[180:183], v[192:195], a[4:7], 0
buffer_load_dwordx4 v236, s[20:23], s50 offen lds
v_mul_f32 v32, s96, v32
v_mfma_f32_16x16x32_bf16 v[184:187], v[192:195], a[8:11], 0
s_add_u32 m0, s49, 57344
v_mul_f32 v33, s96, v33
v_mul_f32 v34, s96, v34
v_mfma_f32_16x16x32_bf16 v[188:191], v[192:195], a[12:15], 0
s_waitcnt lgkmcnt(6)
v_mul_f32 v35, s96, v35
v_mfma_f32_16x16x32_bf16 v[160:163], v[196:199], a[16:19], v[160:163]
s_mov_b32 s50, 1548288
ds_read_b64_tr_b16 v[192:193], v233 offset:12288
ds_read_b64_tr_b16 v[194:195], v233 offset:12800
v_mfma_f32_16x16x32_bf16 v[164:167], v[196:199], a[20:23], v[164:167]
v_exp_f32 v32, v32
v_mfma_f32_16x16x32_bf16 v[168:171], v[196:199], a[24:27], v[168:171]
v_exp_f32 v33, v33
v_mfma_f32_16x16x32_bf16 v[172:175], v[196:199], a[28:31], v[172:175]
s_waitcnt lgkmcnt(6)
v_bfe_u32 v241, v237, 2, 5
v_mfma_f32_16x16x32_bf16 v[176:179], v[200:203], a[16:19], v[176:179]
ds_read_b64_tr_b16 v[196:197], v233 offset:12296
ds_read_b64_tr_b16 v[198:199], v233 offset:12808
v_mfma_f32_16x16x32_bf16 v[180:183], v[200:203], a[20:23], v[180:183]
buffer_load_dwordx4 v236, s[20:23], s50 offen lds
v_mfma_f32_16x16x32_bf16 v[184:187], v[200:203], a[24:27], v[184:187]
s_waitcnt vmcnt(7)
s_barrier
v_mfma_f32_16x16x32_bf16 v[188:191], v[200:203], a[28:31], v[188:191]
s_waitcnt lgkmcnt(6)
v_exp_f32 v34, v34
v_mfma_f32_16x16x32_bf16 v[160:163], v[204:207], a[32:35], v[160:163]
s_add_u32 m0, s49, 61440
ds_read_b64_tr_b16 v[200:201], v233 offset:16384
ds_read_b64_tr_b16 v[202:203], v233 offset:16896
v_mfma_f32_16x16x32_bf16 v[164:167], v[204:207], a[36:39], v[164:167]
s_mov_b32 s50, 1658880
v_exp_f32 v35, v35
v_mfma_f32_16x16x32_bf16 v[168:171], v[204:207], a[40:43], v[168:171]
v_add_u32 v241, s83, v241
v_add_f32 v32, 1.0, v32
v_mfma_f32_16x16x32_bf16 v[172:175], v[204:207], a[44:47], v[172:175]
s_waitcnt lgkmcnt(6)
v_add_f32 v33, 1.0, v33
v_add_f32 v34, 1.0, v34
v_mfma_f32_16x16x32_bf16 v[176:179], v[208:211], a[32:35], v[176:179]
ds_read_b64_tr_b16 v[204:205], v233 offset:16392
ds_read_b64_tr_b16 v[206:207], v233 offset:16904
v_mfma_f32_16x16x32_bf16 v[180:183], v[208:211], a[36:39], v[180:183]
buffer_load_dwordx4 v236, s[20:23], s50 offen lds
v_add_f32 v35, 1.0, v35
v_mfma_f32_16x16x32_bf16 v[184:187], v[208:211], a[40:43], v[184:187]
s_add_u32 m0, s49, 65536
v_mul_f32 v36, s96, v36
v_mul_f32 v37, s96, v37
v_mfma_f32_16x16x32_bf16 v[188:191], v[208:211], a[44:47], v[188:191]
s_waitcnt lgkmcnt(6)
v_mul_f32 v38, s96, v38
v_mul_f32 v39, s96, v39
v_mfma_f32_16x16x32_bf16 v[160:163], v[192:195], a[48:51], v[160:163]
s_mov_b32 s50, 1769472
ds_read_b64_tr_b16 v[208:209], v233 offset:20480
ds_read_b64_tr_b16 v[210:211], v233 offset:20992
v_mfma_f32_16x16x32_bf16 v[164:167], v[192:195], a[52:55], v[164:167]
s_mov_b32 s7, 32768
v_rcp_f32 v32, v32
v_mfma_f32_16x16x32_bf16 v[168:171], v[192:195], a[56:59], v[168:171]
s_mov_b32 s68, 147456
v_rcp_f32 v33, v33
v_mfma_f32_16x16x32_bf16 v[172:175], v[192:195], a[60:63], v[172:175]
s_waitcnt lgkmcnt(6)
v_exp_f32 v36, v36
v_mfma_f32_16x16x32_bf16 v[176:179], v[196:199], a[48:51], v[176:179]
s_mov_b32 s83, 49152
ds_read_b64_tr_b16 v[192:193], v233 offset:20488
ds_read_b64_tr_b16 v[194:195], v233 offset:21000
v_mfma_f32_16x16x32_bf16 v[180:183], v[196:199], a[52:55], v[180:183]
buffer_load_dwordx4 v236, s[20:23], s50 offen lds
v_mfma_f32_16x16x32_bf16 v[184:187], v[196:199], a[56:59], v[184:187]
s_add_u32 m0, s49, 69632
v_exp_f32 v37, v37
v_mfma_f32_16x16x32_bf16 v[188:191], v[196:199], a[60:63], v[188:191]
s_waitcnt lgkmcnt(6)
v_rcp_f32 v34, v34
v_mfma_f32_16x16x32_bf16 v[160:163], v[200:203], a[64:67], v[160:163]
s_mov_b32 s50, 1880064
ds_read_b64_tr_b16 v[196:197], v233 offset:24576
ds_read_b64_tr_b16 v[198:199], v233 offset:25088
v_mfma_f32_16x16x32_bf16 v[164:167], v[200:203], a[68:71], v[164:167]
v_rcp_f32 v35, v35
v_mfma_f32_16x16x32_bf16 v[168:171], v[200:203], a[72:75], v[168:171]
v_exp_f32 v38, v38
v_mfma_f32_16x16x32_bf16 v[172:175], v[200:203], a[76:79], v[172:175]
s_waitcnt lgkmcnt(6)
v_exp_f32 v39, v39
v_mfma_f32_16x16x32_bf16 v[176:179], v[204:207], a[64:67], v[176:179]
ds_read_b64_tr_b16 v[200:201], v233 offset:24584
ds_read_b64_tr_b16 v[202:203], v233 offset:25096
v_mfma_f32_16x16x32_bf16 v[180:183], v[204:207], a[68:71], v[180:183]
buffer_load_dwordx4 v236, s[20:23], s50 offen lds
v_mul_f32 v48, v32, v48
v_mfma_f32_16x16x32_bf16 v[184:187], v[204:207], a[72:75], v[184:187]
v_mul_f32 v49, v33, v49
v_mul_f32 v50, v34, v50
v_mfma_f32_16x16x32_bf16 v[188:191], v[204:207], a[76:79], v[188:191]
s_waitcnt lgkmcnt(6)
v_mul_f32 v51, v35, v51
v_add_f32 v36, 1.0, v36
v_mfma_f32_16x16x32_bf16 v[160:163], v[208:211], a[80:83], v[160:163]
ds_read_b64_tr_b16 v[204:205], v233 offset:28672
ds_read_b64_tr_b16 v[206:207], v233 offset:29184
v_mfma_f32_16x16x32_bf16 v[164:167], v[208:211], a[84:87], v[164:167]
v_add_f32 v37, 1.0, v37
v_add_f32 v38, 1.0, v38
v_mfma_f32_16x16x32_bf16 v[168:171], v[208:211], a[88:91], v[168:171]
v_add_f32 v39, 1.0, v39
v_cvt_pk_bf16_f32 v212, v48, v49
v_mfma_f32_16x16x32_bf16 v[172:175], v[208:211], a[92:95], v[172:175]
s_waitcnt lgkmcnt(6)
v_cvt_pk_bf16_f32 v213, v50, v51
v_mul_f32 v40, s96, v40
v_mfma_f32_16x16x32_bf16 v[176:179], v[192:195], a[80:83], v[176:179]
ds_read_b64_tr_b16 v[208:209], v233 offset:28680
ds_read_b64_tr_b16 v[210:211], v233 offset:29192
v_mfma_f32_16x16x32_bf16 v[180:183], v[192:195], a[84:87], v[180:183]
v_mul_f32 v41, s96, v41
v_mul_f32 v42, s96, v42
v_mfma_f32_16x16x32_bf16 v[184:187], v[192:195], a[88:91], v[184:187]
v_rcp_f32 v36, v36
v_mfma_f32_16x16x32_bf16 v[188:191], v[192:195], a[92:95], v[188:191]
s_waitcnt lgkmcnt(6)
v_rcp_f32 v37, v37
v_mfma_f32_16x16x32_bf16 v[160:163], v[196:199], a[96:99], v[160:163]
ds_read_b64_tr_b16 v[192:193], v233 offset:32768
ds_read_b64_tr_b16 v[194:195], v233 offset:33280
v_mfma_f32_16x16x32_bf16 v[164:167], v[196:199], a[100:103], v[164:167]
v_rcp_f32 v38, v38
v_mfma_f32_16x16x32_bf16 v[168:171], v[196:199], a[104:107], v[168:171]
v_rcp_f32 v39, v39
v_mfma_f32_16x16x32_bf16 v[172:175], v[196:199], a[108:111], v[172:175]
s_waitcnt lgkmcnt(6)
v_mul_f32 v43, s96, v43
v_mul_f32 v52, v36, v52
v_mfma_f32_16x16x32_bf16 v[176:179], v[200:203], a[96:99], v[176:179]
ds_read_b64_tr_b16 v[196:197], v233 offset:32776
ds_read_b64_tr_b16 v[198:199], v233 offset:33288
v_mfma_f32_16x16x32_bf16 v[180:183], v[200:203], a[100:103], v[180:183]
v_exp_f32 v40, v40
v_mfma_f32_16x16x32_bf16 v[184:187], v[200:203], a[104:107], v[184:187]
s_waitcnt vmcnt(4)
s_barrier
v_mfma_f32_16x16x32_bf16 v[188:191], v[200:203], a[108:111], v[188:191]
s_waitcnt lgkmcnt(6)
v_exp_f32 v41, v41
v_mfma_f32_16x16x32_bf16 v[160:163], v[204:207], a[112:115], v[160:163]
s_add_u32 m0, s49, 73728
ds_read_b64_tr_b16 v[200:201], v233 offset:36864
ds_read_b64_tr_b16 v[202:203], v233 offset:37376
v_mfma_f32_16x16x32_bf16 v[164:167], v[204:207], a[116:119], v[164:167]
s_add_u32 s50, s57, 0
buffer_load_dwordx4 v237, s[28:31], s50 offen sc1 lds
v_mul_f32 v53, v37, v53
v_mfma_f32_16x16x32_bf16 v[168:171], v[204:207], a[120:123], v[168:171]
v_exp_f32 v42, v42
v_mfma_f32_16x16x32_bf16 v[172:175], v[204:207], a[124:127], v[172:175]
s_waitcnt lgkmcnt(6)
v_mul_f32 v54, v38, v54
v_mul_f32 v55, v39, v55
v_mfma_f32_16x16x32_bf16 v[176:179], v[208:211], a[112:115], v[176:179]
ds_read_b64_tr_b16 v[204:205], v233 offset:36872
ds_read_b64_tr_b16 v[206:207], v233 offset:37384
v_mfma_f32_16x16x32_bf16 v[180:183], v[208:211], a[116:119], v[180:183]
v_exp_f32 v43, v43
v_mfma_f32_16x16x32_bf16 v[184:187], v[208:211], a[120:123], v[184:187]
v_add_f32 v40, 1.0, v40
v_add_f32 v41, 1.0, v41
v_mfma_f32_16x16x32_bf16 v[188:191], v[208:211], a[124:127], v[188:191]
s_waitcnt lgkmcnt(6)
v_cvt_pk_bf16_f32 v216, v52, v53
v_cvt_pk_bf16_f32 v217, v54, v55
v_mfma_f32_16x16x32_bf16 v[160:163], v[192:195], a[128:131], v[160:163]
ds_read_b64_tr_b16 v[208:209], v233 offset:40960
ds_read_b64_tr_b16 v[210:211], v233 offset:41472
v_mfma_f32_16x16x32_bf16 v[164:167], v[192:195], a[132:135], v[164:167]
v_mul_f32 v44, s96, v44
v_mul_f32 v45, s96, v45
v_mfma_f32_16x16x32_bf16 v[168:171], v[192:195], a[136:139], v[168:171]
v_add_f32 v42, 1.0, v42
v_add_f32 v43, 1.0, v43
v_mfma_f32_16x16x32_bf16 v[172:175], v[192:195], a[140:143], v[172:175]
s_waitcnt lgkmcnt(6)
v_rcp_f32 v40, v40
v_mfma_f32_16x16x32_bf16 v[176:179], v[196:199], a[128:131], v[176:179]
s_add_u32 m0, s49, 77824
ds_read_b64_tr_b16 v[192:193], v233 offset:40968
ds_read_b64_tr_b16 v[194:195], v233 offset:41480
v_mfma_f32_16x16x32_bf16 v[180:183], v[196:199], a[132:135], v[180:183]
s_add_u32 s50, s57, 4096
buffer_load_dwordx4 v237, s[28:31], s50 offen sc1 lds
v_mul_f32 v46, s96, v46
v_mfma_f32_16x16x32_bf16 v[184:187], v[196:199], a[136:139], v[184:187]
v_rcp_f32 v41, v41
v_mfma_f32_16x16x32_bf16 v[188:191], v[196:199], a[140:143], v[188:191]
s_waitcnt lgkmcnt(6)
v_rcp_f32 v42, v42
v_mfma_f32_16x16x32_bf16 v[160:163], v[200:203], a[144:147], v[160:163]
ds_read_b64_tr_b16 v[196:197], v233 offset:45056
ds_read_b64_tr_b16 v[198:199], v233 offset:45568
v_mfma_f32_16x16x32_bf16 v[164:167], v[200:203], a[148:151], v[164:167]
v_rcp_f32 v43, v43
v_mfma_f32_16x16x32_bf16 v[168:171], v[200:203], a[152:155], v[168:171]
v_mul_f32 v47, s96, v47
v_mul_f32 v56, v40, v56
v_mfma_f32_16x16x32_bf16 v[172:175], v[200:203], a[156:159], v[172:175]
s_waitcnt lgkmcnt(6)
v_exp_f32 v44, v44
v_mfma_f32_16x16x32_bf16 v[176:179], v[204:207], a[144:147], v[176:179]
ds_read_b64_tr_b16 v[200:201], v233 offset:45064
ds_read_b64_tr_b16 v[202:203], v233 offset:45576
v_mfma_f32_16x16x32_bf16 v[180:183], v[204:207], a[148:151], v[180:183]
v_exp_f32 v45, v45
v_mfma_f32_16x16x32_bf16 v[184:187], v[204:207], a[152:155], v[184:187]
v_exp_f32 v46, v46
v_mfma_f32_16x16x32_bf16 v[188:191], v[204:207], a[156:159], v[188:191]
s_waitcnt lgkmcnt(6)
v_mul_f32 v57, v41, v57
v_mul_f32 v58, v42, v58
v_mfma_f32_16x16x32_bf16 v[160:163], v[208:211], a[160:163], v[160:163]
ds_read_b64_tr_b16 v[204:205], v233 offset:49152
ds_read_b64_tr_b16 v[206:207], v233 offset:49664
v_mfma_f32_16x16x32_bf16 v[164:167], v[208:211], a[164:167], v[164:167]
v_exp_f32 v47, v47
v_mfma_f32_16x16x32_bf16 v[168:171], v[208:211], a[168:171], v[168:171]
v_add_f32 v44, 1.0, v44
v_add_f32 v45, 1.0, v45
v_mfma_f32_16x16x32_bf16 v[172:175], v[208:211], a[172:175], v[172:175]
s_waitcnt lgkmcnt(6)
v_mul_f32 v59, v43, v59
v_cvt_pk_bf16_f32 v220, v56, v57
v_mfma_f32_16x16x32_bf16 v[176:179], v[192:195], a[160:163], v[176:179]
s_add_u32 m0, s49, 81920
ds_read_b64_tr_b16 v[208:209], v233 offset:49160
ds_read_b64_tr_b16 v[210:211], v233 offset:49672
v_mfma_f32_16x16x32_bf16 v[180:183], v[192:195], a[164:167], v[180:183]
s_add_u32 s50, s57, 8192
buffer_load_dwordx4 v237, s[28:31], s50 offen sc1 lds
v_cvt_pk_bf16_f32 v221, v58, v59
v_mfma_f32_16x16x32_bf16 v[184:187], v[192:195], a[168:171], v[184:187]
v_add_f32 v46, 1.0, v46
v_add_f32 v47, 1.0, v47
v_mfma_f32_16x16x32_bf16 v[188:191], v[192:195], a[172:175], v[188:191]
s_waitcnt lgkmcnt(6)
v_rcp_f32 v44, v44
v_mfma_f32_16x16x32_bf16 v[160:163], v[196:199], a[176:179], v[160:163]
ds_read_b64_tr_b16 v[192:193], v233 offset:53248
ds_read_b64_tr_b16 v[194:195], v233 offset:53760
v_mfma_f32_16x16x32_bf16 v[164:167], v[196:199], a[180:183], v[164:167]
v_rcp_f32 v45, v45
v_mfma_f32_16x16x32_bf16 v[168:171], v[196:199], a[184:187], v[168:171]
v_rcp_f32 v46, v46
v_mfma_f32_16x16x32_bf16 v[172:175], v[196:199], a[188:191], v[172:175]
s_waitcnt lgkmcnt(6)
v_rcp_f32 v47, v47
v_mfma_f32_16x16x32_bf16 v[176:179], v[200:203], a[176:179], v[176:179]
ds_read_b64_tr_b16 v[196:197], v233 offset:53256
ds_read_b64_tr_b16 v[198:199], v233 offset:53768
v_mfma_f32_16x16x32_bf16 v[180:183], v[200:203], a[180:183], v[180:183]
v_mul_f32 v60, v44, v60
v_mul_f32 v61, v45, v61
v_mfma_f32_16x16x32_bf16 v[184:187], v[200:203], a[184:187], v[184:187]
s_waitcnt vmcnt(3)
s_barrier
v_mfma_f32_16x16x32_bf16 v[188:191], v[200:203], a[188:191], v[188:191]
s_waitcnt lgkmcnt(6)
v_mul_f32 v62, v46, v62
v_mul_f32 v63, v47, v63
v_mfma_f32_16x16x32_bf16 v[160:163], v[204:207], a[192:195], v[160:163]
s_add_u32 m0, s49, 86016
ds_read_b64_tr_b16 v[200:201], v233 offset:57344
ds_read_b64_tr_b16 v[202:203], v233 offset:57856
v_mfma_f32_16x16x32_bf16 v[164:167], v[204:207], a[196:199], v[164:167]
s_add_u32 s50, s57, 12288
buffer_load_dwordx4 v237, s[28:31], s50 offen sc1 lds
v_cvt_pk_bf16_f32 v224, v60, v61
v_mfma_f32_16x16x32_bf16 v[168:171], v[204:207], a[200:203], v[168:171]
v_cvt_pk_bf16_f32 v225, v62, v63
v_mul_f32 v64, s96, v64
v_mfma_f32_16x16x32_bf16 v[172:175], v[204:207], a[204:207], v[172:175]
s_waitcnt lgkmcnt(6)
v_mul_f32 v65, s96, v65
v_mul_f32 v66, s96, v66
v_mfma_f32_16x16x32_bf16 v[176:179], v[208:211], a[192:195], v[176:179]
ds_read_b64_tr_b16 v[204:205], v233 offset:57352
ds_read_b64_tr_b16 v[206:207], v233 offset:57864
v_mfma_f32_16x16x32_bf16 v[180:183], v[208:211], a[196:199], v[180:183]
v_mul_f32 v67, s96, v67
v_mul_f32 v68, s96, v68
v_mfma_f32_16x16x32_bf16 v[184:187], v[208:211], a[200:203], v[184:187]
s_waitcnt vmcnt(13)
s_barrier
v_mov_b32 v242, 1
buffer_store_dword v242, off, s[40:43], s60 offset:1024 sc1
v_mfma_f32_16x16x32_bf16 v[188:191], v[208:211], a[204:207], v[188:191]
s_waitcnt lgkmcnt(6)
v_exp_f32 v64, v64
v_mfma_f32_16x16x32_bf16 v[160:163], v[192:195], a[208:211], v[160:163]
s_add_u32 m0, s49, 110592
ds_read_b64_tr_b16 v[208:209], v233 offset:61440
ds_read_b64_tr_b16 v[210:211], v233 offset:61952
v_mfma_f32_16x16x32_bf16 v[164:167], v[192:195], a[212:215], v[164:167]
s_mov_b32 s53, 640
buffer_load_dwordx4 v234, s[12:15], s53 offen lds
v_mul_f32 v69, s96, v69
v_mfma_f32_16x16x32_bf16 v[168:171], v[192:195], a[216:219], v[168:171]
v_exp_f32 v65, v65
v_mfma_f32_16x16x32_bf16 v[172:175], v[192:195], a[220:223], v[172:175]
s_waitcnt lgkmcnt(6)
v_exp_f32 v66, v66
v_mfma_f32_16x16x32_bf16 v[176:179], v[196:199], a[208:211], v[176:179]
ds_read_b64_tr_b16 v[192:193], v233 offset:61448
ds_read_b64_tr_b16 v[194:195], v233 offset:61960
v_mfma_f32_16x16x32_bf16 v[180:183], v[196:199], a[212:215], v[180:183]
v_add_u32 v233, 65536, v233
v_mul_f32 v70, s96, v70
v_mfma_f32_16x16x32_bf16 v[184:187], v[196:199], a[216:219], v[184:187]
v_exp_f32 v67, v67
v_mfma_f32_16x16x32_bf16 v[188:191], v[196:199], a[220:223], v[188:191]
s_waitcnt lgkmcnt(6)
v_add_f32 v64, 1.0, v64
v_add_f32 v65, 1.0, v65
v_mfma_f32_16x16x32_bf16 v[160:163], v[200:203], a[224:227], v[160:163]
s_add_u32 m0, s49, 90112
ds_read_b64_tr_b16 v[196:197], v233 offset:0
ds_read_b64_tr_b16 v[198:199], v233 offset:512
v_mfma_f32_16x16x32_bf16 v[164:167], v[200:203], a[228:231], v[164:167]
s_add_u32 s50, s57, 16384
buffer_load_dwordx4 v237, s[28:31], s50 offen sc1 lds
v_add_f32 v66, 1.0, v66
v_mfma_f32_16x16x32_bf16 v[168:171], v[200:203], a[232:235], v[168:171]
v_add_f32 v67, 1.0, v67
v_mul_f32 v71, s96, v71
v_mfma_f32_16x16x32_bf16 v[172:175], v[200:203], a[236:239], v[172:175]
s_waitcnt lgkmcnt(6)
v_rcp_f32 v64, v64
v_mfma_f32_16x16x32_bf16 v[176:179], v[204:207], a[224:227], v[176:179]
s_add_u32 m0, s49, 114688
ds_read_b64_tr_b16 v[200:201], v233 offset:8
ds_read_b64_tr_b16 v[202:203], v233 offset:520
v_mfma_f32_16x16x32_bf16 v[180:183], v[204:207], a[228:231], v[180:183]
v_rcp_f32 v65, v65
v_mfma_f32_16x16x32_bf16 v[184:187], v[204:207], a[232:235], v[184:187]
v_rcp_f32 v66, v66
v_mfma_f32_16x16x32_bf16 v[188:191], v[204:207], a[236:239], v[188:191]
s_waitcnt lgkmcnt(6)
v_rcp_f32 v67, v67
v_mfma_f32_16x16x32_bf16 v[160:163], v[208:211], a[240:243], v[160:163]
ds_read_b64_tr_b16 v[204:205], v233 offset:4096
ds_read_b64_tr_b16 v[206:207], v233 offset:4608
v_mfma_f32_16x16x32_bf16 v[164:167], v[208:211], a[244:247], v[164:167]
buffer_load_dwordx4 v234, s[16:19], s53 offen lds
v_mul_f32 v80, v64, v80
v_mfma_f32_16x16x32_bf16 v[168:171], v[208:211], a[248:251], v[168:171]
v_exp_f32 v68, v68
v_mfma_f32_16x16x32_bf16 v[172:175], v[208:211], a[252:255], v[172:175]
s_waitcnt lgkmcnt(6)
v_exp_f32 v69, v69
v_mfma_f32_16x16x32_bf16 v[176:179], v[192:195], a[240:243], v[176:179]
s_add_u32 m0, s49, 94208
ds_read_b64_tr_b16 v[208:209], v233 offset:4104
ds_read_b64_tr_b16 v[210:211], v233 offset:4616
v_mfma_f32_16x16x32_bf16 v[180:183], v[192:195], a[244:247], v[180:183]
s_add_u32 s50, s57, 20480
v_xor_b32 v233, 64, v233
v_add_u32 v233, 4294901760, v233
v_mfma_f32_16x16x32_bf16 v[184:187], v[192:195], a[248:251], v[184:187]
buffer_load_dwordx4 v237, s[28:31], s50 offen sc1 lds
v_mul_f32 v81, v65, v81
v_mfma_f32_16x16x32_bf16 v[188:191], v[192:195], a[252:255], v[188:191]
s_waitcnt lgkmcnt(6)
v_exp_f32 v70, v70
v_mfma_f32_16x16x32_bf16 v[160:163], v[196:199], v[0:3], v[160:163]
ds_read_b64_tr_b16 v[192:193], v233 offset:0
ds_read_b64_tr_b16 v[194:195], v233 offset:512
v_mfma_f32_16x16x32_bf16 v[164:167], v[196:199], v[4:7], v[164:167]
v_mul_f32 v82, v66, v82
v_mul_f32 v83, v67, v83
v_mfma_f32_16x16x32_bf16 v[168:171], v[196:199], v[8:11], v[168:171]
s_lshl_b32 s51, s69, 10
v_exp_f32 v71, v71
v_mfma_f32_16x16x32_bf16 v[172:175], v[196:199], v[12:15], v[172:175]
s_waitcnt lgkmcnt(6)
v_add_f32 v68, 1.0, v68
v_add_f32 v69, 1.0, v69
v_mfma_f32_16x16x32_bf16 v[176:179], v[200:203], v[0:3], v[176:179]
s_add_u32 s51, s55, s51
ds_read_b64_tr_b16 v[196:197], v233 offset:8
ds_read_b64_tr_b16 v[198:199], v233 offset:520
v_mfma_f32_16x16x32_bf16 v[180:183], v[200:203], v[4:7], v[180:183]
s_add_u32 s51, s51, 0
v_cvt_pk_bf16_f32 v214, v80, v81
v_cvt_pk_bf16_f32 v215, v82, v83
v_mfma_f32_16x16x32_bf16 v[184:187], v[200:203], v[8:11], v[184:187]
s_add_u32 m0, s49, 118784
buffer_store_dwordx4 v[212:215], v237, s[28:31], s51 offen offset:0 sc1
v_add_f32 v70, 1.0, v70
v_mfma_f32_16x16x32_bf16 v[188:191], v[200:203], v[12:15], v[188:191]
s_waitcnt lgkmcnt(6)
v_add_f32 v71, 1.0, v71
v_mul_f32 v72, s96, v72
v_mfma_f32_16x16x32_bf16 v[160:163], v[204:207], v[16:19], v[160:163]
s_mov_b32 s53, 295552
ds_read_b64_tr_b16 v[200:201], v233 offset:4096
ds_read_b64_tr_b16 v[202:203], v233 offset:4608
v_mfma_f32_16x16x32_bf16 v[164:167], v[204:207], v[20:23], v[164:167]
buffer_load_dwordx4 v234, s[12:15], s53 offen lds
v_mul_f32 v73, s96, v73
v_mfma_f32_16x16x32_bf16 v[168:171], v[204:207], v[24:27], v[168:171]
v_mul_f32 v74, s96, v74
v_mul_f32 v75, s96, v75
v_mfma_f32_16x16x32_bf16 v[172:175], v[204:207], v[28:31], v[172:175]
s_waitcnt lgkmcnt(6)
v_rcp_f32 v68, v68
v_mfma_f32_16x16x32_bf16 v[176:179], v[208:211], v[16:19], v[176:179]
s_add_u32 m0, s49, 98304
ds_read_b64_tr_b16 v[204:205], v233 offset:4104
ds_read_b64_tr_b16 v[206:207], v233 offset:4616
v_mfma_f32_16x16x32_bf16 v[180:183], v[208:211], v[20:23], v[180:183]
s_add_u32 s50, s57, 24576
v_rcp_f32 v69, v69
v_mfma_f32_16x16x32_bf16 v[184:187], v[208:211], v[24:27], v[184:187]
v_exp_f32 v72, v72
v_mfma_f32_16x16x32_bf16 v[188:191], v[208:211], v[28:31], v[188:191]
s_waitcnt lgkmcnt(6)
v_exp_f32 v73, v73
v_mfma_f32_16x16x32_bf16 v[32:35], v[192:195], a[0:3], 0
ds_read_b64_tr_b16 v[208:209], v233 offset:8192
ds_read_b64_tr_b16 v[210:211], v233 offset:8704
v_mfma_f32_16x16x32_bf16 v[36:39], v[192:195], a[4:7], 0
s_waitcnt lgkmcnt(6)
buffer_load_dwordx4 v237, s[28:31], s50 offen sc1 lds
v_mfma_f32_16x16x32_bf16 v[48:51], v[196:199], a[0:3], 0
s_add_u32 m0, s49, 122880
ds_read_b64_tr_b16 v[192:193], v233 offset:8200
ds_read_b64_tr_b16 v[194:195], v233 offset:8712
v_mfma_f32_16x16x32_bf16 v[52:55], v[196:199], a[4:7], 0
TCH_3_v1:
s_cbranch_execz TCH_7_v1
s_waitcnt lgkmcnt(6)
v_rcp_f32 v70, v70
v_mfma_f32_16x16x32_bf16 v[32:35], v[200:203], a[16:19], v[32:35]
ds_read_b64_tr_b16 v[196:197], v233 offset:12288
ds_read_b64_tr_b16 v[198:199], v233 offset:12800
v_mfma_f32_16x16x32_bf16 v[36:39], v[200:203], a[20:23], v[36:39]
s_waitcnt lgkmcnt(6)
buffer_load_dwordx4 v234, s[16:19], s53 offen lds
v_mfma_f32_16x16x32_bf16 v[48:51], v[204:207], a[16:19], v[48:51]
s_add_u32 m0, s49, 102400
ds_read_b64_tr_b16 v[200:201], v233 offset:12296
ds_read_b64_tr_b16 v[202:203], v233 offset:12808
v_mfma_f32_16x16x32_bf16 v[52:55], v[204:207], a[20:23], v[52:55]
s_waitcnt lgkmcnt(6)
v_rcp_f32 v71, v71
v_mfma_f32_16x16x32_bf16 v[32:35], v[208:211], a[32:35], v[32:35]
s_add_u32 s50, s57, 28672
ds_read_b64_tr_b16 v[204:205], v233 offset:16384
ds_read_b64_tr_b16 v[206:207], v233 offset:16896
v_mfma_f32_16x16x32_bf16 v[36:39], v[208:211], a[36:39], v[36:39]
s_waitcnt lgkmcnt(6)
buffer_load_dwordx4 v237, s[28:31], s50 offen sc1 lds
v_mul_f32 v84, v68, v84
v_mfma_f32_16x16x32_bf16 v[48:51], v[192:195], a[32:35], v[48:51]
s_add_u32 m0, s49, 126976
ds_read_b64_tr_b16 v[208:209], v233 offset:16392
ds_read_b64_tr_b16 v[210:211], v233 offset:16904
v_mfma_f32_16x16x32_bf16 v[52:55], v[192:195], a[36:39], v[52:55]
s_waitcnt lgkmcnt(6)
v_exp_f32 v74, v74
v_mfma_f32_16x16x32_bf16 v[32:35], v[196:199], a[48:51], v[32:35]
s_mov_b32 s53, 590464
ds_read_b64_tr_b16 v[192:193], v233 offset:20480
ds_read_b64_tr_b16 v[194:195], v233 offset:20992
v_mfma_f32_16x16x32_bf16 v[36:39], v[196:199], a[52:55], v[36:39]
s_waitcnt lgkmcnt(6)
buffer_load_dwordx4 v234, s[12:15], s53 offen lds
v_mul_f32 v85, v69, v85
v_mfma_f32_16x16x32_bf16 v[48:51], v[200:203], a[48:51], v[48:51]
s_add_u32 m0, s49, 106496
ds_read_b64_tr_b16 v[196:197], v233 offset:20488
ds_read_b64_tr_b16 v[198:199], v233 offset:21000
v_mfma_f32_16x16x32_bf16 v[52:55], v[200:203], a[52:55], v[52:55]
s_waitcnt lgkmcnt(6)
v_exp_f32 v75, v75
v_mfma_f32_16x16x32_bf16 v[32:35], v[204:207], a[64:67], v[32:35]
s_add_u32 s50, s57, 32768
ds_read_b64_tr_b16 v[200:201], v233 offset:24576
ds_read_b64_tr_b16 v[202:203], v233 offset:25088
v_mfma_f32_16x16x32_bf16 v[36:39], v[204:207], a[68:71], v[36:39]
s_waitcnt lgkmcnt(6)
buffer_load_dwordx4 v237, s[28:31], s50 offen sc1 lds
v_add_f32 v72, 1.0, v72
v_mfma_f32_16x16x32_bf16 v[48:51], v[208:211], a[64:67], v[48:51]
s_xor_b32 s64, s69, 0
ds_read_b64_tr_b16 v[204:205], v233 offset:24584
ds_read_b64_tr_b16 v[206:207], v233 offset:25096
v_mfma_f32_16x16x32_bf16 v[52:55], v[208:211], a[68:71], v[52:55]
s_waitcnt lgkmcnt(6)
v_mul_f32 v86, v70, v86
v_mul_f32 v87, v71, v87
v_mfma_f32_16x16x32_bf16 v[32:35], v[192:195], a[80:83], v[32:35]
s_lshl_b32 s66, s69, 10
ds_read_b64_tr_b16 v[208:209], v233 offset:28672
ds_read_b64_tr_b16 v[210:211], v233 offset:29184
v_mfma_f32_16x16x32_bf16 v[36:39], v[192:195], a[84:87], v[36:39]
s_waitcnt lgkmcnt(6)
v_add_f32 v73, 1.0, v73
v_add_f32 v74, 1.0, v74
v_mfma_f32_16x16x32_bf16 v[48:51], v[196:199], a[80:83], v[48:51]
s_add_u32 s66, s55, s66
ds_read_b64_tr_b16 v[192:193], v233 offset:28680
ds_read_b64_tr_b16 v[194:195], v233 offset:29192
v_mfma_f32_16x16x32_bf16 v[52:55], v[196:199], a[84:87], v[52:55]
s_waitcnt lgkmcnt(6)
v_add_f32 v75, 1.0, v75
s_add_u32 s66, s66, 0
v_mfma_f32_16x16x32_bf16 v[32:35], v[200:203], a[96:99], v[32:35]
s_add_u32 s64, s76, s64
ds_read_b64_tr_b16 v[196:197], v233 offset:32768
ds_read_b64_tr_b16 v[198:199], v233 offset:33280
v_mfma_f32_16x16x32_bf16 v[36:39], v[200:203], a[100:103], v[36:39]
s_waitcnt lgkmcnt(6)
v_cvt_pk_bf16_f32 v218, v84, v85
v_cvt_pk_bf16_f32 v219, v86, v87
v_mfma_f32_16x16x32_bf16 v[48:51], v[204:207], a[96:99], v[48:51]
s_add_u32 s11, s97, 0
ds_read_b64_tr_b16 v[200:201], v233 offset:32776
ds_read_b64_tr_b16 v[202:203], v233 offset:33288
v_mfma_f32_16x16x32_bf16 v[52:55], v[204:207], a[100:103], v[52:55]
s_waitcnt lgkmcnt(6)
buffer_store_dwordx4 v[216:219], v237, s[28:31], s66 offen offset:1024 sc1
v_mul_f32 v76, s96, v76
v_mfma_f32_16x16x32_bf16 v[32:35], v[208:211], a[112:115], v[32:35]
s_add_u32 m0, s49, 131072
ds_read_b64_tr_b16 v[204:205], v233 offset:36864
ds_read_b64_tr_b16 v[206:207], v233 offset:37376
v_mfma_f32_16x16x32_bf16 v[36:39], v[208:211], a[116:119], v[36:39]
s_waitcnt lgkmcnt(6)
v_rcp_f32 v72, v72
v_mfma_f32_16x16x32_bf16 v[48:51], v[192:195], a[112:115], v[48:51]
s_and_b32 s64, s64, 3
ds_read_b64_tr_b16 v[208:209], v233 offset:36872
ds_read_b64_tr_b16 v[210:211], v233 offset:37384
v_mfma_f32_16x16x32_bf16 v[52:55], v[192:195], a[116:119], v[52:55]
s_waitcnt lgkmcnt(6)
buffer_load_dwordx4 v234, s[16:19], s53 offen lds
v_mul_f32 v77, s96, v77
v_mfma_f32_16x16x32_bf16 v[32:35], v[196:199], a[128:131], v[32:35]
s_mul_i32 s64, s64, 55296
ds_read_b64_tr_b16 v[192:193], v233 offset:40960
ds_read_b64_tr_b16 v[194:195], v233 offset:41472
v_mfma_f32_16x16x32_bf16 v[36:39], v[196:199], a[132:135], v[36:39]
s_waitcnt lgkmcnt(6)
v_rcp_f32 v73, v73
v_mfma_f32_16x16x32_bf16 v[48:51], v[200:203], a[128:131], v[48:51]
s_add_u32 s64, s64, s58
ds_read_b64_tr_b16 v[196:197], v233 offset:40968
ds_read_b64_tr_b16 v[198:199], v233 offset:41480
v_mfma_f32_16x16x32_bf16 v[52:55], v[200:203], a[132:135], v[52:55]
s_waitcnt lgkmcnt(6)
v_mul_f32 v78, s96, v78
v_mul_f32 v79, s96, v79
v_mfma_f32_16x16x32_bf16 v[32:35], v[204:207], a[144:147], v[32:35]
s_add_u32 m0, s49, 135168
ds_read_b64_tr_b16 v[200:201], v233 offset:45056
ds_read_b64_tr_b16 v[202:203], v233 offset:45568
v_mfma_f32_16x16x32_bf16 v[36:39], v[204:207], a[148:151], v[36:39]
s_waitcnt lgkmcnt(6)
v_rcp_f32 v74, v74
v_mfma_f32_16x16x32_bf16 v[48:51], v[208:211], a[144:147], v[48:51]
s_mov_b32 s53, 885376
ds_read_b64_tr_b16 v[204:205], v233 offset:45064
ds_read_b64_tr_b16 v[206:207], v233 offset:45576
v_mfma_f32_16x16x32_bf16 v[52:55], v[208:211], a[148:151], v[52:55]
s_waitcnt lgkmcnt(6)
buffer_load_dwordx4 v234, s[12:15], s53 offen lds
v_cvt_pk_bf16_f32 v160, v160, v161
v_mfma_f32_16x16x32_bf16 v[32:35], v[192:195], a[160:163], v[32:35]
s_add_u32 m0, s49, 139264
ds_read_b64_tr_b16 v[208:209], v233 offset:49152
ds_read_b64_tr_b16 v[210:211], v233 offset:49664
v_mfma_f32_16x16x32_bf16 v[36:39], v[192:195], a[164:167], v[36:39]
s_waitcnt lgkmcnt(6)
buffer_load_dwordx4 v234, s[16:19], s53 offen lds
v_cvt_pk_bf16_f32 v161, v162, v163
v_mfma_f32_16x16x32_bf16 v[48:51], v[196:199], a[160:163], v[48:51]
s_add_u32 m0, s49, 143360
ds_read_b64_tr_b16 v[192:193], v233 offset:49160
ds_read_b64_tr_b16 v[194:195], v233 offset:49672
v_mfma_f32_16x16x32_bf16 v[52:55], v[196:199], a[164:167], v[52:55]
s_waitcnt lgkmcnt(6)
v_rcp_f32 v75, v75
v_mfma_f32_16x16x32_bf16 v[32:35], v[200:203], a[176:179], v[32:35]
s_mov_b32 s53, 1180288
ds_read_b64_tr_b16 v[196:197], v233 offset:53248
ds_read_b64_tr_b16 v[198:199], v233 offset:53760
v_mfma_f32_16x16x32_bf16 v[36:39], v[200:203], a[180:183], v[36:39]
s_waitcnt lgkmcnt(6)
v_exp_f32 v76, v76
v_mfma_f32_16x16x32_bf16 v[48:51], v[204:207], a[176:179], v[48:51]
ds_read_b64_tr_b16 v[200:201], v233 offset:53256
ds_read_b64_tr_b16 v[202:203], v233 offset:53768
v_mfma_f32_16x16x32_bf16 v[52:55], v[204:207], a[180:183], v[52:55]
s_waitcnt lgkmcnt(6)
buffer_load_dwordx4 v234, s[12:15], s53 offen lds
v_mul_f32 v88, v72, v88
v_mfma_f32_16x16x32_bf16 v[32:35], v[208:211], a[192:195], v[32:35]
s_add_u32 m0, s49, 147456
ds_read_b64_tr_b16 v[204:205], v233 offset:57344
ds_read_b64_tr_b16 v[206:207], v233 offset:57856
v_mfma_f32_16x16x32_bf16 v[36:39], v[208:211], a[196:199], v[36:39]
s_waitcnt lgkmcnt(6)
v_exp_f32 v77, v77
v_mfma_f32_16x16x32_bf16 v[48:51], v[192:195], a[192:195], v[48:51]
ds_read_b64_tr_b16 v[208:209], v233 offset:57352
ds_read_b64_tr_b16 v[210:211], v233 offset:57864
v_mfma_f32_16x16x32_bf16 v[52:55], v[192:195], a[196:199], v[52:55]
s_waitcnt lgkmcnt(6)
v_mul_f32 v89, v73, v89
v_mul_f32 v90, v74, v90
v_mfma_f32_16x16x32_bf16 v[32:35], v[196:199], a[208:211], v[32:35]
ds_read_b64_tr_b16 v[192:193], v233 offset:61440
ds_read_b64_tr_b16 v[194:195], v233 offset:61952
v_mfma_f32_16x16x32_bf16 v[36:39], v[196:199], a[212:215], v[36:39]
s_waitcnt lgkmcnt(6)
buffer_load_dwordx4 v234, s[16:19], s53 offen lds
v_mul_f32 v91, v75, v91
v_mfma_f32_16x16x32_bf16 v[48:51], v[200:203], a[208:211], v[48:51]
s_lshl_b32 s51, s69, 10
ds_read_b64_tr_b16 v[196:197], v233 offset:61448
ds_read_b64_tr_b16 v[198:199], v233 offset:61960
v_mfma_f32_16x16x32_bf16 v[52:55], v[200:203], a[212:215], v[52:55]
s_waitcnt lgkmcnt(6)
v_add_u32 v233, 65536, v233
v_cvt_pk_bf16_f32 v162, v176, v177
v_mfma_f32_16x16x32_bf16 v[32:35], v[204:207], a[224:227], v[32:35]
s_sub_u32 s51, s55, s51
ds_read_b64_tr_b16 v[200:201], v233 offset:0
ds_read_b64_tr_b16 v[202:203], v233 offset:512
v_mfma_f32_16x16x32_bf16 v[36:39], v[204:207], a[228:231], v[36:39]
s_waitcnt lgkmcnt(6)
v_exp_f32 v78, v78
v_mfma_f32_16x16x32_bf16 v[48:51], v[208:211], a[224:227], v[48:51]
s_add_u32 s51, s51, 0
ds_read_b64_tr_b16 v[204:205], v233 offset:8
ds_read_b64_tr_b16 v[206:207], v233 offset:520
v_mfma_f32_16x16x32_bf16 v[52:55], v[208:211], a[228:231], v[52:55]
s_waitcnt lgkmcnt(6)
v_exp_f32 v79, v79
v_mfma_f32_16x16x32_bf16 v[32:35], v[192:195], a[240:243], v[32:35]
s_add_u32 m0, s49, 151552
ds_read_b64_tr_b16 v[208:209], v233 offset:4096
ds_read_b64_tr_b16 v[210:211], v233 offset:4608
v_mfma_f32_16x16x32_bf16 v[36:39], v[192:195], a[244:247], v[36:39]
s_waitcnt lgkmcnt(6)
v_add_f32 v76, 1.0, v76
v_cvt_pk_bf16_f32 v222, v88, v89
v_mfma_f32_16x16x32_bf16 v[48:51], v[196:199], a[240:243], v[48:51]
s_mov_b32 s53, 1475200
ds_read_b64_tr_b16 v[192:193], v233 offset:4104
ds_read_b64_tr_b16 v[194:195], v233 offset:4616
v_mfma_f32_16x16x32_bf16 v[52:55], v[196:199], a[244:247], v[52:55]
s_waitcnt lgkmcnt(6)
v_add_u32 v232, 65536, v232
s_waitcnt vmcnt(6)
s_barrier
v_mfma_f32_16x16x32_bf16 v[32:35], v[200:203], v[0:3], v[32:35]
ds_read_b64_tr_b16 v[196:197], v232 offset:8192
ds_read_b64_tr_b16 v[198:199], v232 offset:8448
v_mfma_f32_16x16x32_bf16 v[36:39], v[200:203], v[4:7], v[36:39]
s_waitcnt lgkmcnt(6)
buffer_load_dwordx4 v234, s[12:15], s53 offen lds
v_cvt_pk_bf16_f32 v223, v90, v91
v_mfma_f32_16x16x32_bf16 v[48:51], v[204:207], v[0:3], v[48:51]
s_add_u32 m0, s49, 155648
ds_read_b64_tr_b16 v[200:201], v232 offset:9216
ds_read_b64_tr_b16 v[202:203], v232 offset:9472
v_mfma_f32_16x16x32_bf16 v[52:55], v[204:207], v[4:7], v[52:55]
s_waitcnt lgkmcnt(6)
buffer_store_dwordx4 v[220:223], v237, s[28:31], s51 offen offset:2048 sc1
v_add_f32 v77, 1.0, v77
v_mfma_f32_16x16x32_bf16 v[32:35], v[208:211], v[16:19], v[32:35]
ds_read_b64_tr_b16 v[204:205], v232 offset:10240
ds_read_b64_tr_b16 v[206:207], v232 offset:10496
v_mfma_f32_16x16x32_bf16 v[36:39], v[208:211], v[20:23], v[36:39]
s_waitcnt lgkmcnt(6)
v_add_f32 v78, 1.0, v78
v_add_f32 v79, 1.0, v79
v_mfma_f32_16x16x32_bf16 v[48:51], v[192:195], v[16:19], v[48:51]
ds_read_b64_tr_b16 v[208:209], v232 offset:11264
ds_read_b64_tr_b16 v[210:211], v232 offset:11520
v_mfma_f32_16x16x32_bf16 v[52:55], v[192:195], v[20:23], v[52:55]
s_waitcnt lgkmcnt(6)
v_rcp_f32 v76, v76
v_rcp_f32 v77, v77
v_rcp_f32 v78, v78
v_rcp_f32 v79, v79
v_mul_f32 v92, v76, v92
v_mul_f32 v93, v77, v93
v_mul_f32 v94, v78, v94
v_mul_f32 v95, v79, v95
s_lshl_b32 s66, s69, 10
s_sub_u32 s66, s55, s66
s_add_u32 s66, s66, 0
v_cvt_pk_bf16_f32 v226, v92, v93
v_cvt_pk_bf16_f32 v227, v94, v95
buffer_store_dwordx4 v[224:227], v237, s[28:31], s66 offen offset:3072 sc1
v_mfma_f32_16x16x32_bf16 v[64:67], v[196:199], a[0:3], 0
ds_read_b64_tr_b16 v[192:193], v232 offset:12288
ds_read_b64_tr_b16 v[194:195], v232 offset:12544
v_mfma_f32_16x16x32_bf16 v[68:71], v[196:199], a[4:7], 0
v_mul_f32 v96, s96, v96
v_mul_f32 v97, s96, v97
v_mfma_f32_16x16x32_bf16 v[72:75], v[196:199], a[8:11], 0
buffer_load_dwordx4 v234, s[16:19], s53 offen lds
v_mul_f32 v98, s96, v98
v_mfma_f32_16x16x32_bf16 v[76:79], v[196:199], a[12:15], 0
s_waitcnt lgkmcnt(6)
v_mul_f32 v99, s96, v99
v_cvt_pk_bf16_f32 v163, v178, v179
v_mfma_f32_16x16x32_bf16 v[80:83], v[200:203], a[0:3], 0
s_add_u32 m0, s49, 0
ds_read_b64_tr_b16 v[196:197], v232 offset:13312
ds_read_b64_tr_b16 v[198:199], v232 offset:13568
v_mfma_f32_16x16x32_bf16 v[84:87], v[200:203], a[4:7], 0
s_mov_b32 s53, 1770112
v_exp_f32 v96, v96
v_mfma_f32_16x16x32_bf16 v[88:91], v[200:203], a[8:11], 0
v_exp_f32 v97, v97
v_mfma_f32_16x16x32_bf16 v[92:95], v[200:203], a[12:15], 0
s_waitcnt lgkmcnt(6)
v_exp_f32 v98, v98
v_mfma_f32_16x16x32_bf16 v[64:67], v[204:207], a[16:19], v[64:67]
ds_read_b64_tr_b16 v[200:201], v232 offset:14336
ds_read_b64_tr_b16 v[202:203], v232 offset:14592
v_mfma_f32_16x16x32_bf16 v[68:71], v[204:207], a[20:23], v[68:71]
buffer_store_dwordx4 v[160:163], v239, s[32:35], s64 offen sc1
v_mul_f32 v100, s96, v100
v_mfma_f32_16x16x32_bf16 v[72:75], v[204:207], a[24:27], v[72:75]
s_xor_b32 s64, s69, 1
v_exp_f32 v99, v99
v_mfma_f32_16x16x32_bf16 v[76:79], v[204:207], a[28:31], v[76:79]
s_waitcnt lgkmcnt(6)
v_add_f32 v96, 1.0, v96
v_add_f32 v97, 1.0, v97
v_mfma_f32_16x16x32_bf16 v[80:83], v[208:211], a[16:19], v[80:83]
s_add_u32 s64, s76, s64
ds_read_b64_tr_b16 v[204:205], v232 offset:15360
ds_read_b64_tr_b16 v[206:207], v232 offset:15616
v_mfma_f32_16x16x32_bf16 v[84:87], v[208:211], a[20:23], v[84:87]
s_and_b32 s64, s64, 3
v_add_f32 v98, 1.0, v98
v_add_f32 v99, 1.0, v99
v_mfma_f32_16x16x32_bf16 v[88:91], v[208:211], a[24:27], v[88:91]
s_mul_i32 s64, s64, 55296
v_mul_f32 v101, s96, v101
v_mul_f32 v102, s96, v102
v_mfma_f32_16x16x32_bf16 v[92:95], v[208:211], a[28:31], v[92:95]
s_waitcnt lgkmcnt(6)
v_rcp_f32 v96, v96
v_mfma_f32_16x16x32_bf16 v[64:67], v[192:195], a[32:35], v[64:67]
s_add_u32 s64, s64, s58
ds_read_b64_tr_b16 v[208:209], v232 offset:16384
ds_read_b64_tr_b16 v[210:211], v232 offset:16640
v_mfma_f32_16x16x32_bf16 v[68:71], v[192:195], a[36:39], v[68:71]
v_rcp_f32 v97, v97
v_mfma_f32_16x16x32_bf16 v[72:75], v[192:195], a[40:43], v[72:75]
v_mul_f32 v103, s96, v103
v_cvt_pk_bf16_f32 v164, v164, v165
v_mfma_f32_16x16x32_bf16 v[76:79], v[192:195], a[44:47], v[76:79]
s_waitcnt lgkmcnt(6)
v_exp_f32 v100, v100
v_mfma_f32_16x16x32_bf16 v[80:83], v[196:199], a[32:35], v[80:83]
ds_read_b64_tr_b16 v[192:193], v232 offset:17408
ds_read_b64_tr_b16 v[194:195], v232 offset:17664
v_mfma_f32_16x16x32_bf16 v[84:87], v[196:199], a[36:39], v[84:87]
v_rcp_f32 v98, v98
v_mfma_f32_16x16x32_bf16 v[88:91], v[196:199], a[40:43], v[88:91]
v_exp_f32 v101, v101
v_mfma_f32_16x16x32_bf16 v[92:95], v[196:199], a[44:47], v[92:95]
s_waitcnt lgkmcnt(6)
v_rcp_f32 v99, v99
v_mfma_f32_16x16x32_bf16 v[64:67], v[200:203], a[48:51], v[64:67]
ds_read_b64_tr_b16 v[196:197], v232 offset:18432
ds_read_b64_tr_b16 v[198:199], v232 offset:18688
v_mfma_f32_16x16x32_bf16 v[68:71], v[200:203], a[52:55], v[68:71]
buffer_load_dwordx4 v234, s[12:15], s53 offen lds
v_mul_f32 v112, v96, v112
v_mfma_f32_16x16x32_bf16 v[72:75], v[200:203], a[56:59], v[72:75]
s_add_u32 m0, s49, 4096
v_exp_f32 v102, v102
v_mfma_f32_16x16x32_bf16 v[76:79], v[200:203], a[60:63], v[76:79]
s_waitcnt lgkmcnt(6)
v_cvt_pk_bf16_f32 v165, v166, v167
v_mul_f32 v113, v97, v113
v_mfma_f32_16x16x32_bf16 v[80:83], v[204:207], a[48:51], v[80:83]
ds_read_b64_tr_b16 v[200:201], v232 offset:19456
ds_read_b64_tr_b16 v[202:203], v232 offset:19712
v_mfma_f32_16x16x32_bf16 v[84:87], v[204:207], a[52:55], v[84:87]
v_exp_f32 v103, v103
v_mfma_f32_16x16x32_bf16 v[88:91], v[204:207], a[56:59], v[88:91]
v_mul_f32 v114, v98, v114
v_mul_f32 v115, v99, v115
v_mfma_f32_16x16x32_bf16 v[92:95], v[204:207], a[60:63], v[92:95]
s_waitcnt lgkmcnt(6)
buffer_load_dwordx4 v234, s[16:19], s53 offen lds
v_add_f32 v100, 1.0, v100
v_mfma_f32_16x16x32_bf16 v[64:67], v[208:211], a[64:67], v[64:67]
s_add_u32 m0, s49, 8192
ds_read_b64_tr_b16 v[204:205], v232 offset:20480
ds_read_b64_tr_b16 v[206:207], v232 offset:20736
v_mfma_f32_16x16x32_bf16 v[68:71], v[208:211], a[68:71], v[68:71]
s_mov_b32 s53, 2065024
v_cvt_pk_bf16_f32 v166, v180, v181
v_cvt_pk_bf16_f32 v212, v112, v113
v_mfma_f32_16x16x32_bf16 v[72:75], v[208:211], a[72:75], v[72:75]
v_add_f32 v101, 1.0, v101
v_add_f32 v102, 1.0, v102
v_mfma_f32_16x16x32_bf16 v[76:79], v[208:211], a[76:79], v[76:79]
s_waitcnt lgkmcnt(6)
v_cvt_pk_bf16_f32 v213, v114, v115
v_add_f32 v103, 1.0, v103
v_mfma_f32_16x16x32_bf16 v[80:83], v[192:195], a[64:67], v[80:83]
ds_read_b64_tr_b16 v[208:209], v232 offset:21504
ds_read_b64_tr_b16 v[210:211], v232 offset:21760
v_mfma_f32_16x16x32_bf16 v[84:87], v[192:195], a[68:71], v[84:87]
buffer_load_dwordx4 v234, s[12:15], s53 offen lds
v_cvt_pk_bf16_f32 v167, v182, v183
v_mfma_f32_16x16x32_bf16 v[88:91], v[192:195], a[72:75], v[88:91]
s_add_u32 m0, s49, 12288
v_mul_f32 v104, s96, v104
v_mul_f32 v105, s96, v105
v_mfma_f32_16x16x32_bf16 v[92:95], v[192:195], a[76:79], v[92:95]
s_waitcnt lgkmcnt(6)
v_rcp_f32 v100, v100
v_mfma_f32_16x16x32_bf16 v[64:67], v[196:199], a[80:83], v[64:67]
ds_read_b64_tr_b16 v[192:193], v232 offset:22528
ds_read_b64_tr_b16 v[194:195], v232 offset:22784
v_mfma_f32_16x16x32_bf16 v[68:71], v[196:199], a[84:87], v[68:71]
v_mul_f32 v106, s96, v106
v_mul_f32 v107, s96, v107
v_mfma_f32_16x16x32_bf16 v[72:75], v[196:199], a[88:91], v[72:75]
buffer_store_dwordx4 v[164:167], v239, s[32:35], s64 offen sc1
s_xor_b32 s64, s69, 2
v_mfma_f32_16x16x32_bf16 v[76:79], v[196:199], a[92:95], v[76:79]
s_waitcnt lgkmcnt(6)
v_rcp_f32 v101, v101
v_mfma_f32_16x16x32_bf16 v[80:83], v[200:203], a[80:83], v[80:83]
s_add_u32 s64, s76, s64
ds_read_b64_tr_b16 v[196:197], v232 offset:23552
ds_read_b64_tr_b16 v[198:199], v232 offset:23808
v_mfma_f32_16x16x32_bf16 v[84:87], v[200:203], a[84:87], v[84:87]
s_and_b32 s64, s64, 3
v_exp_f32 v104, v104
v_mfma_f32_16x16x32_bf16 v[88:91], v[200:203], a[88:91], v[88:91]
s_mul_i32 s64, s64, 55296
v_rcp_f32 v102, v102
v_mfma_f32_16x16x32_bf16 v[92:95], v[200:203], a[92:95], v[92:95]
s_waitcnt lgkmcnt(6)
v_exp_f32 v105, v105
v_mfma_f32_16x16x32_bf16 v[64:67], v[204:207], a[96:99], v[64:67]
s_add_u32 s64, s64, s58
ds_read_b64_tr_b16 v[200:201], v232 offset:24576
ds_read_b64_tr_b16 v[202:203], v232 offset:24832
v_mfma_f32_16x16x32_bf16 v[68:71], v[204:207], a[100:103], v[68:71]
v_rcp_f32 v103, v103
v_mfma_f32_16x16x32_bf16 v[72:75], v[204:207], a[104:107], v[72:75]
v_exp_f32 v106, v106
v_mfma_f32_16x16x32_bf16 v[76:79], v[204:207], a[108:111], v[76:79]
s_waitcnt lgkmcnt(6)
v_mul_f32 v116, v100, v116
v_mul_f32 v117, v101, v117
v_mfma_f32_16x16x32_bf16 v[80:83], v[208:211], a[96:99], v[80:83]
s_waitcnt vmcnt(6)
ds_read_b64_tr_b16 v[204:205], v232 offset:25600
ds_read_b64_tr_b16 v[206:207], v232 offset:25856
v_mfma_f32_16x16x32_bf16 v[84:87], v[208:211], a[100:103], v[84:87]
v_exp_f32 v107, v107
v_mfma_f32_16x16x32_bf16 v[88:91], v[208:211], a[104:107], v[88:91]
v_mul_f32 v118, v102, v118
v_mul_f32 v119, v103, v119
v_mfma_f32_16x16x32_bf16 v[92:95], v[208:211], a[108:111], v[92:95]
s_waitcnt lgkmcnt(6)
v_cvt_pk_bf16_f32 v168, v168, v169
v_add_f32 v104, 1.0, v104
v_mfma_f32_16x16x32_bf16 v[64:67], v[192:195], a[112:115], v[64:67]
ds_read_b64_tr_b16 v[208:209], v232 offset:26624
ds_read_b64_tr_b16 v[210:211], v232 offset:26880
v_mfma_f32_16x16x32_bf16 v[68:71], v[192:195], a[116:119], v[68:71]
v_cvt_pk_bf16_f32 v216, v116, v117
v_add_f32 v105, 1.0, v105
v_mfma_f32_16x16x32_bf16 v[72:75], v[192:195], a[120:123], v[72:75]
v_add_f32 v106, 1.0, v106
v_cvt_pk_bf16_f32 v217, v118, v119
v_mfma_f32_16x16x32_bf16 v[76:79], v[192:195], a[124:127], v[76:79]
s_waitcnt lgkmcnt(6)
v_cvt_pk_bf16_f32 v169, v170, v171
v_add_f32 v107, 1.0, v107
v_mfma_f32_16x16x32_bf16 v[80:83], v[196:199], a[112:115], v[80:83]
ds_read_b64_tr_b16 v[192:193], v232 offset:27648
ds_read_b64_tr_b16 v[194:195], v232 offset:27904
v_mfma_f32_16x16x32_bf16 v[84:87], v[196:199], a[116:119], v[84:87]
buffer_store_dword v242, off, s[28:31], s11 sc1
v_mul_f32 v108, s96, v108
v_mfma_f32_16x16x32_bf16 v[88:91], v[196:199], a[120:123], v[88:91]
buffer_load_dwordx4 v234, s[16:19], s53 offen lds
v_mul_f32 v109, s96, v109
v_mfma_f32_16x16x32_bf16 v[92:95], v[196:199], a[124:127], v[92:95]
s_waitcnt lgkmcnt(6)
v_rcp_f32 v104, v104
v_mfma_f32_16x16x32_bf16 v[64:67], v[200:203], a[128:131], v[64:67]
s_add_u32 m0, s49, 16384
ds_read_b64_tr_b16 v[196:197], v232 offset:28672
ds_read_b64_tr_b16 v[198:199], v232 offset:28928
v_mfma_f32_16x16x32_bf16 v[68:71], v[200:203], a[132:135], v[68:71]
s_mov_b32 s53, 2359936
v_mul_f32 v110, s96, v110
v_cvt_pk_bf16_f32 v170, v184, v185
v_mfma_f32_16x16x32_bf16 v[72:75], v[200:203], a[136:139], v[72:75]
v_rcp_f32 v105, v105
v_mfma_f32_16x16x32_bf16 v[76:79], v[200:203], a[140:143], v[76:79]
s_waitcnt lgkmcnt(6)
v_mul_f32 v111, s96, v111
v_cvt_pk_bf16_f32 v171, v186, v187
v_mfma_f32_16x16x32_bf16 v[80:83], v[204:207], a[128:131], v[80:83]
ds_read_b64_tr_b16 v[200:201], v232 offset:29696
ds_read_b64_tr_b16 v[202:203], v232 offset:29952
v_mfma_f32_16x16x32_bf16 v[84:87], v[204:207], a[132:135], v[84:87]
buffer_load_dwordx4 v234, s[12:15], s53 offen lds
s_add_u32 m0, s49, 20480
v_mfma_f32_16x16x32_bf16 v[88:91], v[204:207], a[136:139], v[88:91]
v_exp_f32 v108, v108
v_mfma_f32_16x16x32_bf16 v[92:95], v[204:207], a[140:143], v[92:95]
s_waitcnt lgkmcnt(6)
v_rcp_f32 v106, v106
v_mfma_f32_16x16x32_bf16 v[64:67], v[208:211], a[144:147], v[64:67]
ds_read_b64_tr_b16 v[204:205], v232 offset:30720
ds_read_b64_tr_b16 v[206:207], v232 offset:30976
v_mfma_f32_16x16x32_bf16 v[68:71], v[208:211], a[148:151], v[68:71]
buffer_store_dwordx4 v[168:171], v239, s[32:35], s64 offen sc1
s_xor_b32 s64, s69, 3
v_mfma_f32_16x16x32_bf16 v[72:75], v[208:211], a[152:155], v[72:75]
s_add_u32 s64, s76, s64
v_exp_f32 v109, v109
v_mfma_f32_16x16x32_bf16 v[76:79], v[208:211], a[156:159], v[76:79]
s_waitcnt lgkmcnt(6)
v_rcp_f32 v107, v107
v_mfma_f32_16x16x32_bf16 v[80:83], v[192:195], a[144:147], v[80:83]
s_and_b32 s64, s64, 3
ds_read_b64_tr_b16 v[208:209], v232 offset:31744
ds_read_b64_tr_b16 v[210:211], v232 offset:32000
v_mfma_f32_16x16x32_bf16 v[84:87], v[192:195], a[148:151], v[84:87]
s_mul_i32 s64, s64, 55296
v_exp_f32 v110, v110
v_mfma_f32_16x16x32_bf16 v[88:91], v[192:195], a[152:155], v[88:91]
s_add_u32 s64, s64, s58
v_mul_f32 v120, v104, v120
v_mul_f32 v121, v105, v121
v_mfma_f32_16x16x32_bf16 v[92:95], v[192:195], a[156:159], v[92:95]
s_waitcnt lgkmcnt(6)
v_exp_f32 v111, v111
v_mfma_f32_16x16x32_bf16 v[64:67], v[196:199], a[160:163], v[64:67]
ds_read_b64_tr_b16 v[192:193], v232 offset:32768
ds_read_b64_tr_b16 v[194:195], v232 offset:33024
v_mfma_f32_16x16x32_bf16 v[68:71], v[196:199], a[164:167], v[68:71]
v_mul_f32 v122, v106, v122
v_mul_f32 v123, v107, v123
v_mfma_f32_16x16x32_bf16 v[72:75], v[196:199], a[168:171], v[72:75]
v_add_f32 v108, 1.0, v108
v_cvt_pk_bf16_f32 v220, v120, v121
v_mfma_f32_16x16x32_bf16 v[76:79], v[196:199], a[172:175], v[76:79]
s_waitcnt lgkmcnt(6)
v_add_f32 v109, 1.0, v109
v_add_f32 v110, 1.0, v110
v_mfma_f32_16x16x32_bf16 v[80:83], v[200:203], a[160:163], v[80:83]
ds_read_b64_tr_b16 v[196:197], v232 offset:33792
ds_read_b64_tr_b16 v[198:199], v232 offset:34048
v_mfma_f32_16x16x32_bf16 v[84:87], v[200:203], a[164:167], v[84:87]
buffer_load_dwordx4 v234, s[16:19], s53 offen lds
v_cvt_pk_bf16_f32 v221, v122, v123
v_mfma_f32_16x16x32_bf16 v[88:91], v[200:203], a[168:171], v[88:91]
s_add_u32 m0, s49, 24576
v_add_f32 v111, 1.0, v111
v_cvt_pk_bf16_f32 v172, v172, v173
v_mfma_f32_16x16x32_bf16 v[92:95], v[200:203], a[172:175], v[92:95]
s_waitcnt lgkmcnt(6)
v_rcp_f32 v108, v108
v_mfma_f32_16x16x32_bf16 v[64:67], v[204:207], a[176:179], v[64:67]
s_mov_b32 s53, 2654848
ds_read_b64_tr_b16 v[200:201], v232 offset:34816
ds_read_b64_tr_b16 v[202:203], v232 offset:35072
v_mfma_f32_16x16x32_bf16 v[68:71], v[204:207], a[180:183], v[68:71]
buffer_load_dwordx4 v234, s[12:15], s53 offen lds
v_cvt_pk_bf16_f32 v173, v174, v175
v_mfma_f32_16x16x32_bf16 v[72:75], v[204:207], a[184:187], v[72:75]
s_add_u32 m0, s49, 28672
v_rcp_f32 v109, v109
v_mfma_f32_16x16x32_bf16 v[76:79], v[204:207], a[188:191], v[76:79]
s_waitcnt lgkmcnt(6)
buffer_load_dwordx4 v234, s[16:19], s53 offen lds
v_cvt_pk_bf16_f32 v174, v188, v189
v_mfma_f32_16x16x32_bf16 v[80:83], v[208:211], a[176:179], v[80:83]
s_add_u32 m0, s49, 32768
ds_read_b64_tr_b16 v[204:205], v232 offset:35840
ds_read_b64_tr_b16 v[206:207], v232 offset:36096
v_mfma_f32_16x16x32_bf16 v[84:87], v[208:211], a[180:183], v[84:87]
s_mov_b32 s53, 2949760
buffer_load_dwordx4 v234, s[12:15], s53 offen lds
v_cvt_pk_bf16_f32 v175, v190, v191
v_mfma_f32_16x16x32_bf16 v[88:91], v[208:211], a[184:187], v[88:91]
s_add_u32 m0, s49, 36864
v_rcp_f32 v110, v110
v_mfma_f32_16x16x32_bf16 v[92:95], v[208:211], a[188:191], v[92:95]
s_waitcnt lgkmcnt(6)
buffer_load_dwordx4 v234, s[16:19], s53 offen lds
s_add_u32 m0, s49, 40960
v_mfma_f32_16x16x32_bf16 v[64:67], v[192:195], a[192:195], v[64:67]
s_mov_b32 s53, 3244672
ds_read_b64_tr_b16 v[208:209], v232 offset:36864
ds_read_b64_tr_b16 v[210:211], v232 offset:37120
v_mfma_f32_16x16x32_bf16 v[68:71], v[192:195], a[196:199], v[68:71]
buffer_load_dwordx4 v234, s[12:15], s53 offen lds
buffer_load_dword v246, v247, s[28:31], s67 offen offset:1024 sc1
v_mfma_f32_16x16x32_bf16 v[72:75], v[192:195], a[200:203], v[72:75]
s_add_u32 m0, s49, 45056
v_rcp_f32 v111, v111
v_mfma_f32_16x16x32_bf16 v[76:79], v[192:195], a[204:207], v[76:79]
s_waitcnt lgkmcnt(6)
v_mul_f32 v124, v108, v124
v_mul_f32 v125, v109, v125
v_mfma_f32_16x16x32_bf16 v[80:83], v[196:199], a[192:195], v[80:83]
ds_read_b64_tr_b16 v[192:193], v232 offset:37888
ds_read_b64_tr_b16 v[194:195], v232 offset:38144
v_mfma_f32_16x16x32_bf16 v[84:87], v[196:199], a[196:199], v[84:87]
v_mul_f32 v126, v110, v126
v_mul_f32 v127, v111, v127
v_mfma_f32_16x16x32_bf16 v[88:91], v[196:199], a[200:203], v[88:91]
v_cvt_pk_bf16_f32 v224, v124, v125
v_cvt_pk_bf16_f32 v225, v126, v127
v_mfma_f32_16x16x32_bf16 v[92:95], v[196:199], a[204:207], v[92:95]
s_waitcnt lgkmcnt(6)
v_mul_f32 v128, s96, v128
v_mul_f32 v129, s96, v129
v_mfma_f32_16x16x32_bf16 v[64:67], v[200:203], a[208:211], v[64:67]
ds_read_b64_tr_b16 v[196:197], v232 offset:38912
ds_read_b64_tr_b16 v[198:199], v232 offset:39168
v_mfma_f32_16x16x32_bf16 v[68:71], v[200:203], a[212:215], v[68:71]
v_mul_f32 v130, s96, v130
v_mul_f32 v131, s96, v131
v_mfma_f32_16x16x32_bf16 v[72:75], v[200:203], a[216:219], v[72:75]
v_exp_f32 v128, v128
v_mfma_f32_16x16x32_bf16 v[76:79], v[200:203], a[220:223], v[76:79]
s_waitcnt lgkmcnt(6)
v_exp_f32 v129, v129
v_mfma_f32_16x16x32_bf16 v[80:83], v[204:207], a[208:211], v[80:83]
ds_read_b64_tr_b16 v[200:201], v232 offset:39936
ds_read_b64_tr_b16 v[202:203], v232 offset:40192
v_mfma_f32_16x16x32_bf16 v[84:87], v[204:207], a[212:215], v[84:87]
TCH_4_v1:
s_cbranch_execz TCH_8_v1
v_exp_f32 v130, v130
v_mfma_f32_16x16x32_bf16 v[88:91], v[204:207], a[216:219], v[88:91]
v_exp_f32 v131, v131
v_mfma_f32_16x16x32_bf16 v[92:95], v[204:207], a[220:223], v[92:95]
s_waitcnt lgkmcnt(6)
v_add_f32 v128, 1.0, v128
v_mfma_f32_16x16x32_bf16 v[64:67], v[208:211], a[224:227], v[64:67]
ds_read_b64_tr_b16 v[204:205], v232 offset:40960
ds_read_b64_tr_b16 v[206:207], v232 offset:41216
v_mfma_f32_16x16x32_bf16 v[68:71], v[208:211], a[228:231], v[68:71]
v_add_f32 v129, 1.0, v129
v_add_f32 v130, 1.0, v130
v_mfma_f32_16x16x32_bf16 v[72:75], v[208:211], a[232:235], v[72:75]
v_add_f32 v131, 1.0, v131
v_mul_f32 v132, s96, v132
v_mfma_f32_16x16x32_bf16 v[76:79], v[208:211], a[236:239], v[76:79]
s_waitcnt lgkmcnt(6)
v_mul_f32 v133, s96, v133
v_mul_f32 v134, s96, v134
v_mfma_f32_16x16x32_bf16 v[80:83], v[192:195], a[224:227], v[80:83]
ds_read_b64_tr_b16 v[208:209], v232 offset:41984
ds_read_b64_tr_b16 v[210:211], v232 offset:42240
v_mfma_f32_16x16x32_bf16 v[84:87], v[192:195], a[228:231], v[84:87]
v_rcp_f32 v128, v128
v_mfma_f32_16x16x32_bf16 v[88:91], v[192:195], a[232:235], v[88:91]
v_rcp_f32 v129, v129
v_mfma_f32_16x16x32_bf16 v[92:95], v[192:195], a[236:239], v[92:95]
s_waitcnt lgkmcnt(6)
v_mul_f32 v135, s96, v135
v_mfma_f32_16x16x32_bf16 v[64:67], v[196:199], a[240:243], v[64:67]
ds_read_b64_tr_b16 v[192:193], v232 offset:43008
ds_read_b64_tr_b16 v[194:195], v232 offset:43264
v_mfma_f32_16x16x32_bf16 v[68:71], v[196:199], a[244:247], v[68:71]
v_exp_f32 v132, v132
v_mfma_f32_16x16x32_bf16 v[72:75], v[196:199], a[248:251], v[72:75]
v_exp_f32 v133, v133
v_mfma_f32_16x16x32_bf16 v[76:79], v[196:199], a[252:255], v[76:79]
s_waitcnt lgkmcnt(6)
v_rcp_f32 v130, v130
v_mfma_f32_16x16x32_bf16 v[80:83], v[200:203], a[240:243], v[80:83]
ds_read_b64_tr_b16 v[196:197], v232 offset:44032
ds_read_b64_tr_b16 v[198:199], v232 offset:44288
v_mfma_f32_16x16x32_bf16 v[84:87], v[200:203], a[244:247], v[84:87]
v_add_u32 v228, 4294934528, v228
v_mfma_f32_16x16x32_bf16 v[88:91], v[200:203], a[248:251], v[88:91]
s_waitcnt vmcnt(6)
s_barrier
v_mfma_f32_16x16x32_bf16 v[92:95], v[200:203], a[252:255], v[92:95]
s_waitcnt lgkmcnt(6)
buffer_store_dwordx4 v[172:175], v239, s[32:35], s64 offen sc1
v_mfma_f32_16x16x32_bf16 v[64:67], v[204:207], v[0:3], v[64:67]
ds_read_b64_tr_b16 v[200:201], v228 offset:12288
ds_read_b64_tr_b16 v[202:203], v228 offset:12800
v_mfma_f32_16x16x32_bf16 v[68:71], v[204:207], v[4:7], v[68:71]
v_rcp_f32 v131, v131
v_mfma_f32_16x16x32_bf16 v[72:75], v[204:207], v[8:11], v[72:75]
v_exp_f32 v134, v134
v_mfma_f32_16x16x32_bf16 v[76:79], v[204:207], v[12:15], v[76:79]
s_waitcnt lgkmcnt(6)
v_mul_f32 v144, v128, v144
v_mul_f32 v145, v129, v145
v_mfma_f32_16x16x32_bf16 v[80:83], v[208:211], v[0:3], v[80:83]
ds_read_b64_tr_b16 v[204:205], v228 offset:16384
ds_read_b64_tr_b16 v[206:207], v228 offset:16896
v_mfma_f32_16x16x32_bf16 v[84:87], v[208:211], v[4:7], v[84:87]
v_exp_f32 v135, v135
v_mfma_f32_16x16x32_bf16 v[88:91], v[208:211], v[8:11], v[88:91]
v_add_f32 v132, 1.0, v132
v_xor_b32 v239, 64, v239
v_mfma_f32_16x16x32_bf16 v[92:95], v[208:211], v[12:15], v[92:95]
s_waitcnt lgkmcnt(6)
v_mul_f32 v146, v130, v146
v_mul_f32 v147, v131, v147
v_mfma_f32_16x16x32_bf16 v[64:67], v[192:195], v[16:19], v[64:67]
s_lshl_b32 s51, s69, 10
ds_read_b64_tr_b16 v[208:209], v228 offset:20480
ds_read_b64_tr_b16 v[210:211], v228 offset:20992
v_mfma_f32_16x16x32_bf16 v[68:71], v[192:195], v[20:23], v[68:71]
s_add_u32 s51, s55, s51
v_add_f32 v133, 1.0, v133
v_add_f32 v134, 1.0, v134
v_mfma_f32_16x16x32_bf16 v[72:75], v[192:195], v[24:27], v[72:75]
s_add_u32 s51, s51, 4096
v_add_f32 v135, 1.0, v135
v_cvt_pk_bf16_f32 v214, v144, v145
v_mfma_f32_16x16x32_bf16 v[76:79], v[192:195], v[28:31], v[76:79]
s_waitcnt lgkmcnt(6)
v_rcp_f32 v132, v132
v_mfma_f32_16x16x32_bf16 v[80:83], v[196:199], v[16:19], v[80:83]
s_xor_b32 s64, s69, 0
ds_read_b64_tr_b16 v[192:193], v228 offset:24576
ds_read_b64_tr_b16 v[194:195], v228 offset:25088
v_mfma_f32_16x16x32_bf16 v[84:87], v[196:199], v[20:23], v[84:87]
s_add_u32 s64, s76, s64
v_rcp_f32 v133, v133
v_mfma_f32_16x16x32_bf16 v[88:91], v[196:199], v[24:27], v[88:91]
s_and_b32 s64, s64, 3
v_rcp_f32 v134, v134
v_mfma_f32_16x16x32_bf16 v[92:95], v[196:199], v[28:31], v[92:95]
s_waitcnt lgkmcnt(6)
v_rcp_f32 v135, v135
v_mfma_f32_16x16x32_bf16 v[160:163], v[200:203], a[0:3], 0
s_mul_i32 s64, s64, 55296
ds_read_b64_tr_b16 v[196:197], v228 offset:28672
ds_read_b64_tr_b16 v[198:199], v228 offset:29184
v_mfma_f32_16x16x32_bf16 v[164:167], v[200:203], a[4:7], 0
s_add_u32 s64, s64, s58
buffer_load_dwordx4 v234, s[16:19], s53 offen lds
v_cvt_pk_bf16_f32 v215, v146, v147
v_mfma_f32_16x16x32_bf16 v[168:171], v[200:203], a[8:11], 0
s_add_u32 m0, s49, 49152
v_cvt_pk_bf16_f32 v32, v32, v33
v_mul_f32 v148, v132, v148
v_mfma_f32_16x16x32_bf16 v[172:175], v[200:203], a[12:15], 0
s_waitcnt lgkmcnt(6)
v_mul_f32 v149, v133, v149
v_cvt_pk_bf16_f32 v33, v34, v35
v_mfma_f32_16x16x32_bf16 v[176:179], v[204:207], a[0:3], 0
s_mov_b32 s53, 3539584
ds_read_b64_tr_b16 v[200:201], v228 offset:32768
ds_read_b64_tr_b16 v[202:203], v228 offset:33280
v_mfma_f32_16x16x32_bf16 v[180:183], v[204:207], a[4:7], 0
buffer_load_dwordx4 v234, s[12:15], s53 offen lds
v_mul_f32 v150, v134, v150
v_mfma_f32_16x16x32_bf16 v[184:187], v[204:207], a[8:11], 0
s_add_u32 m0, s49, 53248
v_mul_f32 v151, v135, v151
v_mfma_f32_16x16x32_bf16 v[188:191], v[204:207], a[12:15], 0
s_waitcnt lgkmcnt(6)
buffer_load_dwordx4 v234, s[16:19], s53 offen lds
s_add_u32 m0, s49, 57344
v_mfma_f32_16x16x32_bf16 v[160:163], v[208:211], a[16:19], v[160:163]
s_mov_b32 s53, 3834496
ds_read_b64_tr_b16 v[204:205], v228 offset:36864
ds_read_b64_tr_b16 v[206:207], v228 offset:37376
v_mfma_f32_16x16x32_bf16 v[164:167], v[208:211], a[20:23], v[164:167]
s_lshl_b32 s66, s69, 10
buffer_load_dwordx4 v234, s[12:15], s53 offen lds
v_cvt_pk_bf16_f32 v34, v48, v49
v_mfma_f32_16x16x32_bf16 v[168:171], v[208:211], a[24:27], v[168:171]
s_add_u32 m0, s49, 61440
s_add_u32 s66, s55, s66
buffer_load_dwordx4 v234, s[16:19], s53 offen lds
v_mfma_f32_16x16x32_bf16 v[172:175], v[208:211], a[28:31], v[172:175]
s_waitcnt lgkmcnt(6)
s_add_u32 s66, s66, 4096
v_cvt_pk_bf16_f32 v218, v148, v149
v_mfma_f32_16x16x32_bf16 v[176:179], v[192:195], a[16:19], v[176:179]
s_add_u32 m0, s49, 65536
ds_read_b64_tr_b16 v[208:209], v228 offset:40960
ds_read_b64_tr_b16 v[210:211], v228 offset:41472
v_mfma_f32_16x16x32_bf16 v[180:183], v[192:195], a[20:23], v[180:183]
s_mov_b32 s53, 4129408
v_add_u32 v229, 4294934528, v229
v_cvt_pk_bf16_f32 v219, v150, v151
v_mfma_f32_16x16x32_bf16 v[184:187], v[192:195], a[24:27], v[184:187]
buffer_load_dwordx4 v234, s[12:15], s53 offen lds
v_cvt_pk_bf16_f32 v35, v50, v51
v_mfma_f32_16x16x32_bf16 v[188:191], v[192:195], a[28:31], v[188:191]
s_waitcnt lgkmcnt(6)
s_waitcnt vmcnt(7)
v_cmp_gt_u32 vcc, 1, v246
v_mfma_f32_16x16x32_bf16 v[160:163], v[196:199], a[32:35], v[160:163]
ds_read_b64_tr_b16 v[192:193], v229 offset:12288
ds_read_b64_tr_b16 v[194:195], v229 offset:12800
v_mfma_f32_16x16x32_bf16 v[164:167], v[196:199], a[36:39], v[164:167]
s_cbranch_vccnz spin_6_v1
ok_5_v1:
v_mfma_f32_16x16x32_bf16 v[168:171], v[196:199], a[40:43], v[168:171]
s_add_u32 m0, s49, 69632
v_mfma_f32_16x16x32_bf16 v[172:175], v[196:199], a[44:47], v[172:175]
s_waitcnt lgkmcnt(6)
v_mfma_f32_16x16x32_bf16 v[176:179], v[200:203], a[32:35], v[176:179]
ds_read_b64_tr_b16 v[196:197], v229 offset:16384
ds_read_b64_tr_b16 v[198:199], v229 offset:16896
v_mfma_f32_16x16x32_bf16 v[180:183], v[200:203], a[36:39], v[180:183]
v_mfma_f32_16x16x32_bf16 v[184:187], v[200:203], a[40:43], v[184:187]
s_waitcnt vmcnt(7)
s_barrier
v_mfma_f32_16x16x32_bf16 v[188:191], v[200:203], a[44:47], v[188:191]
s_waitcnt lgkmcnt(6)
v_mfma_f32_16x16x32_bf16 v[160:163], v[204:207], a[48:51], v[160:163]
ds_read_b64_tr_b16 v[200:201], v229 offset:20480
ds_read_b64_tr_b16 v[202:203], v229 offset:20992
v_mfma_f32_16x16x32_bf16 v[164:167], v[204:207], a[52:55], v[164:167]
v_mfma_f32_16x16x32_bf16 v[168:171], v[204:207], a[56:59], v[168:171]
v_mfma_f32_16x16x32_bf16 v[172:175], v[204:207], a[60:63], v[172:175]
s_waitcnt lgkmcnt(6)
v_mfma_f32_16x16x32_bf16 v[176:179], v[208:211], a[48:51], v[176:179]
ds_read_b64_tr_b16 v[204:205], v229 offset:24576
ds_read_b64_tr_b16 v[206:207], v229 offset:25088
v_mfma_f32_16x16x32_bf16 v[180:183], v[208:211], a[52:55], v[180:183]
v_mfma_f32_16x16x32_bf16 v[184:187], v[208:211], a[56:59], v[184:187]
v_mfma_f32_16x16x32_bf16 v[188:191], v[208:211], a[60:63], v[188:191]
s_waitcnt lgkmcnt(6)
v_mfma_f32_16x16x32_bf16 v[96:99], v[192:195], a[0:3], 0
ds_read_b64_tr_b16 v[208:209], v229 offset:28672
ds_read_b64_tr_b16 v[210:211], v229 offset:29184
v_mfma_f32_16x16x32_bf16 v[100:103], v[192:195], a[4:7], 0
v_mfma_f32_16x16x32_bf16 v[104:107], v[192:195], a[8:11], 0
buffer_store_dwordx4 v[212:215], v237, s[28:31], s51 offen offset:0 sc1
v_mul_f32 v136, s96, v136
v_mfma_f32_16x16x32_bf16 v[108:111], v[192:195], a[12:15], 0
s_waitcnt lgkmcnt(6)
v_mul_f32 v137, s96, v137
v_mul_f32 v138, s96, v138
v_mfma_f32_16x16x32_bf16 v[112:115], v[196:199], a[0:3], 0
ds_read_b64_tr_b16 v[192:193], v229 offset:32768
ds_read_b64_tr_b16 v[194:195], v229 offset:33280
v_mfma_f32_16x16x32_bf16 v[116:119], v[196:199], a[4:7], 0
v_mul_f32 v139, s96, v139
v_mfma_f32_16x16x32_bf16 v[120:123], v[196:199], a[8:11], 0
v_exp_f32 v136, v136
v_mfma_f32_16x16x32_bf16 v[124:127], v[196:199], a[12:15], 0
s_waitcnt lgkmcnt(6)
v_exp_f32 v137, v137
v_mfma_f32_16x16x32_bf16 v[96:99], v[200:203], a[16:19], v[96:99]
ds_read_b64_tr_b16 v[196:197], v229 offset:36864
ds_read_b64_tr_b16 v[198:199], v229 offset:37376
v_mfma_f32_16x16x32_bf16 v[100:103], v[200:203], a[20:23], v[100:103]
v_exp_f32 v138, v138
v_mfma_f32_16x16x32_bf16 v[104:107], v[200:203], a[24:27], v[104:107]
v_exp_f32 v139, v139
v_mfma_f32_16x16x32_bf16 v[108:111], v[200:203], a[28:31], v[108:111]
s_waitcnt lgkmcnt(6)
v_add_f32 v136, 1.0, v136
v_add_f32 v137, 1.0, v137
v_mfma_f32_16x16x32_bf16 v[112:115], v[204:207], a[16:19], v[112:115]
ds_read_b64_tr_b16 v[200:201], v229 offset:40960
ds_read_b64_tr_b16 v[202:203], v229 offset:41472
v_mfma_f32_16x16x32_bf16 v[116:119], v[204:207], a[20:23], v[116:119]
v_add_u32 v230, 4294934528, v230
v_add_f32 v138, 1.0, v138
v_mfma_f32_16x16x32_bf16 v[120:123], v[204:207], a[24:27], v[120:123]
buffer_store_dwordx4 v[216:219], v237, s[28:31], s66 offen offset:1024 sc1
buffer_load_dwordx4 v234, s[16:19], s53 offen lds
v_mfma_f32_16x16x32_bf16 v[124:127], v[204:207], a[28:31], v[124:127]
s_waitcnt lgkmcnt(6)
v_add_f32 v139, 1.0, v139
v_mul_f32 v140, s96, v140
v_mfma_f32_16x16x32_bf16 v[96:99], v[208:211], a[32:35], v[96:99]
s_add_u32 m0, s49, 73728
ds_read_b64_tr_b16 v[204:205], v230 offset:12288
ds_read_b64_tr_b16 v[206:207], v230 offset:12800
v_mfma_f32_16x16x32_bf16 v[100:103], v[208:211], a[36:39], v[100:103]
s_mov_b32 s53, 4424320
buffer_load_dwordx4 v234, s[12:15], s53 offen lds
v_mul_f32 v141, s96, v141
v_mfma_f32_16x16x32_bf16 v[104:107], v[208:211], a[40:43], v[104:107]
s_add_u32 m0, s49, 77824
v_mul_f32 v142, s96, v142
v_mul_f32 v143, s96, v143
v_mfma_f32_16x16x32_bf16 v[108:111], v[208:211], a[44:47], v[108:111]
s_waitcnt lgkmcnt(6)
buffer_load_dwordx4 v234, s[16:19], s53 offen lds
v_mfma_f32_16x16x32_bf16 v[112:115], v[192:195], a[32:35], v[112:115]
s_add_u32 m0, s49, 81920
ds_read_b64_tr_b16 v[208:209], v230 offset:16384
ds_read_b64_tr_b16 v[210:211], v230 offset:16896
v_mfma_f32_16x16x32_bf16 v[116:119], v[192:195], a[36:39], v[116:119]
s_mov_b32 s53, 4719232
buffer_load_dwordx4 v234, s[12:15], s53 offen lds
buffer_load_dword v246, v241, s[28:31], 0 offen sc1
v_mfma_f32_16x16x32_bf16 v[120:123], v[192:195], a[40:43], v[120:123]
s_add_u32 s11, s97, 147456
v_rcp_f32 v136, v136
v_mfma_f32_16x16x32_bf16 v[124:127], v[192:195], a[44:47], v[124:127]
s_waitcnt lgkmcnt(6)
v_rcp_f32 v137, v137
v_mfma_f32_16x16x32_bf16 v[96:99], v[196:199], a[48:51], v[96:99]
s_add_u32 m0, s49, 86016
ds_read_b64_tr_b16 v[192:193], v230 offset:20480
ds_read_b64_tr_b16 v[194:195], v230 offset:20992
v_mfma_f32_16x16x32_bf16 v[100:103], v[196:199], a[52:55], v[100:103]
v_exp_f32 v140, v140
v_mfma_f32_16x16x32_bf16 v[104:107], v[196:199], a[56:59], v[104:107]
v_exp_f32 v141, v141
v_mfma_f32_16x16x32_bf16 v[108:111], v[196:199], a[60:63], v[108:111]
s_waitcnt lgkmcnt(6)
v_rcp_f32 v138, v138
v_mfma_f32_16x16x32_bf16 v[112:115], v[200:203], a[48:51], v[112:115]
ds_read_b64_tr_b16 v[196:197], v230 offset:24576
ds_read_b64_tr_b16 v[198:199], v230 offset:25088
v_mfma_f32_16x16x32_bf16 v[116:119], v[200:203], a[52:55], v[116:119]
v_rcp_f32 v139, v139
v_mfma_f32_16x16x32_bf16 v[120:123], v[200:203], a[56:59], v[120:123]
v_exp_f32 v142, v142
v_mfma_f32_16x16x32_bf16 v[124:127], v[200:203], a[60:63], v[124:127]
s_waitcnt lgkmcnt(6)
v_mul_f32 v152, v136, v152
v_mul_f32 v153, v137, v153
v_mul_f32 v154, v138, v154
v_mul_f32 v155, v139, v155
s_lshl_b32 s51, s69, 10
s_sub_u32 s51, s55, s51
s_add_u32 s51, s51, 4096
v_cvt_pk_bf16_f32 v222, v152, v153
v_cvt_pk_bf16_f32 v223, v154, v155
buffer_store_dwordx4 v[220:223], v237, s[28:31], s51 offen offset:2048 sc1
v_exp_f32 v143, v143
v_add_f32 v140, 1.0, v140
v_add_f32 v141, 1.0, v141
v_add_f32 v142, 1.0, v142
v_add_f32 v143, 1.0, v143
v_rcp_f32 v140, v140
v_rcp_f32 v141, v141
v_rcp_f32 v142, v142
v_rcp_f32 v143, v143
v_mul_f32 v156, v140, v156
v_mul_f32 v157, v141, v157
v_mul_f32 v158, v142, v158
v_mul_f32 v159, v143, v159
s_lshl_b32 s66, s69, 10
s_sub_u32 s66, s55, s66
s_add_u32 s66, s66, 4096
v_cvt_pk_bf16_f32 v226, v156, v157
v_cvt_pk_bf16_f32 v227, v158, v159
buffer_store_dwordx4 v[224:227], v237, s[28:31], s66 offen offset:3072 sc1
v_mfma_f32_16x16x32_bf16 v[128:131], v[204:207], a[0:3], 0
ds_read_b64_tr_b16 v[200:201], v230 offset:28672
ds_read_b64_tr_b16 v[202:203], v230 offset:29184
v_mfma_f32_16x16x32_bf16 v[132:135], v[204:207], a[4:7], 0
v_mul_f32 v64, s96, v64
v_mul_f32 v65, s96, v65
v_mfma_f32_16x16x32_bf16 v[136:139], v[204:207], a[8:11], 0
v_mul_f32 v66, s96, v66
v_mfma_f32_16x16x32_bf16 v[140:143], v[204:207], a[12:15], 0
s_waitcnt lgkmcnt(6)
v_mfma_f32_16x16x32_bf16 v[144:147], v[208:211], a[0:3], 0
ds_read_b64_tr_b16 v[204:205], v230 offset:32768
ds_read_b64_tr_b16 v[206:207], v230 offset:33280
v_mfma_f32_16x16x32_bf16 v[148:151], v[208:211], a[4:7], 0
v_mul_f32 v67, s96, v67
v_mfma_f32_16x16x32_bf16 v[152:155], v[208:211], a[8:11], 0
v_exp_f32 v64, v64
v_mfma_f32_16x16x32_bf16 v[156:159], v[208:211], a[12:15], 0
s_waitcnt lgkmcnt(6)
v_mfma_f32_16x16x32_bf16 v[128:131], v[192:195], a[16:19], v[128:131]
ds_read_b64_tr_b16 v[208:209], v230 offset:36864
ds_read_b64_tr_b16 v[210:211], v230 offset:37376
v_mfma_f32_16x16x32_bf16 v[132:135], v[192:195], a[20:23], v[132:135]
v_exp_f32 v65, v65
v_mfma_f32_16x16x32_bf16 v[136:139], v[192:195], a[24:27], v[136:139]
v_mfma_f32_16x16x32_bf16 v[140:143], v[192:195], a[28:31], v[140:143]
s_waitcnt lgkmcnt(6)
v_mfma_f32_16x16x32_bf16 v[144:147], v[196:199], a[16:19], v[144:147]
ds_read_b64_tr_b16 v[192:193], v230 offset:40960
ds_read_b64_tr_b16 v[194:195], v230 offset:41472
v_mfma_f32_16x16x32_bf16 v[148:151], v[196:199], a[20:23], v[148:151]
v_add_u32 v231, 4294934528, v231
v_mfma_f32_16x16x32_bf16 v[152:155], v[196:199], a[24:27], v[152:155]
buffer_store_dwordx4 v[32:35], v239, s[32:35], s64 offen sc1
s_xor_b32 s64, s69, 1
v_mfma_f32_16x16x32_bf16 v[156:159], v[196:199], a[28:31], v[156:159]
s_waitcnt lgkmcnt(6)
v_exp_f32 v66, v66
v_mfma_f32_16x16x32_bf16 v[128:131], v[200:203], a[32:35], v[128:131]
s_add_u32 s64, s76, s64
ds_read_b64_tr_b16 v[196:197], v231 offset:12288
ds_read_b64_tr_b16 v[198:199], v231 offset:12800
v_mfma_f32_16x16x32_bf16 v[132:135], v[200:203], a[36:39], v[132:135]
s_and_b32 s64, s64, 3
v_exp_f32 v67, v67
v_mfma_f32_16x16x32_bf16 v[136:139], v[200:203], a[40:43], v[136:139]
s_mul_i32 s64, s64, 55296
s_add_u32 s64, s64, s58
v_cvt_pk_bf16_f32 v36, v36, v37
v_mfma_f32_16x16x32_bf16 v[140:143], v[200:203], a[44:47], v[140:143]
s_waitcnt lgkmcnt(6)
v_cvt_pk_bf16_f32 v37, v38, v39
v_cvt_pk_bf16_f32 v38, v52, v53
v_mfma_f32_16x16x32_bf16 v[144:147], v[204:207], a[32:35], v[144:147]
ds_read_b64_tr_b16 v[200:201], v231 offset:16384
ds_read_b64_tr_b16 v[202:203], v231 offset:16896
v_mfma_f32_16x16x32_bf16 v[148:151], v[204:207], a[36:39], v[148:151]
buffer_load_dwordx4 v234, s[16:19], s53 offen lds
v_cvt_pk_bf16_f32 v39, v54, v55
v_mfma_f32_16x16x32_bf16 v[152:155], v[204:207], a[40:43], v[152:155]
s_add_u32 m0, s49, 90112
buffer_store_dwordx4 v[36:39], v239, s[32:35], s64 offen sc1
v_add_f32 v64, 1.0, v64
v_mfma_f32_16x16x32_bf16 v[156:159], v[204:207], a[44:47], v[156:159]
s_waitcnt lgkmcnt(6)
s_mov_b32 s53, 5014144
buffer_load_dwordx4 v234, s[12:15], s53 offen lds
v_mfma_f32_16x16x32_bf16 v[128:131], v[208:211], a[48:51], v[128:131]
s_add_u32 m0, s49, 94208
ds_read_b64_tr_b16 v[204:205], v231 offset:20480
ds_read_b64_tr_b16 v[206:207], v231 offset:20992
v_mfma_f32_16x16x32_bf16 v[132:135], v[208:211], a[52:55], v[132:135]
buffer_load_dwordx4 v234, s[16:19], s53 offen lds
v_add_f32 v65, 1.0, v65
v_mfma_f32_16x16x32_bf16 v[136:139], v[208:211], a[56:59], v[136:139]
v_add_f32 v66, 1.0, v66
v_mfma_f32_16x16x32_bf16 v[140:143], v[208:211], a[60:63], v[140:143]
s_waitcnt lgkmcnt(6)
v_mfma_f32_16x16x32_bf16 v[144:147], v[192:195], a[48:51], v[144:147]
ds_read_b64_tr_b16 v[208:209], v231 offset:24576
ds_read_b64_tr_b16 v[210:211], v231 offset:25088
v_mfma_f32_16x16x32_bf16 v[148:151], v[192:195], a[52:55], v[148:151]
v_add_f32 v67, 1.0, v67
v_mul_f32 v72, s96, v72
v_mfma_f32_16x16x32_bf16 v[152:155], v[192:195], a[56:59], v[152:155]
v_rcp_f32 v64, v64
v_mfma_f32_16x16x32_bf16 v[156:159], v[192:195], a[60:63], v[156:159]
s_waitcnt lgkmcnt(6)
v_mul_f32 v73, s96, v73
v_mul_f32 v74, s96, v74
v_mfma_f32_16x16x32_bf16 v[32:35], v[196:199], a[0:3], 0
ds_read_b64_tr_b16 v[192:193], v231 offset:28672
ds_read_b64_tr_b16 v[194:195], v231 offset:29184
v_mfma_f32_16x16x32_bf16 v[36:39], v[196:199], a[4:7], 0
v_rcp_f32 v65, v65
v_mfma_f32_16x16x32_bf16 v[40:43], v[196:199], a[8:11], 0
v_mul_f32 v75, s96, v75
v_mfma_f32_16x16x32_bf16 v[44:47], v[196:199], a[12:15], 0
s_waitcnt lgkmcnt(6)
v_exp_f32 v72, v72
v_mfma_f32_16x16x32_bf16 v[48:51], v[200:203], a[0:3], 0
ds_read_b64_tr_b16 v[196:197], v231 offset:32768
ds_read_b64_tr_b16 v[198:199], v231 offset:33280
v_mfma_f32_16x16x32_bf16 v[52:55], v[200:203], a[4:7], 0
v_rcp_f32 v66, v66
v_mfma_f32_16x16x32_bf16 v[56:59], v[200:203], a[8:11], 0
v_exp_f32 v73, v73
v_mfma_f32_16x16x32_bf16 v[60:63], v[200:203], a[12:15], 0
s_waitcnt lgkmcnt(6)
v_mfma_f32_16x16x32_bf16 v[32:35], v[204:207], a[16:19], v[32:35]
ds_read_b64_tr_b16 v[200:201], v231 offset:36864
ds_read_b64_tr_b16 v[202:203], v231 offset:37376
v_mfma_f32_16x16x32_bf16 v[36:39], v[204:207], a[20:23], v[36:39]
v_rcp_f32 v67, v67
v_mfma_f32_16x16x32_bf16 v[40:43], v[204:207], a[24:27], v[40:43]
v_exp_f32 v74, v74
v_mfma_f32_16x16x32_bf16 v[44:47], v[204:207], a[28:31], v[44:47]
s_waitcnt lgkmcnt(6)
v_mfma_f32_16x16x32_bf16 v[48:51], v[208:211], a[16:19], v[48:51]
s_waitcnt vmcnt(7)
ds_read_b64_tr_b16 v[204:205], v231 offset:40960
ds_read_b64_tr_b16 v[206:207], v231 offset:41472
v_mfma_f32_16x16x32_bf16 v[52:55], v[208:211], a[20:23], v[52:55]
v_cmp_gt_u32 vcc, 1, v246
v_mul_f32 v80, v64, v80
v_mfma_f32_16x16x32_bf16 v[56:59], v[208:211], a[24:27], v[56:59]
s_cbranch_vccnz spin_8_v1
ok_7_v1:
v_mfma_f32_16x16x32_bf16 v[60:63], v[208:211], a[28:31], v[60:63]
s_waitcnt lgkmcnt(6)
v_mul_f32 v81, v65, v81
v_mfma_f32_16x16x32_bf16 v[32:35], v[192:195], a[32:35], v[32:35]
s_add_u32 m0, s49, 98304
ds_read_b64_tr_b16 v[208:209], v228 offset:45056
ds_read_b64_tr_b16 v[210:211], v228 offset:45568
v_mfma_f32_16x16x32_bf16 v[36:39], v[192:195], a[36:39], v[36:39]
s_add_u32 s50, s81, 0
buffer_load_dwordx4 v237, s[28:31], s50 offen sc1 lds
v_mul_f32 v82, v66, v82
v_mfma_f32_16x16x32_bf16 v[40:43], v[192:195], a[40:43], v[40:43]
v_exp_f32 v75, v75
v_mfma_f32_16x16x32_bf16 v[44:47], v[192:195], a[44:47], v[44:47]
s_waitcnt lgkmcnt(6)
v_mul_f32 v83, v67, v83
v_add_f32 v72, 1.0, v72
v_mfma_f32_16x16x32_bf16 v[48:51], v[196:199], a[32:35], v[48:51]
s_waitcnt vmcnt(6)
ds_read_b64_tr_b16 v[192:193], v228 offset:49152
ds_read_b64_tr_b16 v[194:195], v228 offset:49664
v_mfma_f32_16x16x32_bf16 v[52:55], v[196:199], a[36:39], v[52:55]
buffer_store_dword v242, off, s[28:31], s11 sc1
v_cvt_pk_bf16_f32 v212, v80, v81
v_mfma_f32_16x16x32_bf16 v[56:59], v[196:199], a[40:43], v[56:59]
v_cvt_pk_bf16_f32 v213, v82, v83
v_add_f32 v73, 1.0, v73
v_mfma_f32_16x16x32_bf16 v[60:63], v[196:199], a[44:47], v[60:63]
s_waitcnt lgkmcnt(6)
v_add_f32 v74, 1.0, v74
v_mfma_f32_16x16x32_bf16 v[32:35], v[200:203], a[48:51], v[32:35]
s_add_u32 m0, s49, 102400
ds_read_b64_tr_b16 v[196:197], v228 offset:53248
ds_read_b64_tr_b16 v[198:199], v228 offset:53760
v_mfma_f32_16x16x32_bf16 v[36:39], v[200:203], a[52:55], v[36:39]
s_add_u32 s50, s81, 4096
buffer_load_dwordx4 v237, s[28:31], s50 offen sc1 lds
v_mul_f32 v68, s96, v68
v_mfma_f32_16x16x32_bf16 v[40:43], v[200:203], a[56:59], v[40:43]
v_mul_f32 v69, s96, v69
v_add_f32 v75, 1.0, v75
v_mfma_f32_16x16x32_bf16 v[44:47], v[200:203], a[60:63], v[44:47]
s_waitcnt lgkmcnt(6)
v_rcp_f32 v72, v72
v_mfma_f32_16x16x32_bf16 v[48:51], v[204:207], a[48:51], v[48:51]
s_add_u32 m0, s49, 106496
ds_read_b64_tr_b16 v[200:201], v228 offset:57344
ds_read_b64_tr_b16 v[202:203], v228 offset:57856
v_mfma_f32_16x16x32_bf16 v[52:55], v[204:207], a[52:55], v[52:55]
s_add_u32 s50, s81, 8192
v_add_u32 v228, 4294868992, v228
v_mul_f32 v70, s96, v70
v_mfma_f32_16x16x32_bf16 v[56:59], v[204:207], a[56:59], v[56:59]
buffer_load_dwordx4 v237, s[28:31], s50 offen sc1 lds
v_mul_f32 v71, s96, v71
v_mfma_f32_16x16x32_bf16 v[60:63], v[204:207], a[60:63], v[60:63]
s_waitcnt lgkmcnt(6)
v_rcp_f32 v73, v73
v_mfma_f32_16x16x32_bf16 v[160:163], v[208:211], a[64:67], v[160:163]
s_add_u32 s52, s79, 16384
ds_read_b64_tr_b16 v[204:205], v228 offset:0
ds_read_b64_tr_b16 v[206:207], v228 offset:512
v_mfma_f32_16x16x32_bf16 v[164:167], v[208:211], a[68:71], v[164:167]
v_exp_f32 v68, v68
v_mfma_f32_16x16x32_bf16 v[168:171], v[208:211], a[72:75], v[168:171]
v_exp_f32 v69, v69
v_mfma_f32_16x16x32_bf16 v[172:175], v[208:211], a[76:79], v[172:175]
s_waitcnt lgkmcnt(6)
v_rcp_f32 v74, v74
v_mfma_f32_16x16x32_bf16 v[176:179], v[192:195], a[64:67], v[176:179]
ds_read_b64_tr_b16 v[208:209], v228 offset:4096
ds_read_b64_tr_b16 v[210:211], v228 offset:4608
v_mfma_f32_16x16x32_bf16 v[180:183], v[192:195], a[68:71], v[180:183]
buffer_load_dwordx4 a[0:3], v237, s[28:31], s52 offen offset:0 sc1
buffer_load_dwordx4 a[4:7], v237, s[28:31], s52 offen offset:1024 sc1
v_mfma_f32_16x16x32_bf16 v[184:187], v[192:195], a[72:75], v[184:187]
v_exp_f32 v70, v70
v_mfma_f32_16x16x32_bf16 v[188:191], v[192:195], a[76:79], v[188:191]
s_waitcnt lgkmcnt(6)
v_rcp_f32 v75, v75
v_mfma_f32_16x16x32_bf16 v[160:163], v[196:199], a[80:83], v[160:163]
ds_read_b64_tr_b16 v[192:193], v228 offset:8192
ds_read_b64_tr_b16 v[194:195], v228 offset:8704
v_mfma_f32_16x16x32_bf16 v[164:167], v[196:199], a[84:87], v[164:167]
buffer_load_dwordx4 a[8:11], v237, s[28:31], s52 offen offset:2048 sc1
v_mul_f32 v88, v72, v88
v_mfma_f32_16x16x32_bf16 v[168:171], v[196:199], a[88:91], v[168:171]
v_exp_f32 v71, v71
v_mfma_f32_16x16x32_bf16 v[172:175], v[196:199], a[92:95], v[172:175]
s_waitcnt lgkmcnt(6)
v_mul_f32 v89, v73, v89
v_mfma_f32_16x16x32_bf16 v[176:179], v[200:203], a[80:83], v[176:179]
ds_read_b64_tr_b16 v[196:197], v228 offset:12288
ds_read_b64_tr_b16 v[198:199], v228 offset:12800
v_mfma_f32_16x16x32_bf16 v[180:183], v[200:203], a[84:87], v[180:183]
v_add_f32 v68, 1.0, v68
v_mul_f32 v90, v74, v90
v_mfma_f32_16x16x32_bf16 v[184:187], v[200:203], a[88:91], v[184:187]
v_mul_f32 v91, v75, v91
v_mfma_f32_16x16x32_bf16 v[188:191], v[200:203], a[92:95], v[188:191]
s_waitcnt lgkmcnt(6)
v_mfma_f32_16x16x32_bf16 v[160:163], v[204:207], a[96:99], v[160:163]
ds_read_b64_tr_b16 v[200:201], v228 offset:16384
ds_read_b64_tr_b16 v[202:203], v228 offset:16896
v_mfma_f32_16x16x32_bf16 v[164:167], v[204:207], a[100:103], v[164:167]
buffer_load_dwordx4 a[12:15], v237, s[28:31], s52 offen offset:3072 sc1
v_add_f32 v69, 1.0, v69
v_mfma_f32_16x16x32_bf16 v[168:171], v[204:207], a[104:107], v[168:171]
v_add_f32 v70, 1.0, v70
v_cvt_pk_bf16_f32 v216, v88, v89
v_mfma_f32_16x16x32_bf16 v[172:175], v[204:207], a[108:111], v[172:175]
s_waitcnt lgkmcnt(6)
v_cvt_pk_bf16_f32 v217, v90, v91
v_mfma_f32_16x16x32_bf16 v[176:179], v[208:211], a[96:99], v[176:179]
s_add_u32 s52, s79, 24576
ds_read_b64_tr_b16 v[204:205], v228 offset:20480
ds_read_b64_tr_b16 v[206:207], v228 offset:20992
v_mfma_f32_16x16x32_bf16 v[180:183], v[208:211], a[100:103], v[180:183]
buffer_load_dwordx4 a[16:19], v237, s[28:31], s52 offen offset:0 sc1
v_add_f32 v71, 1.0, v71
v_mfma_f32_16x16x32_bf16 v[184:187], v[208:211], a[104:107], v[184:187]
v_rcp_f32 v68, v68
v_mfma_f32_16x16x32_bf16 v[188:191], v[208:211], a[108:111], v[188:191]
s_waitcnt lgkmcnt(6)
v_mul_f32 v76, s96, v76
v_mul_f32 v77, s96, v77
v_mfma_f32_16x16x32_bf16 v[160:163], v[192:195], a[112:115], v[160:163]
ds_read_b64_tr_b16 v[208:209], v229 offset:45056
ds_read_b64_tr_b16 v[210:211], v229 offset:45568
v_mfma_f32_16x16x32_bf16 v[164:167], v[192:195], a[116:119], v[164:167]
buffer_load_dwordx4 a[20:23], v237, s[28:31], s52 offen offset:1024 sc1
v_mul_f32 v78, s96, v78
v_mfma_f32_16x16x32_bf16 v[168:171], v[192:195], a[120:123], v[168:171]
v_rcp_f32 v69, v69
v_mfma_f32_16x16x32_bf16 v[172:175], v[192:195], a[124:127], v[172:175]
s_waitcnt lgkmcnt(6)
v_mul_f32 v79, s96, v79
v_mfma_f32_16x16x32_bf16 v[176:179], v[196:199], a[112:115], v[176:179]
ds_read_b64_tr_b16 v[192:193], v229 offset:49152
ds_read_b64_tr_b16 v[194:195], v229 offset:49664
v_mfma_f32_16x16x32_bf16 v[180:183], v[196:199], a[116:119], v[180:183]
v_rcp_f32 v70, v70
v_mfma_f32_16x16x32_bf16 v[184:187], v[196:199], a[120:123], v[184:187]
v_exp_f32 v76, v76
v_mfma_f32_16x16x32_bf16 v[188:191], v[196:199], a[124:127], v[188:191]
s_waitcnt lgkmcnt(6)
v_exp_f32 v77, v77
v_mfma_f32_16x16x32_bf16 v[160:163], v[200:203], a[128:131], v[160:163]
ds_read_b64_tr_b16 v[196:197], v229 offset:53248
ds_read_b64_tr_b16 v[198:199], v229 offset:53760
v_mfma_f32_16x16x32_bf16 v[164:167], v[200:203], a[132:135], v[164:167]
buffer_load_dwordx4 a[24:27], v237, s[28:31], s52 offen offset:2048 sc1
buffer_load_dwordx4 a[28:31], v237, s[28:31], s52 offen offset:3072 sc1
v_mfma_f32_16x16x32_bf16 v[168:171], v[200:203], a[136:139], v[168:171]
v_rcp_f32 v71, v71
v_mfma_f32_16x16x32_bf16 v[172:175], v[200:203], a[140:143], v[172:175]
s_waitcnt lgkmcnt(6)
v_exp_f32 v78, v78
v_mfma_f32_16x16x32_bf16 v[176:179], v[204:207], a[128:131], v[176:179]
ds_read_b64_tr_b16 v[200:201], v229 offset:57344
ds_read_b64_tr_b16 v[202:203], v229 offset:57856
v_mfma_f32_16x16x32_bf16 v[180:183], v[204:207], a[132:135], v[180:183]
v_add_u32 v229, 4294868992, v229
v_mul_f32 v84, v68, v84
v_mfma_f32_16x16x32_bf16 v[184:187], v[204:207], a[136:139], v[184:187]
v_mul_f32 v85, v69, v85
v_mfma_f32_16x16x32_bf16 v[188:191], v[204:207], a[140:143], v[188:191]
s_waitcnt lgkmcnt(6)
v_exp_f32 v79, v79
v_mfma_f32_16x16x32_bf16 v[96:99], v[208:211], a[64:67], v[96:99]
s_add_u32 s52, s79, 73728
ds_read_b64_tr_b16 v[204:205], v229 offset:0
ds_read_b64_tr_b16 v[206:207], v229 offset:512
v_mfma_f32_16x16x32_bf16 v[100:103], v[208:211], a[68:71], v[100:103]
buffer_load_dwordx4 a[32:35], v237, s[28:31], s52 offen offset:0 sc1
v_mul_f32 v86, v70, v86
v_mfma_f32_16x16x32_bf16 v[104:107], v[208:211], a[72:75], v[104:107]
TCH_5_v1:
s_cbranch_execz TCH_9_v1
v_mul_f32 v87, v71, v87
v_add_f32 v76, 1.0, v76
v_mfma_f32_16x16x32_bf16 v[108:111], v[208:211], a[76:79], v[108:111]
s_waitcnt lgkmcnt(6)
v_mfma_f32_16x16x32_bf16 v[112:115], v[192:195], a[64:67], v[112:115]
s_lshl_b32 s51, s69, 9
ds_read_b64_tr_b16 v[208:209], v229 offset:4096
ds_read_b64_tr_b16 v[210:211], v229 offset:4608
v_mfma_f32_16x16x32_bf16 v[116:119], v[192:195], a[68:71], v[116:119]
s_add_u32 s51, s56, s51
buffer_load_dwordx4 a[36:39], v237, s[28:31], s52 offen offset:1024 sc1
v_cvt_pk_bf16_f32 v214, v84, v85
v_mfma_f32_16x16x32_bf16 v[120:123], v[192:195], a[72:75], v[120:123]
v_add_f32 v77, 1.0, v77
v_add_f32 v78, 1.0, v78
v_mfma_f32_16x16x32_bf16 v[124:127], v[192:195], a[76:79], v[124:127]
s_waitcnt lgkmcnt(6)
v_mfma_f32_16x16x32_bf16 v[96:99], v[196:199], a[80:83], v[96:99]
ds_read_b64_tr_b16 v[192:193], v229 offset:8192
ds_read_b64_tr_b16 v[194:195], v229 offset:8704
v_mfma_f32_16x16x32_bf16 v[100:103], v[196:199], a[84:87], v[100:103]
v_cvt_pk_bf16_f32 v215, v86, v87
v_add_f32 v79, 1.0, v79
v_mfma_f32_16x16x32_bf16 v[104:107], v[196:199], a[88:91], v[104:107]
v_rcp_f32 v76, v76
v_mfma_f32_16x16x32_bf16 v[108:111], v[196:199], a[92:95], v[108:111]
s_waitcnt lgkmcnt(6)
buffer_store_dwordx4 v[212:215], v237, s[28:31], s51 offen offset:0 sc1
v_mfma_f32_16x16x32_bf16 v[112:115], v[200:203], a[80:83], v[112:115]
ds_read_b64_tr_b16 v[196:197], v229 offset:12288
ds_read_b64_tr_b16 v[198:199], v229 offset:12800
v_mfma_f32_16x16x32_bf16 v[116:119], v[200:203], a[84:87], v[116:119]
v_rcp_f32 v77, v77
v_mfma_f32_16x16x32_bf16 v[120:123], v[200:203], a[88:91], v[120:123]
v_mfma_f32_16x16x32_bf16 v[124:127], v[200:203], a[92:95], v[124:127]
s_waitcnt lgkmcnt(6)
v_mfma_f32_16x16x32_bf16 v[96:99], v[204:207], a[96:99], v[96:99]
ds_read_b64_tr_b16 v[200:201], v229 offset:16384
ds_read_b64_tr_b16 v[202:203], v229 offset:16896
v_mfma_f32_16x16x32_bf16 v[100:103], v[204:207], a[100:103], v[100:103]
v_rcp_f32 v78, v78
v_mfma_f32_16x16x32_bf16 v[104:107], v[204:207], a[104:107], v[104:107]
buffer_load_dwordx4 a[40:43], v237, s[28:31], s52 offen offset:2048 sc1
v_mfma_f32_16x16x32_bf16 v[108:111], v[204:207], a[108:111], v[108:111]
s_waitcnt lgkmcnt(6)
v_mfma_f32_16x16x32_bf16 v[112:115], v[208:211], a[96:99], v[112:115]
ds_read_b64_tr_b16 v[204:205], v229 offset:20480
ds_read_b64_tr_b16 v[206:207], v229 offset:20992
v_mfma_f32_16x16x32_bf16 v[116:119], v[208:211], a[100:103], v[116:119]
v_rcp_f32 v79, v79
v_mfma_f32_16x16x32_bf16 v[120:123], v[208:211], a[104:107], v[120:123]
buffer_load_dwordx4 a[44:47], v237, s[28:31], s52 offen offset:3072 sc1
v_mfma_f32_16x16x32_bf16 v[124:127], v[208:211], a[108:111], v[124:127]
s_waitcnt lgkmcnt(6)
v_mfma_f32_16x16x32_bf16 v[96:99], v[192:195], a[112:115], v[96:99]
s_add_u32 s52, s79, 81920
ds_read_b64_tr_b16 v[208:209], v230 offset:45056
ds_read_b64_tr_b16 v[210:211], v230 offset:45568
v_mfma_f32_16x16x32_bf16 v[100:103], v[192:195], a[116:119], v[100:103]
buffer_load_dwordx4 a[48:51], v237, s[28:31], s52 offen offset:0 sc1
v_mul_f32 v92, v76, v92
v_mfma_f32_16x16x32_bf16 v[104:107], v[192:195], a[120:123], v[104:107]
v_mul_f32 v93, v77, v93
v_mfma_f32_16x16x32_bf16 v[108:111], v[192:195], a[124:127], v[108:111]
s_waitcnt lgkmcnt(6)
v_mfma_f32_16x16x32_bf16 v[112:115], v[196:199], a[112:115], v[112:115]
ds_read_b64_tr_b16 v[192:193], v230 offset:49152
ds_read_b64_tr_b16 v[194:195], v230 offset:49664
v_mfma_f32_16x16x32_bf16 v[116:119], v[196:199], a[116:119], v[116:119]
buffer_load_dwordx4 a[52:55], v237, s[28:31], s52 offen offset:1024 sc1
v_mul_f32 v94, v78, v94
v_mfma_f32_16x16x32_bf16 v[120:123], v[196:199], a[120:123], v[120:123]
v_mul_f32 v95, v79, v95
v_mfma_f32_16x16x32_bf16 v[124:127], v[196:199], a[124:127], v[124:127]
s_waitcnt lgkmcnt(6)
v_mfma_f32_16x16x32_bf16 v[96:99], v[200:203], a[128:131], v[96:99]
s_lshl_b32 s66, s69, 9
ds_read_b64_tr_b16 v[196:197], v230 offset:53248
ds_read_b64_tr_b16 v[198:199], v230 offset:53760
v_mfma_f32_16x16x32_bf16 v[100:103], v[200:203], a[132:135], v[100:103]
s_sub_u32 s66, s56, s66
v_cvt_pk_bf16_f32 v218, v92, v93
v_mfma_f32_16x16x32_bf16 v[104:107], v[200:203], a[136:139], v[104:107]
s_add_u32 s11, s3, 0
v_mfma_f32_16x16x32_bf16 v[108:111], v[200:203], a[140:143], v[108:111]
s_waitcnt lgkmcnt(6)
v_mfma_f32_16x16x32_bf16 v[112:115], v[204:207], a[128:131], v[112:115]
s_waitcnt vmcnt(21)
ds_read_b64_tr_b16 v[200:201], v230 offset:57344
ds_read_b64_tr_b16 v[202:203], v230 offset:57856
v_mfma_f32_16x16x32_bf16 v[116:119], v[204:207], a[132:135], v[116:119]
v_add_u32 v230, 4294868992, v230
v_cvt_pk_bf16_f32 v219, v94, v95
v_mfma_f32_16x16x32_bf16 v[120:123], v[204:207], a[136:139], v[120:123]
buffer_store_dwordx4 v[216:219], v237, s[28:31], s66 offen offset:1024 sc1
buffer_store_dword v242, off, s[32:35], s11 sc1
v_mfma_f32_16x16x32_bf16 v[124:127], v[204:207], a[140:143], v[124:127]
s_waitcnt lgkmcnt(6)
v_mfma_f32_16x16x32_bf16 v[128:131], v[208:211], a[64:67], v[128:131]
s_add_u32 s11, s91, 0
ds_read_b64_tr_b16 v[204:205], v230 offset:0
ds_read_b64_tr_b16 v[206:207], v230 offset:512
v_mfma_f32_16x16x32_bf16 v[132:135], v[208:211], a[68:71], v[132:135]
s_waitcnt vmcnt(23)
buffer_store_dword v242, off, s[32:35], s11 sc1
v_mfma_f32_16x16x32_bf16 v[136:139], v[208:211], a[72:75], v[136:139]
s_add_u32 s11, s97, 16384
v_mfma_f32_16x16x32_bf16 v[140:143], v[208:211], a[76:79], v[140:143]
s_waitcnt lgkmcnt(6)
v_mfma_f32_16x16x32_bf16 v[144:147], v[192:195], a[64:67], v[144:147]
ds_read_b64_tr_b16 v[208:209], v230 offset:4096
ds_read_b64_tr_b16 v[210:211], v230 offset:4608
v_mfma_f32_16x16x32_bf16 v[148:151], v[192:195], a[68:71], v[148:151]
v_mfma_f32_16x16x32_bf16 v[152:155], v[192:195], a[72:75], v[152:155]
v_mfma_f32_16x16x32_bf16 v[156:159], v[192:195], a[76:79], v[156:159]
s_waitcnt lgkmcnt(6)
v_mfma_f32_16x16x32_bf16 v[128:131], v[196:199], a[80:83], v[128:131]
ds_read_b64_tr_b16 v[192:193], v230 offset:8192
ds_read_b64_tr_b16 v[194:195], v230 offset:8704
v_mfma_f32_16x16x32_bf16 v[132:135], v[196:199], a[84:87], v[132:135]
buffer_load_dwordx4 a[56:59], v237, s[28:31], s52 offen offset:2048 sc1
v_mfma_f32_16x16x32_bf16 v[136:139], v[196:199], a[88:91], v[136:139]
v_mfma_f32_16x16x32_bf16 v[140:143], v[196:199], a[92:95], v[140:143]
s_waitcnt lgkmcnt(6)
v_mfma_f32_16x16x32_bf16 v[144:147], v[200:203], a[80:83], v[144:147]
ds_read_b64_tr_b16 v[196:197], v230 offset:12288
ds_read_b64_tr_b16 v[198:199], v230 offset:12800
v_mfma_f32_16x16x32_bf16 v[148:151], v[200:203], a[84:87], v[148:151]
buffer_load_dwordx4 a[60:63], v237, s[28:31], s52 offen offset:3072 sc1
v_mfma_f32_16x16x32_bf16 v[152:155], v[200:203], a[88:91], v[152:155]
v_mfma_f32_16x16x32_bf16 v[156:159], v[200:203], a[92:95], v[156:159]
s_waitcnt lgkmcnt(6)
v_mfma_f32_16x16x32_bf16 v[128:131], v[204:207], a[96:99], v[128:131]
ds_read_b64_tr_b16 v[200:201], v230 offset:16384
ds_read_b64_tr_b16 v[202:203], v230 offset:16896
v_mfma_f32_16x16x32_bf16 v[132:135], v[204:207], a[100:103], v[132:135]
v_lshrrev_b32 v238, 7, v237
v_mul_u32_u24 v236, 11, v238
v_mfma_f32_16x16x32_bf16 v[136:139], v[204:207], a[104:107], v[136:139]
v_mfma_f32_16x16x32_bf16 v[140:143], v[204:207], a[108:111], v[140:143]
s_waitcnt lgkmcnt(6)
v_mfma_f32_16x16x32_bf16 v[144:147], v[208:211], a[96:99], v[144:147]
ds_read_b64_tr_b16 v[204:205], v230 offset:20480
ds_read_b64_tr_b16 v[206:207], v230 offset:20992
v_mfma_f32_16x16x32_bf16 v[148:151], v[208:211], a[100:103], v[148:151]
v_lshrrev_b32 v236, 5, v236
v_mul_u32_u24 v243, 3, v236
v_mfma_f32_16x16x32_bf16 v[152:155], v[208:211], a[104:107], v[152:155]
v_mfma_f32_16x16x32_bf16 v[156:159], v[208:211], a[108:111], v[156:159]
s_waitcnt lgkmcnt(6)
v_mfma_f32_16x16x32_bf16 v[128:131], v[192:195], a[112:115], v[128:131]
s_add_u32 s52, s79, 0
ds_read_b64_tr_b16 v[208:209], v231 offset:45056
ds_read_b64_tr_b16 v[210:211], v231 offset:45568
v_mfma_f32_16x16x32_bf16 v[132:135], v[192:195], a[116:119], v[132:135]
buffer_load_dwordx4 v[64:67], v237, s[28:31], s52 offen offset:0 sc1
v_sub_u32 v243, v238, v243
v_mfma_f32_16x16x32_bf16 v[136:139], v[192:195], a[120:123], v[136:139]
s_lshr_b32 s6, s77, 6
v_sub_u32 v236, s6, v236
v_mfma_f32_16x16x32_bf16 v[140:143], v[192:195], a[124:127], v[140:143]
s_waitcnt lgkmcnt(6)
v_mfma_f32_16x16x32_bf16 v[144:147], v[196:199], a[112:115], v[144:147]
ds_read_b64_tr_b16 v[192:193], v231 offset:49152
ds_read_b64_tr_b16 v[194:195], v231 offset:49664
v_mfma_f32_16x16x32_bf16 v[148:151], v[196:199], a[116:119], v[148:151]
v_max_i32 v236, 0, v236
v_lshl_add_u32 v236, v236, 2, v243
v_mfma_f32_16x16x32_bf16 v[152:155], v[196:199], a[120:123], v[152:155]
v_mfma_f32_16x16x32_bf16 v[156:159], v[196:199], a[124:127], v[156:159]
s_waitcnt lgkmcnt(6)
v_mfma_f32_16x16x32_bf16 v[128:131], v[200:203], a[128:131], v[128:131]
s_bfe_u32 s6, s2, 0x30003
ds_read_b64_tr_b16 v[196:197], v231 offset:53248
ds_read_b64_tr_b16 v[198:199], v231 offset:53760
v_mfma_f32_16x16x32_bf16 v[132:135], v[200:203], a[132:135], v[132:135]
s_lshl_b32 s6, s6, 1
buffer_load_dwordx4 v[68:71], v237, s[28:31], s52 offen offset:1024 sc1
v_lshl_add_u32 v236, v236, 5, s6
v_mfma_f32_16x16x32_bf16 v[136:139], v[200:203], a[136:139], v[136:139]
v_bfe_u32 v243, v237, 4, 2
v_mfma_f32_16x16x32_bf16 v[140:143], v[200:203], a[140:143], v[140:143]
s_waitcnt lgkmcnt(6)
v_mfma_f32_16x16x32_bf16 v[144:147], v[204:207], a[128:131], v[144:147]
ds_read_b64_tr_b16 v[200:201], v231 offset:57344
ds_read_b64_tr_b16 v[202:203], v231 offset:57856
v_mfma_f32_16x16x32_bf16 v[148:151], v[204:207], a[132:135], v[148:151]
v_add_u32 v231, 4294868992, v231
v_add_lshl_u32 v236, v236, v243, 2
v_mfma_f32_16x16x32_bf16 v[152:155], v[204:207], a[136:139], v[152:155]
buffer_load_dwordx4 v[72:75], v237, s[28:31], s52 offen offset:2048 sc1
v_cmp_gt_u32 s[4:5], 6, v238
v_mfma_f32_16x16x32_bf16 v[156:159], v[204:207], a[140:143], v[156:159]
s_waitcnt lgkmcnt(6)
v_mfma_f32_16x16x32_bf16 v[32:35], v[208:211], a[64:67], v[32:35]
ds_read_b64_tr_b16 v[204:205], v231 offset:0
ds_read_b64_tr_b16 v[206:207], v231 offset:512
v_mfma_f32_16x16x32_bf16 v[36:39], v[208:211], a[68:71], v[36:39]
buffer_load_dword v246, v241, s[28:31], s68 offen sc1
v_add_u32 v236, 46198784, v236
v_mfma_f32_16x16x32_bf16 v[40:43], v[208:211], a[72:75], v[40:43]
v_add_u32 v234, 16384, v241
v_mfma_f32_16x16x32_bf16 v[44:47], v[208:211], a[76:79], v[44:47]
s_waitcnt lgkmcnt(6)
v_mfma_f32_16x16x32_bf16 v[48:51], v[192:195], a[64:67], v[48:51]
ds_read_b64_tr_b16 v[208:209], v231 offset:4096
ds_read_b64_tr_b16 v[210:211], v231 offset:4608
v_mfma_f32_16x16x32_bf16 v[52:55], v[192:195], a[68:71], v[52:55]
buffer_load_dwordx4 v[76:79], v237, s[28:31], s52 offen offset:3072 sc1
v_cndmask_b32 v234, v234, v236, s[4:5]
v_mfma_f32_16x16x32_bf16 v[56:59], v[192:195], a[72:75], v[56:59]
v_bfe_u32 v238, v237, 4, 4
v_lshrrev_b32 v236, 8, v237
v_mfma_f32_16x16x32_bf16 v[60:63], v[192:195], a[76:79], v[60:63]
s_waitcnt lgkmcnt(6)
v_mul_u32_u24 v238, 1152, v238
v_add_u32 v238, s85, v238
v_mfma_f32_16x16x32_bf16 v[32:35], v[196:199], a[80:83], v[32:35]
s_add_u32 s52, s79, 8192
ds_read_b64_tr_b16 v[192:193], v231 offset:8192
ds_read_b64_tr_b16 v[194:195], v231 offset:8704
v_mfma_f32_16x16x32_bf16 v[36:39], v[196:199], a[84:87], v[36:39]
buffer_load_dwordx4 v[80:83], v237, s[28:31], s52 offen offset:0 sc1
v_lshl_add_u32 v233, v236, 3, v238
v_mfma_f32_16x16x32_bf16 v[40:43], v[196:199], a[88:91], v[40:43]
v_and_b32 v232, 1, v236
v_lshl_add_u32 v238, v232, 5, v238
v_mfma_f32_16x16x32_bf16 v[44:47], v[196:199], a[92:95], v[44:47]
s_waitcnt lgkmcnt(6)
v_lshrrev_b32 v236, 1, v236
v_lshl_add_u32 v232, v236, 4, v238
v_mfma_f32_16x16x32_bf16 v[48:51], v[200:203], a[80:83], v[48:51]
s_waitcnt vmcnt(10)
ds_read_b64_tr_b16 v[196:197], v231 offset:12288
ds_read_b64_tr_b16 v[198:199], v231 offset:12800
v_mfma_f32_16x16x32_bf16 v[52:55], v[200:203], a[84:87], v[52:55]
buffer_store_dword v242, off, s[28:31], s11 sc1
buffer_load_dwordx4 v[84:87], v237, s[28:31], s52 offen offset:1024 sc1
v_mfma_f32_16x16x32_bf16 v[56:59], v[200:203], a[88:91], v[56:59]
v_lshl_add_u32 v233, v236, 30, v233
v_lshrrev_b32 v239, 1, v237
v_mfma_f32_16x16x32_bf16 v[60:63], v[200:203], a[92:95], v[60:63]
s_waitcnt lgkmcnt(6)
v_lshrrev_b32 v243, 6, v237
v_lshlrev_b32 v243, 4, v243
v_mfma_f32_16x16x32_bf16 v[32:35], v[204:207], a[96:99], v[32:35]
ds_read_b64_tr_b16 v[200:201], v231 offset:16384
ds_read_b64_tr_b16 v[202:203], v231 offset:16896
v_mfma_f32_16x16x32_bf16 v[36:39], v[204:207], a[100:103], v[36:39]
buffer_load_dwordx4 v[88:91], v237, s[28:31], s52 offen offset:2048 sc1
v_and_b32 v240, 8, v239
v_mfma_f32_16x16x32_bf16 v[40:43], v[204:207], a[104:107], v[40:43]
v_add_u32 v240, v240, v243
v_bfe_u32 v239, v237, 5, 1
v_mfma_f32_16x16x32_bf16 v[44:47], v[204:207], a[108:111], v[44:47]
s_waitcnt lgkmcnt(6)
v_mul_u32_u24 v239, 640, v239
v_xor_b32 v239, v239, v240
v_mfma_f32_16x16x32_bf16 v[48:51], v[208:211], a[96:99], v[48:51]
ds_read_b64_tr_b16 v[204:205], v231 offset:20480
ds_read_b64_tr_b16 v[206:207], v231 offset:20992
v_mfma_f32_16x16x32_bf16 v[52:55], v[208:211], a[100:103], v[52:55]
buffer_load_dwordx4 v[92:95], v237, s[28:31], s52 offen offset:3072 sc1
v_add_u32 v239, 98304, v239
v_mfma_f32_16x16x32_bf16 v[56:59], v[208:211], a[104:107], v[56:59]
s_waitcnt vmcnt(34)
s_barrier
v_mfma_f32_16x16x32_bf16 v[60:63], v[208:211], a[108:111], v[60:63]
s_waitcnt lgkmcnt(6)
v_add_u32 v240, 98304, v240
v_mfma_f32_16x16x32_bf16 v[32:35], v[192:195], a[112:115], v[32:35]
s_mov_b32 s24, s46
ds_read_b64_tr_b16 v[208:209], v228 offset:24576
ds_read_b64_tr_b16 v[210:211], v228 offset:25088
v_mfma_f32_16x16x32_bf16 v[36:39], v[192:195], a[116:119], v[36:39]
s_mov_b32 s25, s47
s_mov_b32 s26, 2359296
v_lshrrev_b32 v220, 4, v237
v_mfma_f32_16x16x32_bf16 v[40:43], v[192:195], a[120:123], v[40:43]
v_add_u32 v220, s80, v220
v_add_u32 v220, 0, v220
v_mfma_f32_16x16x32_bf16 v[44:47], v[192:195], a[124:127], v[44:47]
s_waitcnt lgkmcnt(6)
v_mul_u32_u24 v221, 5042, v220
v_lshrrev_b32 v221, 16, v221
v_mfma_f32_16x16x32_bf16 v[48:51], v[196:199], a[112:115], v[48:51]
s_add_u32 s52, s79, 90112
ds_read_b64_tr_b16 v[192:193], v228 offset:28672
ds_read_b64_tr_b16 v[194:195], v228 offset:29184
v_mfma_f32_16x16x32_bf16 v[52:55], v[196:199], a[116:119], v[52:55]
buffer_load_dwordx4 a[64:67], v237, s[28:31], s52 offen offset:0 sc1
v_mul_u32_u24 v222, 13, v221
v_mfma_f32_16x16x32_bf16 v[56:59], v[196:199], a[120:123], v[56:59]
v_sub_u32 v220, v220, v222
v_mul_u32_u24 v222, 11, v220
v_mfma_f32_16x16x32_bf16 v[60:63], v[196:199], a[124:127], v[60:63]
s_waitcnt lgkmcnt(6)
v_lshrrev_b32 v222, 5, v222
v_mul_u32_u24 v222, 12, v222
v_mfma_f32_16x16x32_bf16 v[32:35], v[200:203], a[128:131], v[32:35]
ds_read_b64_tr_b16 v[196:197], v228 offset:32768
ds_read_b64_tr_b16 v[198:199], v228 offset:33280
v_mfma_f32_16x16x32_bf16 v[36:39], v[200:203], a[132:135], v[36:39]
buffer_load_dwordx4 a[68:71], v237, s[28:31], s52 offen offset:1024 sc1
v_lshlrev_b32 v220, 4, v220
v_mfma_f32_16x16x32_bf16 v[40:43], v[200:203], a[136:139], v[40:43]
v_sub_u32 v220, v220, v222
v_add_u32 v221, s77, v221
v_mfma_f32_16x16x32_bf16 v[44:47], v[200:203], a[140:143], v[44:47]
s_waitcnt lgkmcnt(6)
v_mul_u32_u24 v222, 3456, v221
v_add_u32 v236, v222, v220
v_mfma_f32_16x16x32_bf16 v[48:51], v[204:207], a[128:131], v[48:51]
ds_read_b64_tr_b16 v[200:201], v228 offset:36864
ds_read_b64_tr_b16 v[202:203], v228 offset:37376
v_mfma_f32_16x16x32_bf16 v[52:55], v[204:207], a[132:135], v[52:55]
buffer_load_dwordx4 a[72:75], v237, s[28:31], s52 offen offset:2048 sc1
v_lshrrev_b32 v220, 4, v237
v_mfma_f32_16x16x32_bf16 v[56:59], v[204:207], a[136:139], v[56:59]
v_add_u32 v220, s80, v220
v_add_u32 v220, 256, v220
v_mfma_f32_16x16x32_bf16 v[60:63], v[204:207], a[140:143], v[60:63]
s_waitcnt lgkmcnt(6)
v_mul_u32_u24 v221, 5042, v220
v_lshrrev_b32 v221, 16, v221
v_mfma_f32_16x16x32_bf16 v[160:163], v[208:211], a[144:147], v[160:163]
ds_read_b64_tr_b16 v[204:205], v228 offset:40960
ds_read_b64_tr_b16 v[206:207], v228 offset:41472
v_mfma_f32_16x16x32_bf16 v[164:167], v[208:211], a[148:151], v[164:167]
buffer_load_dwordx4 a[76:79], v237, s[28:31], s52 offen offset:3072 sc1
v_mul_u32_u24 v222, 13, v221
v_mfma_f32_16x16x32_bf16 v[168:171], v[208:211], a[152:155], v[168:171]
v_sub_u32 v220, v220, v222
v_mul_u32_u24 v222, 11, v220
v_mfma_f32_16x16x32_bf16 v[172:175], v[208:211], a[156:159], v[172:175]
s_waitcnt lgkmcnt(6)
v_lshrrev_b32 v222, 5, v222
v_mul_u32_u24 v222, 12, v222
v_mfma_f32_16x16x32_bf16 v[176:179], v[192:195], a[144:147], v[176:179]
s_add_u32 m0, s49, 110592
ds_read_b64_tr_b16 v[208:209], v228 offset:45056
ds_read_b64_tr_b16 v[210:211], v228 offset:45568
v_mfma_f32_16x16x32_bf16 v[180:183], v[192:195], a[148:151], v[180:183]
s_add_u32 s50, s81, 12288
buffer_load_dwordx4 v237, s[28:31], s50 offen sc1 lds
v_lshlrev_b32 v220, 4, v220
v_mfma_f32_16x16x32_bf16 v[184:187], v[192:195], a[152:155], v[184:187]
v_sub_u32 v220, v220, v222
v_add_u32 v221, s77, v221
v_mfma_f32_16x16x32_bf16 v[188:191], v[192:195], a[156:159], v[188:191]
s_waitcnt lgkmcnt(6)
v_mul_u32_u24 v222, 3456, v221
v_add_u32 v238, v222, v220
v_mfma_f32_16x16x32_bf16 v[160:163], v[196:199], a[160:163], v[160:163]
ds_read_b64_tr_b16 v[192:193], v228 offset:49152
ds_read_b64_tr_b16 v[194:195], v228 offset:49664
v_mfma_f32_16x16x32_bf16 v[164:167], v[196:199], a[164:167], v[164:167]
v_lshrrev_b32 v220, 4, v237
v_add_u32 v220, s80, v220
v_mfma_f32_16x16x32_bf16 v[168:171], v[196:199], a[168:171], v[168:171]
v_add_u32 v220, 512, v220
v_mul_u32_u24 v221, 5042, v220
v_mfma_f32_16x16x32_bf16 v[172:175], v[196:199], a[172:175], v[172:175]
s_waitcnt lgkmcnt(6)
v_lshrrev_b32 v221, 16, v221
v_mul_u32_u24 v222, 13, v221
v_mfma_f32_16x16x32_bf16 v[176:179], v[200:203], a[160:163], v[176:179]
s_add_u32 m0, s49, 114688
ds_read_b64_tr_b16 v[196:197], v228 offset:53248
ds_read_b64_tr_b16 v[198:199], v228 offset:53760
v_mfma_f32_16x16x32_bf16 v[180:183], v[200:203], a[164:167], v[180:183]
s_add_u32 s50, s81, 16384
buffer_load_dwordx4 v237, s[28:31], s50 offen sc1 lds
v_sub_u32 v220, v220, v222
v_mfma_f32_16x16x32_bf16 v[184:187], v[200:203], a[168:171], v[184:187]
v_mul_u32_u24 v222, 11, v220
v_lshrrev_b32 v222, 5, v222
v_mfma_f32_16x16x32_bf16 v[188:191], v[200:203], a[172:175], v[188:191]
s_waitcnt lgkmcnt(6)
v_mul_u32_u24 v222, 12, v222
v_mfma_f32_16x16x32_bf16 v[160:163], v[204:207], a[176:179], v[160:163]
s_add_u32 m0, s49, 118784
ds_read_b64_tr_b16 v[200:201], v228 offset:57344
ds_read_b64_tr_b16 v[202:203], v228 offset:57856
v_mfma_f32_16x16x32_bf16 v[164:167], v[204:207], a[180:183], v[164:167]
s_add_u32 s50, s81, 20480
buffer_load_dwordx4 v237, s[28:31], s50 offen sc1 lds
v_lshlrev_b32 v220, 4, v220
v_mfma_f32_16x16x32_bf16 v[168:171], v[204:207], a[184:187], v[168:171]
v_sub_u32 v220, v220, v222
v_add_u32 v221, s77, v221
v_mfma_f32_16x16x32_bf16 v[172:175], v[204:207], a[188:191], v[172:175]
s_waitcnt lgkmcnt(6)
v_mul_u32_u24 v222, 3456, v221
v_mfma_f32_16x16x32_bf16 v[176:179], v[208:211], a[176:179], v[176:179]
s_waitcnt vmcnt(13)
ds_read_b64_tr_b16 v[204:205], v228 offset:61440
ds_read_b64_tr_b16 v[206:207], v228 offset:61952
v_mfma_f32_16x16x32_bf16 v[180:183], v[208:211], a[180:183], v[180:183]
v_add_u32 v228, 65536, v228
v_cmp_gt_u32 vcc, 1, v246
v_mfma_f32_16x16x32_bf16 v[184:187], v[208:211], a[184:187], v[184:187]
s_cbranch_vccnz spin_10_v1
ok_9_v1:
v_mfma_f32_16x16x32_bf16 v[188:191], v[208:211], a[188:191], v[188:191]
s_waitcnt lgkmcnt(6)
v_add_u32 v243, v222, v220
v_lshrrev_b32 v220, 4, v237
v_mfma_f32_16x16x32_bf16 v[160:163], v[192:195], a[192:195], v[160:163]
s_add_u32 m0, s49, 122880
ds_read_b64_tr_b16 v[208:209], v228 offset:0
ds_read_b64_tr_b16 v[210:211], v228 offset:512
v_mfma_f32_16x16x32_bf16 v[164:167], v[192:195], a[196:199], v[164:167]
s_add_u32 s50, s81, 24576
buffer_load_dwordx4 v237, s[28:31], s50 offen sc1 lds
v_add_u32 v220, s80, v220
v_mfma_f32_16x16x32_bf16 v[168:171], v[192:195], a[200:203], v[168:171]
s_add_u32 m0, s49, 126976
v_add_u32 v220, 768, v220
v_mul_u32_u24 v221, 5042, v220
v_mfma_f32_16x16x32_bf16 v[172:175], v[192:195], a[204:207], v[172:175]
s_waitcnt lgkmcnt(6)
v_lshrrev_b32 v221, 16, v221
v_mul_u32_u24 v222, 13, v221
v_mfma_f32_16x16x32_bf16 v[176:179], v[196:199], a[192:195], v[176:179]
s_add_u32 s50, s81, 28672
ds_read_b64_tr_b16 v[192:193], v228 offset:4096
ds_read_b64_tr_b16 v[194:195], v228 offset:4608
v_mfma_f32_16x16x32_bf16 v[180:183], v[196:199], a[196:199], v[180:183]
buffer_load_dwordx4 v237, s[28:31], s50 offen sc1 lds
v_sub_u32 v220, v220, v222
v_mfma_f32_16x16x32_bf16 v[184:187], v[196:199], a[200:203], v[184:187]
s_add_u32 m0, s49, 131072
v_mul_u32_u24 v222, 11, v220
v_lshrrev_b32 v222, 5, v222
v_mfma_f32_16x16x32_bf16 v[188:191], v[196:199], a[204:207], v[188:191]
s_waitcnt lgkmcnt(6)
v_mul_u32_u24 v222, 12, v222
v_lshlrev_b32 v220, 4, v220
v_mfma_f32_16x16x32_bf16 v[160:163], v[200:203], a[208:211], v[160:163]
s_add_u32 s50, s81, 32768
ds_read_b64_tr_b16 v[196:197], v228 offset:8192
ds_read_b64_tr_b16 v[198:199], v228 offset:8704
v_mfma_f32_16x16x32_bf16 v[164:167], v[200:203], a[212:215], v[164:167]
buffer_load_dwordx4 v237, s[28:31], s50 offen sc1 lds
v_sub_u32 v220, v220, v222
v_mfma_f32_16x16x32_bf16 v[168:171], v[200:203], a[216:219], v[168:171]
v_add_u32 v221, s77, v221
v_mul_u32_u24 v222, 3456, v221
v_mfma_f32_16x16x32_bf16 v[172:175], v[200:203], a[220:223], v[172:175]
s_waitcnt lgkmcnt(6)
v_add_u32 v247, v222, v220
v_mfma_f32_16x16x32_bf16 v[176:179], v[204:207], a[208:211], v[176:179]
s_add_u32 m0, s49, 135168
ds_read_b64_tr_b16 v[200:201], v228 offset:12288
ds_read_b64_tr_b16 v[202:203], v228 offset:12800
v_mfma_f32_16x16x32_bf16 v[180:183], v[204:207], a[212:215], v[180:183]
s_add_u32 s50, s81, 36864
buffer_load_dwordx4 v237, s[28:31], s50 offen sc1 lds
v_mfma_f32_16x16x32_bf16 v[184:187], v[204:207], a[216:219], v[184:187]
s_add_u32 s8, s76, 1
v_mfma_f32_16x16x32_bf16 v[188:191], v[204:207], a[220:223], v[188:191]
s_waitcnt lgkmcnt(6)
v_mfma_f32_16x16x32_bf16 v[160:163], v[208:211], a[224:227], v[160:163]
s_add_u32 m0, s49, 139264
ds_read_b64_tr_b16 v[204:205], v228 offset:16384
ds_read_b64_tr_b16 v[206:207], v228 offset:16896
v_mfma_f32_16x16x32_bf16 v[164:167], v[208:211], a[228:231], v[164:167]
s_add_u32 s50, s81, 40960
buffer_load_dwordx4 v237, s[28:31], s50 offen sc1 lds
s_and_b32 s8, s8, 3
v_mfma_f32_16x16x32_bf16 v[168:171], v[208:211], a[232:235], v[168:171]
s_mul_i32 s8, s8, 7680
v_mfma_f32_16x16x32_bf16 v[172:175], v[208:211], a[236:239], v[172:175]
s_waitcnt lgkmcnt(6)
v_mfma_f32_16x16x32_bf16 v[176:179], v[192:195], a[224:227], v[176:179]
s_add_u32 m0, s49, 143360
ds_read_b64_tr_b16 v[208:209], v228 offset:20480
ds_read_b64_tr_b16 v[210:211], v228 offset:20992
v_mfma_f32_16x16x32_bf16 v[180:183], v[192:195], a[228:231], v[180:183]
s_add_u32 s50, s81, 45056
buffer_load_dwordx4 v237, s[28:31], s50 offen sc1 lds
s_add_u32 s8, s8, s92
v_mfma_f32_16x16x32_bf16 v[184:187], v[192:195], a[232:235], v[184:187]
s_add_u32 s8, s8, 0
s_add_u32 s9, s76, 2
s_and_b32 s9, s9, 3
v_mfma_f32_16x16x32_bf16 v[188:191], v[192:195], a[236:239], v[188:191]
s_waitcnt lgkmcnt(6)
s_mul_i32 s9, s9, 7680
s_add_u32 s9, s9, s92
v_mfma_f32_16x16x32_bf16 v[160:163], v[196:199], a[240:243], v[160:163]
s_add_u32 m0, s49, 147456
ds_read_b64_tr_b16 v[192:193], v228 offset:24576
ds_read_b64_tr_b16 v[194:195], v228 offset:25088
v_mfma_f32_16x16x32_bf16 v[164:167], v[196:199], a[244:247], v[164:167]
s_add_u32 s50, s81, 49152
buffer_load_dwordx4 v237, s[28:31], s50 offen sc1 lds
s_add_u32 s9, s9, 2560
v_mfma_f32_16x16x32_bf16 v[168:171], v[196:199], a[248:251], v[168:171]
s_add_u32 s10, s76, 3
s_and_b32 s10, s10, 3
s_mul_i32 s10, s10, 7680
v_mfma_f32_16x16x32_bf16 v[172:175], v[196:199], a[252:255], v[172:175]
s_waitcnt lgkmcnt(6)
s_add_u32 s10, s10, s92
s_add_u32 s10, s10, 5120
v_mfma_f32_16x16x32_bf16 v[176:179], v[200:203], a[240:243], v[176:179]
s_add_u32 m0, s49, 151552
ds_read_b64_tr_b16 v[196:197], v228 offset:28672
ds_read_b64_tr_b16 v[198:199], v228 offset:29184
v_mfma_f32_16x16x32_bf16 v[180:183], v[200:203], a[244:247], v[180:183]
s_add_u32 s50, s81, 53248
buffer_load_dwordx4 v237, s[28:31], s50 offen sc1 lds
v_mfma_f32_16x16x32_bf16 v[184:187], v[200:203], a[248:251], v[184:187]
v_mfma_f32_16x16x32_bf16 v[188:191], v[200:203], a[252:255], v[188:191]
s_waitcnt lgkmcnt(6)
v_mfma_f32_16x16x32_bf16 v[160:163], v[204:207], v[0:3], v[160:163]
ds_read_b64_tr_b16 v[200:201], v229 offset:24576
ds_read_b64_tr_b16 v[202:203], v229 offset:25088
v_mfma_f32_16x16x32_bf16 v[164:167], v[204:207], v[4:7], v[164:167]
buffer_load_dword v246, v234, s[28:31], 0 offen sc1
v_mfma_f32_16x16x32_bf16 v[168:171], v[204:207], v[8:11], v[168:171]
v_mfma_f32_16x16x32_bf16 v[172:175], v[204:207], v[12:15], v[172:175]
s_waitcnt lgkmcnt(6)
v_mfma_f32_16x16x32_bf16 v[176:179], v[208:211], v[0:3], v[176:179]
s_add_u32 s52, s79, 98304
ds_read_b64_tr_b16 v[204:205], v229 offset:28672
ds_read_b64_tr_b16 v[206:207], v229 offset:29184
v_mfma_f32_16x16x32_bf16 v[180:183], v[208:211], v[4:7], v[180:183]
buffer_load_dwordx4 a[80:83], v237, s[28:31], s52 offen offset:0 sc1
v_mfma_f32_16x16x32_bf16 v[184:187], v[208:211], v[8:11], v[184:187]
v_mfma_f32_16x16x32_bf16 v[188:191], v[208:211], v[12:15], v[188:191]
s_waitcnt lgkmcnt(6)
v_mfma_f32_16x16x32_bf16 v[160:163], v[192:195], v[16:19], v[160:163]
ds_read_b64_tr_b16 v[208:209], v229 offset:32768
ds_read_b64_tr_b16 v[210:211], v229 offset:33280
v_mfma_f32_16x16x32_bf16 v[164:167], v[192:195], v[20:23], v[164:167]
buffer_load_dwordx4 a[84:87], v237, s[28:31], s52 offen offset:1024 sc1
v_mfma_f32_16x16x32_bf16 v[168:171], v[192:195], v[24:27], v[168:171]
v_mfma_f32_16x16x32_bf16 v[172:175], v[192:195], v[28:31], v[172:175]
s_waitcnt lgkmcnt(6)
v_mfma_f32_16x16x32_bf16 v[176:179], v[196:199], v[16:19], v[176:179]
ds_read_b64_tr_b16 v[192:193], v229 offset:36864
ds_read_b64_tr_b16 v[194:195], v229 offset:37376
v_mfma_f32_16x16x32_bf16 v[180:183], v[196:199], v[20:23], v[180:183]
v_mfma_f32_16x16x32_bf16 v[184:187], v[196:199], v[24:27], v[184:187]
v_mfma_f32_16x16x32_bf16 v[188:191], v[196:199], v[28:31], v[188:191]
s_waitcnt lgkmcnt(6)
v_mfma_f32_16x16x32_bf16 v[96:99], v[200:203], a[144:147], v[96:99]
ds_read_b64_tr_b16 v[196:197], v229 offset:40960
ds_read_b64_tr_b16 v[198:199], v229 offset:41472
v_mfma_f32_16x16x32_bf16 v[100:103], v[200:203], a[148:151], v[100:103]
buffer_load_dwordx4 a[88:91], v237, s[28:31], s52 offen offset:2048 sc1
v_mfma_f32_16x16x32_bf16 v[104:107], v[200:203], a[152:155], v[104:107]
v_mfma_f32_16x16x32_bf16 v[108:111], v[200:203], a[156:159], v[108:111]
s_waitcnt lgkmcnt(6)
v_mfma_f32_16x16x32_bf16 v[112:115], v[204:207], a[144:147], v[112:115]
ds_read_b64_tr_b16 v[200:201], v229 offset:45056
ds_read_b64_tr_b16 v[202:203], v229 offset:45568
v_mfma_f32_16x16x32_bf16 v[116:119], v[204:207], a[148:151], v[116:119]
buffer_load_dwordx4 a[92:95], v237, s[28:31], s52 offen offset:3072 sc1
v_mfma_f32_16x16x32_bf16 v[120:123], v[204:207], a[152:155], v[120:123]
v_mfma_f32_16x16x32_bf16 v[124:127], v[204:207], a[156:159], v[124:127]
s_waitcnt lgkmcnt(6)
v_mfma_f32_16x16x32_bf16 v[96:99], v[208:211], a[160:163], v[96:99]
s_add_u32 m0, s49, 155648
ds_read_b64_tr_b16 v[204:205], v229 offset:49152
ds_read_b64_tr_b16 v[206:207], v229 offset:49664
v_mfma_f32_16x16x32_bf16 v[100:103], v[208:211], a[164:167], v[100:103]
s_add_u32 s50, s81, 57344
buffer_load_dwordx4 v237, s[28:31], s50 offen sc1 lds
v_mul_f32 v160, s96, v160
v_mfma_f32_16x16x32_bf16 v[104:107], v[208:211], a[168:171], v[104:107]
v_mul_f32 v161, s96, v161
v_mul_f32 v162, s96, v162
v_mfma_f32_16x16x32_bf16 v[108:111], v[208:211], a[172:175], v[108:111]
s_waitcnt lgkmcnt(6)
v_mul_f32 v163, s96, v163
v_mfma_f32_16x16x32_bf16 v[112:115], v[192:195], a[160:163], v[112:115]
s_add_u32 m0, s49, 159744
ds_read_b64_tr_b16 v[208:209], v229 offset:53248
ds_read_b64_tr_b16 v[210:211], v229 offset:53760
v_mfma_f32_16x16x32_bf16 v[116:119], v[192:195], a[164:167], v[116:119]
s_add_u32 s50, s81, 61440
v_exp_f32 v160, v160
v_mfma_f32_16x16x32_bf16 v[120:123], v[192:195], a[168:171], v[120:123]
v_exp_f32 v161, v161
v_mfma_f32_16x16x32_bf16 v[124:127], v[192:195], a[172:175], v[124:127]
s_waitcnt lgkmcnt(6)
buffer_load_dwordx4 v237, s[28:31], s50 offen sc1 lds
v_mfma_f32_16x16x32_bf16 v[96:99], v[196:199], a[176:179], v[96:99]
s_add_u32 s52, s79, 4096
ds_read_b64_tr_b16 v[192:193], v229 offset:57344
ds_read_b64_tr_b16 v[194:195], v229 offset:57856
v_mfma_f32_16x16x32_bf16 v[100:103], v[196:199], a[180:183], v[100:103]
TCH_6_v1:
s_cbranch_execz TCH_10_v1
v_exp_f32 v162, v162
v_mfma_f32_16x16x32_bf16 v[104:107], v[196:199], a[184:187], v[104:107]
buffer_load_dwordx4 a[96:99], v237, s[28:31], s52 offen offset:0 sc1
v_mfma_f32_16x16x32_bf16 v[108:111], v[196:199], a[188:191], v[108:111]
s_waitcnt lgkmcnt(6)
v_mfma_f32_16x16x32_bf16 v[112:115], v[200:203], a[176:179], v[112:115]
ds_read_b64_tr_b16 v[196:197], v229 offset:61440
ds_read_b64_tr_b16 v[198:199], v229 offset:61952
v_mfma_f32_16x16x32_bf16 v[116:119], v[200:203], a[180:183], v[116:119]
v_add_u32 v229, 65536, v229
v_mfma_f32_16x16x32_bf16 v[120:123], v[200:203], a[184:187], v[120:123]
v_exp_f32 v163, v163
v_mfma_f32_16x16x32_bf16 v[124:127], v[200:203], a[188:191], v[124:127]
s_waitcnt lgkmcnt(6)
v_add_f32 v160, 1.0, v160
v_mfma_f32_16x16x32_bf16 v[96:99], v[204:207], a[192:195], v[96:99]
ds_read_b64_tr_b16 v[200:201], v229 offset:0
ds_read_b64_tr_b16 v[202:203], v229 offset:512
v_mfma_f32_16x16x32_bf16 v[100:103], v[204:207], a[196:199], v[100:103]
buffer_load_dwordx4 a[100:103], v237, s[28:31], s52 offen offset:1024 sc1
v_add_f32 v161, 1.0, v161
v_mfma_f32_16x16x32_bf16 v[104:107], v[204:207], a[200:203], v[104:107]
v_add_f32 v162, 1.0, v162
v_add_f32 v163, 1.0, v163
v_mfma_f32_16x16x32_bf16 v[108:111], v[204:207], a[204:207], v[108:111]
s_waitcnt lgkmcnt(6)
v_mul_f32 v164, s96, v164
v_mul_f32 v165, s96, v165
v_mfma_f32_16x16x32_bf16 v[112:115], v[208:211], a[192:195], v[112:115]
ds_read_b64_tr_b16 v[204:205], v229 offset:4096
ds_read_b64_tr_b16 v[206:207], v229 offset:4608
v_mfma_f32_16x16x32_bf16 v[116:119], v[208:211], a[196:199], v[116:119]
buffer_load_dwordx4 a[104:107], v237, s[28:31], s52 offen offset:2048 sc1
v_mul_f32 v166, s96, v166
v_mfma_f32_16x16x32_bf16 v[120:123], v[208:211], a[200:203], v[120:123]
v_rcp_f32 v160, v160
v_mfma_f32_16x16x32_bf16 v[124:127], v[208:211], a[204:207], v[124:127]
s_waitcnt lgkmcnt(6)
v_rcp_f32 v161, v161
v_mfma_f32_16x16x32_bf16 v[96:99], v[192:195], a[208:211], v[96:99]
ds_read_b64_tr_b16 v[208:209], v229 offset:8192
ds_read_b64_tr_b16 v[210:211], v229 offset:8704
v_mfma_f32_16x16x32_bf16 v[100:103], v[192:195], a[212:215], v[100:103]
buffer_load_dwordx4 a[108:111], v237, s[28:31], s52 offen offset:3072 sc1
v_mul_f32 v167, s96, v167
v_mfma_f32_16x16x32_bf16 v[104:107], v[192:195], a[216:219], v[104:107]
v_exp_f32 v164, v164
v_mfma_f32_16x16x32_bf16 v[108:111], v[192:195], a[220:223], v[108:111]
s_waitcnt lgkmcnt(6)
v_exp_f32 v165, v165
v_mfma_f32_16x16x32_bf16 v[112:115], v[196:199], a[208:211], v[112:115]
s_add_u32 s52, s79, 12288
ds_read_b64_tr_b16 v[192:193], v229 offset:12288
ds_read_b64_tr_b16 v[194:195], v229 offset:12800
v_mfma_f32_16x16x32_bf16 v[116:119], v[196:199], a[212:215], v[116:119]
v_rcp_f32 v162, v162
v_mfma_f32_16x16x32_bf16 v[120:123], v[196:199], a[216:219], v[120:123]
v_rcp_f32 v163, v163
v_mfma_f32_16x16x32_bf16 v[124:127], v[196:199], a[220:223], v[124:127]
s_waitcnt lgkmcnt(6)
buffer_load_dwordx4 a[112:115], v237, s[28:31], s52 offen offset:0 sc1
v_mul_f32 v176, v160, v176
v_mfma_f32_16x16x32_bf16 v[96:99], v[200:203], a[224:227], v[96:99]
ds_read_b64_tr_b16 v[196:197], v229 offset:16384
ds_read_b64_tr_b16 v[198:199], v229 offset:16896
v_mfma_f32_16x16x32_bf16 v[100:103], v[200:203], a[228:231], v[100:103]
buffer_load_dwordx4 a[116:119], v237, s[28:31], s52 offen offset:1024 sc1
v_mul_f32 v177, v161, v177
v_mfma_f32_16x16x32_bf16 v[104:107], v[200:203], a[232:235], v[104:107]
v_exp_f32 v166, v166
v_mfma_f32_16x16x32_bf16 v[108:111], v[200:203], a[236:239], v[108:111]
s_waitcnt lgkmcnt(6)
v_exp_f32 v167, v167
v_mfma_f32_16x16x32_bf16 v[112:115], v[204:207], a[224:227], v[112:115]
s_waitcnt vmcnt(12)
ds_read_b64_tr_b16 v[200:201], v229 offset:20480
ds_read_b64_tr_b16 v[202:203], v229 offset:20992
v_mfma_f32_16x16x32_bf16 v[116:119], v[204:207], a[228:231], v[116:119]
v_cmp_gt_u32 vcc, 1, v246
v_add_f32 v164, 1.0, v164
v_mfma_f32_16x16x32_bf16 v[120:123], v[204:207], a[232:235], v[120:123]
s_cbranch_vccnz spin_12_v1
ok_11_v1:
v_mfma_f32_16x16x32_bf16 v[124:127], v[204:207], a[236:239], v[124:127]
s_waitcnt lgkmcnt(6)
v_mul_f32 v178, v162, v178
v_mul_f32 v179, v163, v179
v_mfma_f32_16x16x32_bf16 v[96:99], v[208:211], a[240:243], v[96:99]
ds_read_b64_tr_b16 v[204:205], v229 offset:24576
ds_read_b64_tr_b16 v[206:207], v229 offset:25088
v_mfma_f32_16x16x32_bf16 v[100:103], v[208:211], a[244:247], v[100:103]
buffer_load_dwordx4 a[120:123], v237, s[28:31], s52 offen offset:2048 sc1
v_cvt_pk_bf16_f32 v212, v176, v177
v_mfma_f32_16x16x32_bf16 v[104:107], v[208:211], a[248:251], v[104:107]
v_add_f32 v165, 1.0, v165
v_add_f32 v166, 1.0, v166
v_mfma_f32_16x16x32_bf16 v[108:111], v[208:211], a[252:255], v[108:111]
s_waitcnt lgkmcnt(6)
v_add_f32 v167, 1.0, v167
v_cvt_pk_bf16_f32 v213, v178, v179
v_mfma_f32_16x16x32_bf16 v[112:115], v[192:195], a[240:243], v[112:115]
ds_read_b64_tr_b16 v[208:209], v229 offset:28672
ds_read_b64_tr_b16 v[210:211], v229 offset:29184
v_mfma_f32_16x16x32_bf16 v[116:119], v[192:195], a[244:247], v[116:119]
buffer_load_dwordx4 a[124:127], v237, s[28:31], s52 offen offset:3072 sc1
v_mul_f32 v168, s96, v168
v_mfma_f32_16x16x32_bf16 v[120:123], v[192:195], a[248:251], v[120:123]
v_mul_f32 v169, s96, v169
v_mul_f32 v170, s96, v170
v_mfma_f32_16x16x32_bf16 v[124:127], v[192:195], a[252:255], v[124:127]
s_waitcnt lgkmcnt(6)
v_rcp_f32 v164, v164
v_mfma_f32_16x16x32_bf16 v[96:99], v[196:199], v[0:3], v[96:99]
s_add_u32 m0, s49, 0
ds_read_b64_tr_b16 v[192:193], v230 offset:24576
ds_read_b64_tr_b16 v[194:195], v230 offset:25088
v_mfma_f32_16x16x32_bf16 v[100:103], v[196:199], v[4:7], v[100:103]
s_add_u32 s50, s84, 0
buffer_load_dwordx4 v236, s[28:31], s50 offen sc1 lds
v_mul_f32 v171, s96, v171
v_mfma_f32_16x16x32_bf16 v[104:107], v[196:199], v[8:11], v[104:107]
v_rcp_f32 v165, v165
v_mfma_f32_16x16x32_bf16 v[108:111], v[196:199], v[12:15], v[108:111]
s_waitcnt lgkmcnt(6)
v_exp_f32 v168, v168
v_mfma_f32_16x16x32_bf16 v[112:115], v[200:203], v[0:3], v[112:115]
ds_read_b64_tr_b16 v[196:197], v230 offset:28672
ds_read_b64_tr_b16 v[198:199], v230 offset:29184
v_mfma_f32_16x16x32_bf16 v[116:119], v[200:203], v[4:7], v[116:119]
v_rcp_f32 v166, v166
v_mfma_f32_16x16x32_bf16 v[120:123], v[200:203], v[8:11], v[120:123]
v_rcp_f32 v167, v167
v_mfma_f32_16x16x32_bf16 v[124:127], v[200:203], v[12:15], v[124:127]
s_waitcnt lgkmcnt(6)
v_exp_f32 v169, v169
v_mfma_f32_16x16x32_bf16 v[96:99], v[204:207], v[16:19], v[96:99]
s_add_u32 m0, s49, 4096
ds_read_b64_tr_b16 v[200:201], v230 offset:32768
ds_read_b64_tr_b16 v[202:203], v230 offset:33280
v_mfma_f32_16x16x32_bf16 v[100:103], v[204:207], v[20:23], v[100:103]
s_add_u32 s50, s84, 0
buffer_load_dwordx4 v238, s[28:31], s50 offen sc1 lds
v_mul_f32 v180, v164, v180
v_mfma_f32_16x16x32_bf16 v[104:107], v[204:207], v[24:27], v[104:107]
v_mul_f32 v181, v165, v181
v_mul_f32 v182, v166, v182
v_mfma_f32_16x16x32_bf16 v[108:111], v[204:207], v[28:31], v[108:111]
s_waitcnt lgkmcnt(6)
v_exp_f32 v170, v170
v_mfma_f32_16x16x32_bf16 v[112:115], v[208:211], v[16:19], v[112:115]
ds_read_b64_tr_b16 v[204:205], v230 offset:36864
ds_read_b64_tr_b16 v[206:207], v230 offset:37376
v_mfma_f32_16x16x32_bf16 v[116:119], v[208:211], v[20:23], v[116:119]
v_exp_f32 v171, v171
v_mfma_f32_16x16x32_bf16 v[120:123], v[208:211], v[24:27], v[120:123]
v_mul_f32 v183, v167, v183
v_cvt_pk_bf16_f32 v216, v180, v181
v_mfma_f32_16x16x32_bf16 v[124:127], v[208:211], v[28:31], v[124:127]
s_waitcnt lgkmcnt(6)
v_add_f32 v168, 1.0, v168
v_add_f32 v169, 1.0, v169
v_mfma_f32_16x16x32_bf16 v[128:131], v[192:195], a[144:147], v[128:131]
s_add_u32 m0, s49, 8192
ds_read_b64_tr_b16 v[208:209], v230 offset:40960
ds_read_b64_tr_b16 v[210:211], v230 offset:41472
v_mfma_f32_16x16x32_bf16 v[132:135], v[192:195], a[148:151], v[132:135]
s_add_u32 s50, s84, 0
buffer_load_dwordx4 v243, s[28:31], s50 offen sc1 lds
v_add_f32 v170, 1.0, v170
v_mfma_f32_16x16x32_bf16 v[136:139], v[192:195], a[152:155], v[136:139]
v_cvt_pk_bf16_f32 v217, v182, v183
v_mul_f32 v172, s96, v172
v_mfma_f32_16x16x32_bf16 v[140:143], v[192:195], a[156:159], v[140:143]
s_waitcnt lgkmcnt(6)
v_mul_f32 v173, s96, v173
v_add_f32 v171, 1.0, v171
v_mfma_f32_16x16x32_bf16 v[144:147], v[196:199], a[144:147], v[144:147]
ds_read_b64_tr_b16 v[192:193], v230 offset:45056
ds_read_b64_tr_b16 v[194:195], v230 offset:45568
v_mfma_f32_16x16x32_bf16 v[148:151], v[196:199], a[148:151], v[148:151]
v_rcp_f32 v168, v168
v_mfma_f32_16x16x32_bf16 v[152:155], v[196:199], a[152:155], v[152:155]
v_mul_f32 v174, s96, v174
v_mul_f32 v175, s96, v175
v_mfma_f32_16x16x32_bf16 v[156:159], v[196:199], a[156:159], v[156:159]
s_waitcnt lgkmcnt(6)
v_exp_f32 v172, v172
v_mfma_f32_16x16x32_bf16 v[128:131], v[200:203], a[160:163], v[128:131]
s_add_u32 m0, s49, 12288
ds_read_b64_tr_b16 v[196:197], v230 offset:49152
ds_read_b64_tr_b16 v[198:199], v230 offset:49664
v_mfma_f32_16x16x32_bf16 v[132:135], v[200:203], a[164:167], v[132:135]
s_add_u32 s50, s84, 0
v_rcp_f32 v169, v169
v_mfma_f32_16x16x32_bf16 v[136:139], v[200:203], a[168:171], v[136:139]
v_rcp_f32 v170, v170
v_mfma_f32_16x16x32_bf16 v[140:143], v[200:203], a[172:175], v[140:143]
s_waitcnt lgkmcnt(6)
v_exp_f32 v173, v173
v_mfma_f32_16x16x32_bf16 v[144:147], v[204:207], a[160:163], v[144:147]
ds_read_b64_tr_b16 v[200:201], v230 offset:53248
ds_read_b64_tr_b16 v[202:203], v230 offset:53760
v_mfma_f32_16x16x32_bf16 v[148:151], v[204:207], a[164:167], v[148:151]
buffer_load_dwordx4 v247, s[28:31], s50 offen sc1 lds
v_mfma_f32_16x16x32_bf16 v[152:155], v[204:207], a[168:171], v[152:155]
v_rcp_f32 v171, v171
v_mfma_f32_16x16x32_bf16 v[156:159], v[204:207], a[172:175], v[156:159]
s_waitcnt lgkmcnt(6)
v_exp_f32 v174, v174
v_mfma_f32_16x16x32_bf16 v[128:131], v[208:211], a[176:179], v[128:131]
s_add_u32 m0, s49, 16384
ds_read_b64_tr_b16 v[204:205], v230 offset:57344
ds_read_b64_tr_b16 v[206:207], v230 offset:57856
v_mfma_f32_16x16x32_bf16 v[132:135], v[208:211], a[180:183], v[132:135]
s_add_u32 s50, s84, 4294920064
buffer_load_dwordx4 v236, s[28:31], s50 offen sc1 lds
v_mul_f32 v184, v168, v184
v_mfma_f32_16x16x32_bf16 v[136:139], v[208:211], a[184:187], v[136:139]
v_exp_f32 v175, v175
v_mfma_f32_16x16x32_bf16 v[140:143], v[208:211], a[188:191], v[140:143]
s_waitcnt lgkmcnt(6)
v_mul_f32 v185, v169, v185
v_mul_f32 v186, v170, v186
v_mfma_f32_16x16x32_bf16 v[144:147], v[192:195], a[176:179], v[144:147]
ds_read_b64_tr_b16 v[208:209], v230 offset:61440
ds_read_b64_tr_b16 v[210:211], v230 offset:61952
v_mfma_f32_16x16x32_bf16 v[148:151], v[192:195], a[180:183], v[148:151]
v_add_u32 v230, 65536, v230
v_add_f32 v172, 1.0, v172
v_mfma_f32_16x16x32_bf16 v[152:155], v[192:195], a[184:187], v[152:155]
v_add_f32 v173, 1.0, v173
v_add_f32 v174, 1.0, v174
v_mfma_f32_16x16x32_bf16 v[156:159], v[192:195], a[188:191], v[156:159]
s_waitcnt lgkmcnt(6)
v_mul_f32 v187, v171, v187
v_cvt_pk_bf16_f32 v220, v184, v185
v_mfma_f32_16x16x32_bf16 v[128:131], v[196:199], a[192:195], v[128:131]
s_add_u32 m0, s49, 20480
ds_read_b64_tr_b16 v[192:193], v230 offset:0
ds_read_b64_tr_b16 v[194:195], v230 offset:512
v_mfma_f32_16x16x32_bf16 v[132:135], v[196:199], a[196:199], v[132:135]
s_add_u32 s50, s84, 4294920064
buffer_load_dwordx4 v238, s[28:31], s50 offen sc1 lds
v_cvt_pk_bf16_f32 v221, v186, v187
v_mfma_f32_16x16x32_bf16 v[136:139], v[196:199], a[200:203], v[136:139]
v_add_f32 v175, 1.0, v175
v_mfma_f32_16x16x32_bf16 v[140:143], v[196:199], a[204:207], v[140:143]
s_waitcnt lgkmcnt(6)
v_rcp_f32 v172, v172
v_mfma_f32_16x16x32_bf16 v[144:147], v[200:203], a[192:195], v[144:147]
ds_read_b64_tr_b16 v[196:197], v230 offset:4096
ds_read_b64_tr_b16 v[198:199], v230 offset:4608
v_mfma_f32_16x16x32_bf16 v[148:151], v[200:203], a[196:199], v[148:151]
v_rcp_f32 v173, v173
v_mfma_f32_16x16x32_bf16 v[152:155], v[200:203], a[200:203], v[152:155]
v_rcp_f32 v174, v174
v_mfma_f32_16x16x32_bf16 v[156:159], v[200:203], a[204:207], v[156:159]
s_waitcnt lgkmcnt(6)
v_rcp_f32 v175, v175
v_mfma_f32_16x16x32_bf16 v[128:131], v[204:207], a[208:211], v[128:131]
ds_read_b64_tr_b16 v[200:201], v230 offset:8192
ds_read_b64_tr_b16 v[202:203], v230 offset:8704
v_mfma_f32_16x16x32_bf16 v[132:135], v[204:207], a[212:215], v[132:135]
v_mul_f32 v188, v172, v188
v_mul_f32 v189, v173, v189
v_mfma_f32_16x16x32_bf16 v[136:139], v[204:207], a[216:219], v[136:139]
v_mul_f32 v190, v174, v190
v_mul_f32 v191, v175, v191
v_mfma_f32_16x16x32_bf16 v[140:143], v[204:207], a[220:223], v[140:143]
s_waitcnt lgkmcnt(6)
v_cvt_pk_bf16_f32 v224, v188, v189
v_cvt_pk_bf16_f32 v225, v190, v191
v_mfma_f32_16x16x32_bf16 v[144:147], v[208:211], a[208:211], v[144:147]
ds_read_b64_tr_b16 v[204:205], v230 offset:12288
ds_read_b64_tr_b16 v[206:207], v230 offset:12800
v_mfma_f32_16x16x32_bf16 v[148:151], v[208:211], a[212:215], v[148:151]
v_mul_f32 v96, s96, v96
v_mul_f32 v97, s96, v97
v_mfma_f32_16x16x32_bf16 v[152:155], v[208:211], a[216:219], v[152:155]
v_mul_f32 v98, s96, v98
v_mul_f32 v99, s96, v99
v_mfma_f32_16x16x32_bf16 v[156:159], v[208:211], a[220:223], v[156:159]
s_waitcnt lgkmcnt(6)
v_exp_f32 v96, v96
v_mfma_f32_16x16x32_bf16 v[128:131], v[192:195], a[224:227], v[128:131]
ds_read_b64_tr_b16 v[208:209], v230 offset:16384
ds_read_b64_tr_b16 v[210:211], v230 offset:16896
v_mfma_f32_16x16x32_bf16 v[132:135], v[192:195], a[228:231], v[132:135]
v_exp_f32 v97, v97
v_mfma_f32_16x16x32_bf16 v[136:139], v[192:195], a[232:235], v[136:139]
v_exp_f32 v98, v98
v_mfma_f32_16x16x32_bf16 v[140:143], v[192:195], a[236:239], v[140:143]
s_waitcnt lgkmcnt(6)
v_exp_f32 v99, v99
v_mfma_f32_16x16x32_bf16 v[144:147], v[196:199], a[224:227], v[144:147]
ds_read_b64_tr_b16 v[192:193], v230 offset:20480
ds_read_b64_tr_b16 v[194:195], v230 offset:20992
v_mfma_f32_16x16x32_bf16 v[148:151], v[196:199], a[228:231], v[148:151]
v_add_f32 v96, 1.0, v96
v_add_f32 v97, 1.0, v97
v_mfma_f32_16x16x32_bf16 v[152:155], v[196:199], a[232:235], v[152:155]
v_add_f32 v98, 1.0, v98
v_add_f32 v99, 1.0, v99
v_mfma_f32_16x16x32_bf16 v[156:159], v[196:199], a[236:239], v[156:159]
s_waitcnt lgkmcnt(6)
v_rcp_f32 v96, v96
v_mfma_f32_16x16x32_bf16 v[128:131], v[200:203], a[240:243], v[128:131]
s_add_u32 s52, s79, 32768
ds_read_b64_tr_b16 v[196:197], v230 offset:24576
ds_read_b64_tr_b16 v[198:199], v230 offset:25088
v_mfma_f32_16x16x32_bf16 v[132:135], v[200:203], a[244:247], v[132:135]
buffer_load_dwordx4 v[160:163], v237, s[28:31], s52 offen offset:0 sc1
v_mul_f32 v100, s96, v100
v_mfma_f32_16x16x32_bf16 v[136:139], v[200:203], a[248:251], v[136:139]
v_mul_f32 v101, s96, v101
v_mul_f32 v102, s96, v102
v_mfma_f32_16x16x32_bf16 v[140:143], v[200:203], a[252:255], v[140:143]
s_waitcnt lgkmcnt(6)
v_rcp_f32 v97, v97
v_mfma_f32_16x16x32_bf16 v[144:147], v[204:207], a[240:243], v[144:147]
ds_read_b64_tr_b16 v[200:201], v230 offset:28672
ds_read_b64_tr_b16 v[202:203], v230 offset:29184
v_mfma_f32_16x16x32_bf16 v[148:151], v[204:207], a[244:247], v[148:151]
v_rcp_f32 v98, v98
v_mfma_f32_16x16x32_bf16 v[152:155], v[204:207], a[248:251], v[152:155]
v_rcp_f32 v99, v99
v_mfma_f32_16x16x32_bf16 v[156:159], v[204:207], a[252:255], v[156:159]
s_waitcnt lgkmcnt(6)
v_mul_f32 v103, s96, v103
v_mfma_f32_16x16x32_bf16 v[128:131], v[208:211], v[0:3], v[128:131]
ds_read_b64_tr_b16 v[204:205], v231 offset:24576
ds_read_b64_tr_b16 v[206:207], v231 offset:25088
v_mfma_f32_16x16x32_bf16 v[132:135], v[208:211], v[4:7], v[132:135]
buffer_load_dwordx4 v[164:167], v237, s[28:31], s52 offen offset:2048 sc1
v_mul_f32 v112, v96, v112
v_mfma_f32_16x16x32_bf16 v[136:139], v[208:211], v[8:11], v[136:139]
v_exp_f32 v100, v100
v_mfma_f32_16x16x32_bf16 v[140:143], v[208:211], v[12:15], v[140:143]
s_waitcnt lgkmcnt(6)
v_exp_f32 v101, v101
v_mfma_f32_16x16x32_bf16 v[144:147], v[192:195], v[0:3], v[144:147]
ds_read_b64_tr_b16 v[208:209], v231 offset:28672
ds_read_b64_tr_b16 v[210:211], v231 offset:29184
v_mfma_f32_16x16x32_bf16 v[148:151], v[192:195], v[4:7], v[148:151]
buffer_load_dwordx4 v[168:171], v237, s[28:31], s52 offen offset:1024 sc1
v_mul_f32 v113, v97, v113
v_mfma_f32_16x16x32_bf16 v[152:155], v[192:195], v[8:11], v[152:155]
v_exp_f32 v102, v102
v_mfma_f32_16x16x32_bf16 v[156:159], v[192:195], v[12:15], v[156:159]
s_waitcnt lgkmcnt(6)
v_exp_f32 v103, v103
v_mfma_f32_16x16x32_bf16 v[128:131], v[196:199], v[16:19], v[128:131]
ds_read_b64_tr_b16 v[192:193], v231 offset:32768
ds_read_b64_tr_b16 v[194:195], v231 offset:33280
v_mfma_f32_16x16x32_bf16 v[132:135], v[196:199], v[20:23], v[132:135]
v_mul_f32 v114, v98, v114
v_add_f32 v100, 1.0, v100
v_mfma_f32_16x16x32_bf16 v[136:139], v[196:199], v[24:27], v[136:139]
v_add_f32 v101, 1.0, v101
v_mul_f32 v115, v99, v115
v_mfma_f32_16x16x32_bf16 v[140:143], v[196:199], v[28:31], v[140:143]
s_waitcnt lgkmcnt(6)
v_add_f32 v102, 1.0, v102
v_add_f32 v103, 1.0, v103
v_mfma_f32_16x16x32_bf16 v[144:147], v[200:203], v[16:19], v[144:147]
s_lshl_b32 s51, s69, 10
ds_read_b64_tr_b16 v[196:197], v231 offset:36864
ds_read_b64_tr_b16 v[198:199], v231 offset:37376
v_mfma_f32_16x16x32_bf16 v[148:151], v[200:203], v[20:23], v[148:151]
s_add_u32 s51, s55, s51
v_rcp_f32 v100, v100
v_mfma_f32_16x16x32_bf16 v[152:155], v[200:203], v[24:27], v[152:155]
s_add_u32 s51, s51, 40960
v_cvt_pk_bf16_f32 v214, v112, v113
v_cvt_pk_bf16_f32 v215, v114, v115
v_mfma_f32_16x16x32_bf16 v[156:159], v[200:203], v[28:31], v[156:159]
s_waitcnt lgkmcnt(6)
buffer_store_dwordx4 v[212:215], v237, s[28:31], s51 offen offset:0 sc1
v_mul_f32 v104, s96, v104
v_mfma_f32_16x16x32_bf16 v[32:35], v[204:207], a[144:147], v[32:35]
ds_read_b64_tr_b16 v[200:201], v231 offset:40960
ds_read_b64_tr_b16 v[202:203], v231 offset:41472
v_mfma_f32_16x16x32_bf16 v[36:39], v[204:207], a[148:151], v[36:39]
buffer_load_dwordx4 v[172:175], v237, s[28:31], s52 offen offset:3072 sc1
v_mul_f32 v105, s96, v105
v_mfma_f32_16x16x32_bf16 v[40:43], v[204:207], a[152:155], v[40:43]
v_rcp_f32 v101, v101
v_mfma_f32_16x16x32_bf16 v[44:47], v[204:207], a[156:159], v[44:47]
s_waitcnt lgkmcnt(6)
v_rcp_f32 v102, v102
v_mfma_f32_16x16x32_bf16 v[48:51], v[208:211], a[144:147], v[48:51]
s_add_u32 s52, s79, 36864
ds_read_b64_tr_b16 v[204:205], v231 offset:45056
ds_read_b64_tr_b16 v[206:207], v231 offset:45568
v_mfma_f32_16x16x32_bf16 v[52:55], v[208:211], a[148:151], v[52:55]
buffer_load_dwordx4 v[176:179], v237, s[28:31], s52 offen offset:0 sc1
v_mul_f32 v106, s96, v106
v_mfma_f32_16x16x32_bf16 v[56:59], v[208:211], a[152:155], v[56:59]
v_rcp_f32 v103, v103
v_mfma_f32_16x16x32_bf16 v[60:63], v[208:211], a[156:159], v[60:63]
s_waitcnt lgkmcnt(6)
v_mul_f32 v107, s96, v107
v_mul_f32 v116, v100, v116
v_mfma_f32_16x16x32_bf16 v[32:35], v[192:195], a[160:163], v[32:35]
ds_read_b64_tr_b16 v[208:209], v231 offset:49152
ds_read_b64_tr_b16 v[210:211], v231 offset:49664
v_mfma_f32_16x16x32_bf16 v[36:39], v[192:195], a[164:167], v[36:39]
v_exp_f32 v104, v104
v_mfma_f32_16x16x32_bf16 v[40:43], v[192:195], a[168:171], v[40:43]
v_exp_f32 v105, v105
v_mfma_f32_16x16x32_bf16 v[44:47], v[192:195], a[172:175], v[44:47]
s_waitcnt lgkmcnt(6)
v_exp_f32 v106, v106
v_mfma_f32_16x16x32_bf16 v[48:51], v[196:199], a[160:163], v[48:51]
ds_read_b64_tr_b16 v[192:193], v231 offset:53248
ds_read_b64_tr_b16 v[194:195], v231 offset:53760
v_mfma_f32_16x16x32_bf16 v[52:55], v[196:199], a[164:167], v[52:55]
buffer_load_dwordx4 v[180:183], v237, s[28:31], s52 offen offset:2048 sc1
v_mul_f32 v117, v101, v117
v_mfma_f32_16x16x32_bf16 v[56:59], v[196:199], a[168:171], v[56:59]
v_mul_f32 v118, v102, v118
v_mul_f32 v119, v103, v119
v_mfma_f32_16x16x32_bf16 v[60:63], v[196:199], a[172:175], v[60:63]
s_waitcnt lgkmcnt(6)
v_exp_f32 v107, v107
v_mfma_f32_16x16x32_bf16 v[32:35], v[200:203], a[176:179], v[32:35]
s_lshl_b32 s66, s69, 10
ds_read_b64_tr_b16 v[196:197], v231 offset:57344
ds_read_b64_tr_b16 v[198:199], v231 offset:57856
v_mfma_f32_16x16x32_bf16 v[36:39], v[200:203], a[180:183], v[36:39]
s_add_u32 s66, s55, s66
v_add_f32 v104, 1.0, v104
v_add_f32 v105, 1.0, v105
v_mfma_f32_16x16x32_bf16 v[40:43], v[200:203], a[184:187], v[40:43]
s_add_u32 s66, s66, 40960
v_cvt_pk_bf16_f32 v218, v116, v117
v_cvt_pk_bf16_f32 v219, v118, v119
v_mfma_f32_16x16x32_bf16 v[44:47], v[200:203], a[188:191], v[44:47]
s_waitcnt lgkmcnt(6)
buffer_store_dwordx4 v[216:219], v237, s[28:31], s66 offen offset:1024 sc1
v_add_f32 v106, 1.0, v106
v_mfma_f32_16x16x32_bf16 v[48:51], v[204:207], a[176:179], v[48:51]
ds_read_b64_tr_b16 v[200:201], v231 offset:61440
ds_read_b64_tr_b16 v[202:203], v231 offset:61952
v_mfma_f32_16x16x32_bf16 v[52:55], v[204:207], a[180:183], v[52:55]
v_add_u32 v231, 65536, v231
v_add_f32 v107, 1.0, v107
v_mfma_f32_16x16x32_bf16 v[56:59], v[204:207], a[184:187], v[56:59]
buffer_load_dwordx4 v[184:187], v237, s[28:31], s52 offen offset:1024 sc1
v_mul_f32 v108, s96, v108
v_mfma_f32_16x16x32_bf16 v[60:63], v[204:207], a[188:191], v[60:63]
s_waitcnt lgkmcnt(6)
v_mul_f32 v109, s96, v109
v_mul_f32 v110, s96, v110
v_mfma_f32_16x16x32_bf16 v[32:35], v[208:211], a[192:195], v[32:35]
ds_read_b64_tr_b16 v[204:205], v231 offset:0
ds_read_b64_tr_b16 v[206:207], v231 offset:512
v_mfma_f32_16x16x32_bf16 v[36:39], v[208:211], a[196:199], v[36:39]
buffer_load_dwordx4 v[188:191], v237, s[28:31], s52 offen offset:3072 sc1
v_mul_f32 v111, s96, v111
v_mfma_f32_16x16x32_bf16 v[40:43], v[208:211], a[200:203], v[40:43]
v_rcp_f32 v104, v104
v_mfma_f32_16x16x32_bf16 v[44:47], v[208:211], a[204:207], v[44:47]
s_waitcnt lgkmcnt(6)
v_rcp_f32 v105, v105
v_mfma_f32_16x16x32_bf16 v[48:51], v[192:195], a[192:195], v[48:51]
ds_read_b64_tr_b16 v[208:209], v231 offset:4096
ds_read_b64_tr_b16 v[210:211], v231 offset:4608
v_mfma_f32_16x16x32_bf16 v[52:55], v[192:195], a[196:199], v[52:55]
v_exp_f32 v108, v108
v_mfma_f32_16x16x32_bf16 v[56:59], v[192:195], a[200:203], v[56:59]
v_rcp_f32 v106, v106
v_mfma_f32_16x16x32_bf16 v[60:63], v[192:195], a[204:207], v[60:63]
s_waitcnt lgkmcnt(6)
v_exp_f32 v109, v109
v_mfma_f32_16x16x32_bf16 v[32:35], v[196:199], a[208:211], v[32:35]
ds_read_b64_tr_b16 v[192:193], v231 offset:8192
ds_read_b64_tr_b16 v[194:195], v231 offset:8704
v_mfma_f32_16x16x32_bf16 v[36:39], v[196:199], a[212:215], v[36:39]
v_exp_f32 v110, v110
v_mfma_f32_16x16x32_bf16 v[40:43], v[196:199], a[216:219], v[40:43]
v_rcp_f32 v107, v107
v_mfma_f32_16x16x32_bf16 v[44:47], v[196:199], a[220:223], v[44:47]
s_waitcnt lgkmcnt(6)
v_mul_f32 v120, v104, v120
v_mul_f32 v121, v105, v121
v_mfma_f32_16x16x32_bf16 v[48:51], v[200:203], a[208:211], v[48:51]
s_add_u32 s52, s79, 20480
ds_read_b64_tr_b16 v[196:197], v231 offset:12288
ds_read_b64_tr_b16 v[198:199], v231 offset:12800
v_mfma_f32_16x16x32_bf16 v[52:55], v[200:203], a[212:215], v[52:55]
buffer_load_dwordx4 a[128:131], v237, s[28:31], s52 offen offset:0 sc1
v_mul_f32 v122, v106, v122
v_mfma_f32_16x16x32_bf16 v[56:59], v[200:203], a[216:219], v[56:59]
v_exp_f32 v111, v111
v_mfma_f32_16x16x32_bf16 v[60:63], v[200:203], a[220:223], v[60:63]
s_waitcnt lgkmcnt(6)
v_mul_f32 v123, v107, v123
v_add_f32 v108, 1.0, v108
v_mfma_f32_16x16x32_bf16 v[32:35], v[204:207], a[224:227], v[32:35]
s_lshl_b32 s51, s69, 10
ds_read_b64_tr_b16 v[200:201], v231 offset:16384
ds_read_b64_tr_b16 v[202:203], v231 offset:16896
v_mfma_f32_16x16x32_bf16 v[36:39], v[204:207], a[228:231], v[36:39]
s_sub_u32 s51, s55, s51
buffer_load_dwordx4 a[132:135], v237, s[28:31], s52 offen offset:1024 sc1
v_add_f32 v109, 1.0, v109
v_mfma_f32_16x16x32_bf16 v[40:43], v[204:207], a[232:235], v[40:43]
s_add_u32 s51, s51, 40960
v_add_f32 v110, 1.0, v110
v_add_f32 v111, 1.0, v111
v_mfma_f32_16x16x32_bf16 v[44:47], v[204:207], a[236:239], v[44:47]
s_waitcnt lgkmcnt(6)
v_cvt_pk_bf16_f32 v222, v120, v121
v_cvt_pk_bf16_f32 v223, v122, v123
v_mfma_f32_16x16x32_bf16 v[48:51], v[208:211], a[224:227], v[48:51]
ds_read_b64_tr_b16 v[204:205], v231 offset:20480
ds_read_b64_tr_b16 v[206:207], v231 offset:20992
v_mfma_f32_16x16x32_bf16 v[52:55], v[208:211], a[228:231], v[52:55]
buffer_store_dwordx4 v[220:223], v237, s[28:31], s51 offen offset:2048 sc1
v_mfma_f32_16x16x32_bf16 v[56:59], v[208:211], a[232:235], v[56:59]
v_rcp_f32 v108, v108
v_mfma_f32_16x16x32_bf16 v[60:63], v[208:211], a[236:239], v[60:63]
s_waitcnt lgkmcnt(6)
v_rcp_f32 v109, v109
v_mfma_f32_16x16x32_bf16 v[32:35], v[192:195], a[240:243], v[32:35]
s_add_u32 s11, s97, 32768
ds_read_b64_tr_b16 v[208:209], v231 offset:24576
ds_read_b64_tr_b16 v[210:211], v231 offset:25088
v_mfma_f32_16x16x32_bf16 v[36:39], v[192:195], a[244:247], v[36:39]
v_rcp_f32 v110, v110
v_mfma_f32_16x16x32_bf16 v[40:43], v[192:195], a[248:251], v[40:43]
v_rcp_f32 v111, v111
v_mfma_f32_16x16x32_bf16 v[44:47], v[192:195], a[252:255], v[44:47]
s_waitcnt lgkmcnt(6)
v_mul_f32 v124, v108, v124
v_mul_f32 v125, v109, v125
v_mfma_f32_16x16x32_bf16 v[48:51], v[196:199], a[240:243], v[48:51]
ds_read_b64_tr_b16 v[192:193], v231 offset:28672
ds_read_b64_tr_b16 v[194:195], v231 offset:29184
v_mfma_f32_16x16x32_bf16 v[52:55], v[196:199], a[244:247], v[52:55]
buffer_load_dwordx4 a[136:139], v237, s[28:31], s52 offen offset:2048 sc1
v_mul_f32 v126, v110, v126
v_mfma_f32_16x16x32_bf16 v[56:59], v[196:199], a[248:251], v[56:59]
s_waitcnt vmcnt(44)
s_barrier
v_mfma_f32_16x16x32_bf16 v[60:63], v[196:199], a[252:255], v[60:63]
s_waitcnt lgkmcnt(6)
v_mul_f32 v127, v111, v127
v_mul_f32 v128, s96, v128
v_mfma_f32_16x16x32_bf16 v[32:35], v[200:203], v[0:3], v[32:35]
s_lshl_b32 s66, s69, 10
ds_read_b64_tr_b16 v[196:197], v239 offset:0
ds_read_b64_tr_b16 v[198:199], v239 offset:256
v_mfma_f32_16x16x32_bf16 v[36:39], v[200:203], v[4:7], v[36:39]
s_sub_u32 s66, s55, s66
buffer_load_dwordx4 a[140:143], v237, s[28:31], s52 offen offset:3072 sc1
v_mul_f32 v129, s96, v129
v_mfma_f32_16x16x32_bf16 v[40:43], v[200:203], v[8:11], v[40:43]
s_add_u32 s66, s66, 40960
v_cvt_pk_bf16_f32 v226, v124, v125
v_cvt_pk_bf16_f32 v227, v126, v127
v_mfma_f32_16x16x32_bf16 v[44:47], v[200:203], v[12:15], v[44:47]
s_waitcnt lgkmcnt(6)
buffer_store_dwordx4 v[224:227], v237, s[28:31], s66 offen offset:3072 sc1
v_mul_f32 v130, s96, v130
v_mfma_f32_16x16x32_bf16 v[48:51], v[204:207], v[0:3], v[48:51]
s_add_u32 s52, s79, 28672
ds_read_b64_tr_b16 v[200:201], v239 offset:1024
ds_read_b64_tr_b16 v[202:203], v239 offset:1280
v_mfma_f32_16x16x32_bf16 v[52:55], v[204:207], v[4:7], v[52:55]
buffer_load_dwordx4 a[144:147], v237, s[28:31], s52 offen offset:0 sc1
v_mul_f32 v131, s96, v131
v_mfma_f32_16x16x32_bf16 v[56:59], v[204:207], v[8:11], v[56:59]
v_exp_f32 v128, v128
v_mfma_f32_16x16x32_bf16 v[60:63], v[204:207], v[12:15], v[60:63]
s_waitcnt lgkmcnt(6)
v_exp_f32 v129, v129
v_mfma_f32_16x16x32_bf16 v[32:35], v[208:211], v[16:19], v[32:35]
ds_read_b64_tr_b16 v[204:205], v239 offset:2048
ds_read_b64_tr_b16 v[206:207], v239 offset:2304
v_mfma_f32_16x16x32_bf16 v[36:39], v[208:211], v[20:23], v[36:39]
v_exp_f32 v130, v130
v_mfma_f32_16x16x32_bf16 v[40:43], v[208:211], v[24:27], v[40:43]
v_exp_f32 v131, v131
v_mfma_f32_16x16x32_bf16 v[44:47], v[208:211], v[28:31], v[44:47]
s_waitcnt lgkmcnt(6)
v_add_f32 v128, 1.0, v128
v_add_f32 v129, 1.0, v129
v_mfma_f32_16x16x32_bf16 v[48:51], v[192:195], v[16:19], v[48:51]
ds_read_b64_tr_b16 v[208:209], v239 offset:3072
ds_read_b64_tr_b16 v[210:211], v239 offset:3328
v_mfma_f32_16x16x32_bf16 v[52:55], v[192:195], v[20:23], v[52:55]
buffer_load_dwordx4 a[148:151], v237, s[28:31], s52 offen offset:1024 sc1
v_add_f32 v130, 1.0, v130
v_mfma_f32_16x16x32_bf16 v[56:59], v[192:195], v[24:27], v[56:59]
v_add_f32 v131, 1.0, v131
v_mul_f32 v132, s96, v132
v_mfma_f32_16x16x32_bf16 v[60:63], v[192:195], v[28:31], v[60:63]
s_waitcnt vmcnt(59) lgkmcnt(6)
v_mul_f32 v133, s96, v133
v_mul_f32 v134, s96, v134
v_mfma_f32_16x16x32_bf16 v[0:3], v[196:199], v[64:67], 0
ds_read_b64_tr_b16 v[192:193], v240 offset:4096
ds_read_b64_tr_b16 v[194:195], v240 offset:4352
v_mfma_f32_16x16x32_bf16 a[192:195], v[196:199], v[68:71], 0
buffer_load_dwordx4 a[152:155], v237, s[28:31], s52 offen offset:2048 sc1
v_mul_f32 v135, s96, v135
v_mfma_f32_16x16x32_bf16 a[196:199], v[196:199], v[72:75], 0
v_rcp_f32 v128, v128
v_mfma_f32_16x16x32_bf16 a[200:203], v[196:199], v[76:79], 0
s_waitcnt lgkmcnt(6)
v_rcp_f32 v129, v129
v_mfma_f32_16x16x32_bf16 v[4:7], v[200:203], v[64:67], 0
ds_read_b64_tr_b16 v[196:197], v239 offset:4608
ds_read_b64_tr_b16 v[198:199], v239 offset:4864
v_mfma_f32_16x16x32_bf16 a[204:207], v[200:203], v[68:71], 0
v_exp_f32 v132, v132
v_mfma_f32_16x16x32_bf16 a[208:211], v[200:203], v[72:75], 0
v_exp_f32 v133, v133
v_mfma_f32_16x16x32_bf16 a[212:215], v[200:203], v[76:79], 0
s_waitcnt lgkmcnt(6)
v_rcp_f32 v130, v130
v_mfma_f32_16x16x32_bf16 v[8:11], v[204:207], v[64:67], 0
ds_read_b64_tr_b16 v[200:201], v239 offset:5632
ds_read_b64_tr_b16 v[202:203], v239 offset:5888
v_mfma_f32_16x16x32_bf16 a[216:219], v[204:207], v[68:71], 0
buffer_load_dwordx4 a[156:159], v237, s[28:31], s52 offen offset:3072 sc1
v_mfma_f32_16x16x32_bf16 a[220:223], v[204:207], v[72:75], 0
s_add_u32 m0, s49, 24576
v_rcp_f32 v131, v131
v_mfma_f32_16x16x32_bf16 a[224:227], v[204:207], v[76:79], 0
s_waitcnt lgkmcnt(6)
v_exp_f32 v134, v134
v_mfma_f32_16x16x32_bf16 v[12:15], v[208:211], v[64:67], 0
s_add_u32 s50, s84, 4294920064
ds_read_b64_tr_b16 v[204:205], v239 offset:6656
ds_read_b64_tr_b16 v[206:207], v239 offset:6912
v_mfma_f32_16x16x32_bf16 a[228:231], v[208:211], v[68:71], 0
TCH_7_v1:
s_cbranch_execz TCH_11_v1
buffer_load_dwordx4 v243, s[28:31], s50 offen sc1 lds
v_mul_f32 v144, v128, v144
v_mfma_f32_16x16x32_bf16 a[232:235], v[208:211], v[72:75], 0
v_mul_f32 v145, v129, v145
v_mul_f32 v146, v130, v146
v_mfma_f32_16x16x32_bf16 a[236:239], v[208:211], v[76:79], 0
s_waitcnt lgkmcnt(6)
v_exp_f32 v135, v135
v_mfma_f32_16x16x32_bf16 v[16:19], v[192:195], v[64:67], 0
s_add_u32 m0, s49, 28672
ds_read_b64_tr_b16 v[208:209], v239 offset:7680
ds_read_b64_tr_b16 v[210:211], v239 offset:7936
v_mfma_f32_16x16x32_bf16 a[240:243], v[192:195], v[68:71], 0
s_add_u32 s50, s84, 4294920064
buffer_load_dwordx4 v247, s[28:31], s50 offen sc1 lds
v_add_f32 v132, 1.0, v132
v_mfma_f32_16x16x32_bf16 a[244:247], v[192:195], v[72:75], 0
v_mul_f32 v147, v131, v147
v_cvt_pk_bf16_f32 v212, v144, v145
v_mfma_f32_16x16x32_bf16 a[248:251], v[192:195], v[76:79], 0
s_waitcnt vmcnt(58) lgkmcnt(6)
v_add_f32 v133, 1.0, v133
v_add_f32 v134, 1.0, v134
v_mfma_f32_16x16x32_bf16 v[0:3], v[196:199], v[80:83], v[0:3]
s_add_u32 m0, s49, 32768
ds_read_b64_tr_b16 v[192:193], v240 offset:8704
ds_read_b64_tr_b16 v[194:195], v240 offset:8960
v_mfma_f32_16x16x32_bf16 a[192:195], v[196:199], v[84:87], a[192:195]
s_add_u32 s50, s84, 4294921216
buffer_load_dwordx4 v236, s[28:31], s50 offen sc1 lds
v_add_f32 v135, 1.0, v135
v_mfma_f32_16x16x32_bf16 a[196:199], v[196:199], v[88:91], a[196:199]
v_cvt_pk_bf16_f32 v213, v146, v147
v_mul_f32 v136, s96, v136
v_mfma_f32_16x16x32_bf16 a[200:203], v[196:199], v[92:95], a[200:203]
s_waitcnt lgkmcnt(6)
v_mul_f32 v137, s96, v137
v_mul_f32 v138, s96, v138
v_mfma_f32_16x16x32_bf16 v[4:7], v[200:203], v[80:83], v[4:7]
ds_read_b64_tr_b16 v[196:197], v239 offset:9216
ds_read_b64_tr_b16 v[198:199], v239 offset:9472
v_mfma_f32_16x16x32_bf16 a[204:207], v[200:203], v[84:87], a[204:207]
v_rcp_f32 v132, v132
v_mfma_f32_16x16x32_bf16 a[208:211], v[200:203], v[88:91], a[208:211]
v_rcp_f32 v133, v133
v_mfma_f32_16x16x32_bf16 a[212:215], v[200:203], v[92:95], a[212:215]
s_waitcnt lgkmcnt(6)
v_rcp_f32 v134, v134
v_mfma_f32_16x16x32_bf16 v[8:11], v[204:207], v[80:83], v[8:11]
s_add_u32 m0, s49, 36864
ds_read_b64_tr_b16 v[200:201], v239 offset:10240
ds_read_b64_tr_b16 v[202:203], v239 offset:10496
v_mfma_f32_16x16x32_bf16 a[216:219], v[204:207], v[84:87], a[216:219]
s_add_u32 s50, s84, 4294921216
buffer_load_dwordx4 v238, s[28:31], s50 offen sc1 lds
v_mul_f32 v139, s96, v139
v_mfma_f32_16x16x32_bf16 a[220:223], v[204:207], v[88:91], a[220:223]
v_exp_f32 v136, v136
v_mfma_f32_16x16x32_bf16 a[224:227], v[204:207], v[92:95], a[224:227]
s_waitcnt lgkmcnt(6)
v_rcp_f32 v135, v135
v_mfma_f32_16x16x32_bf16 v[12:15], v[208:211], v[80:83], v[12:15]
ds_read_b64_tr_b16 v[204:205], v239 offset:11264
ds_read_b64_tr_b16 v[206:207], v239 offset:11520
v_mfma_f32_16x16x32_bf16 a[228:231], v[208:211], v[84:87], a[228:231]
v_exp_f32 v137, v137
v_mfma_f32_16x16x32_bf16 a[232:235], v[208:211], v[88:91], a[232:235]
v_mul_f32 v148, v132, v148
v_mul_f32 v149, v133, v149
v_mfma_f32_16x16x32_bf16 a[236:239], v[208:211], v[92:95], a[236:239]
s_waitcnt lgkmcnt(6)
v_exp_f32 v138, v138
v_mfma_f32_16x16x32_bf16 v[16:19], v[192:195], v[80:83], v[16:19]
s_add_u32 m0, s49, 40960
ds_read_b64_tr_b16 v[208:209], v239 offset:12288
ds_read_b64_tr_b16 v[210:211], v239 offset:12544
v_mfma_f32_16x16x32_bf16 a[240:243], v[192:195], v[84:87], a[240:243]
s_add_u32 s50, s84, 4294921216
buffer_load_dwordx4 v243, s[28:31], s50 offen sc1 lds
v_mul_f32 v150, v134, v150
v_mfma_f32_16x16x32_bf16 a[244:247], v[192:195], v[88:91], a[244:247]
v_exp_f32 v139, v139
v_mfma_f32_16x16x32_bf16 a[248:251], v[192:195], v[92:95], a[248:251]
s_waitcnt vmcnt(63) lgkmcnt(6)
v_mul_f32 v151, v135, v151
v_cvt_pk_bf16_f32 v216, v148, v149
v_mfma_f32_16x16x32_bf16 v[0:3], v[196:199], a[0:3], v[0:3]
s_waitcnt vmcnt(9)
ds_read_b64_tr_b16 v[192:193], v240 offset:13312
ds_read_b64_tr_b16 v[194:195], v240 offset:13568
v_mfma_f32_16x16x32_bf16 a[192:195], v[196:199], a[4:7], a[192:195]
buffer_store_dword v242, off, s[28:31], s11 sc1
v_add_f32 v136, 1.0, v136
v_mfma_f32_16x16x32_bf16 a[196:199], v[196:199], a[8:11], a[196:199]
v_add_f32 v137, 1.0, v137
v_add_f32 v138, 1.0, v138
v_mfma_f32_16x16x32_bf16 a[200:203], v[196:199], a[12:15], a[200:203]
s_waitcnt lgkmcnt(6)
v_cvt_pk_bf16_f32 v217, v150, v151
v_mul_f32 v140, s96, v140
v_mfma_f32_16x16x32_bf16 v[4:7], v[200:203], a[0:3], v[4:7]
s_add_u32 m0, s49, 45056
ds_read_b64_tr_b16 v[196:197], v239 offset:13824
ds_read_b64_tr_b16 v[198:199], v239 offset:14080
v_mfma_f32_16x16x32_bf16 a[204:207], v[200:203], a[4:7], a[204:207]
s_add_u32 s50, s84, 4294921216
buffer_load_dwordx4 v247, s[28:31], s50 offen sc1 lds
v_mul_f32 v141, s96, v141
v_mfma_f32_16x16x32_bf16 a[208:211], v[200:203], a[8:11], a[208:211]
v_add_f32 v139, 1.0, v139
v_mul_f32 v142, s96, v142
v_mfma_f32_16x16x32_bf16 a[212:215], v[200:203], a[12:15], a[212:215]
s_waitcnt lgkmcnt(6)
v_rcp_f32 v136, v136
v_mfma_f32_16x16x32_bf16 v[8:11], v[204:207], a[0:3], v[8:11]
s_add_u32 s52, s79, 106496
ds_read_b64_tr_b16 v[200:201], v239 offset:14848
ds_read_b64_tr_b16 v[202:203], v239 offset:15104
v_mfma_f32_16x16x32_bf16 a[216:219], v[204:207], a[4:7], a[216:219]
buffer_load_dwordx4 v[64:67], v237, s[28:31], s52 offen offset:0 sc1
v_mul_f32 v143, s96, v143
v_mfma_f32_16x16x32_bf16 a[220:223], v[204:207], a[8:11], a[220:223]
v_exp_f32 v140, v140
v_mfma_f32_16x16x32_bf16 a[224:227], v[204:207], a[12:15], a[224:227]
s_waitcnt lgkmcnt(6)
v_rcp_f32 v137, v137
v_mfma_f32_16x16x32_bf16 v[12:15], v[208:211], a[0:3], v[12:15]
ds_read_b64_tr_b16 v[204:205], v239 offset:15872
ds_read_b64_tr_b16 v[206:207], v239 offset:16128
v_mfma_f32_16x16x32_bf16 a[228:231], v[208:211], a[4:7], a[228:231]
buffer_load_dwordx4 v[68:71], v237, s[28:31], s52 offen offset:2048 sc1
v_lshrrev_b32 v229, 4, v237
v_mfma_f32_16x16x32_bf16 a[232:235], v[208:211], a[8:11], a[232:235]
v_rcp_f32 v138, v138
v_mfma_f32_16x16x32_bf16 a[236:239], v[208:211], a[12:15], a[236:239]
s_waitcnt lgkmcnt(6)
v_exp_f32 v141, v141
v_mfma_f32_16x16x32_bf16 v[16:19], v[192:195], a[0:3], v[16:19]
ds_read_b64_tr_b16 v[208:209], v239 offset:16896
ds_read_b64_tr_b16 v[210:211], v239 offset:17152
v_mfma_f32_16x16x32_bf16 a[240:243], v[192:195], a[4:7], a[240:243]
buffer_load_dwordx4 v[72:75], v237, s[28:31], s52 offen offset:1024 sc1
v_sub_u32 v229, s76, v229
v_mfma_f32_16x16x32_bf16 a[244:247], v[192:195], a[8:11], a[244:247]
v_rcp_f32 v139, v139
v_mfma_f32_16x16x32_bf16 a[248:251], v[192:195], a[12:15], a[248:251]
s_waitcnt vmcnt(63) lgkmcnt(6)
v_exp_f32 v142, v142
v_mfma_f32_16x16x32_bf16 v[0:3], v[196:199], a[16:19], v[0:3]
ds_read_b64_tr_b16 v[192:193], v240 offset:17920
ds_read_b64_tr_b16 v[194:195], v240 offset:18176
v_mfma_f32_16x16x32_bf16 a[192:195], v[196:199], a[20:23], a[192:195]
buffer_load_dwordx4 v[76:79], v237, s[28:31], s52 offen offset:3072 sc1
v_mul_f32 v152, v136, v152
v_mfma_f32_16x16x32_bf16 a[196:199], v[196:199], a[24:27], a[196:199]
s_waitcnt vmcnt(57)
s_barrier
v_mfma_f32_16x16x32_bf16 a[200:203], v[196:199], a[28:31], a[200:203]
s_waitcnt lgkmcnt(6)
v_exp_f32 v143, v143
v_mfma_f32_16x16x32_bf16 v[4:7], v[200:203], a[16:19], v[4:7]
ds_read_b64_tr_b16 v[196:197], v239 offset:18432
ds_read_b64_tr_b16 v[198:199], v239 offset:18688
v_mfma_f32_16x16x32_bf16 a[204:207], v[200:203], a[20:23], a[204:207]
v_mul_f32 v153, v137, v153
v_mul_f32 v154, v138, v154
v_mfma_f32_16x16x32_bf16 a[208:211], v[200:203], a[24:27], a[208:211]
v_add_f32 v140, 1.0, v140
v_add_f32 v141, 1.0, v141
v_mfma_f32_16x16x32_bf16 a[212:215], v[200:203], a[28:31], a[212:215]
s_waitcnt lgkmcnt(6)
v_add_f32 v142, 1.0, v142
v_mul_f32 v155, v139, v155
v_mfma_f32_16x16x32_bf16 v[8:11], v[204:207], a[16:19], v[8:11]
s_add_u32 s52, s79, 110592
ds_read_b64_tr_b16 v[200:201], v239 offset:19456
ds_read_b64_tr_b16 v[202:203], v239 offset:19712
v_mfma_f32_16x16x32_bf16 a[216:219], v[204:207], a[20:23], a[216:219]
buffer_load_dwordx4 v[80:83], v237, s[28:31], s52 offen offset:0 sc1
v_cvt_pk_bf16_f32 v220, v152, v153
v_mfma_f32_16x16x32_bf16 a[220:223], v[204:207], a[24:27], a[220:223]
v_cvt_pk_bf16_f32 v221, v154, v155
v_add_f32 v143, 1.0, v143
v_mfma_f32_16x16x32_bf16 a[224:227], v[204:207], a[28:31], a[224:227]
s_waitcnt lgkmcnt(6)
v_rcp_f32 v140, v140
v_mfma_f32_16x16x32_bf16 v[12:15], v[208:211], a[16:19], v[12:15]
ds_read_b64_tr_b16 v[204:205], v239 offset:20480
ds_read_b64_tr_b16 v[206:207], v239 offset:20736
v_mfma_f32_16x16x32_bf16 a[228:231], v[208:211], a[20:23], a[228:231]
buffer_load_dwordx4 v[84:87], v237, s[28:31], s52 offen offset:2048 sc1
v_add_u32 v229, 3, v229
v_mfma_f32_16x16x32_bf16 a[232:235], v[208:211], a[24:27], a[232:235]
v_rcp_f32 v141, v141
v_mfma_f32_16x16x32_bf16 a[236:239], v[208:211], a[28:31], a[236:239]
s_waitcnt lgkmcnt(6)
v_rcp_f32 v142, v142
v_mfma_f32_16x16x32_bf16 v[16:19], v[192:195], a[16:19], v[16:19]
ds_read_b64_tr_b16 v[208:209], v239 offset:21504
ds_read_b64_tr_b16 v[210:211], v239 offset:21760
v_mfma_f32_16x16x32_bf16 a[240:243], v[192:195], a[20:23], a[240:243]
buffer_load_dwordx4 v[88:91], v237, s[28:31], s52 offen offset:1024 sc1
v_and_b32 v229, 3, v229
v_mfma_f32_16x16x32_bf16 a[244:247], v[192:195], a[24:27], a[244:247]
v_rcp_f32 v143, v143
v_mfma_f32_16x16x32_bf16 a[248:251], v[192:195], a[28:31], a[248:251]
s_waitcnt vmcnt(63) lgkmcnt(6)
v_mul_f32 v156, v140, v156
v_mul_f32 v157, v141, v157
v_mfma_f32_16x16x32_bf16 v[0:3], v[196:199], a[32:35], v[0:3]
ds_read_b64_tr_b16 v[192:193], v240 offset:22528
ds_read_b64_tr_b16 v[194:195], v240 offset:22784
v_mfma_f32_16x16x32_bf16 a[192:195], v[196:199], a[36:39], a[192:195]
buffer_load_dwordx4 v[92:95], v237, s[28:31], s52 offen offset:3072 sc1
v_mul_f32 v158, v142, v158
v_mfma_f32_16x16x32_bf16 a[196:199], v[196:199], a[40:43], a[196:199]
v_lshl_add_u32 v229, v229, 2, s93
v_mul_f32 v159, v143, v159
v_mfma_f32_16x16x32_bf16 a[200:203], v[196:199], a[44:47], a[200:203]
s_waitcnt lgkmcnt(6)
v_cvt_pk_bf16_f32 v224, v156, v157
v_cvt_pk_bf16_f32 v225, v158, v159
v_mfma_f32_16x16x32_bf16 v[4:7], v[200:203], a[32:35], v[4:7]
s_add_u32 m0, s49, 98304
ds_read_b64_tr_b16 v[196:197], v239 offset:23040
ds_read_b64_tr_b16 v[198:199], v239 offset:23296
v_mfma_f32_16x16x32_bf16 a[204:207], v[200:203], a[36:39], a[204:207]
s_add_u32 s50, s81, 65536
buffer_load_dwordx4 v237, s[28:31], s50 offen sc1 lds
v_lshrrev_b32 v228, 8, v237
v_mfma_f32_16x16x32_bf16 a[208:211], v[200:203], a[40:43], a[208:211]
v_mul_f32 v32, s96, v32
v_mul_f32 v33, s96, v33
v_mfma_f32_16x16x32_bf16 a[212:215], v[200:203], a[44:47], a[212:215]
s_waitcnt lgkmcnt(6)
v_mul_f32 v34, s96, v34
v_mul_f32 v35, s96, v35
v_mfma_f32_16x16x32_bf16 v[8:11], v[204:207], a[32:35], v[8:11]
s_add_u32 m0, s49, 102400
ds_read_b64_tr_b16 v[200:201], v239 offset:24064
ds_read_b64_tr_b16 v[202:203], v239 offset:24320
v_mfma_f32_16x16x32_bf16 a[216:219], v[204:207], a[36:39], a[216:219]
s_add_u32 s50, s81, 69632
buffer_load_dwordx4 v237, s[28:31], s50 offen sc1 lds
v_lshl_add_u32 v228, v228, 7, s90
v_mfma_f32_16x16x32_bf16 a[220:223], v[204:207], a[40:43], a[220:223]
v_exp_f32 v32, v32
v_mfma_f32_16x16x32_bf16 a[224:227], v[204:207], a[44:47], a[224:227]
s_waitcnt lgkmcnt(6)
v_exp_f32 v33, v33
v_mfma_f32_16x16x32_bf16 v[12:15], v[208:211], a[32:35], v[12:15]
s_add_u32 m0, s49, 106496
ds_read_b64_tr_b16 v[204:205], v239 offset:25088
ds_read_b64_tr_b16 v[206:207], v239 offset:25344
v_mfma_f32_16x16x32_bf16 a[228:231], v[208:211], a[36:39], a[228:231]
s_add_u32 s50, s81, 73728
buffer_load_dwordx4 v237, s[28:31], s50 offen sc1 lds
v_bfe_u32 v30, v237, 2, 5
v_mfma_f32_16x16x32_bf16 a[232:235], v[208:211], a[40:43], a[232:235]
v_exp_f32 v34, v34
v_mfma_f32_16x16x32_bf16 a[236:239], v[208:211], a[44:47], a[236:239]
s_waitcnt lgkmcnt(6)
v_exp_f32 v35, v35
v_mfma_f32_16x16x32_bf16 v[16:19], v[192:195], a[32:35], v[16:19]
s_waitcnt vmcnt(33)
ds_read_b64_tr_b16 v[208:209], v239 offset:26112
ds_read_b64_tr_b16 v[210:211], v239 offset:26368
v_mfma_f32_16x16x32_bf16 a[240:243], v[192:195], a[36:39], a[240:243]
s_add_u32 m0, s49, 110592
v_swap_b32 v162, v164
v_swap_b32 v163, v165
v_mfma_f32_16x16x32_bf16 a[244:247], v[192:195], a[40:43], a[244:247]
s_add_u32 s50, s81, 77824
buffer_load_dwordx4 v237, s[28:31], s50 offen sc1 lds
v_swap_b32 v170, v172
v_mfma_f32_16x16x32_bf16 a[248:251], v[192:195], a[44:47], a[248:251]
s_waitcnt vmcnt(63) lgkmcnt(6)
v_swap_b32 v171, v173
v_add_f32 v32, 1.0, v32
v_mfma_f32_16x16x32_bf16 v[0:3], v[196:199], a[48:51], v[0:3]
s_add_u32 s52, s79, 77824
ds_read_b64_tr_b16 v[192:193], v240 offset:27136
ds_read_b64_tr_b16 v[194:195], v240 offset:27392
v_mfma_f32_16x16x32_bf16 a[192:195], v[196:199], a[52:55], a[192:195]
buffer_load_dwordx4 a[160:163], v237, s[28:31], s52 offen offset:0 sc1
v_add_f32 v33, 1.0, v33
v_mfma_f32_16x16x32_bf16 a[196:199], v[196:199], a[56:59], a[196:199]
v_add_f32 v34, 1.0, v34
v_add_f32 v35, 1.0, v35
v_mfma_f32_16x16x32_bf16 a[200:203], v[196:199], a[60:63], a[200:203]
s_waitcnt lgkmcnt(6)
v_rcp_f32 v32, v32
v_mfma_f32_16x16x32_bf16 v[4:7], v[200:203], a[48:51], v[4:7]
ds_read_b64_tr_b16 v[196:197], v239 offset:27648
ds_read_b64_tr_b16 v[198:199], v239 offset:27904
v_mfma_f32_16x16x32_bf16 a[204:207], v[200:203], a[52:55], a[204:207]
v_mul_f32 v36, s96, v36
v_mul_f32 v37, s96, v37
v_mfma_f32_16x16x32_bf16 a[208:211], v[200:203], a[56:59], a[208:211]
v_mul_f32 v38, s96, v38
v_mul_f32 v39, s96, v39
v_mfma_f32_16x16x32_bf16 a[212:215], v[200:203], a[60:63], a[212:215]
s_waitcnt lgkmcnt(6)
v_add_u32 v228, v228, v30
v_and_b32 v30, 0xff, v237
v_mfma_f32_16x16x32_bf16 v[8:11], v[204:207], a[48:51], v[8:11]
ds_read_b64_tr_b16 v[200:201], v239 offset:28672
ds_read_b64_tr_b16 v[202:203], v239 offset:28928
v_mfma_f32_16x16x32_bf16 a[216:219], v[204:207], a[52:55], a[216:219]
buffer_load_dwordx4 a[164:167], v237, s[28:31], s52 offen offset:1024 sc1
v_lshl_add_u32 v230, s80, 2, v30
v_mfma_f32_16x16x32_bf16 a[220:223], v[204:207], a[56:59], a[220:223]
v_rcp_f32 v33, v33
v_mfma_f32_16x16x32_bf16 a[224:227], v[204:207], a[60:63], a[224:227]
s_waitcnt lgkmcnt(6)
v_rcp_f32 v34, v34
v_mfma_f32_16x16x32_bf16 v[12:15], v[208:211], a[48:51], v[12:15]
ds_read_b64_tr_b16 v[204:205], v239 offset:29696
ds_read_b64_tr_b16 v[206:207], v239 offset:29952
v_mfma_f32_16x16x32_bf16 a[228:231], v[208:211], a[52:55], a[228:231]
buffer_load_dwordx4 a[168:171], v237, s[28:31], s52 offen offset:2048 sc1
v_lshrrev_b32 v31, 8, v237
v_mfma_f32_16x16x32_bf16 a[232:235], v[208:211], a[56:59], a[232:235]
v_exp_f32 v36, v36
v_mfma_f32_16x16x32_bf16 a[236:239], v[208:211], a[60:63], a[236:239]
s_waitcnt lgkmcnt(6)
v_exp_f32 v37, v37
v_mfma_f32_16x16x32_bf16 v[16:19], v[192:195], a[48:51], v[16:19]
s_waitcnt vmcnt(32)
ds_read_b64_tr_b16 v[208:209], v239 offset:30720
ds_read_b64_tr_b16 v[210:211], v239 offset:30976
v_mfma_f32_16x16x32_bf16 a[240:243], v[192:195], a[52:55], a[240:243]
v_swap_b32 v178, v180
v_swap_b32 v179, v181
v_mfma_f32_16x16x32_bf16 a[244:247], v[192:195], a[56:59], a[244:247]
v_swap_b32 v186, v188
v_swap_b32 v187, v189
v_mfma_f32_16x16x32_bf16 a[248:251], v[192:195], a[60:63], a[248:251]
s_waitcnt vmcnt(37) lgkmcnt(6)
v_rcp_f32 v35, v35
v_mfma_f32_16x16x32_bf16 v[0:3], v[196:199], v[160:163], v[0:3]
ds_read_b64_tr_b16 v[192:193], v240 offset:31744
ds_read_b64_tr_b16 v[194:195], v240 offset:32000
v_mfma_f32_16x16x32_bf16 a[192:195], v[196:199], v[164:167], a[192:195]
v_exp_f32 v38, v38
v_mfma_f32_16x16x32_bf16 a[196:199], v[196:199], v[168:171], a[196:199]
v_exp_f32 v39, v39
v_mfma_f32_16x16x32_bf16 a[200:203], v[196:199], v[172:175], a[200:203]
s_waitcnt lgkmcnt(6)
v_mul_f32 v48, v32, v48
v_mul_f32 v49, v33, v49
v_mfma_f32_16x16x32_bf16 v[4:7], v[200:203], v[160:163], v[4:7]
ds_read_b64_tr_b16 v[196:197], v239 offset:32256
ds_read_b64_tr_b16 v[198:199], v239 offset:32512
v_mfma_f32_16x16x32_bf16 a[204:207], v[200:203], v[164:167], a[204:207]
buffer_load_dwordx4 a[172:175], v237, s[28:31], s52 offen offset:3072 sc1
v_mul_f32 v50, v34, v50
v_mfma_f32_16x16x32_bf16 a[208:211], v[200:203], v[168:171], a[208:211]
v_add_f32 v36, 1.0, v36
v_add_f32 v37, 1.0, v37
v_mfma_f32_16x16x32_bf16 a[212:215], v[200:203], v[172:175], a[212:215]
s_waitcnt lgkmcnt(6)
v_mul_f32 v51, v35, v51
v_add_f32 v38, 1.0, v38
v_mfma_f32_16x16x32_bf16 v[8:11], v[204:207], v[160:163], v[8:11]
s_lshl_b32 s51, s69, 10
ds_read_b64_tr_b16 v[200:201], v239 offset:33280
ds_read_b64_tr_b16 v[202:203], v239 offset:33536
v_mfma_f32_16x16x32_bf16 a[216:219], v[204:207], v[164:167], a[216:219]
s_add_u32 s51, s55, s51
v_add_f32 v39, 1.0, v39
v_lshl_add_u32 v231, v31, 28, v30
v_mfma_f32_16x16x32_bf16 a[220:223], v[204:207], v[168:171], a[220:223]
s_add_u32 s51, s51, 45056
v_cvt_pk_bf16_f32 v214, v48, v49
v_cvt_pk_bf16_f32 v215, v50, v51
v_mfma_f32_16x16x32_bf16 a[224:227], v[204:207], v[172:175], a[224:227]
s_waitcnt lgkmcnt(6)
buffer_store_dwordx4 v[212:215], v237, s[28:31], s51 offen offset:0 sc1
v_mul_f32 v40, s96, v40
v_mfma_f32_16x16x32_bf16 v[12:15], v[208:211], v[160:163], v[12:15]
s_lshr_b32 s80, s80, 4
ds_read_b64_tr_b16 v[204:205], v239 offset:34304
ds_read_b64_tr_b16 v[206:207], v239 offset:34560
v_mfma_f32_16x16x32_bf16 a[228:231], v[208:211], v[164:167], a[228:231]
s_add_u32 s52, s79, 86016
buffer_load_dwordx4 a[176:179], v237, s[28:31], s52 offen offset:0 sc1
buffer_load_dwordx4 a[180:183], v237, s[28:31], s52 offen offset:1024 sc1
v_mfma_f32_16x16x32_bf16 a[232:235], v[208:211], v[168:171], a[232:235]
v_rcp_f32 v36, v36
v_mfma_f32_16x16x32_bf16 a[236:239], v[208:211], v[172:175], a[236:239]
s_waitcnt lgkmcnt(6)
v_mul_f32 v41, s96, v41
v_mul_f32 v42, s96, v42
v_mfma_f32_16x16x32_bf16 v[16:19], v[192:195], v[160:163], v[16:19]
s_waitcnt vmcnt(15)
ds_read_b64_tr_b16 v[208:209], v239 offset:35328
ds_read_b64_tr_b16 v[210:211], v239 offset:35584
v_mfma_f32_16x16x32_bf16 a[240:243], v[192:195], v[164:167], a[240:243]
buffer_load_dwordx4 a[184:187], v237, s[28:31], s52 offen offset:2048 sc1
v_swap_b32 v66, v68
v_mfma_f32_16x16x32_bf16 a[244:247], v[192:195], v[168:171], a[244:247]
v_rcp_f32 v37, v37
v_mfma_f32_16x16x32_bf16 a[248:251], v[192:195], v[172:175], a[248:251]
s_waitcnt vmcnt(37) lgkmcnt(6)
v_rcp_f32 v38, v38
v_mfma_f32_16x16x32_bf16 v[0:3], v[196:199], v[176:179], v[0:3]
ds_read_b64_tr_b16 v[192:193], v240 offset:36352
ds_read_b64_tr_b16 v[194:195], v240 offset:36608
v_mfma_f32_16x16x32_bf16 a[192:195], v[196:199], v[180:183], a[192:195]
v_swap_b32 v67, v69
v_swap_b32 v74, v76
v_mfma_f32_16x16x32_bf16 a[196:199], v[196:199], v[184:187], a[196:199]
s_waitcnt vmcnt(20)
s_barrier
v_mfma_f32_16x16x32_bf16 a[200:203], v[196:199], v[188:191], a[200:203]
s_waitcnt lgkmcnt(6)
v_swap_b32 v75, v77
v_mul_f32 v43, s96, v43
v_mfma_f32_16x16x32_bf16 v[4:7], v[200:203], v[176:179], v[4:7]
ds_read_b64_tr_b16 v[196:197], v239 offset:36864
ds_read_b64_tr_b16 v[198:199], v239 offset:37120
v_mfma_f32_16x16x32_bf16 a[204:207], v[200:203], v[180:183], a[204:207]
buffer_load_dwordx4 a[188:191], v237, s[28:31], s52 offen offset:3072 sc1
v_mul_u32_u24 v238, 13, v237
v_mfma_f32_16x16x32_bf16 a[208:211], v[200:203], v[184:187], a[208:211]
v_exp_f32 v40, v40
v_mfma_f32_16x16x32_bf16 a[212:215], v[200:203], v[188:191], a[212:215]
s_waitcnt lgkmcnt(6)
v_rcp_f32 v39, v39
v_mfma_f32_16x16x32_bf16 v[8:11], v[204:207], v[176:179], v[8:11]
s_add_u32 s52, s79, 94208
ds_read_b64_tr_b16 v[200:201], v239 offset:37888
ds_read_b64_tr_b16 v[202:203], v239 offset:38144
v_mfma_f32_16x16x32_bf16 a[216:219], v[204:207], v[180:183], a[216:219]
buffer_load_dwordx4 a[0:3], v237, s[28:31], s52 offen offset:0 sc1
v_mul_f32 v52, v36, v52
v_mfma_f32_16x16x32_bf16 a[220:223], v[204:207], v[184:187], a[220:223]
v_exp_f32 v41, v41
v_mfma_f32_16x16x32_bf16 a[224:227], v[204:207], v[188:191], a[224:227]
s_waitcnt lgkmcnt(6)
v_exp_f32 v42, v42
v_mfma_f32_16x16x32_bf16 v[12:15], v[208:211], v[176:179], v[12:15]
ds_read_b64_tr_b16 v[204:205], v239 offset:38912
ds_read_b64_tr_b16 v[206:207], v239 offset:39168
v_mfma_f32_16x16x32_bf16 a[228:231], v[208:211], v[180:183], a[228:231]
v_mul_f32 v53, v37, v53
v_mul_f32 v54, v38, v54
v_mfma_f32_16x16x32_bf16 a[232:235], v[208:211], v[184:187], a[232:235]
v_exp_f32 v43, v43
v_mfma_f32_16x16x32_bf16 a[236:239], v[208:211], v[188:191], a[236:239]
s_waitcnt lgkmcnt(6)
v_mul_f32 v55, v39, v55
v_add_f32 v40, 1.0, v40
v_mfma_f32_16x16x32_bf16 v[16:19], v[192:195], v[176:179], v[16:19]
s_lshl_b32 s66, s69, 10
ds_read_b64_tr_b16 v[208:209], v239 offset:39936
ds_read_b64_tr_b16 v[210:211], v239 offset:40192
v_mfma_f32_16x16x32_bf16 a[240:243], v[192:195], v[180:183], a[240:243]
s_add_u32 s66, s55, s66
v_add_f32 v41, 1.0, v41
v_add_f32 v42, 1.0, v42
v_mfma_f32_16x16x32_bf16 a[244:247], v[192:195], v[184:187], a[244:247]
s_add_u32 s66, s66, 45056
v_cvt_pk_bf16_f32 v218, v52, v53
v_cvt_pk_bf16_f32 v219, v54, v55
v_mfma_f32_16x16x32_bf16 a[248:251], v[192:195], v[188:191], a[248:251]
s_waitcnt vmcnt(18) lgkmcnt(6)
buffer_store_dwordx4 v[216:219], v237, s[28:31], s66 offen offset:1024 sc1
v_add_f32 v43, 1.0, v43
v_mfma_f32_16x16x32_bf16 v[0:3], v[196:199], v[64:67], v[0:3]
s_waitcnt vmcnt(15)
ds_read_b64_tr_b16 v[192:193], v240 offset:40960
ds_read_b64_tr_b16 v[194:195], v240 offset:41216
v_mfma_f32_16x16x32_bf16 a[192:195], v[196:199], v[68:71], a[192:195]
s_add_u32 s11, s97, 49152
buffer_load_dword v246, v241, s[28:31], s7 offen sc1
v_mul_f32 v44, s96, v44
v_mfma_f32_16x16x32_bf16 a[196:199], v[196:199], v[72:75], a[196:199]
v_mul_f32 v45, s96, v45
v_mul_f32 v46, s96, v46
v_mfma_f32_16x16x32_bf16 a[200:203], v[196:199], v[76:79], a[200:203]
s_waitcnt lgkmcnt(6)
v_rcp_f32 v40, v40
v_mfma_f32_16x16x32_bf16 v[4:7], v[200:203], v[64:67], v[4:7]
ds_read_b64_tr_b16 v[196:197], v239 offset:41472
ds_read_b64_tr_b16 v[198:199], v239 offset:41728
v_mfma_f32_16x16x32_bf16 a[204:207], v[200:203], v[68:71], a[204:207]
buffer_load_dwordx4 a[4:7], v237, s[28:31], s52 offen offset:1024 sc1
v_mul_f32 v47, s96, v47
v_mfma_f32_16x16x32_bf16 a[208:211], v[200:203], v[72:75], a[208:211]
v_rcp_f32 v41, v41
v_mfma_f32_16x16x32_bf16 a[212:215], v[200:203], v[76:79], a[212:215]
s_waitcnt lgkmcnt(6)
v_exp_f32 v44, v44
v_mfma_f32_16x16x32_bf16 v[8:11], v[204:207], v[64:67], v[8:11]
ds_read_b64_tr_b16 v[200:201], v239 offset:42496
ds_read_b64_tr_b16 v[202:203], v239 offset:42752
v_mfma_f32_16x16x32_bf16 a[216:219], v[204:207], v[68:71], a[216:219]
buffer_load_dwordx4 a[8:11], v237, s[28:31], s52 offen offset:2048 sc1
v_swap_b32 v82, v84
v_mfma_f32_16x16x32_bf16 a[220:223], v[204:207], v[72:75], a[220:223]
v_swap_b32 v83, v85
v_swap_b32 v90, v92
v_mfma_f32_16x16x32_bf16 a[224:227], v[204:207], v[76:79], a[224:227]
s_waitcnt lgkmcnt(6)
v_swap_b32 v91, v93
v_add_u32 v238, s86, v238
v_mfma_f32_16x16x32_bf16 v[12:15], v[208:211], v[64:67], v[12:15]
ds_read_b64_tr_b16 v[204:205], v239 offset:43520
ds_read_b64_tr_b16 v[206:207], v239 offset:43776
v_mfma_f32_16x16x32_bf16 a[228:231], v[208:211], v[68:71], a[228:231]
ds_read_b128 v[96:99], v238 offset:0
ds_read_b128 v[100:103], v238 offset:16
v_mfma_f32_16x16x32_bf16 a[232:235], v[208:211], v[72:75], a[232:235]
ds_read_b64 v[104:105], v238 offset:32
ds_read_b128 v[106:109], v238 offset:19296
v_mfma_f32_16x16x32_bf16 a[236:239], v[208:211], v[76:79], a[236:239]
s_waitcnt lgkmcnt(10)
ds_read_b128 v[110:113], v238 offset:19312
ds_read_b64 v[114:115], v238 offset:19328
v_mfma_f32_16x16x32_bf16 v[16:19], v[192:195], v[64:67], v[16:19]
ds_read_b64_tr_b16 v[208:209], v239 offset:44544
ds_read_b64_tr_b16 v[210:211], v239 offset:44800
v_mfma_f32_16x16x32_bf16 a[240:243], v[192:195], v[68:71], a[240:243]
buffer_load_dwordx4 a[12:15], v237, s[28:31], s52 offen offset:3072 sc1
v_mfma_f32_16x16x32_bf16 a[244:247], v[192:195], v[72:75], a[244:247]
s_add_u32 m0, s49, 114688
v_rcp_f32 v42, v42
v_mfma_f32_16x16x32_bf16 a[248:251], v[192:195], v[76:79], a[248:251]
s_waitcnt vmcnt(19) lgkmcnt(12)
ds_read_b128 v[116:119], v238 offset:18880
v_mfma_f32_16x16x32_bf16 v[0:3], v[196:199], v[80:83], v[0:3]
s_add_u32 s50, s81, 81920
ds_read_b64_tr_b16 v[192:193], v240 offset:45568
ds_read_b64_tr_b16 v[194:195], v240 offset:45824
v_mfma_f32_16x16x32_bf16 a[192:195], v[196:199], v[84:87], a[192:195]
buffer_load_dwordx4 v237, s[28:31], s50 offen sc1 lds
v_mfma_f32_16x16x32_bf16 a[196:199], v[196:199], v[88:91], a[196:199]
s_add_u32 m0, s49, 118784
v_exp_f32 v45, v45
v_mfma_f32_16x16x32_bf16 a[200:203], v[196:199], v[92:95], a[200:203]
s_waitcnt lgkmcnt(13)
v_exp_f32 v46, v46
v_mfma_f32_16x16x32_bf16 v[4:7], v[200:203], v[80:83], v[4:7]
s_add_u32 s50, s81, 86016
ds_read_b64_tr_b16 v[196:197], v239 offset:46080
ds_read_b64_tr_b16 v[198:199], v239 offset:46336
v_mfma_f32_16x16x32_bf16 a[204:207], v[200:203], v[84:87], a[204:207]
buffer_load_dwordx4 v237, s[28:31], s50 offen sc1 lds
v_mfma_f32_16x16x32_bf16 a[208:211], v[200:203], v[88:91], a[208:211]
s_add_u32 m0, s49, 122880
v_rcp_f32 v43, v43
v_mfma_f32_16x16x32_bf16 a[212:215], v[200:203], v[92:95], a[212:215]
s_waitcnt lgkmcnt(13)
v_mul_f32 v56, v40, v56
v_mul_f32 v57, v41, v57
v_mfma_f32_16x16x32_bf16 v[8:11], v[204:207], v[80:83], v[8:11]
s_add_u32 s50, s81, 90112
ds_read_b64_tr_b16 v[200:201], v239 offset:47104
ds_read_b64_tr_b16 v[202:203], v239 offset:47360
v_mfma_f32_16x16x32_bf16 a[216:219], v[204:207], v[84:87], a[216:219]
buffer_load_dwordx4 v237, s[28:31], s50 offen sc1 lds
v_mul_f32 v58, v42, v58
v_mfma_f32_16x16x32_bf16 a[220:223], v[204:207], v[88:91], a[220:223]
s_add_u32 s52, s79, 102400
buffer_load_dwordx4 a[16:19], v237, s[28:31], s52 offen offset:0 sc1
v_mul_f32 v59, v43, v59
v_mfma_f32_16x16x32_bf16 a[224:227], v[204:207], v[92:95], a[224:227]
s_waitcnt lgkmcnt(7)
ds_read_b128 v[120:123], v238 offset:18896
ds_read_b64 v[124:125], v238 offset:18912
v_mfma_f32_16x16x32_bf16 v[12:15], v[208:211], v[80:83], v[12:15]
s_lshl_b32 s51, s69, 10
ds_read_b64_tr_b16 v[204:205], v239 offset:48128
ds_read_b64_tr_b16 v[206:207], v239 offset:48384
v_mfma_f32_16x16x32_bf16 a[228:231], v[208:211], v[84:87], a[228:231]
s_sub_u32 s51, s55, s51
ds_read_b128 v[126:129], v238 offset:18464
ds_read_b128 v[130:133], v238 offset:18480
v_mfma_f32_16x16x32_bf16 a[232:235], v[208:211], v[88:91], a[232:235]
s_add_u32 s51, s51, 45056
buffer_load_dwordx4 a[20:23], v237, s[28:31], s52 offen offset:1024 sc1
v_cvt_pk_bf16_f32 v222, v56, v57
v_mfma_f32_16x16x32_bf16 a[236:239], v[208:211], v[92:95], a[236:239]
s_waitcnt lgkmcnt(10)
ds_read_b64 v[134:135], v238 offset:18496
ds_read_b128 v[136:139], v238 offset:18048
v_cvt_pk_bf16_f32 v223, v58, v59
buffer_store_dwordx4 v[220:223], v237, s[28:31], s51 offen offset:2048 sc1
v_exp_f32 v47, v47
v_add_f32 v44, 1.0, v44
v_add_f32 v45, 1.0, v45
v_add_f32 v46, 1.0, v46
v_add_f32 v47, 1.0, v47
v_rcp_f32 v44, v44
v_rcp_f32 v45, v45
v_rcp_f32 v46, v46
v_rcp_f32 v47, v47
v_mul_f32 v60, v44, v60
v_mul_f32 v61, v45, v61
v_mul_f32 v62, v46, v62
v_mul_f32 v63, v47, v63
s_lshl_b32 s66, s69, 10
s_sub_u32 s66, s55, s66
s_add_u32 s66, s66, 45056
v_cvt_pk_bf16_f32 v226, v60, v61
v_cvt_pk_bf16_f32 v227, v62, v63
buffer_store_dwordx4 v[224:227], v237, s[28:31], s66 offen offset:3072 sc1
v_mfma_f32_16x16x32_bf16 v[16:19], v[192:195], v[80:83], v[16:19]
ds_read_b64_tr_b16 v[208:209], v239 offset:49152
ds_read_b64_tr_b16 v[210:211], v239 offset:49408
v_mfma_f32_16x16x32_bf16 a[240:243], v[192:195], v[84:87], a[240:243]
buffer_load_dwordx4 a[24:27], v237, s[28:31], s52 offen offset:2048 sc1
v_mfma_f32_16x16x32_bf16 a[244:247], v[192:195], v[88:91], a[244:247]
v_mfma_f32_16x16x32_bf16 a[248:251], v[192:195], v[92:95], a[248:251]
s_waitcnt vmcnt(63) lgkmcnt(12)
ds_read_b128 v[140:143], v238 offset:18064
v_mfma_f32_16x16x32_bf16 v[0:3], v[196:199], a[64:67], v[0:3]
ds_read_b64_tr_b16 v[192:193], v240 offset:50176
ds_read_b64_tr_b16 v[194:195], v240 offset:50432
v_mfma_f32_16x16x32_bf16 a[192:195], v[196:199], a[68:71], a[192:195]
TCH_8_v1:
s_cbranch_execz TCH_12_v1
buffer_load_dwordx4 a[28:31], v237, s[28:31], s52 offen offset:3072 sc1
v_mfma_f32_16x16x32_bf16 a[196:199], v[196:199], a[72:75], a[196:199]
v_mfma_f32_16x16x32_bf16 a[200:203], v[196:199], a[76:79], a[200:203]
s_waitcnt lgkmcnt(13)
v_mfma_f32_16x16x32_bf16 v[4:7], v[200:203], a[64:67], v[4:7]
ds_read_b64_tr_b16 v[196:197], v239 offset:50688
ds_read_b64_tr_b16 v[198:199], v239 offset:50944
v_mfma_f32_16x16x32_bf16 a[204:207], v[200:203], a[68:71], a[204:207]
v_mfma_f32_16x16x32_bf16 a[208:211], v[200:203], a[72:75], a[208:211]
v_mfma_f32_16x16x32_bf16 a[212:215], v[200:203], a[76:79], a[212:215]
s_waitcnt lgkmcnt(11)
ds_read_b64 v[144:145], v238 offset:18080
ds_read_b128 v[146:149], v238 offset:17632
v_mfma_f32_16x16x32_bf16 v[8:11], v[204:207], a[64:67], v[8:11]
s_add_u32 m0, s49, 126976
ds_read_b64_tr_b16 v[200:201], v239 offset:51712
ds_read_b64_tr_b16 v[202:203], v239 offset:51968
v_mfma_f32_16x16x32_bf16 a[216:219], v[204:207], a[68:71], a[216:219]
s_add_u32 s50, s81, 94208
buffer_load_dwordx4 v237, s[28:31], s50 offen sc1 lds
v_mfma_f32_16x16x32_bf16 a[220:223], v[204:207], a[72:75], a[220:223]
s_add_u32 m0, s49, 131072
v_mfma_f32_16x16x32_bf16 a[224:227], v[204:207], a[76:79], a[224:227]
s_waitcnt lgkmcnt(9)
ds_read_b128 v[150:153], v238 offset:17648
ds_read_b64 v[154:155], v238 offset:17664
v_mfma_f32_16x16x32_bf16 v[12:15], v[208:211], a[64:67], v[12:15]
s_add_u32 s50, s81, 98304
ds_read_b64_tr_b16 v[204:205], v239 offset:52736
ds_read_b64_tr_b16 v[206:207], v239 offset:52992
v_mfma_f32_16x16x32_bf16 a[228:231], v[208:211], a[68:71], a[228:231]
buffer_load_dwordx4 v237, s[28:31], s50 offen sc1 lds
v_mfma_f32_16x16x32_bf16 a[232:235], v[208:211], a[72:75], a[232:235]
s_add_u32 m0, s49, 49152
v_mfma_f32_16x16x32_bf16 a[236:239], v[208:211], a[76:79], a[236:239]
s_waitcnt lgkmcnt(10)
ds_read_b128 v[156:159], v238 offset:17216
ds_read_b128 v[160:163], v238 offset:17232
v_mfma_f32_16x16x32_bf16 v[16:19], v[192:195], a[64:67], v[16:19]
s_add_u32 s50, s82, 0
ds_read_b64_tr_b16 v[208:209], v239 offset:53760
ds_read_b64_tr_b16 v[210:211], v239 offset:54016
v_mfma_f32_16x16x32_bf16 a[240:243], v[192:195], a[68:71], a[240:243]
buffer_load_dwordx4 v237, s[28:31], s50 offen sc1 lds
s_add_u32 m0, s49, 53248
v_mfma_f32_16x16x32_bf16 a[244:247], v[192:195], a[72:75], a[244:247]
s_add_u32 s50, s82, 4096
buffer_load_dwordx4 v237, s[28:31], s50 offen sc1 lds
s_add_u32 m0, s49, 57344
v_mfma_f32_16x16x32_bf16 a[248:251], v[192:195], a[76:79], a[248:251]
s_waitcnt vmcnt(63) lgkmcnt(12)
ds_read_b64 v[164:165], v238 offset:17248
s_add_u32 s50, s82, 8192
v_mfma_f32_16x16x32_bf16 v[0:3], v[196:199], a[80:83], v[0:3]
ds_read_b64_tr_b16 v[192:193], v240 offset:54784
ds_read_b64_tr_b16 v[194:195], v240 offset:55040
v_mfma_f32_16x16x32_bf16 a[192:195], v[196:199], a[84:87], a[192:195]
buffer_load_dwordx4 v237, s[28:31], s50 offen sc1 lds
s_add_u32 m0, s49, 61440
v_mfma_f32_16x16x32_bf16 a[196:199], v[196:199], a[88:91], a[196:199]
s_waitcnt vmcnt(31)
s_barrier
v_mfma_f32_16x16x32_bf16 a[200:203], v[196:199], a[92:95], a[200:203]
s_waitcnt lgkmcnt(11)
ds_read_b128 v[166:169], v238 offset:16800
ds_read_b128 v[170:173], v238 offset:16816
v_mfma_f32_16x16x32_bf16 v[4:7], v[200:203], a[80:83], v[4:7]
s_add_u32 s50, s82, 12288
ds_read_b64_tr_b16 v[196:197], v239 offset:55296
ds_read_b64_tr_b16 v[198:199], v239 offset:55552
v_mfma_f32_16x16x32_bf16 a[204:207], v[200:203], a[84:87], a[204:207]
buffer_load_dwordx4 v237, s[28:31], s50 offen sc1 lds
s_add_u32 m0, s49, 65536
v_mfma_f32_16x16x32_bf16 a[208:211], v[200:203], a[88:91], a[208:211]
s_add_u32 s50, s82, 16384
buffer_load_dwordx4 v237, s[28:31], s50 offen sc1 lds
v_mfma_f32_16x16x32_bf16 a[212:215], v[200:203], a[92:95], a[212:215]
s_waitcnt lgkmcnt(11)
ds_read_b64 v[174:175], v238 offset:16832
ds_read_b128 v[176:179], v238 offset:16384
v_mfma_f32_16x16x32_bf16 v[8:11], v[204:207], a[80:83], v[8:11]
s_waitcnt vmcnt(19)
ds_read_b64_tr_b16 v[200:201], v239 offset:56320
ds_read_b64_tr_b16 v[202:203], v239 offset:56576
v_mfma_f32_16x16x32_bf16 a[216:219], v[204:207], a[84:87], a[216:219]
v_cmp_gt_u32 vcc, 1, v246
v_mfma_f32_16x16x32_bf16 a[220:223], v[204:207], a[88:91], a[220:223]
s_cbranch_vccnz spin_14_v1
ok_13_v1:
v_mfma_f32_16x16x32_bf16 a[224:227], v[204:207], a[92:95], a[224:227]
s_waitcnt lgkmcnt(11)
ds_read_b128 v[180:183], v238 offset:16400
ds_read_b64 v[184:185], v238 offset:16416
v_mfma_f32_16x16x32_bf16 v[12:15], v[208:211], a[80:83], v[12:15]
s_add_u32 m0, s49, 69632
ds_read_b64_tr_b16 v[204:205], v239 offset:57344
ds_read_b64_tr_b16 v[206:207], v239 offset:57600
v_mfma_f32_16x16x32_bf16 a[228:231], v[208:211], a[84:87], a[228:231]
s_add_u32 s50, s82, 20480
buffer_load_dwordx4 v237, s[28:31], s50 offen sc1 lds
v_lshrrev_b32 v186, 4, v237
v_mfma_f32_16x16x32_bf16 a[232:235], v[208:211], a[88:91], a[232:235]
s_add_u32 s52, s79, 40960
buffer_load_dwordx4 a[32:35], v237, s[28:31], s52 offen offset:0 sc1
buffer_load_dwordx4 a[36:39], v237, s[28:31], s52 offen offset:1024 sc1
v_mfma_f32_16x16x32_bf16 a[236:239], v[208:211], a[92:95], a[236:239]
s_waitcnt lgkmcnt(12)
v_mov_b32 v189, 0xf149f2ca
v_mfma_f32_16x16x32_bf16 v[16:19], v[192:195], a[80:83], v[16:19]
ds_read_b64_tr_b16 v[208:209], v239 offset:58368
ds_read_b64_tr_b16 v[210:211], v239 offset:58624
v_mfma_f32_16x16x32_bf16 a[240:243], v[192:195], a[84:87], a[240:243]
buffer_load_dwordx4 a[40:43], v237, s[28:31], s52 offen offset:2048 sc1
v_mfma_f32_16x16x32_bf16 a[244:247], v[192:195], a[88:91], a[244:247]
v_dot2_f32_bf16 v32, v96, v106, 0
v_dot2_f32_bf16 v33, v96, v116, 0
v_dot2_f32_bf16 v34, v96, v126, 0
v_dot2_f32_bf16 v35, v96, v136, 0
v_dot2c_f32_bf16 v32, v97, v107
v_dot2c_f32_bf16 v33, v97, v117
v_dot2c_f32_bf16 v34, v97, v127
v_dot2c_f32_bf16 v35, v97, v137
v_dot2c_f32_bf16 v32, v98, v108
buffer_load_dwordx4 a[44:47], v237, s[28:31], s52 offen offset:3072 sc1
v_dot2c_f32_bf16 v33, v98, v118
v_dot2c_f32_bf16 v34, v98, v128
v_dot2c_f32_bf16 v35, v98, v138
v_dot2c_f32_bf16 v32, v99, v109
v_dot2c_f32_bf16 v33, v99, v119
v_dot2c_f32_bf16 v34, v99, v129
v_dot2c_f32_bf16 v35, v99, v139
v_dot2c_f32_bf16 v32, v100, v110
v_dot2c_f32_bf16 v33, v100, v120
v_dot2c_f32_bf16 v34, v100, v130
v_dot2c_f32_bf16 v35, v100, v140
v_dot2c_f32_bf16 v32, v101, v111
v_dot2c_f32_bf16 v33, v101, v121
v_dot2c_f32_bf16 v34, v101, v131
v_dot2c_f32_bf16 v35, v101, v141
v_dot2c_f32_bf16 v32, v102, v112
v_dot2c_f32_bf16 v33, v102, v122
v_dot2c_f32_bf16 v34, v102, v132
v_dot2c_f32_bf16 v35, v102, v142
v_dot2c_f32_bf16 v32, v103, v113
v_dot2c_f32_bf16 v33, v103, v123
v_dot2c_f32_bf16 v34, v103, v133
v_dot2c_f32_bf16 v35, v103, v143
v_dot2c_f32_bf16 v32, v104, v114
v_dot2c_f32_bf16 v33, v104, v124
v_dot2c_f32_bf16 v34, v104, v134
v_dot2c_f32_bf16 v35, v104, v144
s_nop 1
v_mfma_f32_16x16x32_bf16 a[248:251], v[192:195], a[92:95], a[248:251]
s_waitcnt vmcnt(63) lgkmcnt(10)
v_mfma_f32_16x16x32_bf16 v[0:3], v[196:199], a[96:99], v[0:3]
ds_read_b64_tr_b16 v[192:193], v240 offset:59392
ds_read_b64_tr_b16 v[194:195], v240 offset:59648
v_mfma_f32_16x16x32_bf16 a[192:195], v[196:199], a[100:103], a[192:195]
v_mfma_f32_16x16x32_bf16 a[196:199], v[196:199], a[104:107], a[196:199]
v_mfma_f32_16x16x32_bf16 a[200:203], v[196:199], a[108:111], a[200:203]
s_waitcnt lgkmcnt(8)
v_mfma_f32_16x16x32_bf16 v[4:7], v[200:203], a[96:99], v[4:7]
s_add_u32 m0, s49, 135168
ds_read_b64_tr_b16 v[196:197], v239 offset:59904
ds_read_b64_tr_b16 v[198:199], v239 offset:60160
v_mfma_f32_16x16x32_bf16 a[204:207], v[200:203], a[100:103], a[204:207]
s_add_u32 s50, s81, 102400
buffer_load_dwordx4 v237, s[28:31], s50 offen sc1 lds
v_mfma_f32_16x16x32_bf16 a[208:211], v[200:203], a[104:107], a[208:211]
v_mfma_f32_16x16x32_bf16 a[212:215], v[200:203], a[108:111], a[212:215]
s_waitcnt lgkmcnt(6)
v_dot2_f32_bf16 v36, v96, v146, 0
v_dot2_f32_bf16 v37, v96, v156, 0
v_dot2_f32_bf16 v38, v96, v166, 0
v_dot2_f32_bf16 v39, v96, v176, 0
v_dot2c_f32_bf16 v36, v97, v147
v_dot2c_f32_bf16 v37, v97, v157
v_dot2c_f32_bf16 v38, v97, v167
v_dot2c_f32_bf16 v39, v97, v177
v_dot2c_f32_bf16 v36, v98, v148
s_add_u32 m0, s49, 139264
s_add_u32 s50, s81, 106496
buffer_load_dwordx4 v237, s[28:31], s50 offen sc1 lds
v_dot2c_f32_bf16 v37, v98, v158
v_dot2c_f32_bf16 v38, v98, v168
v_dot2c_f32_bf16 v39, v98, v178
v_dot2c_f32_bf16 v36, v99, v149
v_dot2c_f32_bf16 v37, v99, v159
v_dot2c_f32_bf16 v38, v99, v169
v_dot2c_f32_bf16 v39, v99, v179
v_dot2c_f32_bf16 v36, v100, v150
v_dot2c_f32_bf16 v37, v100, v160
s_add_u32 s52, s79, 49152
buffer_load_dwordx4 a[48:51], v237, s[28:31], s52 offen offset:0 sc1
v_dot2c_f32_bf16 v38, v100, v170
v_dot2c_f32_bf16 v39, v100, v180
v_dot2c_f32_bf16 v36, v101, v151
v_dot2c_f32_bf16 v37, v101, v161
v_dot2c_f32_bf16 v38, v101, v171
v_dot2c_f32_bf16 v39, v101, v181
v_dot2c_f32_bf16 v36, v102, v152
v_dot2c_f32_bf16 v37, v102, v162
v_dot2c_f32_bf16 v38, v102, v172
buffer_load_dwordx4 a[52:55], v237, s[28:31], s52 offen offset:1024 sc1
v_dot2c_f32_bf16 v39, v102, v182
v_dot2c_f32_bf16 v36, v103, v153
v_dot2c_f32_bf16 v37, v103, v163
v_dot2c_f32_bf16 v38, v103, v173
v_dot2c_f32_bf16 v39, v103, v183
v_dot2c_f32_bf16 v36, v104, v154
v_dot2c_f32_bf16 v37, v104, v164
v_dot2c_f32_bf16 v38, v104, v174
v_dot2c_f32_bf16 v39, v104, v184
s_nop 1
v_mfma_f32_16x16x32_bf16 v[8:11], v[204:207], a[96:99], v[8:11]
s_waitcnt vmcnt(18)
ds_read_b64_tr_b16 v[200:201], v239 offset:60928
ds_read_b64_tr_b16 v[202:203], v239 offset:61184
v_mfma_f32_16x16x32_bf16 a[216:219], v[204:207], a[100:103], a[216:219]
s_mul_i32 s4, s78, 2
buffer_store_dword v242, off, s[28:31], s11 sc1
s_lshl_b64 s[4:5], -1, s4
v_mfma_f32_16x16x32_bf16 a[220:223], v[204:207], a[104:107], a[220:223]
v_cndmask_b32 v33, v189, v33, s[4:5]
s_mul_i32 s4, s78, 4
v_mfma_f32_16x16x32_bf16 a[224:227], v[204:207], a[108:111], a[224:227]
s_waitcnt lgkmcnt(6)
s_lshl_b64 s[4:5], -1, s4
ds_read_b128 v[106:109], v238 offset:35680
v_mfma_f32_16x16x32_bf16 v[12:15], v[208:211], a[96:99], v[12:15]
ds_read_b64_tr_b16 v[204:205], v239 offset:61952
ds_read_b64_tr_b16 v[206:207], v239 offset:62208
v_mfma_f32_16x16x32_bf16 a[228:231], v[208:211], a[100:103], a[228:231]
v_cndmask_b32 v34, v189, v34, s[4:5]
s_mul_i32 s4, s78, 6
v_mfma_f32_16x16x32_bf16 a[232:235], v[208:211], a[104:107], a[232:235]
s_lshl_b64 s[4:5], -1, s4
v_cndmask_b32 v35, v189, v35, s[4:5]
s_mul_i32 s4, s78, 8
v_mfma_f32_16x16x32_bf16 a[236:239], v[208:211], a[108:111], a[236:239]
s_waitcnt lgkmcnt(7)
ds_read_b128 v[110:113], v238 offset:35696
s_lshl_b64 s[4:5], -1, s4
v_mfma_f32_16x16x32_bf16 v[16:19], v[192:195], a[96:99], v[16:19]
ds_read_b64_tr_b16 v[208:209], v239 offset:62976
ds_read_b64_tr_b16 v[210:211], v239 offset:63232
v_mfma_f32_16x16x32_bf16 a[240:243], v[192:195], a[100:103], a[240:243]
v_cndmask_b32 v36, v189, v36, s[4:5]
s_mul_i32 s4, s78, 10
v_mfma_f32_16x16x32_bf16 a[244:247], v[192:195], a[104:107], a[244:247]
s_lshl_b64 s[4:5], -1, s4
ds_read_b64 v[114:115], v238 offset:35712
v_cndmask_b32 v37, v189, v37, s[4:5]
v_mfma_f32_16x16x32_bf16 a[248:251], v[192:195], a[108:111], a[248:251]
s_waitcnt vmcnt(63) lgkmcnt(9)
s_mul_i32 s4, s78, 12
s_lshl_b64 s[4:5], -1, s4
v_mfma_f32_16x16x32_bf16 v[0:3], v[196:199], a[112:115], v[0:3]
ds_read_b64_tr_b16 v[192:193], v240 offset:64000
ds_read_b64_tr_b16 v[194:195], v240 offset:64256
v_mfma_f32_16x16x32_bf16 a[192:195], v[196:199], a[116:119], a[192:195]
buffer_load_dwordx4 a[56:59], v237, s[28:31], s52 offen offset:2048 sc1
v_cndmask_b32 v38, v189, v38, s[4:5]
v_mfma_f32_16x16x32_bf16 a[196:199], v[196:199], a[120:123], a[196:199]
s_mul_i32 s4, s78, 14
ds_read_b128 v[116:119], v238 offset:35264
s_lshl_b64 s[4:5], -1, s4
v_mfma_f32_16x16x32_bf16 a[200:203], v[196:199], a[124:127], a[200:203]
s_waitcnt lgkmcnt(10)
v_cndmask_b32 v39, v189, v39, s[4:5]
v_max3_f32 v189, v32, v33, v34
v_mfma_f32_16x16x32_bf16 v[4:7], v[200:203], a[112:115], v[4:7]
ds_read_b64_tr_b16 v[196:197], v239 offset:64512
ds_read_b64_tr_b16 v[198:199], v239 offset:64768
v_mfma_f32_16x16x32_bf16 a[204:207], v[200:203], a[116:119], a[204:207]
buffer_load_dwordx4 a[60:63], v237, s[28:31], s52 offen offset:3072 sc1
v_max3_f32 v189, v189, v35, v36
v_mfma_f32_16x16x32_bf16 a[208:211], v[200:203], a[120:123], a[208:211]
v_max3_f32 v189, v189, v37, v38
v_mfma_f32_16x16x32_bf16 a[212:215], v[200:203], a[124:127], a[212:215]
s_waitcnt lgkmcnt(9)
ds_read_b128 v[120:123], v238 offset:35280
v_max_f32 v189, v189, v39
v_mfma_f32_16x16x32_bf16 v[8:11], v[204:207], a[112:115], v[8:11]
s_add_u32 s52, s79, 57344
ds_read_b64_tr_b16 v[200:201], v239 offset:0
ds_read_b64_tr_b16 v[202:203], v239 offset:256
v_mfma_f32_16x16x32_bf16 a[216:219], v[204:207], a[116:119], a[216:219]
buffer_load_dwordx4 a[64:67], v237, s[28:31], s52 offen offset:0 sc1
v_sub_f32 v32, v32, v189
v_mfma_f32_16x16x32_bf16 a[220:223], v[204:207], a[120:123], a[220:223]
v_sub_f32 v33, v33, v189
v_sub_f32 v34, v34, v189
v_mfma_f32_16x16x32_bf16 a[224:227], v[204:207], a[124:127], a[224:227]
s_waitcnt lgkmcnt(9)
ds_read_b64 v[124:125], v238 offset:35296
v_sub_f32 v35, v35, v189
v_mfma_f32_16x16x32_bf16 v[12:15], v[208:211], a[112:115], v[12:15]
ds_read_b64_tr_b16 v[204:205], v239 offset:1024
ds_read_b64_tr_b16 v[206:207], v239 offset:1280
v_mfma_f32_16x16x32_bf16 a[228:231], v[208:211], a[116:119], a[228:231]
buffer_load_dwordx4 a[68:71], v237, s[28:31], s52 offen offset:1024 sc1
v_sub_f32 v36, v36, v189
v_mfma_f32_16x16x32_bf16 a[232:235], v[208:211], a[120:123], a[232:235]
v_sub_f32 v37, v37, v189
v_sub_f32 v38, v38, v189
v_mfma_f32_16x16x32_bf16 a[236:239], v[208:211], a[124:127], a[236:239]
s_waitcnt lgkmcnt(9)
v_sub_f32 v39, v39, v189
v_mfma_f32_16x16x32_bf16 v[16:19], v[192:195], a[112:115], v[16:19]
ds_read_b64_tr_b16 v[208:209], v239 offset:2048
ds_read_b64_tr_b16 v[210:211], v239 offset:2304
v_mfma_f32_16x16x32_bf16 a[240:243], v[192:195], a[116:119], a[240:243]
ds_read_b128 v[126:129], v238 offset:34848
buffer_load_dwordx4 a[72:75], v237, s[28:31], s52 offen offset:2048 sc1
v_mfma_f32_16x16x32_bf16 a[244:247], v[192:195], a[120:123], a[244:247]
v_mul_f32 v32, 0x3eae1a93, v32
v_mul_f32 v33, 0x3eae1a93, v33
v_mfma_f32_16x16x32_bf16 a[248:251], v[192:195], a[124:127], a[248:251]
s_waitcnt vmcnt(63) lgkmcnt(9)
v_mul_f32 v34, 0x3eae1a93, v34
v_mul_f32 v35, 0x3eae1a93, v35
v_mfma_f32_16x16x32_bf16 v[0:3], v[196:199], a[128:131], v[0:3]
ds_read_b64_tr_b16 v[192:193], v240 offset:3072
ds_read_b64_tr_b16 v[194:195], v240 offset:3328
v_mfma_f32_16x16x32_bf16 a[192:195], v[196:199], a[132:135], a[192:195]
buffer_load_dwordx4 a[76:79], v237, s[28:31], s52 offen offset:3072 sc1
v_mul_f32 v36, 0x3eae1a93, v36
v_mfma_f32_16x16x32_bf16 a[196:199], v[196:199], a[136:139], a[196:199]
ds_read_b128 v[130:133], v238 offset:34864
v_mul_f32 v37, 0x3eae1a93, v37
v_mfma_f32_16x16x32_bf16 a[200:203], v[196:199], a[140:143], a[200:203]
s_waitcnt lgkmcnt(9)
v_mul_f32 v38, 0x3eae1a93, v38
v_mul_f32 v39, 0x3eae1a93, v39
v_mfma_f32_16x16x32_bf16 v[4:7], v[200:203], a[128:131], v[4:7]
s_add_u32 s52, s79, 65536
ds_read_b64_tr_b16 v[196:197], v239 offset:3584
ds_read_b64_tr_b16 v[198:199], v239 offset:3840
v_mfma_f32_16x16x32_bf16 a[204:207], v[200:203], a[132:135], a[204:207]
v_exp_f32 v32, v32
v_mfma_f32_16x16x32_bf16 a[208:211], v[200:203], a[136:139], a[208:211]
ds_read_b64 v[134:135], v238 offset:34880
buffer_load_dwordx4 a[80:83], v237, s[28:31], s52 offen offset:0 sc1
v_mfma_f32_16x16x32_bf16 a[212:215], v[200:203], a[140:143], a[212:215]
s_waitcnt lgkmcnt(9)
v_exp_f32 v33, v33
v_mfma_f32_16x16x32_bf16 v[8:11], v[204:207], a[128:131], v[8:11]
ds_read_b64_tr_b16 v[200:201], v239 offset:4608
ds_read_b64_tr_b16 v[202:203], v239 offset:4864
v_mfma_f32_16x16x32_bf16 a[216:219], v[204:207], a[132:135], a[216:219]
v_exp_f32 v34, v34
v_mfma_f32_16x16x32_bf16 a[220:223], v[204:207], a[136:139], a[220:223]
v_exp_f32 v35, v35
v_mfma_f32_16x16x32_bf16 a[224:227], v[204:207], a[140:143], a[224:227]
s_waitcnt lgkmcnt(9)
v_exp_f32 v36, v36
v_mfma_f32_16x16x32_bf16 v[12:15], v[208:211], a[128:131], v[12:15]
ds_read_b64_tr_b16 v[204:205], v239 offset:5632
ds_read_b64_tr_b16 v[206:207], v239 offset:5888
v_mfma_f32_16x16x32_bf16 a[228:231], v[208:211], a[132:135], a[228:231]
v_exp_f32 v37, v37
v_mfma_f32_16x16x32_bf16 a[232:235], v[208:211], a[136:139], a[232:235]
ds_read_b128 v[136:139], v238 offset:34432
buffer_load_dwordx4 a[84:87], v237, s[28:31], s52 offen offset:1024 sc1
v_mfma_f32_16x16x32_bf16 a[236:239], v[208:211], a[140:143], a[236:239]
s_waitcnt lgkmcnt(9)
v_exp_f32 v38, v38
v_mfma_f32_16x16x32_bf16 v[16:19], v[192:195], a[128:131], v[16:19]
ds_read_b64_tr_b16 v[208:209], v239 offset:6656
ds_read_b64_tr_b16 v[210:211], v239 offset:6912
v_mfma_f32_16x16x32_bf16 a[240:243], v[192:195], a[132:135], a[240:243]
v_exp_f32 v39, v39
v_mfma_f32_16x16x32_bf16 a[244:247], v[192:195], a[136:139], a[244:247]
buffer_load_dwordx4 a[88:91], v237, s[28:31], s52 offen offset:2048 sc1
v_add_f32 v189, v32, v33
v_mfma_f32_16x16x32_bf16 a[248:251], v[192:195], a[140:143], a[248:251]
s_waitcnt vmcnt(63) lgkmcnt(8)
v_add_f32 v189, v189, v34
v_add_f32 v189, v189, v35
v_mfma_f32_16x16x32_bf16 v[0:3], v[196:199], a[144:147], v[0:3]
ds_read_b64_tr_b16 v[192:193], v240 offset:7680
ds_read_b64_tr_b16 v[194:195], v240 offset:7936
v_mfma_f32_16x16x32_bf16 a[192:195], v[196:199], a[148:151], a[192:195]
ds_read_b128 v[140:143], v238 offset:34448
buffer_load_dwordx4 a[92:95], v237, s[28:31], s52 offen offset:3072 sc1
v_mfma_f32_16x16x32_bf16 a[196:199], v[196:199], a[152:155], a[196:199]
s_waitcnt vmcnt(33)
s_barrier
v_mfma_f32_16x16x32_bf16 a[200:203], v[196:199], a[156:159], a[200:203]
s_waitcnt lgkmcnt(8)
v_add_f32 v189, v189, v36
v_add_f32 v189, v189, v37
v_mfma_f32_16x16x32_bf16 v[4:7], v[200:203], a[144:147], v[4:7]
s_add_u32 m0, s49, 143360
ds_read_b64_tr_b16 v[196:197], v239 offset:8192
ds_read_b64_tr_b16 v[198:199], v239 offset:8448
v_mfma_f32_16x16x32_bf16 a[204:207], v[200:203], a[148:151], a[204:207]
s_add_u32 s50, s81, 110592
buffer_load_dwordx4 v237, s[28:31], s50 offen sc1 lds
v_add_f32 v189, v189, v38
v_mfma_f32_16x16x32_bf16 a[208:211], v[200:203], a[152:155], a[208:211]
v_add_f32 v189, v189, v39
v_mfma_f32_16x16x32_bf16 a[212:215], v[200:203], a[156:159], a[212:215]
s_waitcnt lgkmcnt(8)
ds_read_b64 v[144:145], v238 offset:34464
v_mfma_f32_16x16x32_bf16 v[8:11], v[204:207], a[144:147], v[8:11]
s_add_u32 m0, s49, 147456
ds_read_b64_tr_b16 v[200:201], v239 offset:9216
ds_read_b64_tr_b16 v[202:203], v239 offset:9472
v_mfma_f32_16x16x32_bf16 a[216:219], v[204:207], a[148:151], a[216:219]
s_add_u32 s50, s81, 114688
v_rcp_f32 v189, v189
v_mfma_f32_16x16x32_bf16 a[220:223], v[204:207], a[152:155], a[220:223]
s_mov_b32 s4, 0x05040100
buffer_load_dwordx4 v237, s[28:31], s50 offen sc1 lds
s_mov_b32 s5, 0x07060302
v_mfma_f32_16x16x32_bf16 a[224:227], v[204:207], a[156:159], a[224:227]
s_waitcnt lgkmcnt(8)
v_mul_f32 v32, v189, v32
v_mul_f32 v33, v189, v33
v_mfma_f32_16x16x32_bf16 v[12:15], v[208:211], a[144:147], v[12:15]
s_add_u32 s52, s79, 114688
ds_read_b64_tr_b16 v[204:205], v239 offset:10240
ds_read_b64_tr_b16 v[206:207], v239 offset:10496
v_mfma_f32_16x16x32_bf16 a[228:231], v[208:211], a[148:151], a[228:231]
buffer_load_dwordx4 a[96:99], v237, s[28:31], s52 offen offset:0 sc1
v_mul_f32 v34, v189, v34
v_mfma_f32_16x16x32_bf16 a[232:235], v[208:211], a[152:155], a[232:235]
v_mul_f32 v35, v189, v35
v_mul_f32 v36, v189, v36
v_mfma_f32_16x16x32_bf16 a[236:239], v[208:211], a[156:159], a[236:239]
s_waitcnt lgkmcnt(8)
v_mul_f32 v37, v189, v37
v_mul_f32 v38, v189, v38
v_mfma_f32_16x16x32_bf16 v[16:19], v[192:195], a[144:147], v[16:19]
ds_read_b64_tr_b16 v[208:209], v239 offset:11264
ds_read_b64_tr_b16 v[210:211], v239 offset:11520
v_mfma_f32_16x16x32_bf16 a[240:243], v[192:195], a[148:151], a[240:243]
buffer_load_dwordx4 a[100:103], v237, s[28:31], s52 offen offset:1024 sc1
v_mul_f32 v39, v189, v39
v_mfma_f32_16x16x32_bf16 a[244:247], v[192:195], a[152:155], a[244:247]
v_cvt_pk_bf16_f32 v32, v32, v33
v_cvt_pk_bf16_f32 v33, v34, v35
v_mfma_f32_16x16x32_bf16 a[248:251], v[192:195], a[156:159], a[248:251]
s_waitcnt vmcnt(51) lgkmcnt(7)
v_cvt_pk_bf16_f32 v34, v36, v37
v_cvt_pk_bf16_f32 v35, v38, v39
v_mfma_f32_16x16x32_bf16 v[0:3], v[196:199], a[160:163], v[0:3]
ds_read_b64_tr_b16 v[192:193], v240 offset:12288
ds_read_b64_tr_b16 v[194:195], v240 offset:12544
v_mfma_f32_16x16x32_bf16 a[192:195], v[196:199], a[164:167], a[192:195]
buffer_load_dwordx4 a[104:107], v237, s[28:31], s52 offen offset:2048 sc1
v_perm_b32 v96, v116, v106, s4
v_mfma_f32_16x16x32_bf16 a[196:199], v[196:199], a[168:171], a[196:199]
v_perm_b32 v106, v116, v106, s5
v_perm_b32 v97, v117, v107, s4
v_mfma_f32_16x16x32_bf16 a[200:203], v[196:199], a[172:175], a[200:203]
s_waitcnt lgkmcnt(6)
ds_read_b128 v[146:149], v238 offset:34016
v_perm_b32 v107, v117, v107, s5
v_mfma_f32_16x16x32_bf16 v[4:7], v[200:203], a[160:163], v[4:7]
ds_read_b64_tr_b16 v[196:197], v239 offset:12800
ds_read_b64_tr_b16 v[198:199], v239 offset:13056
v_mfma_f32_16x16x32_bf16 a[204:207], v[200:203], a[164:167], a[204:207]
buffer_load_dwordx4 a[108:111], v237, s[28:31], s52 offen offset:3072 sc1
v_perm_b32 v98, v118, v108, s4
v_mfma_f32_16x16x32_bf16 a[208:211], v[200:203], a[168:171], a[208:211]
v_perm_b32 v108, v118, v108, s5
v_mfma_f32_16x16x32_bf16 a[212:215], v[200:203], a[172:175], a[212:215]
s_waitcnt lgkmcnt(7)
ds_read_b128 v[150:153], v238 offset:34032
v_perm_b32 v99, v119, v109, s4
v_mfma_f32_16x16x32_bf16 v[8:11], v[204:207], a[160:163], v[8:11]
s_add_u32 m0, s49, 151552
ds_read_b64_tr_b16 v[200:201], v239 offset:13824
ds_read_b64_tr_b16 v[202:203], v239 offset:14080
v_mfma_f32_16x16x32_bf16 a[216:219], v[204:207], a[164:167], a[216:219]
s_add_u32 s50, s81, 118784
buffer_load_dwordx4 v237, s[28:31], s50 offen sc1 lds
v_perm_b32 v109, v119, v109, s5
v_mfma_f32_16x16x32_bf16 a[220:223], v[204:207], a[168:171], a[220:223]
v_perm_b32 v100, v120, v110, s4
v_mfma_f32_16x16x32_bf16 a[224:227], v[204:207], a[172:175], a[224:227]
s_waitcnt lgkmcnt(8)
ds_read_b64 v[154:155], v238 offset:34048
v_perm_b32 v110, v120, v110, s5
v_mfma_f32_16x16x32_bf16 v[12:15], v[208:211], a[160:163], v[12:15]
s_add_u32 m0, s49, 155648
ds_read_b64_tr_b16 v[204:205], v239 offset:14848
ds_read_b64_tr_b16 v[206:207], v239 offset:15104
v_mfma_f32_16x16x32_bf16 a[228:231], v[208:211], a[164:167], a[228:231]
s_add_u32 s50, s81, 122880
buffer_load_dwordx4 v237, s[28:31], s50 offen sc1 lds
v_perm_b32 v101, v121, v111, s4
v_mfma_f32_16x16x32_bf16 a[232:235], v[208:211], a[168:171], a[232:235]
v_perm_b32 v111, v121, v111, s5
v_mfma_f32_16x16x32_bf16 a[236:239], v[208:211], a[172:175], a[236:239]
s_waitcnt lgkmcnt(9)
ds_read_b128 v[156:159], v238 offset:33600
v_perm_b32 v102, v122, v112, s4
v_mfma_f32_16x16x32_bf16 v[16:19], v[192:195], a[160:163], v[16:19]
s_add_u32 m0, s49, 159744
ds_read_b64_tr_b16 v[208:209], v239 offset:15872
ds_read_b64_tr_b16 v[210:211], v239 offset:16128
v_mfma_f32_16x16x32_bf16 a[240:243], v[192:195], a[164:167], a[240:243]
s_add_u32 s50, s81, 126976
buffer_load_dwordx4 v237, s[28:31], s50 offen sc1 lds
v_perm_b32 v112, v122, v112, s5
v_mfma_f32_16x16x32_bf16 a[244:247], v[192:195], a[168:171], a[244:247]
s_add_u32 s52, s79, 122880
buffer_load_dwordx4 a[112:115], v237, s[28:31], s52 offen offset:0 sc1
v_perm_b32 v103, v123, v113, s4
v_mfma_f32_16x16x32_bf16 a[248:251], v[192:195], a[172:175], a[248:251]
s_waitcnt vmcnt(52) lgkmcnt(9)
ds_read_b128 v[160:163], v238 offset:33616
v_perm_b32 v113, v123, v113, s5
v_mfma_f32_16x16x32_bf16 v[0:3], v[196:199], a[176:179], v[0:3]
ds_read_b64_tr_b16 v[192:193], v240 offset:16896
ds_read_b64_tr_b16 v[194:195], v240 offset:17152
v_mfma_f32_16x16x32_bf16 a[192:195], v[196:199], a[180:183], a[192:195]
buffer_load_dwordx4 a[116:119], v237, s[28:31], s52 offen offset:1024 sc1
v_perm_b32 v104, v124, v114, s4
v_mfma_f32_16x16x32_bf16 a[196:199], v[196:199], a[184:187], a[196:199]
v_perm_b32 v114, v124, v114, s5
v_mfma_f32_16x16x32_bf16 a[200:203], v[196:199], a[188:191], a[200:203]
s_waitcnt lgkmcnt(9)
ds_read_b64 v[164:165], v238 offset:33632
v_mfma_f32_16x16x32_bf16 v[4:7], v[200:203], a[176:179], v[4:7]
ds_read_b64_tr_b16 v[196:197], v239 offset:17408
ds_read_b64_tr_b16 v[198:199], v239 offset:17664
v_mfma_f32_16x16x32_bf16 a[204:207], v[200:203], a[180:183], a[204:207]
buffer_load_dword v246, v241, s[28:31], s83 offen sc1
v_mfma_f32_16x16x32_bf16 a[208:211], v[200:203], a[184:187], a[208:211]
v_dot2_f32_bf16 v40, v96, v32, 0
v_dot2_f32_bf16 v41, v106, v32, 0
v_dot2_f32_bf16 v42, v97, v32, 0
v_dot2_f32_bf16 v43, v107, v32, 0
v_dot2_f32_bf16 v44, v98, v32, 0
v_dot2_f32_bf16 v45, v108, v32, 0
v_dot2_f32_bf16 v46, v99, v32, 0
v_dot2_f32_bf16 v47, v109, v32, 0
v_dot2_f32_bf16 v48, v100, v32, 0
buffer_load_dwordx4 a[120:123], v237, s[28:31], s52 offen offset:2048 sc1
v_dot2_f32_bf16 v49, v110, v32, 0
v_dot2_f32_bf16 v50, v101, v32, 0
v_dot2_f32_bf16 v51, v111, v32, 0
v_dot2_f32_bf16 v52, v102, v32, 0
v_dot2_f32_bf16 v53, v112, v32, 0
v_dot2_f32_bf16 v54, v103, v32, 0
v_dot2_f32_bf16 v55, v113, v32, 0
v_dot2_f32_bf16 v56, v104, v32, 0
v_dot2_f32_bf16 v57, v114, v32, 0
s_nop 1
v_mfma_f32_16x16x32_bf16 a[212:215], v[200:203], a[188:191], a[212:215]
s_waitcnt lgkmcnt(9)
v_perm_b32 v96, v136, v126, s4
v_perm_b32 v126, v136, v126, s5
v_mfma_f32_16x16x32_bf16 v[8:11], v[204:207], a[176:179], v[8:11]
ds_read_b64_tr_b16 v[200:201], v239 offset:18432
ds_read_b64_tr_b16 v[202:203], v239 offset:18688
v_mfma_f32_16x16x32_bf16 a[216:219], v[204:207], a[180:183], a[216:219]
v_perm_b32 v97, v137, v127, s4
v_mfma_f32_16x16x32_bf16 a[220:223], v[204:207], a[184:187], a[220:223]
ds_read_b128 v[166:169], v238 offset:33184
v_perm_b32 v127, v137, v127, s5
v_mfma_f32_16x16x32_bf16 a[224:227], v[204:207], a[188:191], a[224:227]
s_waitcnt lgkmcnt(9)
v_perm_b32 v98, v138, v128, s4
v_perm_b32 v128, v138, v128, s5
v_mfma_f32_16x16x32_bf16 v[12:15], v[208:211], a[176:179], v[12:15]
ds_read_b64_tr_b16 v[204:205], v239 offset:19456
ds_read_b64_tr_b16 v[206:207], v239 offset:19712
v_mfma_f32_16x16x32_bf16 a[228:231], v[208:211], a[180:183], a[228:231]
ds_read_b128 v[170:173], v238 offset:33200
buffer_load_dwordx4 a[124:127], v237, s[28:31], s52 offen offset:3072 sc1
v_mfma_f32_16x16x32_bf16 a[232:235], v[208:211], a[184:187], a[232:235]
v_perm_b32 v99, v139, v129, s4
v_perm_b32 v129, v139, v129, s5
v_mfma_f32_16x16x32_bf16 a[236:239], v[208:211], a[188:191], a[236:239]
s_waitcnt lgkmcnt(9)
v_perm_b32 v100, v140, v130, s4
v_mfma_f32_16x16x32_bf16 v[16:19], v[192:195], a[176:179], v[16:19]
s_add_u32 s52, s79, 131072
ds_read_b64_tr_b16 v[208:209], v239 offset:20480
ds_read_b64_tr_b16 v[210:211], v239 offset:20736
v_mfma_f32_16x16x32_bf16 a[240:243], v[192:195], a[180:183], a[240:243]
ds_read_b64 v[174:175], v238 offset:33216
buffer_load_dwordx4 a[128:131], v237, s[28:31], s52 offen offset:0 sc1
v_mfma_f32_16x16x32_bf16 a[244:247], v[192:195], a[184:187], a[244:247]
v_perm_b32 v130, v140, v130, s5
v_perm_b32 v101, v141, v131, s4
v_mfma_f32_16x16x32_bf16 a[248:251], v[192:195], a[188:191], a[248:251]
s_waitcnt vmcnt(51) lgkmcnt(9)
v_perm_b32 v131, v141, v131, s5
v_mfma_f32_16x16x32_bf16 v[0:3], v[196:199], a[0:3], v[0:3]
TCH_9_v1:
s_cbranch_execz TCH_back
ds_read_b64_tr_b16 v[192:193], v240 offset:21504
ds_read_b64_tr_b16 v[194:195], v240 offset:21760
v_mfma_f32_16x16x32_bf16 a[192:195], v[196:199], a[4:7], a[192:195]
ds_read_b128 v[176:179], v238 offset:32768
buffer_load_dwordx4 a[132:135], v237, s[28:31], s52 offen offset:1024 sc1
v_mfma_f32_16x16x32_bf16 a[196:199], v[196:199], a[8:11], a[196:199]
v_perm_b32 v102, v142, v132, s4
v_perm_b32 v132, v142, v132, s5
v_mfma_f32_16x16x32_bf16 a[200:203], v[196:199], a[12:15], a[200:203]
s_waitcnt lgkmcnt(10)
v_perm_b32 v103, v143, v133, s4
v_mfma_f32_16x16x32_bf16 v[4:7], v[200:203], a[0:3], v[4:7]
ds_read_b64_tr_b16 v[196:197], v239 offset:22016
ds_read_b64_tr_b16 v[198:199], v239 offset:22272
v_mfma_f32_16x16x32_bf16 a[204:207], v[200:203], a[4:7], a[204:207]
ds_read_b128 v[180:183], v238 offset:32784
buffer_load_dwordx4 a[136:139], v237, s[28:31], s52 offen offset:2048 sc1
v_mfma_f32_16x16x32_bf16 a[208:211], v[200:203], a[8:11], a[208:211]
buffer_load_dwordx4 a[140:143], v237, s[28:31], s52 offen offset:3072 sc1
v_perm_b32 v133, v143, v133, s5
v_mfma_f32_16x16x32_bf16 a[212:215], v[200:203], a[12:15], a[212:215]
s_waitcnt lgkmcnt(10)
v_perm_b32 v104, v144, v134, s4
v_perm_b32 v134, v144, v134, s5
v_mfma_f32_16x16x32_bf16 v[8:11], v[204:207], a[0:3], v[8:11]
s_add_u32 s52, s79, 139264
ds_read_b64_tr_b16 v[200:201], v239 offset:23040
ds_read_b64_tr_b16 v[202:203], v239 offset:23296
v_mfma_f32_16x16x32_bf16 a[216:219], v[204:207], a[4:7], a[216:219]
ds_read_b64 v[184:185], v238 offset:32800
buffer_load_dwordx4 a[144:147], v237, s[28:31], s52 offen offset:0 sc1
v_mfma_f32_16x16x32_bf16 a[220:223], v[204:207], a[8:11], a[220:223]
v_dot2c_f32_bf16 v40, v96, v33
v_dot2c_f32_bf16 v41, v126, v33
v_dot2c_f32_bf16 v42, v97, v33
v_dot2c_f32_bf16 v43, v127, v33
v_dot2c_f32_bf16 v44, v98, v33
v_dot2c_f32_bf16 v45, v128, v33
v_dot2c_f32_bf16 v46, v99, v33
v_dot2c_f32_bf16 v47, v129, v33
v_dot2c_f32_bf16 v48, v100, v33
buffer_load_dwordx4 a[148:151], v237, s[28:31], s52 offen offset:1024 sc1
v_dot2c_f32_bf16 v49, v130, v33
v_dot2c_f32_bf16 v50, v101, v33
v_dot2c_f32_bf16 v51, v131, v33
v_dot2c_f32_bf16 v52, v102, v33
v_dot2c_f32_bf16 v53, v132, v33
v_dot2c_f32_bf16 v54, v103, v33
v_dot2c_f32_bf16 v55, v133, v33
v_dot2c_f32_bf16 v56, v104, v33
v_dot2c_f32_bf16 v57, v134, v33
s_nop 1
v_mfma_f32_16x16x32_bf16 a[224:227], v[204:207], a[12:15], a[224:227]
s_waitcnt lgkmcnt(10)
v_perm_b32 v96, v156, v146, s4
v_perm_b32 v146, v156, v146, s5
v_mfma_f32_16x16x32_bf16 v[12:15], v[208:211], a[0:3], v[12:15]
ds_read_b64_tr_b16 v[204:205], v239 offset:24064
ds_read_b64_tr_b16 v[206:207], v239 offset:24320
v_mfma_f32_16x16x32_bf16 a[228:231], v[208:211], a[4:7], a[228:231]
v_perm_b32 v97, v157, v147, s4
v_perm_b32 v147, v157, v147, s5
v_mfma_f32_16x16x32_bf16 a[232:235], v[208:211], a[8:11], a[232:235]
v_perm_b32 v98, v158, v148, s4
v_perm_b32 v148, v158, v148, s5
v_mfma_f32_16x16x32_bf16 a[236:239], v[208:211], a[12:15], a[236:239]
s_waitcnt lgkmcnt(9)
v_perm_b32 v99, v159, v149, s4
v_perm_b32 v149, v159, v149, s5
v_mfma_f32_16x16x32_bf16 v[16:19], v[192:195], a[0:3], v[16:19]
ds_read_b64_tr_b16 v[208:209], v239 offset:25088
ds_read_b64_tr_b16 v[210:211], v239 offset:25344
v_mfma_f32_16x16x32_bf16 a[240:243], v[192:195], a[4:7], a[240:243]
v_perm_b32 v100, v160, v150, s4
v_perm_b32 v150, v160, v150, s5
v_mfma_f32_16x16x32_bf16 a[244:247], v[192:195], a[8:11], a[244:247]
v_perm_b32 v101, v161, v151, s4
v_mfma_f32_16x16x32_bf16 a[248:251], v[192:195], a[12:15], a[248:251]
s_waitcnt vmcnt(47) lgkmcnt(8)
v_mfma_f32_16x16x32_bf16 v[0:3], v[196:199], a[16:19], v[0:3]
ds_read_b64_tr_b16 v[192:193], v240 offset:26112
ds_read_b64_tr_b16 v[194:195], v240 offset:26368
v_mfma_f32_16x16x32_bf16 a[192:195], v[196:199], a[20:23], a[192:195]
buffer_load_dwordx4 a[152:155], v237, s[28:31], s52 offen offset:2048 sc1
v_perm_b32 v151, v161, v151, s5
v_mfma_f32_16x16x32_bf16 a[196:199], v[196:199], a[24:27], a[196:199]
s_waitcnt vmcnt(34)
s_barrier
v_mfma_f32_16x16x32_bf16 a[200:203], v[196:199], a[28:31], a[200:203]
s_waitcnt lgkmcnt(7)
v_perm_b32 v102, v162, v152, s4
v_perm_b32 v152, v162, v152, s5
v_mfma_f32_16x16x32_bf16 v[4:7], v[200:203], a[16:19], v[4:7]
ds_read_b64_tr_b16 v[196:197], v239 offset:26624
ds_read_b64_tr_b16 v[198:199], v239 offset:26880
v_mfma_f32_16x16x32_bf16 a[204:207], v[200:203], a[20:23], a[204:207]
buffer_load_dwordx4 a[156:159], v237, s[28:31], s52 offen offset:3072 sc1
v_perm_b32 v103, v163, v153, s4
v_mfma_f32_16x16x32_bf16 a[208:211], v[200:203], a[24:27], a[208:211]
v_perm_b32 v153, v163, v153, s5
v_perm_b32 v104, v164, v154, s4
v_mfma_f32_16x16x32_bf16 a[212:215], v[200:203], a[28:31], a[212:215]
s_waitcnt lgkmcnt(6)
v_perm_b32 v154, v164, v154, s5
v_mfma_f32_16x16x32_bf16 v[8:11], v[204:207], a[16:19], v[8:11]
s_add_u32 m0, s49, 98304
ds_read_b64_tr_b16 v[200:201], v239 offset:27648
ds_read_b64_tr_b16 v[202:203], v239 offset:27904
v_mfma_f32_16x16x32_bf16 a[216:219], v[204:207], a[20:23], a[216:219]
s_add_u32 s50, s81, 131072
buffer_load_dwordx4 v237, s[28:31], s50 offen sc1 lds
v_mfma_f32_16x16x32_bf16 a[220:223], v[204:207], a[24:27], a[220:223]
s_add_u32 m0, s49, 102400
v_dot2c_f32_bf16 v40, v96, v34
v_dot2c_f32_bf16 v41, v146, v34
v_dot2c_f32_bf16 v42, v97, v34
v_dot2c_f32_bf16 v43, v147, v34
v_dot2c_f32_bf16 v44, v98, v34
v_dot2c_f32_bf16 v45, v148, v34
v_dot2c_f32_bf16 v46, v99, v34
v_dot2c_f32_bf16 v47, v149, v34
v_dot2c_f32_bf16 v48, v100, v34
s_add_u32 s50, s81, 135168
buffer_load_dwordx4 v237, s[28:31], s50 offen sc1 lds
v_dot2c_f32_bf16 v49, v150, v34
v_dot2c_f32_bf16 v50, v101, v34
v_dot2c_f32_bf16 v51, v151, v34
v_dot2c_f32_bf16 v52, v102, v34
v_dot2c_f32_bf16 v53, v152, v34
v_dot2c_f32_bf16 v54, v103, v34
v_dot2c_f32_bf16 v55, v153, v34
v_dot2c_f32_bf16 v56, v104, v34
v_dot2c_f32_bf16 v57, v154, v34
s_nop 1
v_mfma_f32_16x16x32_bf16 a[224:227], v[204:207], a[28:31], a[224:227]
s_waitcnt lgkmcnt(6)
v_perm_b32 v96, v176, v166, s4
v_perm_b32 v166, v176, v166, s5
v_mfma_f32_16x16x32_bf16 v[12:15], v[208:211], a[16:19], v[12:15]
s_add_u32 m0, s49, 73728
ds_read_b64_tr_b16 v[204:205], v239 offset:28672
ds_read_b64_tr_b16 v[206:207], v239 offset:28928
v_mfma_f32_16x16x32_bf16 a[228:231], v[208:211], a[20:23], a[228:231]
s_add_u32 s50, s82, 24576
buffer_load_dwordx4 v237, s[28:31], s50 offen sc1 lds
v_perm_b32 v97, v177, v167, s4
v_mfma_f32_16x16x32_bf16 a[232:235], v[208:211], a[24:27], a[232:235]
v_perm_b32 v167, v177, v167, s5
v_perm_b32 v98, v178, v168, s4
v_mfma_f32_16x16x32_bf16 a[236:239], v[208:211], a[28:31], a[236:239]
s_waitcnt lgkmcnt(6)
v_perm_b32 v168, v178, v168, s5
v_mfma_f32_16x16x32_bf16 v[16:19], v[192:195], a[16:19], v[16:19]
s_add_u32 m0, s49, 77824
ds_read_b64_tr_b16 v[208:209], v239 offset:29696
ds_read_b64_tr_b16 v[210:211], v239 offset:29952
v_mfma_f32_16x16x32_bf16 a[240:243], v[192:195], a[20:23], a[240:243]
s_add_u32 s50, s82, 28672
buffer_load_dwordx4 v237, s[28:31], s50 offen sc1 lds
v_perm_b32 v99, v179, v169, s4
v_mfma_f32_16x16x32_bf16 a[244:247], v[192:195], a[24:27], a[244:247]
v_perm_b32 v169, v179, v169, s5
v_perm_b32 v100, v180, v170, s4
v_mfma_f32_16x16x32_bf16 a[248:251], v[192:195], a[28:31], a[248:251]
s_waitcnt vmcnt(41) lgkmcnt(6)
v_mfma_f32_16x16x32_bf16 v[0:3], v[196:199], a[32:35], v[0:3]
s_add_u32 m0, s49, 81920
ds_read_b64_tr_b16 v[192:193], v240 offset:30720
ds_read_b64_tr_b16 v[194:195], v240 offset:30976
v_mfma_f32_16x16x32_bf16 a[192:195], v[196:199], a[36:39], a[192:195]
s_add_u32 s50, s82, 32768
buffer_load_dwordx4 v237, s[28:31], s50 offen sc1 lds
v_perm_b32 v170, v180, v170, s5
v_mfma_f32_16x16x32_bf16 a[196:199], v[196:199], a[40:43], a[196:199]
v_perm_b32 v101, v181, v171, s4
v_perm_b32 v171, v181, v171, s5
v_mfma_f32_16x16x32_bf16 a[200:203], v[196:199], a[44:47], a[200:203]
s_waitcnt lgkmcnt(6)
v_perm_b32 v102, v182, v172, s4
v_mfma_f32_16x16x32_bf16 v[4:7], v[200:203], a[32:35], v[4:7]
s_waitcnt vmcnt(15)
ds_read_b64_tr_b16 v[196:197], v239 offset:31232
ds_read_b64_tr_b16 v[198:199], v239 offset:31488
v_mfma_f32_16x16x32_bf16 a[204:207], v[200:203], a[36:39], a[204:207]
v_cmp_gt_u32 vcc, 1, v246
v_perm_b32 v172, v182, v172, s5
v_mfma_f32_16x16x32_bf16 a[208:211], v[200:203], a[40:43], a[208:211]
s_cbranch_vccnz spin_16_v1
ok_15_v1:
v_mfma_f32_16x16x32_bf16 a[212:215], v[200:203], a[44:47], a[212:215]
s_waitcnt lgkmcnt(6)
v_perm_b32 v103, v183, v173, s4
v_perm_b32 v173, v183, v173, s5
v_mfma_f32_16x16x32_bf16 v[8:11], v[204:207], a[32:35], v[8:11]
s_add_u32 m0, s49, 106496
ds_read_b64_tr_b16 v[200:201], v239 offset:32256
ds_read_b64_tr_b16 v[202:203], v239 offset:32512
v_mfma_f32_16x16x32_bf16 a[216:219], v[204:207], a[36:39], a[216:219]
s_add_u32 s50, s81, 139264
buffer_load_dwordx4 v237, s[28:31], s50 offen sc1 lds
v_perm_b32 v104, v184, v174, s4
v_mfma_f32_16x16x32_bf16 a[220:223], v[204:207], a[40:43], a[220:223]
s_add_u32 m0, s49, 110592
v_perm_b32 v174, v184, v174, s5
v_mfma_f32_16x16x32_bf16 a[224:227], v[204:207], a[44:47], a[224:227]
s_waitcnt lgkmcnt(6)
v_dot2c_f32_bf16 v40, v96, v35
v_dot2c_f32_bf16 v41, v166, v35
v_dot2c_f32_bf16 v42, v97, v35
v_dot2c_f32_bf16 v43, v167, v35
v_dot2c_f32_bf16 v44, v98, v35
v_dot2c_f32_bf16 v45, v168, v35
v_dot2c_f32_bf16 v46, v99, v35
v_dot2c_f32_bf16 v47, v169, v35
v_dot2c_f32_bf16 v48, v100, v35
s_add_u32 s50, s81, 143360
buffer_load_dwordx4 v237, s[28:31], s50 offen sc1 lds
v_dot2c_f32_bf16 v49, v170, v35
v_dot2c_f32_bf16 v50, v101, v35
v_dot2c_f32_bf16 v51, v171, v35
v_dot2c_f32_bf16 v52, v102, v35
v_dot2c_f32_bf16 v53, v172, v35
v_dot2c_f32_bf16 v54, v103, v35
v_dot2c_f32_bf16 v55, v173, v35
v_dot2c_f32_bf16 v56, v104, v35
v_dot2c_f32_bf16 v57, v174, v35
s_nop 1
v_mfma_f32_16x16x32_bf16 v[12:15], v[208:211], a[32:35], v[12:15]
s_add_u32 s52, s79, 45056
ds_read_b64_tr_b16 v[204:205], v239 offset:33280
ds_read_b64_tr_b16 v[206:207], v239 offset:33536
v_mfma_f32_16x16x32_bf16 a[228:231], v[208:211], a[36:39], a[228:231]
buffer_load_dwordx4 a[160:163], v237, s[28:31], s52 offen offset:0 sc1
buffer_load_dwordx4 a[164:167], v237, s[28:31], s52 offen offset:1024 sc1
v_mfma_f32_16x16x32_bf16 a[232:235], v[208:211], a[40:43], a[232:235]
v_lshrrev_b32 v187, 4, v186
v_lshlrev_b32 v187, 10, v187
v_mfma_f32_16x16x32_bf16 a[236:239], v[208:211], a[44:47], a[236:239]
s_waitcnt lgkmcnt(6)
v_and_b32 v188, 15, v186
v_lshl_add_u32 v187, v188, 4, v187
v_mfma_f32_16x16x32_bf16 v[16:19], v[192:195], a[32:35], v[16:19]
ds_read_b64_tr_b16 v[208:209], v239 offset:34304
ds_read_b64_tr_b16 v[210:211], v239 offset:34560
v_mfma_f32_16x16x32_bf16 a[240:243], v[192:195], a[36:39], a[240:243]
buffer_load_dwordx4 a[168:171], v237, s[28:31], s52 offen offset:2048 sc1
v_lshl_add_u32 v188, v186, 4, s80
v_mfma_f32_16x16x32_bf16 a[244:247], v[192:195], a[40:43], a[244:247]
v_cvt_pk_bf16_f32 v68, v56, v57
v_mfma_f32_16x16x32_bf16 a[248:251], v[192:195], a[44:47], a[248:251]
s_waitcnt vmcnt(40) lgkmcnt(6)
ds_write_b32 v188, v68 offset:13312
v_mfma_f32_16x16x32_bf16 v[0:3], v[196:199], a[48:51], v[0:3]
ds_read_b64_tr_b16 v[192:193], v240 offset:35328
ds_read_b64_tr_b16 v[194:195], v240 offset:35584
v_mfma_f32_16x16x32_bf16 a[192:195], v[196:199], a[52:55], a[192:195]
buffer_load_dwordx4 a[172:175], v237, s[28:31], s52 offen offset:3072 sc1
v_cvt_pk_bf16_f32 v60, v40, v41
v_mfma_f32_16x16x32_bf16 a[196:199], v[196:199], a[56:59], a[196:199]
v_cvt_pk_bf16_f32 v61, v42, v43
v_cvt_pk_bf16_f32 v62, v44, v45
v_mfma_f32_16x16x32_bf16 a[200:203], v[196:199], a[60:63], a[200:203]
s_waitcnt lgkmcnt(7)
v_cvt_pk_bf16_f32 v63, v46, v47
v_mfma_f32_16x16x32_bf16 v[4:7], v[200:203], a[48:51], v[4:7]
ds_read_b64_tr_b16 v[196:197], v239 offset:35840
ds_read_b64_tr_b16 v[198:199], v239 offset:36096
v_mfma_f32_16x16x32_bf16 a[204:207], v[200:203], a[52:55], a[204:207]
v_cvt_pk_bf16_f32 v64, v48, v49
v_cvt_pk_bf16_f32 v65, v50, v51
v_mfma_f32_16x16x32_bf16 a[208:211], v[200:203], a[56:59], a[208:211]
v_cvt_pk_bf16_f32 v66, v52, v53
v_mfma_f32_16x16x32_bf16 a[212:215], v[200:203], a[60:63], a[212:215]
s_waitcnt lgkmcnt(7)
v_mfma_f32_16x16x32_bf16 v[8:11], v[204:207], a[48:51], v[8:11]
ds_read_b64_tr_b16 v[200:201], v239 offset:36864
ds_read_b64_tr_b16 v[202:203], v239 offset:37120
v_mfma_f32_16x16x32_bf16 a[216:219], v[204:207], a[52:55], a[216:219]
v_cvt_pk_bf16_f32 v67, v54, v55
v_mfma_f32_16x16x32_bf16 a[220:223], v[204:207], a[56:59], a[220:223]
buffer_store_dwordx4 v[60:63], v187, s[28:31], s87 offen sc1
buffer_store_dwordx4 v[64:67], v187, s[28:31], s87 offen offset:256 sc1
v_mfma_f32_16x16x32_bf16 a[224:227], v[204:207], a[60:63], a[224:227]
s_waitcnt lgkmcnt(7)
v_mfma_f32_16x16x32_bf16 v[12:15], v[208:211], a[48:51], v[12:15]
ds_read_b64_tr_b16 v[204:205], v239 offset:37888
ds_read_b64_tr_b16 v[206:207], v239 offset:38144
v_mfma_f32_16x16x32_bf16 a[228:231], v[208:211], a[52:55], a[228:231]
v_mfma_f32_16x16x32_bf16 a[232:235], v[208:211], a[56:59], a[232:235]
v_mfma_f32_16x16x32_bf16 a[236:239], v[208:211], a[60:63], a[236:239]
s_waitcnt lgkmcnt(6)
v_mfma_f32_16x16x32_bf16 v[16:19], v[192:195], a[48:51], v[16:19]
s_add_u32 s52, s79, 53248
ds_read_b64_tr_b16 v[208:209], v239 offset:38912
ds_read_b64_tr_b16 v[210:211], v239 offset:39168
v_mfma_f32_16x16x32_bf16 a[240:243], v[192:195], a[52:55], a[240:243]
buffer_load_dwordx4 a[176:179], v237, s[28:31], s52 offen offset:0 sc1
v_mfma_f32_16x16x32_bf16 a[244:247], v[192:195], a[56:59], a[244:247]
v_mfma_f32_16x16x32_bf16 a[248:251], v[192:195], a[60:63], a[248:251]
s_waitcnt vmcnt(40) lgkmcnt(6)
v_mfma_f32_16x16x32_bf16 v[0:3], v[196:199], a[64:67], v[0:3]
ds_read_b64_tr_b16 v[192:193], v240 offset:39936
ds_read_b64_tr_b16 v[194:195], v240 offset:40192
v_mfma_f32_16x16x32_bf16 a[192:195], v[196:199], a[68:71], a[192:195]
buffer_load_dwordx4 a[180:183], v237, s[28:31], s52 offen offset:1024 sc1
v_mfma_f32_16x16x32_bf16 a[196:199], v[196:199], a[72:75], a[196:199]
v_mfma_f32_16x16x32_bf16 a[200:203], v[196:199], a[76:79], a[200:203]
s_waitcnt lgkmcnt(6)
v_mfma_f32_16x16x32_bf16 v[4:7], v[200:203], a[64:67], v[4:7]
ds_read_b64_tr_b16 v[196:197], v239 offset:40448
ds_read_b64_tr_b16 v[198:199], v239 offset:40704
v_mfma_f32_16x16x32_bf16 a[204:207], v[200:203], a[68:71], a[204:207]
buffer_load_dwordx4 a[184:187], v237, s[28:31], s52 offen offset:2048 sc1
v_mfma_f32_16x16x32_bf16 a[208:211], v[200:203], a[72:75], a[208:211]
v_mfma_f32_16x16x32_bf16 a[212:215], v[200:203], a[76:79], a[212:215]
s_waitcnt lgkmcnt(6)
v_mfma_f32_16x16x32_bf16 v[8:11], v[204:207], a[64:67], v[8:11]
ds_read_b64_tr_b16 v[200:201], v239 offset:41472
ds_read_b64_tr_b16 v[202:203], v239 offset:41728
v_mfma_f32_16x16x32_bf16 a[216:219], v[204:207], a[68:71], a[216:219]
buffer_load_dwordx4 a[188:191], v237, s[28:31], s52 offen offset:3072 sc1
v_mfma_f32_16x16x32_bf16 a[220:223], v[204:207], a[72:75], a[220:223]
v_mfma_f32_16x16x32_bf16 a[224:227], v[204:207], a[76:79], a[224:227]
s_waitcnt lgkmcnt(6)
v_mfma_f32_16x16x32_bf16 v[12:15], v[208:211], a[64:67], v[12:15]
s_add_u32 s52, s79, 61440
ds_read_b64_tr_b16 v[204:205], v239 offset:42496
ds_read_b64_tr_b16 v[206:207], v239 offset:42752
v_mfma_f32_16x16x32_bf16 a[228:231], v[208:211], a[68:71], a[228:231]
buffer_load_dwordx4 a[0:3], v237, s[28:31], s52 offen offset:0 sc1
v_mfma_f32_16x16x32_bf16 a[232:235], v[208:211], a[72:75], a[232:235]
v_mfma_f32_16x16x32_bf16 a[236:239], v[208:211], a[76:79], a[236:239]
s_waitcnt lgkmcnt(6)
v_mfma_f32_16x16x32_bf16 v[16:19], v[192:195], a[64:67], v[16:19]
ds_read_b64_tr_b16 v[208:209], v239 offset:43520
ds_read_b64_tr_b16 v[210:211], v239 offset:43776
v_mfma_f32_16x16x32_bf16 a[240:243], v[192:195], a[68:71], a[240:243]
buffer_load_dwordx4 a[4:7], v237, s[28:31], s52 offen offset:1024 sc1
v_mfma_f32_16x16x32_bf16 a[244:247], v[192:195], a[72:75], a[244:247]
v_mfma_f32_16x16x32_bf16 a[248:251], v[192:195], a[76:79], a[248:251]
s_waitcnt vmcnt(41) lgkmcnt(6)
v_mfma_f32_16x16x32_bf16 v[0:3], v[196:199], a[80:83], v[0:3]
ds_read_b64_tr_b16 v[192:193], v240 offset:44544
ds_read_b64_tr_b16 v[194:195], v240 offset:44800
v_mfma_f32_16x16x32_bf16 a[192:195], v[196:199], a[84:87], a[192:195]
v_mfma_f32_16x16x32_bf16 a[196:199], v[196:199], a[88:91], a[196:199]
s_waitcnt vmcnt(32)
s_barrier
v_mfma_f32_16x16x32_bf16 a[200:203], v[196:199], a[92:95], a[200:203]
s_waitcnt lgkmcnt(6)
v_mfma_f32_16x16x32_bf16 v[4:7], v[200:203], a[80:83], v[4:7]
ds_read_b64_tr_b16 v[196:197], v239 offset:45056
ds_read_b64_tr_b16 v[198:199], v239 offset:45312
v_mfma_f32_16x16x32_bf16 a[204:207], v[200:203], a[84:87], a[204:207]
ds_read_b128 v[56:59], v230 offset:13312
v_mfma_f32_16x16x32_bf16 a[208:211], v[200:203], a[88:91], a[208:211]
v_mfma_f32_16x16x32_bf16 a[212:215], v[200:203], a[92:95], a[212:215]
s_waitcnt lgkmcnt(7)
v_mfma_f32_16x16x32_bf16 v[8:11], v[204:207], a[80:83], v[8:11]
ds_read_b64_tr_b16 v[200:201], v239 offset:46080
ds_read_b64_tr_b16 v[202:203], v239 offset:46336
v_mfma_f32_16x16x32_bf16 a[216:219], v[204:207], a[84:87], a[216:219]
buffer_load_dwordx4 a[8:11], v237, s[28:31], s52 offen offset:2048 sc1
v_mfma_f32_16x16x32_bf16 a[220:223], v[204:207], a[88:91], a[220:223]
v_mfma_f32_16x16x32_bf16 a[224:227], v[204:207], a[92:95], a[224:227]
s_waitcnt lgkmcnt(7)
v_mfma_f32_16x16x32_bf16 v[12:15], v[208:211], a[80:83], v[12:15]
ds_read_b64_tr_b16 v[204:205], v239 offset:47104
ds_read_b64_tr_b16 v[206:207], v239 offset:47360
v_mfma_f32_16x16x32_bf16 a[228:231], v[208:211], a[84:87], a[228:231]
buffer_load_dwordx4 a[12:15], v237, s[28:31], s52 offen offset:3072 sc1
v_mfma_f32_16x16x32_bf16 a[232:235], v[208:211], a[88:91], a[232:235]
v_mfma_f32_16x16x32_bf16 a[236:239], v[208:211], a[92:95], a[236:239]
s_waitcnt lgkmcnt(7)
v_mfma_f32_16x16x32_bf16 v[16:19], v[192:195], a[80:83], v[16:19]
s_add_u32 s52, s79, 69632
ds_read_b64_tr_b16 v[208:209], v239 offset:48128
ds_read_b64_tr_b16 v[210:211], v239 offset:48384
v_mfma_f32_16x16x32_bf16 a[240:243], v[192:195], a[84:87], a[240:243]
buffer_load_dwordx4 a[16:19], v237, s[28:31], s52 offen offset:0 sc1
v_mfma_f32_16x16x32_bf16 a[244:247], v[192:195], a[88:91], a[244:247]
v_mfma_f32_16x16x32_bf16 a[248:251], v[192:195], a[92:95], a[248:251]
s_waitcnt vmcnt(38) lgkmcnt(7)
v_mfma_f32_16x16x32_bf16 v[0:3], v[196:199], a[96:99], v[0:3]
ds_read_b64_tr_b16 v[192:193], v240 offset:49152
ds_read_b64_tr_b16 v[194:195], v240 offset:49408
v_mfma_f32_16x16x32_bf16 a[192:195], v[196:199], a[100:103], a[192:195]
buffer_load_dwordx4 a[20:23], v237, s[28:31], s52 offen offset:1024 sc1
v_mfma_f32_16x16x32_bf16 a[196:199], v[196:199], a[104:107], a[196:199]
v_mfma_f32_16x16x32_bf16 a[200:203], v[196:199], a[108:111], a[200:203]
s_waitcnt lgkmcnt(6)
buffer_store_dwordx4 v[56:59], v231, s[28:31], s88 offen sc1
v_mfma_f32_16x16x32_bf16 v[4:7], v[200:203], a[96:99], v[4:7]
ds_read_b64_tr_b16 v[196:197], v239 offset:49664
ds_read_b64_tr_b16 v[198:199], v239 offset:49920
v_mfma_f32_16x16x32_bf16 a[204:207], v[200:203], a[100:103], a[204:207]
buffer_load_dwordx4 a[24:27], v237, s[28:31], s52 offen offset:2048 sc1
v_mfma_f32_16x16x32_bf16 a[208:211], v[200:203], a[104:107], a[208:211]
v_mfma_f32_16x16x32_bf16 a[212:215], v[200:203], a[108:111], a[212:215]
s_waitcnt lgkmcnt(6)
v_mfma_f32_16x16x32_bf16 v[8:11], v[204:207], a[96:99], v[8:11]
ds_read_b64_tr_b16 v[200:201], v239 offset:50688
ds_read_b64_tr_b16 v[202:203], v239 offset:50944
v_mfma_f32_16x16x32_bf16 a[216:219], v[204:207], a[100:103], a[216:219]
buffer_load_dwordx4 a[28:31], v237, s[28:31], s52 offen offset:3072 sc1
v_mfma_f32_16x16x32_bf16 a[220:223], v[204:207], a[104:107], a[220:223]
v_mfma_f32_16x16x32_bf16 a[224:227], v[204:207], a[108:111], a[224:227]
s_waitcnt lgkmcnt(6)
v_mfma_f32_16x16x32_bf16 v[12:15], v[208:211], a[96:99], v[12:15]
s_add_u32 m0, s49, 114688
ds_read_b64_tr_b16 v[204:205], v239 offset:51712
ds_read_b64_tr_b16 v[206:207], v239 offset:51968
v_mfma_f32_16x16x32_bf16 a[228:231], v[208:211], a[100:103], a[228:231]
s_add_u32 s50, s81, 147456
buffer_load_dwordx4 v237, s[28:31], s50 offen sc1 lds
v_mfma_f32_16x16x32_bf16 a[232:235], v[208:211], a[104:107], a[232:235]
v_mfma_f32_16x16x32_bf16 a[236:239], v[208:211], a[108:111], a[236:239]
s_waitcnt lgkmcnt(6)
v_mfma_f32_16x16x32_bf16 v[16:19], v[192:195], a[96:99], v[16:19]
s_add_u32 m0, s49, 118784
ds_read_b64_tr_b16 v[208:209], v239 offset:52736
ds_read_b64_tr_b16 v[210:211], v239 offset:52992
v_mfma_f32_16x16x32_bf16 a[240:243], v[192:195], a[100:103], a[240:243]
s_add_u32 s50, s81, 151552
buffer_load_dwordx4 v237, s[28:31], s50 offen sc1 lds
v_mfma_f32_16x16x32_bf16 a[244:247], v[192:195], a[104:107], a[244:247]
v_mfma_f32_16x16x32_bf16 a[248:251], v[192:195], a[108:111], a[248:251]
s_waitcnt vmcnt(36) lgkmcnt(6)
v_mfma_f32_16x16x32_bf16 v[0:3], v[196:199], a[112:115], v[0:3]
s_add_u32 m0, s49, 122880
ds_read_b64_tr_b16 v[192:193], v240 offset:53760
ds_read_b64_tr_b16 v[194:195], v240 offset:54016
v_mfma_f32_16x16x32_bf16 a[192:195], v[196:199], a[116:119], a[192:195]
s_add_u32 s50, s81, 155648
buffer_load_dwordx4 v237, s[28:31], s50 offen sc1 lds
v_mfma_f32_16x16x32_bf16 a[196:199], v[196:199], a[120:123], a[196:199]
v_mfma_f32_16x16x32_bf16 a[200:203], v[196:199], a[124:127], a[200:203]
s_waitcnt lgkmcnt(6)
v_mfma_f32_16x16x32_bf16 v[4:7], v[200:203], a[112:115], v[4:7]
s_add_u32 m0, s49, 126976
ds_read_b64_tr_b16 v[196:197], v239 offset:54272
ds_read_b64_tr_b16 v[198:199], v239 offset:54528
v_mfma_f32_16x16x32_bf16 a[204:207], v[200:203], a[116:119], a[204:207]
s_add_u32 s50, s81, 159744
buffer_load_dwordx4 v237, s[28:31], s50 offen sc1 lds
v_mfma_f32_16x16x32_bf16 a[208:211], v[200:203], a[120:123], a[208:211]
v_mfma_f32_16x16x32_bf16 a[212:215], v[200:203], a[124:127], a[212:215]
s_waitcnt lgkmcnt(6)
v_mfma_f32_16x16x32_bf16 v[8:11], v[204:207], a[112:115], v[8:11]
s_add_u32 m0, s49, 131072
ds_read_b64_tr_b16 v[200:201], v239 offset:55296
ds_read_b64_tr_b16 v[202:203], v239 offset:55552
v_mfma_f32_16x16x32_bf16 a[216:219], v[204:207], a[116:119], a[216:219]
s_add_u32 s50, s81, 163840
buffer_load_dwordx4 v237, s[28:31], s50 offen sc1 lds
v_mfma_f32_16x16x32_bf16 a[220:223], v[204:207], a[120:123], a[220:223]
v_mfma_f32_16x16x32_bf16 a[224:227], v[204:207], a[124:127], a[224:227]
s_waitcnt lgkmcnt(6)
v_mfma_f32_16x16x32_bf16 v[12:15], v[208:211], a[112:115], v[12:15]
ds_read_b64_tr_b16 v[204:205], v239 offset:56320
ds_read_b64_tr_b16 v[206:207], v239 offset:56576
v_mfma_f32_16x16x32_bf16 a[228:231], v[208:211], a[116:119], a[228:231]
v_mfma_f32_16x16x32_bf16 a[232:235], v[208:211], a[120:123], a[232:235]
v_mfma_f32_16x16x32_bf16 a[236:239], v[208:211], a[124:127], a[236:239]
s_waitcnt lgkmcnt(6)
v_mfma_f32_16x16x32_bf16 v[16:19], v[192:195], a[112:115], v[16:19]
s_add_u32 s52, s79, 118784
ds_read_b64_tr_b16 v[208:209], v239 offset:57344
ds_read_b64_tr_b16 v[210:211], v239 offset:57600
v_mfma_f32_16x16x32_bf16 a[240:243], v[192:195], a[116:119], a[240:243]
buffer_load_dwordx4 a[32:35], v237, s[28:31], s52 offen offset:0 sc1
v_mfma_f32_16x16x32_bf16 a[244:247], v[192:195], a[120:123], a[244:247]
v_mfma_f32_16x16x32_bf16 a[248:251], v[192:195], a[124:127], a[248:251]
s_waitcnt vmcnt(36) lgkmcnt(6)
v_mfma_f32_16x16x32_bf16 v[0:3], v[196:199], a[128:131], v[0:3]
ds_read_b64_tr_b16 v[192:193], v240 offset:58368
ds_read_b64_tr_b16 v[194:195], v240 offset:58624
v_mfma_f32_16x16x32_bf16 a[192:195], v[196:199], a[132:135], a[192:195]
buffer_load_dwordx4 a[36:39], v237, s[28:31], s52 offen offset:1024 sc1
v_mfma_f32_16x16x32_bf16 a[196:199], v[196:199], a[136:139], a[196:199]
v_mfma_f32_16x16x32_bf16 a[200:203], v[196:199], a[140:143], a[200:203]
s_waitcnt lgkmcnt(6)
v_mfma_f32_16x16x32_bf16 v[4:7], v[200:203], a[128:131], v[4:7]
ds_read_b64_tr_b16 v[196:197], v239 offset:58880
ds_read_b64_tr_b16 v[198:199], v239 offset:59136
v_mfma_f32_16x16x32_bf16 a[204:207], v[200:203], a[132:135], a[204:207]
buffer_load_dwordx4 a[40:43], v237, s[28:31], s52 offen offset:2048 sc1
v_mfma_f32_16x16x32_bf16 a[208:211], v[200:203], a[136:139], a[208:211]
v_mfma_f32_16x16x32_bf16 a[212:215], v[200:203], a[140:143], a[212:215]
s_waitcnt lgkmcnt(6)
v_mfma_f32_16x16x32_bf16 v[8:11], v[204:207], a[128:131], v[8:11]
s_waitcnt vmcnt(10)
ds_read_b64_tr_b16 v[200:201], v239 offset:59904
ds_read_b64_tr_b16 v[202:203], v239 offset:60160
v_mfma_f32_16x16x32_bf16 a[216:219], v[204:207], a[132:135], a[216:219]
buffer_store_dword v242, off, s[28:31], s89 sc1
buffer_load_dwordx4 a[44:47], v237, s[28:31], s52 offen offset:3072 sc1
v_mfma_f32_16x16x32_bf16 a[220:223], v[204:207], a[136:139], a[220:223]
v_mfma_f32_16x16x32_bf16 a[224:227], v[204:207], a[140:143], a[224:227]
s_waitcnt lgkmcnt(6)
v_mfma_f32_16x16x32_bf16 v[12:15], v[208:211], a[128:131], v[12:15]
s_add_u32 s52, s79, 126976
ds_read_b64_tr_b16 v[204:205], v239 offset:60928
ds_read_b64_tr_b16 v[206:207], v239 offset:61184
v_mfma_f32_16x16x32_bf16 a[228:231], v[208:211], a[132:135], a[228:231]
buffer_load_dwordx4 a[48:51], v237, s[28:31], s52 offen offset:0 sc1
v_mfma_f32_16x16x32_bf16 a[232:235], v[208:211], a[136:139], a[232:235]
v_mfma_f32_16x16x32_bf16 a[236:239], v[208:211], a[140:143], a[236:239]
s_waitcnt lgkmcnt(6)
v_mfma_f32_16x16x32_bf16 v[16:19], v[192:195], a[128:131], v[16:19]
ds_read_b64_tr_b16 v[208:209], v239 offset:61952
ds_read_b64_tr_b16 v[210:211], v239 offset:62208
v_mfma_f32_16x16x32_bf16 a[240:243], v[192:195], a[132:135], a[240:243]
buffer_load_dwordx4 a[52:55], v237, s[28:31], s52 offen offset:1024 sc1
v_mfma_f32_16x16x32_bf16 a[244:247], v[192:195], a[136:139], a[244:247]
v_mfma_f32_16x16x32_bf16 a[248:251], v[192:195], a[140:143], a[248:251]
s_waitcnt vmcnt(38) lgkmcnt(6)
v_mfma_f32_16x16x32_bf16 v[0:3], v[196:199], a[144:147], v[0:3]
ds_read_b64_tr_b16 v[192:193], v240 offset:62976
ds_read_b64_tr_b16 v[194:195], v240 offset:63232
v_mfma_f32_16x16x32_bf16 a[192:195], v[196:199], a[148:151], a[192:195]
buffer_load_dwordx4 a[56:59], v237, s[28:31], s52 offen offset:2048 sc1
v_lshrrev_b32 v243, 9, v237
v_mfma_f32_16x16x32_bf16 a[196:199], v[196:199], a[152:155], a[196:199]
s_waitcnt vmcnt(32)
s_barrier
v_mfma_f32_16x16x32_bf16 a[200:203], v[196:199], a[156:159], a[200:203]
s_waitcnt lgkmcnt(6)
v_lshrrev_b32 v96, 1, v237
v_lshl_add_u32 v243, v243, 30, v96
v_mfma_f32_16x16x32_bf16 v[4:7], v[200:203], a[144:147], v[4:7]
s_mov_b32 s6, 0xffff0000
ds_read_b64_tr_b16 v[196:197], v239 offset:63488
ds_read_b64_tr_b16 v[198:199], v239 offset:63744
v_mfma_f32_16x16x32_bf16 a[204:207], v[200:203], a[148:151], a[204:207]
buffer_load_dwordx4 a[60:63], v237, s[28:31], s52 offen offset:3072 sc1
v_lshlrev_b32 v116, 16, v248
v_mfma_f32_16x16x32_bf16 a[208:211], v[200:203], a[152:155], a[208:211]
v_and_b32 v117, s6, v248
v_mfma_f32_16x16x32_bf16 a[212:215], v[200:203], a[156:159], a[212:215]
s_waitcnt lgkmcnt(6)
v_mfma_f32_16x16x32_bf16 v[8:11], v[204:207], a[144:147], v[8:11]
ds_read_b64_tr_b16 v[200:201], v239 offset:64512
ds_read_b64_tr_b16 v[202:203], v239 offset:64768
v_mfma_f32_16x16x32_bf16 a[216:219], v[204:207], a[148:151], a[216:219]
v_lshlrev_b32 v118, 16, v249
v_and_b32 v119, s6, v249
v_mfma_f32_16x16x32_bf16 a[220:223], v[204:207], a[152:155], a[220:223]
v_mfma_f32_16x16x32_bf16 a[224:227], v[204:207], a[156:159], a[224:227]
s_waitcnt lgkmcnt(6)
v_mfma_f32_16x16x32_bf16 v[12:15], v[208:211], a[144:147], v[12:15]
s_add_u32 s52, s79, 135168
ds_read_b64_tr_b16 v[204:205], v239 offset:0
ds_read_b64_tr_b16 v[206:207], v239 offset:256
v_mfma_f32_16x16x32_bf16 a[228:231], v[208:211], a[148:151], a[228:231]
buffer_load_dwordx4 a[64:67], v237, s[28:31], s52 offen offset:0 sc1
v_lshlrev_b32 v120, 16, v250
v_mfma_f32_16x16x32_bf16 a[232:235], v[208:211], a[152:155], a[232:235]
v_and_b32 v121, s6, v250
v_mfma_f32_16x16x32_bf16 a[236:239], v[208:211], a[156:159], a[236:239]
s_waitcnt lgkmcnt(6)
v_mfma_f32_16x16x32_bf16 v[16:19], v[192:195], a[144:147], v[16:19]
ds_read_b64_tr_b16 v[208:209], v239 offset:1024
ds_read_b64_tr_b16 v[210:211], v239 offset:1280
v_mfma_f32_16x16x32_bf16 a[240:243], v[192:195], a[148:151], a[240:243]
buffer_load_dwordx4 a[68:71], v237, s[28:31], s52 offen offset:1024 sc1
v_lshlrev_b32 v122, 16, v251
v_mfma_f32_16x16x32_bf16 a[244:247], v[192:195], a[152:155], a[244:247]
v_and_b32 v123, s6, v251
v_mfma_f32_16x16x32_bf16 a[248:251], v[192:195], a[156:159], a[248:251]
s_waitcnt vmcnt(31) lgkmcnt(6)
v_mfma_f32_16x16x32_bf16 v[0:3], v[196:199], a[160:163], v[0:3]
ds_read_b64_tr_b16 v[192:193], v240 offset:2048
ds_read_b64_tr_b16 v[194:195], v240 offset:2304
v_mfma_f32_16x16x32_bf16 a[192:195], v[196:199], a[164:167], a[192:195]
buffer_load_dwordx4 a[72:75], v237, s[28:31], s52 offen offset:2048 sc1
v_lshlrev_b32 v124, 16, v252
v_mfma_f32_16x16x32_bf16 a[196:199], v[196:199], a[168:171], a[196:199]
TCH_10_v1:
s_cbranch_execz TCH_back
v_and_b32 v125, s6, v252
v_lshlrev_b32 v126, 16, v253
v_mfma_f32_16x16x32_bf16 a[200:203], v[196:199], a[172:175], a[200:203]
s_waitcnt lgkmcnt(6)
v_mfma_f32_16x16x32_bf16 v[4:7], v[200:203], a[160:163], v[4:7]
ds_read_b64_tr_b16 v[196:197], v239 offset:2560
ds_read_b64_tr_b16 v[198:199], v239 offset:2816
v_mfma_f32_16x16x32_bf16 a[204:207], v[200:203], a[164:167], a[204:207]
buffer_load_dwordx4 a[76:79], v237, s[28:31], s52 offen offset:3072 sc1
v_and_b32 v127, s6, v253
v_mfma_f32_16x16x32_bf16 a[208:211], v[200:203], a[168:171], a[208:211]
v_lshlrev_b32 v128, 16, v254
v_mfma_f32_16x16x32_bf16 a[212:215], v[200:203], a[172:175], a[212:215]
s_waitcnt lgkmcnt(6)
v_mfma_f32_16x16x32_bf16 v[8:11], v[204:207], a[160:163], v[8:11]
s_add_u32 s52, s79, 143360
ds_read_b64_tr_b16 v[200:201], v239 offset:3584
ds_read_b64_tr_b16 v[202:203], v239 offset:3840
v_mfma_f32_16x16x32_bf16 a[216:219], v[204:207], a[164:167], a[216:219]
buffer_load_dwordx4 a[80:83], v237, s[28:31], s52 offen offset:0 sc1
v_and_b32 v129, s6, v254
v_mfma_f32_16x16x32_bf16 a[220:223], v[204:207], a[168:171], a[220:223]
v_lshlrev_b32 v130, 16, v255
v_mfma_f32_16x16x32_bf16 a[224:227], v[204:207], a[172:175], a[224:227]
s_waitcnt lgkmcnt(6)
v_mfma_f32_16x16x32_bf16 v[12:15], v[208:211], a[160:163], v[12:15]
ds_read_b64_tr_b16 v[204:205], v239 offset:4608
ds_read_b64_tr_b16 v[206:207], v239 offset:4864
v_mfma_f32_16x16x32_bf16 a[228:231], v[208:211], a[164:167], a[228:231]
buffer_load_dwordx4 a[84:87], v237, s[28:31], s52 offen offset:1024 sc1
v_and_b32 v131, s6, v255
v_mfma_f32_16x16x32_bf16 a[232:235], v[208:211], a[168:171], a[232:235]
v_lshlrev_b32 v132, 16, v244
v_mfma_f32_16x16x32_bf16 a[236:239], v[208:211], a[172:175], a[236:239]
s_waitcnt lgkmcnt(6)
v_mfma_f32_16x16x32_bf16 v[16:19], v[192:195], a[160:163], v[16:19]
ds_read_b64_tr_b16 v[208:209], v239 offset:5632
ds_read_b64_tr_b16 v[210:211], v239 offset:5888
v_mfma_f32_16x16x32_bf16 a[240:243], v[192:195], a[164:167], a[240:243]
buffer_load_dwordx4 a[88:91], v237, s[28:31], s52 offen offset:2048 sc1
v_and_b32 v133, s6, v244
v_mfma_f32_16x16x32_bf16 a[244:247], v[192:195], a[168:171], a[244:247]
v_lshlrev_b32 v134, 16, v245
v_and_b32 v135, s6, v245
v_mfma_f32_16x16x32_bf16 a[248:251], v[192:195], a[172:175], a[248:251]
s_waitcnt vmcnt(30) lgkmcnt(6)
v_mfma_f32_16x16x32_bf16 v[0:3], v[196:199], a[176:179], v[0:3]
ds_read_b64_tr_b16 v[192:193], v240 offset:6656
ds_read_b64_tr_b16 v[194:195], v240 offset:6912
v_mfma_f32_16x16x32_bf16 a[192:195], v[196:199], a[180:183], a[192:195]
buffer_load_dwordx4 a[92:95], v237, s[28:31], s52 offen offset:3072 sc1
v_mov_b32 v136, 0
v_mfma_f32_16x16x32_bf16 a[196:199], v[196:199], a[184:187], a[196:199]
v_mov_b32 v137, 0
v_mfma_f32_16x16x32_bf16 a[200:203], v[196:199], a[188:191], a[200:203]
s_waitcnt lgkmcnt(6)
v_mfma_f32_16x16x32_bf16 v[4:7], v[200:203], a[176:179], v[4:7]
s_add_u32 m0, s49, 86016
ds_read_b64_tr_b16 v[196:197], v239 offset:7168
ds_read_b64_tr_b16 v[198:199], v239 offset:7424
v_mfma_f32_16x16x32_bf16 a[204:207], v[200:203], a[180:183], a[204:207]
s_add_u32 s50, s82, 36864
buffer_load_dwordx4 v237, s[28:31], s50 offen sc1 lds
v_mov_b32 v140, 0
v_mfma_f32_16x16x32_bf16 a[208:211], v[200:203], a[184:187], a[208:211]
v_mov_b32 v141, 0
v_mfma_f32_16x16x32_bf16 a[212:215], v[200:203], a[188:191], a[212:215]
s_waitcnt lgkmcnt(6)
v_mfma_f32_16x16x32_bf16 v[8:11], v[204:207], a[176:179], v[8:11]
s_add_u32 m0, s49, 90112
ds_read_b64_tr_b16 v[200:201], v239 offset:8192
ds_read_b64_tr_b16 v[202:203], v239 offset:8448
v_mfma_f32_16x16x32_bf16 a[216:219], v[204:207], a[180:183], a[216:219]
s_add_u32 s50, s82, 40960
buffer_load_dwordx4 v237, s[28:31], s50 offen sc1 lds
v_mov_b32 v62, 0
v_mfma_f32_16x16x32_bf16 a[220:223], v[204:207], a[184:187], a[220:223]
v_mov_b32 v63, 0
v_mfma_f32_16x16x32_bf16 a[224:227], v[204:207], a[188:191], a[224:227]
s_waitcnt lgkmcnt(6)
v_mfma_f32_16x16x32_bf16 v[12:15], v[208:211], a[176:179], v[12:15]
s_add_u32 m0, s49, 94208
ds_read_b64_tr_b16 v[204:205], v239 offset:9216
ds_read_b64_tr_b16 v[206:207], v239 offset:9472
v_mfma_f32_16x16x32_bf16 a[228:231], v[208:211], a[180:183], a[228:231]
s_add_u32 s50, s82, 45056
buffer_load_dwordx4 v237, s[28:31], s50 offen sc1 lds
v_mov_b32 v74, 0
v_mfma_f32_16x16x32_bf16 a[232:235], v[208:211], a[184:187], a[232:235]
v_mov_b32 v75, 0
v_mfma_f32_16x16x32_bf16 a[236:239], v[208:211], a[188:191], a[236:239]
s_waitcnt lgkmcnt(6)
v_mfma_f32_16x16x32_bf16 v[16:19], v[192:195], a[176:179], v[16:19]
s_add_u32 m0, s49, 0
ds_read_b64_tr_b16 v[208:209], v239 offset:10240
ds_read_b64_tr_b16 v[210:211], v239 offset:10496
v_mfma_f32_16x16x32_bf16 a[240:243], v[192:195], a[180:183], a[240:243]
s_add_u32 s50, s82, 49152
buffer_load_dwordx4 v237, s[28:31], s50 offen sc1 lds
v_mov_b32 v86, 0
v_mfma_f32_16x16x32_bf16 a[244:247], v[192:195], a[184:187], a[244:247]
v_mov_b32 v87, 0
v_bfe_u32 v96, v237, 6, 2
v_mfma_f32_16x16x32_bf16 a[248:251], v[192:195], a[188:191], a[248:251]
s_waitcnt vmcnt(31) lgkmcnt(6)
v_mfma_f32_16x16x32_bf16 v[0:3], v[196:199], a[0:3], v[0:3]
s_add_u32 m0, s49, 4096
ds_read_b64_tr_b16 v[192:193], v240 offset:11264
ds_read_b64_tr_b16 v[194:195], v240 offset:11520
v_mfma_f32_16x16x32_bf16 a[192:195], v[196:199], a[4:7], a[192:195]
s_add_u32 s50, s82, 53248
buffer_load_dwordx4 v237, s[28:31], s50 offen sc1 lds
v_lshrrev_b32 v97, 8, v237
v_mfma_f32_16x16x32_bf16 a[196:199], v[196:199], a[8:11], a[196:199]
v_bfe_u32 v98, v237, 5, 1
v_mfma_f32_16x16x32_bf16 a[200:203], v[196:199], a[12:15], a[200:203]
s_waitcnt lgkmcnt(6)
v_mfma_f32_16x16x32_bf16 v[4:7], v[200:203], a[0:3], v[4:7]
s_add_u32 m0, s49, 8192
ds_read_b64_tr_b16 v[196:197], v239 offset:11776
ds_read_b64_tr_b16 v[198:199], v239 offset:12032
v_mfma_f32_16x16x32_bf16 a[204:207], v[200:203], a[4:7], a[204:207]
s_add_u32 s50, s82, 57344
buffer_load_dwordx4 v237, s[28:31], s50 offen sc1 lds
v_lshl_add_u32 v96, v96, 1, v98
v_mfma_f32_16x16x32_bf16 a[208:211], v[200:203], a[8:11], a[208:211]
v_lshlrev_b32 v97, 1, v97
v_mfma_f32_16x16x32_bf16 a[212:215], v[200:203], a[12:15], a[212:215]
s_waitcnt lgkmcnt(6)
v_mfma_f32_16x16x32_bf16 v[8:11], v[204:207], a[0:3], v[8:11]
s_add_u32 m0, s49, 12288
ds_read_b64_tr_b16 v[200:201], v239 offset:12800
ds_read_b64_tr_b16 v[202:203], v239 offset:13056
v_mfma_f32_16x16x32_bf16 a[216:219], v[204:207], a[4:7], a[216:219]
s_add_u32 s50, s82, 61440
buffer_load_dwordx4 v237, s[28:31], s50 offen sc1 lds
v_and_b32 v98, 16, v237
v_mfma_f32_16x16x32_bf16 a[220:223], v[204:207], a[8:11], a[220:223]
v_mov_b32 v99, 0x3f80
v_mfma_f32_16x16x32_bf16 a[224:227], v[204:207], a[12:15], a[224:227]
s_waitcnt lgkmcnt(6)
v_mfma_f32_16x16x32_bf16 v[12:15], v[208:211], a[0:3], v[12:15]
s_add_u32 m0, s49, 16384
ds_read_b64_tr_b16 v[204:205], v239 offset:13824
ds_read_b64_tr_b16 v[206:207], v239 offset:14080
v_mfma_f32_16x16x32_bf16 a[228:231], v[208:211], a[4:7], a[228:231]
s_add_u32 s50, s82, 65536
buffer_load_dwordx4 v237, s[28:31], s50 offen sc1 lds
v_lshlrev_b32 v98, v98, v99
v_mfma_f32_16x16x32_bf16 a[232:235], v[208:211], a[8:11], a[232:235]
v_cmp_eq_u32 s[4:5], v96, v97
v_add_u32 v97, 1, v97
v_mfma_f32_16x16x32_bf16 a[236:239], v[208:211], a[12:15], a[236:239]
s_waitcnt lgkmcnt(6)
v_mfma_f32_16x16x32_bf16 v[16:19], v[192:195], a[0:3], v[16:19]
s_nop 0
ds_read_b64_tr_b16 v[208:209], v239 offset:14848
ds_read_b64_tr_b16 v[210:211], v239 offset:15104
v_mfma_f32_16x16x32_bf16 a[240:243], v[192:195], a[4:7], a[240:243]
v_cndmask_b32 v138, 0, v98, s[4:5]
v_cmp_eq_u32 s[4:5], v96, v97
v_mfma_f32_16x16x32_bf16 a[244:247], v[192:195], a[8:11], a[244:247]
v_mfma_f32_16x16x32_bf16 a[248:251], v[192:195], a[12:15], a[248:251]
s_waitcnt vmcnt(30) lgkmcnt(6)
v_mfma_f32_16x16x32_bf16 v[0:3], v[196:199], a[16:19], v[0:3]
s_nop 1
ds_read_b64_tr_b16 v[192:193], v240 offset:15872
ds_read_b64_tr_b16 v[194:195], v240 offset:16128
v_mfma_f32_16x16x32_bf16 a[192:195], v[196:199], a[20:23], a[192:195]
s_add_u32 m0, s49, 20480
v_cndmask_b32 v139, 0, v98, s[4:5]
v_mfma_f32_16x16x32_bf16 a[196:199], v[196:199], a[24:27], a[196:199]
s_waitcnt vmcnt(25)
s_barrier
v_mfma_f32_16x16x32_bf16 a[200:203], v[196:199], a[28:31], a[200:203]
s_waitcnt lgkmcnt(6)
v_mfma_f32_16x16x32_bf16 v[4:7], v[200:203], a[16:19], v[4:7]
s_add_u32 s50, s82, 69632
ds_read_b64_tr_b16 v[196:197], v240 offset:20480
ds_read_b64_tr_b16 v[198:199], v240 offset:20736
v_mfma_f32_16x16x32_bf16 a[204:207], v[200:203], a[20:23], a[204:207]
buffer_load_dwordx4 v237, s[28:31], s50 offen sc1 lds
v_mfma_f32_16x16x32_bf16 a[208:211], v[200:203], a[24:27], a[208:211]
s_add_u32 m0, s49, 24576
v_mfma_f32_16x16x32_bf16 a[212:215], v[200:203], a[28:31], a[212:215]
s_waitcnt lgkmcnt(6)
v_mfma_f32_16x16x32_bf16 v[8:11], v[204:207], a[16:19], v[8:11]
s_add_u32 s50, s82, 73728
ds_read_b64_tr_b16 v[200:201], v240 offset:25088
ds_read_b64_tr_b16 v[202:203], v240 offset:25344
v_mfma_f32_16x16x32_bf16 a[216:219], v[204:207], a[20:23], a[216:219]
buffer_load_dwordx4 v237, s[28:31], s50 offen sc1 lds
v_mfma_f32_16x16x32_bf16 a[220:223], v[204:207], a[24:27], a[220:223]
s_add_u32 m0, s49, 28672
v_mfma_f32_16x16x32_bf16 a[224:227], v[204:207], a[28:31], a[224:227]
s_waitcnt lgkmcnt(6)
v_mfma_f32_16x16x32_bf16 v[12:15], v[208:211], a[16:19], v[12:15]
s_add_u32 s50, s82, 77824
ds_read_b64_tr_b16 v[204:205], v240 offset:29696
ds_read_b64_tr_b16 v[206:207], v240 offset:29952
v_mfma_f32_16x16x32_bf16 a[228:231], v[208:211], a[20:23], a[228:231]
buffer_load_dwordx4 v237, s[28:31], s50 offen sc1 lds
v_mfma_f32_16x16x32_bf16 a[232:235], v[208:211], a[24:27], a[232:235]
s_add_u32 m0, s49, 32768
v_mfma_f32_16x16x32_bf16 a[236:239], v[208:211], a[28:31], a[236:239]
s_waitcnt lgkmcnt(6)
v_mfma_f32_16x16x32_bf16 v[16:19], v[192:195], a[16:19], v[16:19]
s_add_u32 s50, s82, 81920
ds_read_b64_tr_b16 v[208:209], v240 offset:34304
ds_read_b64_tr_b16 v[210:211], v240 offset:34560
v_mfma_f32_16x16x32_bf16 a[240:243], v[192:195], a[20:23], a[240:243]
buffer_load_dwordx4 v237, s[28:31], s50 offen sc1 lds
v_mfma_f32_16x16x32_bf16 a[244:247], v[192:195], a[24:27], a[244:247]
v_mfma_f32_16x16x32_bf16 a[248:251], v[192:195], a[28:31], a[248:251]
s_waitcnt vmcnt(24) lgkmcnt(6)
v_mfma_f32_16x16x32_bf16 a[240:243], v[196:199], a[36:39], a[240:243]
ds_read_b64_tr_b16 v[192:193], v239 offset:16384
ds_read_b64_tr_b16 v[194:195], v239 offset:16640
v_mfma_f32_16x16x32_bf16 a[244:247], v[196:199], a[40:43], a[244:247]
v_mfma_f32_16x16x32_bf16 a[248:251], v[196:199], a[44:47], a[248:251]
s_waitcnt vmcnt(20) lgkmcnt(6)
v_mfma_f32_16x16x32_bf16 a[240:243], v[200:203], a[52:55], a[240:243]
ds_read_b64_tr_b16 v[196:197], v239 offset:20992
ds_read_b64_tr_b16 v[198:199], v239 offset:21248
v_mfma_f32_16x16x32_bf16 a[244:247], v[200:203], a[56:59], a[244:247]
v_mfma_f32_16x16x32_bf16 a[248:251], v[200:203], a[60:63], a[248:251]
s_waitcnt vmcnt(16) lgkmcnt(6)
v_mfma_f32_16x16x32_bf16 a[240:243], v[204:207], a[68:71], a[240:243]
ds_read_b64_tr_b16 v[200:201], v239 offset:25600
ds_read_b64_tr_b16 v[202:203], v239 offset:25856
v_mfma_f32_16x16x32_bf16 a[244:247], v[204:207], a[72:75], a[244:247]
v_mfma_f32_16x16x32_bf16 a[248:251], v[204:207], a[76:79], a[248:251]
s_waitcnt vmcnt(12) lgkmcnt(6)
v_mfma_f32_16x16x32_bf16 a[240:243], v[208:211], a[84:87], a[240:243]
ds_read_b64_tr_b16 v[204:205], v239 offset:30208
ds_read_b64_tr_b16 v[206:207], v239 offset:30464
v_mfma_f32_16x16x32_bf16 a[244:247], v[208:211], a[88:91], a[244:247]
v_mfma_f32_16x16x32_bf16 a[248:251], v[208:211], a[92:95], a[248:251]
s_waitcnt lgkmcnt(6)
v_mfma_f32_16x16x32_bf16 a[192:195], v[192:195], a[36:39], a[192:195]
ds_read_b64_tr_b16 v[208:209], v239 offset:17408
ds_read_b64_tr_b16 v[210:211], v239 offset:17664
v_mfma_f32_16x16x32_bf16 a[196:199], v[192:195], a[40:43], a[196:199]
v_mfma_f32_16x16x32_bf16 a[200:203], v[192:195], a[44:47], a[200:203]
s_waitcnt lgkmcnt(6)
v_mfma_f32_16x16x32_bf16 a[192:195], v[196:199], a[52:55], a[192:195]
ds_read_b64_tr_b16 v[192:193], v239 offset:22016
ds_read_b64_tr_b16 v[194:195], v239 offset:22272
v_mfma_f32_16x16x32_bf16 a[196:199], v[196:199], a[56:59], a[196:199]
v_accvgpr_read_b32 v92, a240
v_accvgpr_read_b32 v93, a241
v_mfma_f32_16x16x32_bf16 a[200:203], v[196:199], a[60:63], a[200:203]
s_waitcnt lgkmcnt(6)
v_accvgpr_read_b32 v94, a242
v_accvgpr_read_b32 v95, a243
v_mfma_f32_16x16x32_bf16 a[192:195], v[200:203], a[68:71], a[192:195]
ds_read_b64_tr_b16 v[196:197], v239 offset:26624
ds_read_b64_tr_b16 v[198:199], v239 offset:26880
v_mfma_f32_16x16x32_bf16 a[196:199], v[200:203], a[72:75], a[196:199]
v_cvt_pk_bf16_f32 v60, v92, v93
v_cvt_pk_bf16_f32 v61, v94, v95
v_mfma_f32_16x16x32_bf16 a[200:203], v[200:203], a[76:79], a[200:203]
s_waitcnt lgkmcnt(6)
buffer_store_dwordx2 v[60:61], v243, s[28:31], s8 offen offset:2048 sc1
v_accvgpr_read_b32 v88, a244
v_mfma_f32_16x16x32_bf16 a[192:195], v[204:207], a[84:87], a[192:195]
ds_read_b64_tr_b16 v[200:201], v239 offset:31232
ds_read_b64_tr_b16 v[202:203], v239 offset:31488
v_mfma_f32_16x16x32_bf16 a[196:199], v[204:207], a[88:91], a[196:199]
v_accvgpr_read_b32 v89, a245
v_accvgpr_read_b32 v90, a246
v_mfma_f32_16x16x32_bf16 a[200:203], v[204:207], a[92:95], a[200:203]
s_waitcnt lgkmcnt(6)
v_accvgpr_read_b32 v91, a247
v_cvt_pk_bf16_f32 v72, v88, v89
v_mfma_f32_16x16x32_bf16 a[204:207], v[208:211], a[36:39], a[204:207]
ds_read_b64_tr_b16 v[204:205], v239 offset:18432
ds_read_b64_tr_b16 v[206:207], v239 offset:18688
v_mfma_f32_16x16x32_bf16 a[208:211], v[208:211], a[40:43], a[208:211]
v_cvt_pk_bf16_f32 v73, v90, v91
v_mfma_f32_16x16x32_bf16 a[212:215], v[208:211], a[44:47], a[212:215]
s_waitcnt lgkmcnt(6)
buffer_store_dwordx2 v[72:73], v243, s[28:31], s9 offen offset:2048 sc1
v_accvgpr_read_b32 v92, a248
v_mfma_f32_16x16x32_bf16 a[204:207], v[192:195], a[52:55], a[204:207]
ds_read_b64_tr_b16 v[208:209], v239 offset:23040
ds_read_b64_tr_b16 v[210:211], v239 offset:23296
v_mfma_f32_16x16x32_bf16 a[208:211], v[192:195], a[56:59], a[208:211]
v_accvgpr_read_b32 v93, a249
v_accvgpr_read_b32 v94, a250
v_mfma_f32_16x16x32_bf16 a[212:215], v[192:195], a[60:63], a[212:215]
s_waitcnt lgkmcnt(6)
v_accvgpr_read_b32 v95, a251
v_cvt_pk_bf16_f32 v84, v92, v93
v_mfma_f32_16x16x32_bf16 a[204:207], v[196:199], a[68:71], a[204:207]
ds_read_b64_tr_b16 v[192:193], v239 offset:27648
ds_read_b64_tr_b16 v[194:195], v239 offset:27904
v_mfma_f32_16x16x32_bf16 a[208:211], v[196:199], a[72:75], a[208:211]
buffer_load_dword v246, v228, s[28:31], 0 offen sc1
v_cvt_pk_bf16_f32 v85, v94, v95
v_mfma_f32_16x16x32_bf16 a[212:215], v[196:199], a[76:79], a[212:215]
s_waitcnt lgkmcnt(6)
buffer_store_dwordx2 v[84:85], v243, s[28:31], s10 offen offset:2048 sc1
v_accvgpr_read_b32 v92, a192
v_mfma_f32_16x16x32_bf16 a[204:207], v[200:203], a[84:87], a[204:207]
ds_read_b64_tr_b16 v[196:197], v239 offset:32256
ds_read_b64_tr_b16 v[198:199], v239 offset:32512
v_mfma_f32_16x16x32_bf16 a[208:211], v[200:203], a[88:91], a[208:211]
v_accvgpr_read_b32 v93, a193
v_accvgpr_read_b32 v94, a194
v_mfma_f32_16x16x32_bf16 a[212:215], v[200:203], a[92:95], a[212:215]
s_waitcnt lgkmcnt(6)
v_accvgpr_read_b32 v95, a195
v_cvt_pk_bf16_f32 v52, v92, v93
v_mfma_f32_16x16x32_bf16 a[216:219], v[204:207], a[36:39], a[216:219]
ds_read_b64_tr_b16 v[200:201], v239 offset:19456
ds_read_b64_tr_b16 v[202:203], v239 offset:19712
v_mfma_f32_16x16x32_bf16 a[220:223], v[204:207], a[40:43], a[220:223]
v_cvt_pk_bf16_f32 v53, v94, v95
v_accvgpr_read_b32 v88, a196
v_mfma_f32_16x16x32_bf16 a[224:227], v[204:207], a[44:47], a[224:227]
s_waitcnt lgkmcnt(6)
v_accvgpr_read_b32 v89, a197
v_accvgpr_read_b32 v90, a198
v_mfma_f32_16x16x32_bf16 a[216:219], v[208:211], a[52:55], a[216:219]
ds_read_b64_tr_b16 v[204:205], v239 offset:24064
ds_read_b64_tr_b16 v[206:207], v239 offset:24320
v_mfma_f32_16x16x32_bf16 a[220:223], v[208:211], a[56:59], a[220:223]
v_accvgpr_read_b32 v91, a199
v_cvt_pk_bf16_f32 v64, v88, v89
v_mfma_f32_16x16x32_bf16 a[224:227], v[208:211], a[60:63], a[224:227]
s_waitcnt lgkmcnt(6)
v_cvt_pk_bf16_f32 v65, v90, v91
v_accvgpr_read_b32 v92, a200
v_mfma_f32_16x16x32_bf16 a[216:219], v[192:195], a[68:71], a[216:219]
ds_read_b64_tr_b16 v[208:209], v239 offset:28672
ds_read_b64_tr_b16 v[210:211], v239 offset:28928
v_mfma_f32_16x16x32_bf16 a[220:223], v[192:195], a[72:75], a[220:223]
v_accvgpr_read_b32 v93, a201
v_accvgpr_read_b32 v94, a202
v_mfma_f32_16x16x32_bf16 a[224:227], v[192:195], a[76:79], a[224:227]
s_waitcnt lgkmcnt(6)
v_accvgpr_read_b32 v95, a203
v_cvt_pk_bf16_f32 v76, v92, v93
v_mfma_f32_16x16x32_bf16 a[216:219], v[196:199], a[84:87], a[216:219]
ds_read_b64_tr_b16 v[192:193], v239 offset:33280
ds_read_b64_tr_b16 v[194:195], v239 offset:33536
v_mfma_f32_16x16x32_bf16 a[220:223], v[196:199], a[88:91], a[220:223]
v_cvt_pk_bf16_f32 v77, v94, v95
v_accvgpr_read_b32 v92, a204
v_mfma_f32_16x16x32_bf16 a[224:227], v[196:199], a[92:95], a[224:227]
s_waitcnt lgkmcnt(6)
v_accvgpr_read_b32 v93, a205
v_accvgpr_read_b32 v94, a206
v_mfma_f32_16x16x32_bf16 a[228:231], v[200:203], a[36:39], a[228:231]
v_accvgpr_read_b32 v95, a207
v_cvt_pk_bf16_f32 v54, v92, v93
v_mfma_f32_16x16x32_bf16 a[232:235], v[200:203], a[40:43], a[232:235]
v_cvt_pk_bf16_f32 v55, v94, v95
v_accvgpr_read_b32 v88, a208
v_mfma_f32_16x16x32_bf16 a[236:239], v[200:203], a[44:47], a[236:239]
s_waitcnt lgkmcnt(4)
v_accvgpr_read_b32 v89, a209
v_accvgpr_read_b32 v90, a210
v_mfma_f32_16x16x32_bf16 a[228:231], v[204:207], a[52:55], a[228:231]
v_accvgpr_read_b32 v91, a211
v_cvt_pk_bf16_f32 v66, v88, v89
v_mfma_f32_16x16x32_bf16 a[232:235], v[204:207], a[56:59], a[232:235]
v_cvt_pk_bf16_f32 v67, v90, v91
v_permlane16_swap_b32 v52, v54
v_mfma_f32_16x16x32_bf16 a[236:239], v[204:207], a[60:63], a[236:239]
s_waitcnt lgkmcnt(2)
v_permlane16_swap_b32 v53, v55
v_mfma_f32_16x16x32_bf16 a[228:231], v[208:211], a[68:71], a[228:231]
buffer_store_dwordx4 v[52:55], v237, s[28:31], s8 offen offset:0 sc1
v_accvgpr_read_b32 v92, a212
v_mfma_f32_16x16x32_bf16 a[232:235], v[208:211], a[72:75], a[232:235]
v_accvgpr_read_b32 v93, a213
v_accvgpr_read_b32 v94, a214
v_mfma_f32_16x16x32_bf16 a[236:239], v[208:211], a[76:79], a[236:239]
s_waitcnt lgkmcnt(0)
v_accvgpr_read_b32 v95, a215
v_cvt_pk_bf16_f32 v78, v92, v93
v_mfma_f32_16x16x32_bf16 a[228:231], v[192:195], a[84:87], a[228:231]
v_cvt_pk_bf16_f32 v79, v94, v95
v_permlane16_swap_b32 v64, v66
v_mfma_f32_16x16x32_bf16 a[232:235], v[192:195], a[88:91], a[232:235]
v_permlane16_swap_b32 v65, v67
v_mfma_f32_16x16x32_bf16 a[236:239], v[192:195], a[92:95], a[236:239]
buffer_store_dwordx4 v[64:67], v237, s[28:31], s9 offen offset:0 sc1
s_nop 1
v_permlane16_swap_b32 v76, v78
v_permlane16_swap_b32 v77, v79
buffer_store_dwordx4 v[76:79], v237, s[28:31], s10 offen offset:0 sc1
v_accvgpr_read_b32 v92, a216
v_accvgpr_read_b32 v93, a217
v_accvgpr_read_b32 v94, a218
v_accvgpr_read_b32 v95, a219
v_cvt_pk_bf16_f32 v56, v92, v93
v_cvt_pk_bf16_f32 v57, v94, v95
v_accvgpr_read_b32 v88, a220
v_accvgpr_read_b32 v89, a221
v_accvgpr_read_b32 v90, a222
v_accvgpr_read_b32 v91, a223
v_cvt_pk_bf16_f32 v68, v88, v89
v_cvt_pk_bf16_f32 v69, v90, v91
v_accvgpr_read_b32 v92, a224
v_accvgpr_read_b32 v93, a225
v_accvgpr_read_b32 v94, a226
v_accvgpr_read_b32 v95, a227
v_cvt_pk_bf16_f32 v80, v92, v93
v_cvt_pk_bf16_f32 v81, v94, v95
s_nop 7
v_accvgpr_read_b32 v92, a228
v_accvgpr_read_b32 v93, a229
v_accvgpr_read_b32 v94, a230
v_accvgpr_read_b32 v95, a231
v_cvt_pk_bf16_f32 v58, v92, v93
v_cvt_pk_bf16_f32 v59, v94, v95
v_accvgpr_read_b32 v88, a232
v_accvgpr_read_b32 v89, a233
v_accvgpr_read_b32 v90, a234
v_accvgpr_read_b32 v91, a235
v_cvt_pk_bf16_f32 v70, v88, v89
v_cvt_pk_bf16_f32 v71, v90, v91
v_permlane16_swap_b32 v56, v58
v_permlane16_swap_b32 v57, v59
buffer_store_dwordx4 v[56:59], v237, s[28:31], s8 offen offset:1024 sc1
v_accvgpr_read_b32 v92, a236
v_accvgpr_read_b32 v93, a237
v_accvgpr_read_b32 v94, a238
v_accvgpr_read_b32 v95, a239
v_cvt_pk_bf16_f32 v82, v92, v93
v_cvt_pk_bf16_f32 v83, v94, v95
v_permlane16_swap_b32 v68, v70
v_permlane16_swap_b32 v69, v71
buffer_store_dwordx4 v[68:71], v237, s[28:31], s9 offen offset:1024 sc1
s_nop 1
v_permlane16_swap_b32 v80, v82
v_permlane16_swap_b32 v81, v83
buffer_store_dwordx4 v[80:83], v237, s[28:31], s10 offen offset:1024 sc1
s_waitcnt vmcnt(7)
v_cmp_gt_u32 vcc, 1, v246
s_cbranch_vccnz spin_18_v1
ok_17_v1:
s_add_u32 s53, s61, 0
buffer_load_dwordx4 a[96:99], v237, s[28:31], s53 offen sc1
s_add_u32 s53, s61, 4096
buffer_load_dwordx4 a[100:103], v237, s[28:31], s53 offen sc1
s_add_u32 s53, s61, 8192
buffer_load_dwordx4 a[104:107], v237, s[28:31], s53 offen sc1
s_add_u32 s53, s61, 12288
buffer_load_dwordx4 a[108:111], v237, s[28:31], s53 offen sc1
s_add_u32 s53, s61, 16384
buffer_load_dwordx4 a[112:115], v237, s[28:31], s53 offen sc1
s_add_u32 s53, s61, 20480
buffer_load_dwordx4 a[116:119], v237, s[28:31], s53 offen sc1
ds_read_b64_tr_b16 v[160:161], v239 offset:16384
ds_read_b64_tr_b16 v[162:163], v239 offset:16640
ds_read_b64_tr_b16 v[164:165], v239 offset:17408
ds_read_b64_tr_b16 v[166:167], v239 offset:17664
ds_read_b64_tr_b16 v[168:169], v239 offset:18432
ds_read_b64_tr_b16 v[170:171], v239 offset:18688
ds_read_b64_tr_b16 v[172:173], v239 offset:19456
ds_read_b64_tr_b16 v[174:175], v239 offset:19712
ds_read_b64_tr_b16 v[176:177], v240 offset:20480
ds_read_b64_tr_b16 v[178:179], v240 offset:20736
ds_read_b64_tr_b16 v[180:181], v239 offset:20992
ds_read_b64_tr_b16 v[182:183], v239 offset:21248
ds_read_b64_tr_b16 v[184:185], v239 offset:22016
ds_read_b64_tr_b16 v[186:187], v239 offset:22272
s_waitcnt lgkmcnt(12)
v_mfma_f32_16x16x32_bf16 v[0:3], v[160:163], a[32:35], v[0:3]
s_waitcnt lgkmcnt(10)
ds_read_b64_tr_b16 v[188:189], v239 offset:23040
ds_read_b64_tr_b16 v[190:191], v239 offset:23296
v_mfma_f32_16x16x32_bf16 v[4:7], v[164:167], a[32:35], v[4:7]
s_waitcnt lgkmcnt(10)
ds_read_b64_tr_b16 v[160:161], v239 offset:24064
ds_read_b64_tr_b16 v[162:163], v239 offset:24320
v_mfma_f32_16x16x32_bf16 v[8:11], v[168:171], a[32:35], v[8:11]
s_waitcnt lgkmcnt(10)
ds_read_b64_tr_b16 v[164:165], v240 offset:25088
ds_read_b64_tr_b16 v[166:167], v240 offset:25344
v_mfma_f32_16x16x32_bf16 v[12:15], v[172:175], a[32:35], v[12:15]
s_waitcnt lgkmcnt(10)
ds_read_b64_tr_b16 v[168:169], v239 offset:25600
ds_read_b64_tr_b16 v[170:171], v239 offset:25856
v_mfma_f32_16x16x32_bf16 v[16:19], v[176:179], a[32:35], v[16:19]
s_waitcnt lgkmcnt(10)
ds_read_b64_tr_b16 v[172:173], v239 offset:26624
ds_read_b64_tr_b16 v[174:175], v239 offset:26880
v_mfma_f32_16x16x32_bf16 v[0:3], v[180:183], a[48:51], v[0:3]
s_waitcnt lgkmcnt(10)
ds_read_b64_tr_b16 v[176:177], v239 offset:27648
ds_read_b64_tr_b16 v[178:179], v239 offset:27904
v_mfma_f32_16x16x32_bf16 v[4:7], v[184:187], a[48:51], v[4:7]
s_waitcnt lgkmcnt(10)
ds_read_b64_tr_b16 v[180:181], v239 offset:28672
ds_read_b64_tr_b16 v[182:183], v239 offset:28928
v_mfma_f32_16x16x32_bf16 v[8:11], v[188:191], a[48:51], v[8:11]
s_waitcnt lgkmcnt(10)
ds_read_b64_tr_b16 v[184:185], v240 offset:29696
ds_read_b64_tr_b16 v[186:187], v240 offset:29952
v_mfma_f32_16x16x32_bf16 v[12:15], v[160:163], a[48:51], v[12:15]
s_waitcnt lgkmcnt(10)
ds_read_b64_tr_b16 v[188:189], v239 offset:30208
ds_read_b64_tr_b16 v[190:191], v239 offset:30464
v_mfma_f32_16x16x32_bf16 v[16:19], v[164:167], a[48:51], v[16:19]
s_waitcnt lgkmcnt(10)
ds_read_b64_tr_b16 v[160:161], v239 offset:31232
ds_read_b64_tr_b16 v[162:163], v239 offset:31488
v_mfma_f32_16x16x32_bf16 v[0:3], v[168:171], a[64:67], v[0:3]
s_waitcnt lgkmcnt(10)
ds_read_b64_tr_b16 v[164:165], v239 offset:32256
ds_read_b64_tr_b16 v[166:167], v239 offset:32512
v_mfma_f32_16x16x32_bf16 v[4:7], v[172:175], a[64:67], v[4:7]
s_waitcnt lgkmcnt(10)
ds_read_b64_tr_b16 v[168:169], v239 offset:33280
ds_read_b64_tr_b16 v[170:171], v239 offset:33536
v_mfma_f32_16x16x32_bf16 v[8:11], v[176:179], a[64:67], v[8:11]
s_waitcnt lgkmcnt(10)
ds_read_b64_tr_b16 v[172:173], v240 offset:34304
ds_read_b64_tr_b16 v[174:175], v240 offset:34560
v_add_u32 v239, 4294901760, v239
s_waitcnt vmcnt(16)
s_barrier
v_mfma_f32_16x16x32_bf16 v[12:15], v[180:183], a[64:67], v[12:15]
s_waitcnt lgkmcnt(10)
ds_read_b64_tr_b16 v[176:177], v239 offset:16384
ds_read_b64_tr_b16 v[178:179], v239 offset:16640
v_mfma_f32_16x16x32_bf16 v[16:19], v[184:187], a[64:67], v[16:19]
s_waitcnt lgkmcnt(10)
ds_read_b64_tr_b16 v[180:181], v239 offset:17408
ds_read_b64_tr_b16 v[182:183], v239 offset:17664
s_waitcnt vmcnt(6)
buffer_store_dword v242, off, s[28:31], s94 sc1
v_mfma_f32_16x16x32_bf16 v[0:3], v[188:191], a[80:83], v[0:3]
s_waitcnt lgkmcnt(10)
ds_read_b64_tr_b16 v[184:185], v239 offset:18432
ds_read_b64_tr_b16 v[186:187], v239 offset:18688
v_mfma_f32_16x16x32_bf16 v[4:7], v[160:163], a[80:83], v[4:7]
s_waitcnt lgkmcnt(10)
ds_read_b64_tr_b16 v[188:189], v239 offset:19456
ds_read_b64_tr_b16 v[190:191], v239 offset:19712
v_add_u32 v240, 4294901760, v240
v_mfma_f32_16x16x32_bf16 v[8:11], v[164:167], a[80:83], v[8:11]
s_waitcnt lgkmcnt(10)
ds_read_b64_tr_b16 v[160:161], v240 offset:20480
ds_read_b64_tr_b16 v[162:163], v240 offset:20736
v_mfma_f32_16x16x32_bf16 v[12:15], v[168:171], a[80:83], v[12:15]
s_waitcnt lgkmcnt(10)
ds_read_b64_tr_b16 v[164:165], v239 offset:20992
ds_read_b64_tr_b16 v[166:167], v239 offset:21248
v_mfma_f32_16x16x32_bf16 v[16:19], v[172:175], a[80:83], v[16:19]
s_waitcnt vmcnt(5) lgkmcnt(10)
ds_read_b64_tr_b16 v[168:169], v239 offset:22016
ds_read_b64_tr_b16 v[170:171], v239 offset:22272
s_add_u32 s53, s61, 24576
buffer_load_dwordx4 a[120:123], v237, s[28:31], s53 offen sc1
v_mfma_f32_16x16x32_bf16 v[32:35], v[176:179], a[96:99], 0
s_waitcnt lgkmcnt(10)
ds_read_b64_tr_b16 v[172:173], v239 offset:23040
ds_read_b64_tr_b16 v[174:175], v239 offset:23296
v_mfma_f32_16x16x32_bf16 v[36:39], v[180:183], a[96:99], 0
s_waitcnt lgkmcnt(10)
ds_read_b64_tr_b16 v[176:177], v239 offset:24064
ds_read_b64_tr_b16 v[178:179], v239 offset:24320
s_add_u32 s53, s61, 28672
buffer_load_dwordx4 a[124:127], v237, s[28:31], s53 offen sc1
v_mfma_f32_16x16x32_bf16 v[40:43], v[184:187], a[96:99], 0
TCH_11_v1:
s_cbranch_execz TCH_back
s_waitcnt lgkmcnt(10)
ds_read_b64_tr_b16 v[180:181], v240 offset:25088
ds_read_b64_tr_b16 v[182:183], v240 offset:25344
v_mfma_f32_16x16x32_bf16 v[44:47], v[188:191], a[96:99], 0
s_waitcnt lgkmcnt(10)
ds_read_b64_tr_b16 v[184:185], v239 offset:25600
ds_read_b64_tr_b16 v[186:187], v239 offset:25856
s_add_u32 s53, s61, 32768
buffer_load_dwordx4 a[128:131], v237, s[28:31], s53 offen sc1
v_mfma_f32_16x16x32_bf16 v[48:51], v[160:163], a[96:99], 0
s_waitcnt lgkmcnt(10)
ds_read_b64_tr_b16 v[188:189], v239 offset:26624
ds_read_b64_tr_b16 v[190:191], v239 offset:26880
v_mfma_f32_16x16x32_bf16 v[32:35], v[164:167], a[100:103], v[32:35]
s_waitcnt lgkmcnt(10)
ds_read_b64_tr_b16 v[160:161], v239 offset:27648
ds_read_b64_tr_b16 v[162:163], v239 offset:27904
s_add_u32 s53, s61, 36864
buffer_load_dwordx4 a[132:135], v237, s[28:31], s53 offen sc1
v_mfma_f32_16x16x32_bf16 v[36:39], v[168:171], a[100:103], v[36:39]
s_waitcnt lgkmcnt(10)
ds_read_b64_tr_b16 v[164:165], v239 offset:28672
ds_read_b64_tr_b16 v[166:167], v239 offset:28928
v_mfma_f32_16x16x32_bf16 v[40:43], v[172:175], a[100:103], v[40:43]
s_waitcnt lgkmcnt(10)
ds_read_b64_tr_b16 v[168:169], v240 offset:29696
ds_read_b64_tr_b16 v[170:171], v240 offset:29952
s_add_u32 s53, s61, 40960
buffer_load_dwordx4 a[136:139], v237, s[28:31], s53 offen sc1
v_mfma_f32_16x16x32_bf16 v[44:47], v[176:179], a[100:103], v[44:47]
s_waitcnt lgkmcnt(10)
ds_read_b64_tr_b16 v[172:173], v239 offset:30208
ds_read_b64_tr_b16 v[174:175], v239 offset:30464
v_mfma_f32_16x16x32_bf16 v[48:51], v[180:183], a[100:103], v[48:51]
s_waitcnt vmcnt(8) lgkmcnt(10)
ds_read_b64_tr_b16 v[176:177], v239 offset:31232
ds_read_b64_tr_b16 v[178:179], v239 offset:31488
s_add_u32 s53, s61, 45056
buffer_load_dwordx4 a[140:143], v237, s[28:31], s53 offen sc1
v_mfma_f32_16x16x32_bf16 v[32:35], v[184:187], a[104:107], v[32:35]
s_waitcnt lgkmcnt(10)
ds_read_b64_tr_b16 v[180:181], v239 offset:32256
ds_read_b64_tr_b16 v[182:183], v239 offset:32512
v_mfma_f32_16x16x32_bf16 v[36:39], v[188:191], a[104:107], v[36:39]
s_waitcnt lgkmcnt(10)
ds_read_b64_tr_b16 v[184:185], v239 offset:33280
ds_read_b64_tr_b16 v[186:187], v239 offset:33536
s_add_u32 s53, s61, 49152
buffer_load_dwordx4 a[144:147], v237, s[28:31], s53 offen sc1
v_mfma_f32_16x16x32_bf16 v[40:43], v[160:163], a[104:107], v[40:43]
s_waitcnt lgkmcnt(10)
ds_read_b64_tr_b16 v[188:189], v240 offset:34304
ds_read_b64_tr_b16 v[190:191], v240 offset:34560
v_mfma_f32_16x16x32_bf16 v[44:47], v[164:167], a[104:107], v[44:47]
s_waitcnt lgkmcnt(10)
ds_read_b64_tr_b16 v[160:161], v239 offset:34816
ds_read_b64_tr_b16 v[162:163], v239 offset:35072
s_add_u32 s53, s61, 53248
buffer_load_dwordx4 a[148:151], v237, s[28:31], s53 offen sc1
v_mfma_f32_16x16x32_bf16 v[48:51], v[168:171], a[104:107], v[48:51]
s_waitcnt lgkmcnt(10)
ds_read_b64_tr_b16 v[164:165], v239 offset:35840
ds_read_b64_tr_b16 v[166:167], v239 offset:36096
v_mfma_f32_16x16x32_bf16 v[32:35], v[172:175], a[108:111], v[32:35]
s_waitcnt lgkmcnt(10)
ds_read_b64_tr_b16 v[168:169], v239 offset:36864
ds_read_b64_tr_b16 v[170:171], v239 offset:37120
s_add_u32 s53, s61, 57344
buffer_load_dwordx4 a[152:155], v237, s[28:31], s53 offen sc1
v_mfma_f32_16x16x32_bf16 v[36:39], v[176:179], a[108:111], v[36:39]
s_waitcnt lgkmcnt(10)
ds_read_b64_tr_b16 v[172:173], v239 offset:37888
ds_read_b64_tr_b16 v[174:175], v239 offset:38144
v_mfma_f32_16x16x32_bf16 v[40:43], v[180:183], a[108:111], v[40:43]
s_waitcnt lgkmcnt(10)
ds_read_b64_tr_b16 v[176:177], v240 offset:38912
ds_read_b64_tr_b16 v[178:179], v240 offset:39168
s_add_u32 s53, s61, 61440
buffer_load_dwordx4 a[156:159], v237, s[28:31], s53 offen sc1
v_mfma_f32_16x16x32_bf16 v[44:47], v[184:187], a[108:111], v[44:47]
s_waitcnt lgkmcnt(10)
ds_read_b64_tr_b16 v[180:181], v239 offset:39424
ds_read_b64_tr_b16 v[182:183], v239 offset:39680
v_mfma_f32_16x16x32_bf16 v[48:51], v[188:191], a[108:111], v[48:51]
s_waitcnt vmcnt(11) lgkmcnt(10)
ds_read_b64_tr_b16 v[184:185], v239 offset:40448
ds_read_b64_tr_b16 v[186:187], v239 offset:40704
s_add_u32 s53, s61, 65536
buffer_load_dwordx4 a[160:163], v237, s[28:31], s53 offen sc1
v_mfma_f32_16x16x32_bf16 v[32:35], v[160:163], a[112:115], v[32:35]
s_waitcnt lgkmcnt(10)
ds_read_b64_tr_b16 v[188:189], v239 offset:41472
ds_read_b64_tr_b16 v[190:191], v239 offset:41728
v_mfma_f32_16x16x32_bf16 v[36:39], v[164:167], a[112:115], v[36:39]
s_waitcnt lgkmcnt(10)
ds_read_b64_tr_b16 v[160:161], v239 offset:42496
ds_read_b64_tr_b16 v[162:163], v239 offset:42752
s_add_u32 s53, s61, 69632
buffer_load_dwordx4 a[164:167], v237, s[28:31], s53 offen sc1
v_mfma_f32_16x16x32_bf16 v[40:43], v[168:171], a[112:115], v[40:43]
s_waitcnt lgkmcnt(10)
ds_read_b64_tr_b16 v[164:165], v240 offset:43520
ds_read_b64_tr_b16 v[166:167], v240 offset:43776
v_mfma_f32_16x16x32_bf16 v[44:47], v[172:175], a[112:115], v[44:47]
s_waitcnt lgkmcnt(10)
ds_read_b64_tr_b16 v[168:169], v239 offset:44032
ds_read_b64_tr_b16 v[170:171], v239 offset:44288
buffer_load_dword v246, v229, s[28:31], 0 offen sc1
v_mfma_f32_16x16x32_bf16 v[48:51], v[176:179], a[112:115], v[48:51]
s_waitcnt lgkmcnt(10)
ds_read_b64_tr_b16 v[172:173], v239 offset:45056
ds_read_b64_tr_b16 v[174:175], v239 offset:45312
v_mfma_f32_16x16x32_bf16 v[32:35], v[180:183], a[116:119], v[32:35]
s_waitcnt lgkmcnt(10)
ds_read_b64_tr_b16 v[176:177], v239 offset:46080
ds_read_b64_tr_b16 v[178:179], v239 offset:46336
v_mfma_f32_16x16x32_bf16 v[36:39], v[184:187], a[116:119], v[36:39]
s_waitcnt lgkmcnt(10)
ds_read_b64_tr_b16 v[180:181], v239 offset:47104
ds_read_b64_tr_b16 v[182:183], v239 offset:47360
v_mfma_f32_16x16x32_bf16 v[40:43], v[188:191], a[116:119], v[40:43]
s_waitcnt lgkmcnt(10)
ds_read_b64_tr_b16 v[184:185], v240 offset:48128
ds_read_b64_tr_b16 v[186:187], v240 offset:48384
v_mfma_f32_16x16x32_bf16 v[44:47], v[160:163], a[116:119], v[44:47]
s_waitcnt lgkmcnt(10)
ds_read_b64_tr_b16 v[188:189], v239 offset:48640
ds_read_b64_tr_b16 v[190:191], v239 offset:48896
v_mfma_f32_16x16x32_bf16 v[48:51], v[164:167], a[116:119], v[48:51]
s_waitcnt vmcnt(11) lgkmcnt(10)
ds_read_b64_tr_b16 v[160:161], v239 offset:49664
ds_read_b64_tr_b16 v[162:163], v239 offset:49920
v_mfma_f32_16x16x32_bf16 v[32:35], v[168:171], a[120:123], v[32:35]
s_waitcnt lgkmcnt(10)
ds_read_b64_tr_b16 v[164:165], v239 offset:50688
ds_read_b64_tr_b16 v[166:167], v239 offset:50944
v_mfma_f32_16x16x32_bf16 v[36:39], v[172:175], a[120:123], v[36:39]
s_waitcnt lgkmcnt(10)
ds_read_b64_tr_b16 v[168:169], v239 offset:51712
ds_read_b64_tr_b16 v[170:171], v239 offset:51968
v_mfma_f32_16x16x32_bf16 v[40:43], v[176:179], a[120:123], v[40:43]
s_waitcnt lgkmcnt(10)
ds_read_b64_tr_b16 v[172:173], v240 offset:52736
ds_read_b64_tr_b16 v[174:175], v240 offset:52992
v_mfma_f32_16x16x32_bf16 v[44:47], v[180:183], a[120:123], v[44:47]
s_waitcnt lgkmcnt(10)
ds_read_b64_tr_b16 v[176:177], v239 offset:53248
ds_read_b64_tr_b16 v[178:179], v239 offset:53504
v_mfma_f32_16x16x32_bf16 v[48:51], v[184:187], a[120:123], v[48:51]
s_waitcnt lgkmcnt(10)
ds_read_b64_tr_b16 v[180:181], v239 offset:54272
ds_read_b64_tr_b16 v[182:183], v239 offset:54528
v_mfma_f32_16x16x32_bf16 v[32:35], v[188:191], a[124:127], v[32:35]
s_waitcnt lgkmcnt(10)
ds_read_b64_tr_b16 v[184:185], v239 offset:55296
ds_read_b64_tr_b16 v[186:187], v239 offset:55552
v_mfma_f32_16x16x32_bf16 v[36:39], v[160:163], a[124:127], v[36:39]
s_waitcnt lgkmcnt(10)
ds_read_b64_tr_b16 v[188:189], v239 offset:56320
ds_read_b64_tr_b16 v[190:191], v239 offset:56576
v_mfma_f32_16x16x32_bf16 v[40:43], v[164:167], a[124:127], v[40:43]
s_waitcnt lgkmcnt(10)
ds_read_b64_tr_b16 v[160:161], v240 offset:57344
ds_read_b64_tr_b16 v[162:163], v240 offset:57600
v_mfma_f32_16x16x32_bf16 v[44:47], v[168:171], a[124:127], v[44:47]
s_waitcnt lgkmcnt(10)
ds_read_b64_tr_b16 v[164:165], v239 offset:57856
ds_read_b64_tr_b16 v[166:167], v239 offset:58112
v_mfma_f32_16x16x32_bf16 v[48:51], v[172:175], a[124:127], v[48:51]
s_waitcnt vmcnt(9) lgkmcnt(10)
ds_read_b64_tr_b16 v[168:169], v239 offset:58880
ds_read_b64_tr_b16 v[170:171], v239 offset:59136
v_mfma_f32_16x16x32_bf16 v[32:35], v[176:179], a[128:131], v[32:35]
s_waitcnt lgkmcnt(10)
ds_read_b64_tr_b16 v[172:173], v239 offset:59904
ds_read_b64_tr_b16 v[174:175], v239 offset:60160
v_mfma_f32_16x16x32_bf16 v[36:39], v[180:183], a[128:131], v[36:39]
s_waitcnt lgkmcnt(10)
ds_read_b64_tr_b16 v[176:177], v239 offset:60928
ds_read_b64_tr_b16 v[178:179], v239 offset:61184
v_mfma_f32_16x16x32_bf16 v[40:43], v[184:187], a[128:131], v[40:43]
s_waitcnt lgkmcnt(10)
ds_read_b64_tr_b16 v[180:181], v240 offset:61952
ds_read_b64_tr_b16 v[182:183], v240 offset:62208
v_mfma_f32_16x16x32_bf16 v[44:47], v[188:191], a[128:131], v[44:47]
s_waitcnt lgkmcnt(10)
ds_read_b64_tr_b16 v[184:185], v239 offset:62464
ds_read_b64_tr_b16 v[186:187], v239 offset:62720
v_mfma_f32_16x16x32_bf16 v[48:51], v[160:163], a[128:131], v[48:51]
s_waitcnt lgkmcnt(10)
ds_read_b64_tr_b16 v[188:189], v239 offset:63488
ds_read_b64_tr_b16 v[190:191], v239 offset:63744
v_mfma_f32_16x16x32_bf16 v[32:35], v[164:167], a[132:135], v[32:35]
s_waitcnt lgkmcnt(10)
ds_read_b64_tr_b16 v[160:161], v239 offset:64512
ds_read_b64_tr_b16 v[162:163], v239 offset:64768
v_add_u32 v239, 4294934528, v239
v_mfma_f32_16x16x32_bf16 v[36:39], v[168:171], a[132:135], v[36:39]
s_waitcnt lgkmcnt(10)
ds_read_b64_tr_b16 v[164:165], v239 offset:0
ds_read_b64_tr_b16 v[166:167], v239 offset:256
v_add_u32 v240, 4294934528, v240
v_mfma_f32_16x16x32_bf16 v[40:43], v[172:175], a[132:135], v[40:43]
s_waitcnt lgkmcnt(10)
ds_read_b64_tr_b16 v[168:169], v240 offset:1024
ds_read_b64_tr_b16 v[170:171], v240 offset:1280
v_mfma_f32_16x16x32_bf16 v[44:47], v[176:179], a[132:135], v[44:47]
s_waitcnt lgkmcnt(10)
ds_read_b64_tr_b16 v[172:173], v239 offset:1536
ds_read_b64_tr_b16 v[174:175], v239 offset:1792
v_mfma_f32_16x16x32_bf16 v[48:51], v[180:183], a[132:135], v[48:51]
s_waitcnt vmcnt(7) lgkmcnt(10)
ds_read_b64_tr_b16 v[176:177], v239 offset:2560
ds_read_b64_tr_b16 v[178:179], v239 offset:2816
v_mfma_f32_16x16x32_bf16 v[32:35], v[184:187], a[136:139], v[32:35]
s_waitcnt lgkmcnt(10)
ds_read_b64_tr_b16 v[180:181], v239 offset:3584
ds_read_b64_tr_b16 v[182:183], v239 offset:3840
v_mfma_f32_16x16x32_bf16 v[36:39], v[188:191], a[136:139], v[36:39]
s_waitcnt lgkmcnt(10)
ds_read_b64_tr_b16 v[184:185], v239 offset:4608
ds_read_b64_tr_b16 v[186:187], v239 offset:4864
v_mfma_f32_16x16x32_bf16 v[40:43], v[160:163], a[136:139], v[40:43]
s_waitcnt lgkmcnt(10)
ds_read_b64_tr_b16 v[188:189], v240 offset:5632
ds_read_b64_tr_b16 v[190:191], v240 offset:5888
v_mfma_f32_16x16x32_bf16 v[44:47], v[164:167], a[136:139], v[44:47]
s_waitcnt lgkmcnt(10)
ds_read_b64_tr_b16 v[160:161], v239 offset:6144
ds_read_b64_tr_b16 v[162:163], v239 offset:6400
v_mfma_f32_16x16x32_bf16 v[48:51], v[168:171], a[136:139], v[48:51]
s_waitcnt lgkmcnt(10)
ds_read_b64_tr_b16 v[164:165], v239 offset:7168
ds_read_b64_tr_b16 v[166:167], v239 offset:7424
v_mfma_f32_16x16x32_bf16 v[32:35], v[172:175], a[140:143], v[32:35]
s_waitcnt lgkmcnt(10)
ds_read_b64_tr_b16 v[168:169], v239 offset:8192
ds_read_b64_tr_b16 v[170:171], v239 offset:8448
v_mfma_f32_16x16x32_bf16 v[36:39], v[176:179], a[140:143], v[36:39]
s_waitcnt lgkmcnt(10)
ds_read_b64_tr_b16 v[172:173], v239 offset:9216
ds_read_b64_tr_b16 v[174:175], v239 offset:9472
v_mfma_f32_16x16x32_bf16 v[40:43], v[180:183], a[140:143], v[40:43]
s_waitcnt lgkmcnt(10)
ds_read_b64_tr_b16 v[176:177], v240 offset:10240
ds_read_b64_tr_b16 v[178:179], v240 offset:10496
v_mfma_f32_16x16x32_bf16 v[44:47], v[184:187], a[140:143], v[44:47]
s_waitcnt lgkmcnt(10)
ds_read_b64_tr_b16 v[180:181], v239 offset:10752
ds_read_b64_tr_b16 v[182:183], v239 offset:11008
v_permlane16_swap_b32 v0, v4
v_permlane16_swap_b32 v1, v5
v_permlane16_swap_b32 v2, v6
v_permlane16_swap_b32 v3, v7
v_permlane16_swap_b32 v8, v12
v_permlane16_swap_b32 v9, v13
v_permlane16_swap_b32 v10, v14
v_permlane16_swap_b32 v11, v15
v_mfma_f32_16x16x32_bf16 v[48:51], v[188:191], a[140:143], v[48:51]
s_waitcnt vmcnt(0) lgkmcnt(10)
ds_read_b64_tr_b16 v[184:185], v239 offset:11776
ds_read_b64_tr_b16 v[186:187], v239 offset:12032
v_cmp_eq_u32 vcc, 1, v246
s_mul_i32 s50, s76, 7680
s_add_u32 s50, s50, s92
s_and_b32 s66, vcc_lo, 7
s_cmp_eq_u32 s66, 7
s_cbranch_scc0 sk_19_v1
s_add_u32 s51, s50, 2560
s_add_u32 s52, s50, 5120
buffer_load_dwordx4 v[52:55], v237, s[28:31], s50 offen offset:0 sc1
buffer_load_dwordx4 v[64:67], v237, s[28:31], s51 offen offset:0 sc1
buffer_load_dwordx4 v[76:79], v237, s[28:31], s52 offen offset:0 sc1
buffer_load_dwordx4 v[56:59], v237, s[28:31], s50 offen offset:1024 sc1
buffer_load_dwordx4 v[68:71], v237, s[28:31], s51 offen offset:1024 sc1
buffer_load_dwordx4 v[80:83], v237, s[28:31], s52 offen offset:1024 sc1
buffer_load_dwordx2 v[60:61], v243, s[28:31], s50 offen offset:2048 sc1
buffer_load_dwordx2 v[72:73], v243, s[28:31], s51 offen offset:2048 sc1
buffer_load_dwordx2 v[84:85], v243, s[28:31], s52 offen offset:2048 sc1
s_branch sk_20_v1
sk_19_v1:
s_bitcmp1_b32 s66, 0
s_cbranch_scc0 sk_21_v1
s_add_u32 s51, s50, 0
buffer_load_dwordx4 v[52:55], v237, s[28:31], s51 offen offset:0 sc1
buffer_load_dwordx4 v[56:59], v237, s[28:31], s51 offen offset:1024 sc1
buffer_load_dwordx2 v[60:61], v243, s[28:31], s51 offen offset:2048 sc1
sk_21_v1:
s_bitcmp1_b32 s66, 1
s_cbranch_scc0 sk_22_v1
s_add_u32 s51, s50, 2560
buffer_load_dwordx4 v[64:67], v237, s[28:31], s51 offen offset:0 sc1
buffer_load_dwordx4 v[68:71], v237, s[28:31], s51 offen offset:1024 sc1
buffer_load_dwordx2 v[72:73], v243, s[28:31], s51 offen offset:2048 sc1
sk_22_v1:
s_bitcmp1_b32 s66, 2
s_cbranch_scc0 sk_23_v1
s_add_u32 s51, s50, 5120
buffer_load_dwordx4 v[76:79], v237, s[28:31], s51 offen offset:0 sc1
buffer_load_dwordx4 v[80:83], v237, s[28:31], s51 offen offset:1024 sc1
buffer_load_dwordx2 v[84:85], v243, s[28:31], s51 offen offset:2048 sc1
sk_23_v1:
sk_20_v1:
v_mfma_f32_16x16x32_bf16 v[32:35], v[160:163], a[144:147], v[32:35]
s_waitcnt lgkmcnt(10)
ds_read_b64_tr_b16 v[188:189], v239 offset:12800
ds_read_b64_tr_b16 v[190:191], v239 offset:13056
s_cmp_eq_u32 s66, 7
s_cbranch_scc1 sk_24_v1
buffer_load_dword v246, v229, s[28:31], 0 offen sc1
sk_24_v1:
v_mfma_f32_16x16x32_bf16 v[36:39], v[164:167], a[144:147], v[36:39]
s_waitcnt lgkmcnt(10)
ds_read_b64_tr_b16 v[160:161], v239 offset:13824
ds_read_b64_tr_b16 v[162:163], v239 offset:14080
v_mfma_f32_16x16x32_bf16 v[40:43], v[168:171], a[144:147], v[40:43]
s_waitcnt lgkmcnt(10)
ds_read_b64_tr_b16 v[164:165], v240 offset:14848
ds_read_b64_tr_b16 v[166:167], v240 offset:15104
v_mfma_f32_16x16x32_bf16 v[44:47], v[172:175], a[144:147], v[44:47]
s_waitcnt lgkmcnt(10)
ds_read_b64_tr_b16 v[168:169], v239 offset:15360
ds_read_b64_tr_b16 v[170:171], v239 offset:15616
v_mfma_f32_16x16x32_bf16 v[48:51], v[176:179], a[144:147], v[48:51]
s_waitcnt lgkmcnt(10)
ds_read_b64_tr_b16 v[172:173], v239 offset:16384
ds_read_b64_tr_b16 v[174:175], v239 offset:16640
v_mfma_f32_16x16x32_bf16 v[32:35], v[180:183], a[148:151], v[32:35]
s_waitcnt lgkmcnt(10)
ds_read_b64_tr_b16 v[176:177], v239 offset:17408
ds_read_b64_tr_b16 v[178:179], v239 offset:17664
v_mfma_f32_16x16x32_bf16 v[36:39], v[184:187], a[148:151], v[36:39]
s_waitcnt lgkmcnt(10)
ds_read_b64_tr_b16 v[180:181], v239 offset:18432
ds_read_b64_tr_b16 v[182:183], v239 offset:18688
v_mfma_f32_16x16x32_bf16 v[40:43], v[188:191], a[148:151], v[40:43]
s_waitcnt lgkmcnt(10)
ds_read_b64_tr_b16 v[184:185], v240 offset:19456
ds_read_b64_tr_b16 v[186:187], v240 offset:19712
v_mfma_f32_16x16x32_bf16 v[44:47], v[160:163], a[148:151], v[44:47]
s_waitcnt lgkmcnt(10)
ds_read_b64_tr_b16 v[188:189], v239 offset:19968
ds_read_b64_tr_b16 v[190:191], v239 offset:20224
v_mfma_f32_16x16x32_bf16 v[48:51], v[164:167], a[148:151], v[48:51]
s_waitcnt lgkmcnt(10)
ds_read_b64_tr_b16 v[160:161], v239 offset:20992
ds_read_b64_tr_b16 v[162:163], v239 offset:21248
v_mfma_f32_16x16x32_bf16 v[32:35], v[168:171], a[152:155], v[32:35]
s_waitcnt lgkmcnt(10)
ds_read_b64_tr_b16 v[164:165], v239 offset:22016
ds_read_b64_tr_b16 v[166:167], v239 offset:22272
v_mfma_f32_16x16x32_bf16 v[36:39], v[172:175], a[152:155], v[36:39]
s_waitcnt lgkmcnt(10)
ds_read_b64_tr_b16 v[168:169], v239 offset:23040
ds_read_b64_tr_b16 v[170:171], v239 offset:23296
v_mfma_f32_16x16x32_bf16 v[40:43], v[176:179], a[152:155], v[40:43]
s_waitcnt lgkmcnt(10)
ds_read_b64_tr_b16 v[172:173], v240 offset:24064
ds_read_b64_tr_b16 v[174:175], v240 offset:24320
v_mfma_f32_16x16x32_bf16 v[44:47], v[180:183], a[152:155], v[44:47]
s_waitcnt lgkmcnt(10)
ds_read_b64_tr_b16 v[176:177], v239 offset:24576
ds_read_b64_tr_b16 v[178:179], v239 offset:24832
v_mfma_f32_16x16x32_bf16 v[48:51], v[184:187], a[152:155], v[48:51]
s_waitcnt lgkmcnt(10)
ds_read_b64_tr_b16 v[180:181], v239 offset:25600
ds_read_b64_tr_b16 v[182:183], v239 offset:25856
v_mfma_f32_16x16x32_bf16 v[32:35], v[188:191], a[156:159], v[32:35]
s_waitcnt lgkmcnt(10)
ds_read_b64_tr_b16 v[184:185], v239 offset:26624
ds_read_b64_tr_b16 v[186:187], v239 offset:26880
v_mfma_f32_16x16x32_bf16 v[36:39], v[160:163], a[156:159], v[36:39]
s_waitcnt lgkmcnt(10)
ds_read_b64_tr_b16 v[188:189], v239 offset:27648
ds_read_b64_tr_b16 v[190:191], v239 offset:27904
v_mfma_f32_16x16x32_bf16 v[40:43], v[164:167], a[156:159], v[40:43]
s_waitcnt lgkmcnt(10)
ds_read_b64_tr_b16 v[160:161], v240 offset:28672
ds_read_b64_tr_b16 v[162:163], v240 offset:28928
v_mfma_f32_16x16x32_bf16 v[44:47], v[168:171], a[156:159], v[44:47]
s_waitcnt lgkmcnt(10)
ds_read_b64_tr_b16 v[164:165], v239 offset:29184
ds_read_b64_tr_b16 v[166:167], v239 offset:29440
v_mfma_f32_16x16x32_bf16 v[48:51], v[172:175], a[156:159], v[48:51]
s_waitcnt lgkmcnt(10)
ds_read_b64_tr_b16 v[168:169], v239 offset:30208
ds_read_b64_tr_b16 v[170:171], v239 offset:30464
v_mfma_f32_16x16x32_bf16 v[32:35], v[176:179], a[160:163], v[32:35]
s_waitcnt lgkmcnt(10)
ds_read_b64_tr_b16 v[172:173], v239 offset:31232
ds_read_b64_tr_b16 v[174:175], v239 offset:31488
v_mfma_f32_16x16x32_bf16 v[36:39], v[180:183], a[160:163], v[36:39]
s_waitcnt lgkmcnt(10)
ds_read_b64_tr_b16 v[176:177], v239 offset:32256
ds_read_b64_tr_b16 v[178:179], v239 offset:32512
v_mfma_f32_16x16x32_bf16 v[40:43], v[184:187], a[160:163], v[40:43]
s_waitcnt lgkmcnt(10)
ds_read_b64_tr_b16 v[180:181], v240 offset:33280
ds_read_b64_tr_b16 v[182:183], v240 offset:33536
v_mfma_f32_16x16x32_bf16 v[44:47], v[188:191], a[160:163], v[44:47]
s_waitcnt lgkmcnt(10)
v_mfma_f32_16x16x32_bf16 v[48:51], v[160:163], a[160:163], v[48:51]
s_waitcnt lgkmcnt(8)
v_mfma_f32_16x16x32_bf16 v[32:35], v[164:167], a[164:167], v[32:35]
s_waitcnt lgkmcnt(6)
v_mfma_f32_16x16x32_bf16 v[36:39], v[168:171], a[164:167], v[36:39]
s_waitcnt lgkmcnt(4)
v_mfma_f32_16x16x32_bf16 v[40:43], v[172:175], a[164:167], v[40:43]
s_waitcnt lgkmcnt(2)
v_mfma_f32_16x16x32_bf16 v[44:47], v[176:179], a[164:167], v[44:47]
s_waitcnt lgkmcnt(0)
v_mfma_f32_16x16x32_bf16 v[48:51], v[180:183], a[164:167], v[48:51]
s_mov_b32 s4, 0xffff0000
s_mov_b32 s65, 0
s_nop 5
v_permlane16_swap_b32 v32, v36
v_permlane16_swap_b32 v33, v37
v_permlane16_swap_b32 v34, v38
v_permlane16_swap_b32 v35, v39
v_permlane16_swap_b32 v40, v44
v_permlane16_swap_b32 v41, v45
v_permlane16_swap_b32 v42, v46
v_permlane16_swap_b32 v43, v47
s_cmp_eq_u32 s66, 7
s_cbranch_scc1 K_x4_v1
K_x1_v1:
s_waitcnt vmcnt(0)
v_cmp_eq_u32 vcc, 1, v246
s_add_u32 s65, s65, 1
s_andn2_b32 s64, vcc_lo, s66
s_and_b32 s64, s64, 7
s_cmp_eq_u32 s64, 7
s_cbranch_scc0 sk_25_v1
s_add_u32 s51, s50, 2560
s_add_u32 s52, s50, 5120
buffer_load_dwordx4 v[52:55], v237, s[28:31], s50 offen offset:0 sc1
buffer_load_dwordx4 v[64:67], v237, s[28:31], s51 offen offset:0 sc1
buffer_load_dwordx4 v[76:79], v237, s[28:31], s52 offen offset:0 sc1
buffer_load_dwordx4 v[56:59], v237, s[28:31], s50 offen offset:1024 sc1
buffer_load_dwordx4 v[68:71], v237, s[28:31], s51 offen offset:1024 sc1
buffer_load_dwordx4 v[80:83], v237, s[28:31], s52 offen offset:1024 sc1
buffer_load_dwordx2 v[60:61], v243, s[28:31], s50 offen offset:2048 sc1
buffer_load_dwordx2 v[72:73], v243, s[28:31], s51 offen offset:2048 sc1
buffer_load_dwordx2 v[84:85], v243, s[28:31], s52 offen offset:2048 sc1
s_branch K_x4_v1
sk_25_v1:
s_bitcmp1_b32 s64, 0
s_cbranch_scc0 sk_27_v1
s_add_u32 s51, s50, 0
buffer_load_dwordx4 v[52:55], v237, s[28:31], s51 offen offset:0 sc1
buffer_load_dwordx4 v[56:59], v237, s[28:31], s51 offen offset:1024 sc1
buffer_load_dwordx2 v[60:61], v243, s[28:31], s51 offen offset:2048 sc1
sk_27_v1:
s_bitcmp1_b32 s64, 1
s_cbranch_scc0 sk_28_v1
s_add_u32 s51, s50, 2560
buffer_load_dwordx4 v[64:67], v237, s[28:31], s51 offen offset:0 sc1
buffer_load_dwordx4 v[68:71], v237, s[28:31], s51 offen offset:1024 sc1
buffer_load_dwordx2 v[72:73], v243, s[28:31], s51 offen offset:2048 sc1
sk_28_v1:
s_bitcmp1_b32 s64, 2
s_cbranch_scc0 sk_29_v1
s_add_u32 s51, s50, 5120
buffer_load_dwordx4 v[76:79], v237, s[28:31], s51 offen offset:0 sc1
buffer_load_dwordx4 v[80:83], v237, s[28:31], s51 offen offset:1024 sc1
buffer_load_dwordx2 v[84:85], v243, s[28:31], s51 offen offset:2048 sc1
sk_29_v1:
sk_26_v1:
s_or_b32 s66, s66, s64
s_cmp_eq_u32 s66, 7
s_cbranch_scc1 K_x3_v1
buffer_load_dword v246, v229, s[28:31], 0 offen sc1
s_cmp_le_u32 s65, 100000
s_cbranch_scc1 K_x1_v1
K_x3_v1:
s_waitcnt vmcnt(0)
K_x4_v1:
s_mov_b32 s6, s96
s_mov_b32 s7, s96
s_waitcnt vmcnt(6)
v_mfma_f32_16x16x32_bf16 v[0:3], v[138:141], v[52:55], v[0:3]
v_mfma_f32_16x16x32_bf16 v[4:7], v[136:139], v[52:55], v[4:7]
v_mfma_f32_16x16x32_bf16 v[0:3], v[138:141], v[64:67], v[0:3]
v_mfma_f32_16x16x32_bf16 v[4:7], v[136:139], v[64:67], v[4:7]
v_mfma_f32_16x16x32_bf16 v[0:3], v[138:141], v[76:79], v[0:3]
v_mfma_f32_16x16x32_bf16 v[4:7], v[136:139], v[76:79], v[4:7]
s_nop 7
v_pk_mul_f32 v[96:97], v[0:1], s[6:7]
v_pk_mul_f32 v[98:99], v[2:3], s[6:7]
v_pk_mul_f32 v[100:101], v[4:5], s[6:7]
v_pk_mul_f32 v[102:103], v[6:7], s[6:7]
v_exp_f32 v96, v96
v_exp_f32 v97, v97
v_exp_f32 v98, v98
v_exp_f32 v99, v99
v_exp_f32 v100, v100
v_exp_f32 v101, v101
v_exp_f32 v102, v102
v_exp_f32 v103, v103
v_pk_add_f32 v[96:97], v[96:97], 1.0 op_sel_hi:[1,0]
v_pk_add_f32 v[98:99], v[98:99], 1.0 op_sel_hi:[1,0]
v_pk_add_f32 v[100:101], v[100:101], 1.0 op_sel_hi:[1,0]
v_pk_add_f32 v[102:103], v[102:103], 1.0 op_sel_hi:[1,0]
v_rcp_f32 v96, v96
v_rcp_f32 v97, v97
v_rcp_f32 v98, v98
v_rcp_f32 v99, v99
v_rcp_f32 v100, v100
v_rcp_f32 v101, v101
v_rcp_f32 v102, v102
v_rcp_f32 v103, v103
s_waitcnt vmcnt(3)
v_mfma_f32_16x16x32_bf16 v[8:11], v[138:141], v[56:59], v[8:11]
v_mfma_f32_16x16x32_bf16 v[12:15], v[136:139], v[56:59], v[12:15]
v_mfma_f32_16x16x32_bf16 v[8:11], v[138:141], v[68:71], v[8:11]
v_mfma_f32_16x16x32_bf16 v[12:15], v[136:139], v[68:71], v[12:15]
v_mfma_f32_16x16x32_bf16 v[8:11], v[138:141], v[80:83], v[8:11]
v_mfma_f32_16x16x32_bf16 v[12:15], v[136:139], v[80:83], v[12:15]
v_pk_mul_f32 v[0:1], v[0:1], v[32:33]
v_pk_mul_f32 v[2:3], v[2:3], v[34:35]
v_pk_mul_f32 v[4:5], v[4:5], v[36:37]
v_pk_mul_f32 v[6:7], v[6:7], v[38:39]
v_pk_fma_f32 v[0:1], v[0:1], v[96:97], v[116:117]
v_pk_fma_f32 v[2:3], v[2:3], v[98:99], v[118:119]
v_pk_fma_f32 v[4:5], v[4:5], v[100:101], v[120:121]
v_pk_fma_f32 v[6:7], v[6:7], v[102:103], v[122:123]
v_cvt_pk_bf16_f32 v20, v0, v1
v_cvt_pk_bf16_f32 v21, v2, v3
v_cvt_pk_bf16_f32 v22, v4, v5
v_cvt_pk_bf16_f32 v23, v6, v7
buffer_store_dwordx4 v[20:23], v232, s[24:27], 0 offen offset:0
v_pk_mul_f32 v[96:97], v[8:9], s[6:7]
v_pk_mul_f32 v[98:99], v[10:11], s[6:7]
v_pk_mul_f32 v[100:101], v[12:13], s[6:7]
v_pk_mul_f32 v[102:103], v[14:15], s[6:7]
v_exp_f32 v96, v96
v_exp_f32 v97, v97
v_exp_f32 v98, v98
v_exp_f32 v99, v99
v_exp_f32 v100, v100
v_exp_f32 v101, v101
v_exp_f32 v102, v102
v_exp_f32 v103, v103
v_pk_add_f32 v[96:97], v[96:97], 1.0 op_sel_hi:[1,0]
v_pk_add_f32 v[98:99], v[98:99], 1.0 op_sel_hi:[1,0]
v_pk_add_f32 v[100:101], v[100:101], 1.0 op_sel_hi:[1,0]
v_pk_add_f32 v[102:103], v[102:103], 1.0 op_sel_hi:[1,0]
v_rcp_f32 v96, v96
v_rcp_f32 v97, v97
v_rcp_f32 v98, v98
v_rcp_f32 v99, v99
v_rcp_f32 v100, v100
v_rcp_f32 v101, v101
v_rcp_f32 v102, v102
v_rcp_f32 v103, v103
s_waitcnt vmcnt(1)
v_mfma_f32_16x16x32_bf16 v[16:19], v[138:141], v[60:63], v[16:19]
v_mfma_f32_16x16x32_bf16 v[16:19], v[138:141], v[72:75], v[16:19]
v_mfma_f32_16x16x32_bf16 v[16:19], v[138:141], v[84:87], v[16:19]
v_pk_mul_f32 v[8:9], v[8:9], v[40:41]
v_pk_mul_f32 v[10:11], v[10:11], v[42:43]
v_pk_mul_f32 v[12:13], v[12:13], v[44:45]
v_pk_mul_f32 v[14:15], v[14:15], v[46:47]
v_pk_fma_f32 v[8:9], v[8:9], v[96:97], v[124:125]
v_pk_fma_f32 v[10:11], v[10:11], v[98:99], v[126:127]
v_pk_fma_f32 v[12:13], v[12:13], v[100:101], v[128:129]
v_pk_fma_f32 v[14:15], v[14:15], v[102:103], v[130:131]
v_cvt_pk_bf16_f32 v24, v8, v9
v_cvt_pk_bf16_f32 v25, v10, v11
v_cvt_pk_bf16_f32 v26, v12, v13
v_cvt_pk_bf16_f32 v27, v14, v15
buffer_store_dwordx4 v[24:27], v232, s[24:27], 0 offen offset:64
v_pk_mul_f32 v[96:97], v[16:17], s[6:7]
v_pk_mul_f32 v[98:99], v[18:19], s[6:7]
v_exp_f32 v96, v96
v_exp_f32 v97, v97
v_exp_f32 v98, v98
v_exp_f32 v99, v99
v_pk_add_f32 v[96:97], v[96:97], 1.0 op_sel_hi:[1,0]
v_pk_add_f32 v[98:99], v[98:99], 1.0 op_sel_hi:[1,0]
v_rcp_f32 v96, v96
v_rcp_f32 v97, v97
v_rcp_f32 v98, v98
v_rcp_f32 v99, v99
v_pk_mul_f32 v[16:17], v[16:17], v[48:49]
v_pk_mul_f32 v[18:19], v[18:19], v[50:51]
v_pk_fma_f32 v[16:17], v[16:17], v[96:97], v[132:133]
v_pk_fma_f32 v[18:19], v[18:19], v[98:99], v[134:135]
v_cvt_pk_bf16_f32 v28, v16, v17
v_cvt_pk_bf16_f32 v29, v18, v19
buffer_store_dwordx2 v[28:29], v233, s[24:27], 0 offen offset:128
s_branch K_end
spin_2_v1:
s_mov_b32 s65, 0
spin_2_l_v1:
s_sleep 2
global_load_dword v246, v245, s[62:63] sc1
s_add_u32 s65, s65, 1
s_waitcnt vmcnt(0)
v_cmp_gt_u32 vcc, 32, v246
s_cmp_gt_u32 s65, 100000
s_cbranch_scc1 ok_1_v1
s_cbranch_vccnz spin_2_l_v1
s_branch ok_1_v1
spin_4_v1:
s_mov_b32 s65, 0
spin_4_l_v1:
s_sleep 2
buffer_load_dword v246, v247, s[28:31], s67 offen offset:0 sc1
s_add_u32 s65, s65, 1
s_waitcnt vmcnt(0)
v_cmp_gt_u32 vcc, 1, v246
s_cmp_gt_u32 s65, 100000
s_cbranch_scc1 ok_3_v1
s_cbranch_vccnz spin_4_l_v1
s_branch ok_3_v1
spin_6_v1:
s_mov_b32 s65, 0
spin_6_l_v1:
s_sleep 2
buffer_load_dword v246, v247, s[28:31], s67 offen offset:1024 sc1
s_add_u32 s65, s65, 1
s_waitcnt vmcnt(0)
v_cmp_gt_u32 vcc, 1, v246
s_cmp_gt_u32 s65, 100000
s_cbranch_scc1 ok_5_v1
s_cbranch_vccnz spin_6_l_v1
s_branch ok_5_v1
spin_8_v1:
s_mov_b32 s65, 0
spin_8_l_v1:
s_sleep 2
buffer_load_dword v246, v241, s[28:31], 0 offen sc1
s_add_u32 s65, s65, 1
s_waitcnt vmcnt(0)
v_cmp_gt_u32 vcc, 1, v246
s_cmp_gt_u32 s65, 100000
s_cbranch_scc1 ok_7_v1
s_cbranch_vccnz spin_8_l_v1
s_branch ok_7_v1
spin_10_v1:
s_mov_b32 s65, 0
spin_10_l_v1:
s_sleep 2
buffer_load_dword v246, v241, s[28:31], s68 offen sc1
s_add_u32 s65, s65, 1
s_waitcnt vmcnt(0)
v_cmp_gt_u32 vcc, 1, v246
s_cmp_gt_u32 s65, 100000
s_cbranch_scc1 ok_9_v1
s_cbranch_vccnz spin_10_l_v1
s_branch ok_9_v1
spin_12_v1:
TCH_12_v1:
s_cbranch_execz TCH_back
s_mov_b32 s65, 0
spin_12_l_v1:
s_sleep 2
buffer_load_dword v246, v234, s[28:31], 0 offen sc1
s_add_u32 s65, s65, 1
s_waitcnt vmcnt(0)
v_cmp_gt_u32 vcc, 1, v246
s_cmp_gt_u32 s65, 100000
s_cbranch_scc1 ok_11_v1
s_cbranch_vccnz spin_12_l_v1
s_branch ok_11_v1
spin_14_v1:
s_mov_b32 s65, 0
spin_14_l_v1:
s_sleep 2
buffer_load_dword v246, v241, s[28:31], s7 offen sc1
s_add_u32 s65, s65, 1
s_waitcnt vmcnt(0)
v_cmp_gt_u32 vcc, 1, v246
s_cmp_gt_u32 s65, 100000
s_cbranch_scc1 ok_13_v1
s_cbranch_vccnz spin_14_l_v1
s_branch ok_13_v1
spin_16_v1:
s_mov_b32 s65, 0
spin_16_l_v1:
s_sleep 2
buffer_load_dword v246, v241, s[28:31], s83 offen sc1
s_add_u32 s65, s65, 1
s_waitcnt vmcnt(0)
v_cmp_gt_u32 vcc, 1, v246
s_cmp_gt_u32 s65, 100000
s_cbranch_scc1 ok_15_v1
s_cbranch_vccnz spin_16_l_v1
s_branch ok_15_v1
spin_18_v1:
s_mov_b32 s65, 0
spin_18_l_v1:
s_sleep 2
buffer_load_dword v246, v228, s[28:31], 0 offen sc1
s_add_u32 s65, s65, 1
s_waitcnt vmcnt(0)
v_cmp_gt_u32 vcc, 1, v246
s_cmp_gt_u32 s65, 100000
s_cbranch_scc1 ok_17_v1
s_cbranch_vccnz spin_18_l_v1
s_branch ok_17_v1
K_end:
    s_endpgm
.section .rodata,"a"
.p2align 6
.amdhsa_kernel recurrent_scan__sliding_local_dilated__glu_gated_glu__prompt_kernel
  .amdhsa_next_free_vgpr 512
  .amdhsa_next_free_sgpr 102
  .amdhsa_accum_offset 256
  .amdhsa_group_segment_fixed_size 0
  .amdhsa_kernarg_size 80
  .amdhsa_user_sgpr_count 2
  .amdhsa_user_sgpr_kernarg_segment_ptr 1
  .amdhsa_system_sgpr_workgroup_id_x 1
.end_amdhsa_kernel
```
